```python
import torch

def _softmax(x, axis=-1):
    return torch.softmax(x, dim=axis)
def _gelu(x):
    return torch.nn.functional.gelu(x, approximate="tanh")
def _silu(x):
    return torch.nn.functional.silu(x)
def _sigmoid(x):
    return torch.sigmoid(x)
def _layernorm(x, axis=-1, eps=1e-5):
    m = x.mean(dim=axis, keepdim=True)
    v = x.var(dim=axis, keepdim=True, unbiased=False)
    return (x - m) / torch.sqrt(v + eps)
def _scatter_add(tgt, idx, src, axis=0):
    return tgt.clone().index_add_(axis, idx, src)
def _segment_sum(src, seg, n):
    out = torch.zeros((n,) + src.shape[1:], dtype=src.dtype)
    return out.index_add_(0, seg, src)
def _pad(x, pw):
    flat = tuple(v for pair in reversed(pw) for v in pair)
    return torch.nn.functional.pad(x, flat)

kernel_name = 'standalone__paged_block_table_kv_pagedattention__sampling'

def setup_inputs():

    _w = (lambda a: (lambda t: t.to(torch.bfloat16) if t.is_floating_point() else t)(torch.as_tensor(a)))
    B, Hq, Hkv, Sq, Skv, D = 32, 32, 8, 16, 2048, 128
    bs = 16
    nbps = max(1, Skv // bs)
    num_phys = B * nbps + 4
    bt = torch.randperm(num_phys)[: B * nbps].reshape(B, nbps).to(torch.int64)
    cl = (nbps * bs - (torch.arange(1, B + 1, dtype=torch.int64) * 2654435761) % max(1, nbps * bs // 2)).to(torch.int64)
    return {
        "q": _w((lambda *s: torch.randn(*s, dtype=torch.bfloat16) * 0.8)(B, Hq, Sq, D)),
        "k_cache": _w((lambda *s: torch.randn(*s, dtype=torch.bfloat16) * 0.8)(num_phys, bs, Hkv, D)),
        "v_cache": _w((lambda *s: torch.randn(*s, dtype=torch.bfloat16) * 0.05)(num_phys, bs, Hkv, D)),
        "block_table": _w(bt),
        "context_lens": _w(cl),
    }

def reference(q, k_cache, v_cache, block_table, context_lens):
    B, Hq, Sq, D = q.shape
    bs = k_cache.shape[1]
    Hkv = k_cache.shape[2]
    nbps = block_table.shape[1]
    Skv = nbps * bs
    bt = block_table.reshape(-1)
    k = (lambda x, *d: x.permute(*d))(k_cache[bt].reshape(B, Skv, Hkv, D), 0, 2, 1, 3)
    v = (lambda x, *d: x.permute(*d))(v_cache[bt].reshape(B, Skv, Hkv, D), 0, 2, 1, 3)
    g = Hq // Hkv
    qg = q.reshape(B, Hkv, g, Sq, D)
    scores = torch.einsum("bhgqd,bhkd->bhgqk", qg, k) * (D ** -0.5)
    pos = torch.arange(Skv)
    msk = pos[None, :] < context_lens[:, None]
    scores = torch.where(msk[:, None, None, None, :], scores, -1e9)
    p = _softmax(scores, axis=-1)
    out = torch.einsum("bhgqk,bhkd->bhgqd", p, v)
    return out.reshape(B, Hq, Sq, D)
```

```asm
; @launch grid=(256,1,1) block=(256,1,1) lds=136192
.amdgcn_target "amdgcn-amd-amdhsa--gfx950"
.text
.globl standalone__paged_block_table_kv_pagedattention__sampling_kernel
.p2align 8
.type standalone__paged_block_table_kv_pagedattention__sampling_kernel,@function
standalone__paged_block_table_kv_pagedattention__sampling_kernel:
    s_cmp_ge_u32 s2, 256
    s_cbranch_scc1 L_end
    s_load_dwordx16 s[16:31], s[0:1], 0
    v_lshrrev_b32 v2, 6, v0
    v_and_b32 v1, 63, v0
    v_readfirstlane_b32 s66, v2
    s_lshr_b32 s3, s2, 3
    s_lshl1_add_u32 s82, s3, s2
    s_and_b32 s82, s82, 7
    s_lshl3_add_u32 s85, s3, s82
    s_lshl_b32 s85, s85, 14
    v_lshrrev_b32 v46, 4, v1
    v_and_b32 v47, 15, v1
    s_cmp_lg_u32 s66, 0
    s_cbranch_scc1 L_consumer
    v_lshlrev_b32 v6, 3, v1
    s_lshl_b32 s80, s3, 9
    s_lshl_b32 s81, s3, 2
    s_movk_i32 s78, 0x4000
    s_mov_b32 s79, 0x20000
    s_mov_b32 s14, 4194304
    s_mov_b32 s15, 0x20000
    s_mov_b32 s6, 134348800
    s_mov_b32 s7, 0x20000
    v_xor_b32 v52, v47, v46
    v_lshlrev_b32 v48, 4, v52
    v_lshl_add_u32 v16, v46, 8, v48
    v_xor_b32 v53, 4, v52
    v_lshlrev_b32 v49, 4, v53
    v_lshl_add_u32 v17, v46, 8, v49
    v_xor_b32 v53, 8, v52
    v_lshlrev_b32 v50, 4, v53
    v_lshl_add_u32 v18, v46, 8, v50
    v_xor_b32 v53, 12, v52
    v_lshlrev_b32 v51, 4, v53
    v_lshl_add_u32 v19, v46, 8, v51
    s_waitcnt lgkmcnt(0)
    s_mov_b32 s76, s22
    s_mov_b32 s77, s23
    s_load_dword s64, s[24:25], s81
    buffer_load_dwordx2 v[20:21], v6, s[76:79], s80 offen
    s_mov_b32 s12, s16
    s_mov_b32 s13, s17
    s_mov_b32 m0, 98304
    s_add_u32 s83, s85, 0
    buffer_load_dwordx4 v16, s[12:15], s83 offen offset:0 nt lds
    buffer_load_dwordx4 v17, s[12:15], s83 offen offset:1024 nt lds
    buffer_load_dwordx4 v18, s[12:15], s83 offen offset:2048 nt lds
    buffer_load_dwordx4 v19, s[12:15], s83 offen offset:3072 nt lds
    s_mov_b32 m0, 102400
    s_add_u32 s83, s85, 4096
    buffer_load_dwordx4 v16, s[12:15], s83 offen offset:0 nt lds
    buffer_load_dwordx4 v17, s[12:15], s83 offen offset:1024 nt lds
    buffer_load_dwordx4 v18, s[12:15], s83 offen offset:2048 nt lds
    buffer_load_dwordx4 v19, s[12:15], s83 offen offset:3072 nt lds
    s_mov_b32 m0, 106496
    s_add_u32 s83, s85, 8192
    buffer_load_dwordx4 v16, s[12:15], s83 offen offset:0 nt lds
    buffer_load_dwordx4 v17, s[12:15], s83 offen offset:1024 nt lds
    buffer_load_dwordx4 v18, s[12:15], s83 offen offset:2048 nt lds
    buffer_load_dwordx4 v19, s[12:15], s83 offen offset:3072 nt lds
    s_mov_b32 m0, 110592
    s_add_u32 s83, s85, 12288
    buffer_load_dwordx4 v16, s[12:15], s83 offen offset:0 nt lds
    buffer_load_dwordx4 v17, s[12:15], s83 offen offset:1024 nt lds
    buffer_load_dwordx4 v18, s[12:15], s83 offen offset:2048 nt lds
    buffer_load_dwordx4 v19, s[12:15], s83 offen offset:3072 nt lds
    s_mov_b32 s4, s18
    s_mov_b32 s5, s19
    s_lshl_b32 s84, s82, 8
    v_lshlrev_b32 v54, 11, v46
    v_add_u32 v54, s84, v54
    v_add_u32 v8, v54, v48
    v_add_u32 v53, 7168, v54
    v_add_u32 v9, v53, v49
    v_add_u32 v53, 14336, v54
    v_add_u32 v10, v53, v50
    v_add_u32 v53, 21504, v54
    v_add_u32 v11, v53, v51
    v_lshlrev_b32 v5, 1, v1
    v_add_u32 v7, 1, v5
    v_mov_b32 v61, 134348800
    s_mov_b32 s53, 0
    s_waitcnt lgkmcnt(0)
    s_max_i32 s64, s64, 0
    s_min_i32 s64, s64, 2048
    s_cmp_eq_u32 s64, 0
    s_cselect_b32 s65, 2048, s64
    s_add_u32 s77, s65, 31
    s_lshr_b32 s77, s77, 5
    s_sub_u32 s67, s77, s53
    s_sub_u32 s83, s67, 1
    s_mul_i32 s84, s83, 171
    s_lshr_b32 s84, s84, 9
    s_mul_i32 s84, s84, 3
    s_sub_u32 s83, s83, s84
    s_sub_u32 s58, 5, s83
    s_cmp_ge_u32 s58, 3
    s_cselect_b32 s84, 3, 0
    s_sub_u32 s58, s58, s84
    s_add_u32 s68, s65, 15
    s_lshr_b32 s68, s68, 4
    v_cmp_gt_u32 vcc, s68, v5
    v_cmp_gt_u32 s[32:33], s68, v7
    s_waitcnt vmcnt(16)
    v_lshlrev_b32 v20, 15, v20
    v_lshlrev_b32 v21, 15, v21
    v_cndmask_b32 v20, v61, v20, vcc
    v_cndmask_b32 v21, v61, v21, s[32:33]
    s_lshl_b32 s74, s58, 15
    s_mov_b32 s36, s53
    s_mov_b32 s87, s58
    s_mov_b32 s70, 0
    s_min_u32 s68, s67, 4
    s_add_u32 s83, s68, 2
    v_mov_b32 v23, s83
    s_add_u32 s68, s68, s53
L_burst0:
    v_readlane_b32 s80, v20, s36
    v_readlane_b32 s81, v21, s36
    s_nop 2
    s_add_u32 m0, s74, 0
    s_nop 0
    buffer_load_dwordx4 v8, s[4:7], s80 offen offset:0 nt lds
    buffer_load_dwordx4 v9, s[4:7], s80 offen offset:1024 nt lds
    buffer_load_dwordx4 v10, s[4:7], s80 offen offset:2048 nt lds
    buffer_load_dwordx4 v11, s[4:7], s80 offen offset:3072 nt lds
    s_add_u32 m0, s74, 4096
    s_nop 0
    buffer_load_dwordx4 v8, s[4:7], s81 offen offset:0 nt lds
    buffer_load_dwordx4 v9, s[4:7], s81 offen offset:1024 nt lds
    buffer_load_dwordx4 v10, s[4:7], s81 offen offset:2048 nt lds
    buffer_load_dwordx4 v11, s[4:7], s81 offen offset:3072 nt lds
    s_add_u32 s36, s36, 1
    s_add_u32 s87, s87, 1
    s_add_u32 s74, s74, 32768
    s_add_u32 s83, s70, 2
    s_lshl_b32 s84, s83, 13
    s_and_b32 s84, s84, 16384
    s_cmp_eq_u32 s87, 3
    s_cselect_b32 s87, 0, s87
    s_cselect_b32 s70, s83, s70
    s_cselect_b32 s74, s84, s74
    s_cmp_lt_u32 s36, s68
    s_cbranch_scc1 L_burst0
    s_mov_b32 s75, s53
    s_mov_b32 s38, s58
    s_mov_b32 s39, 0
    s_lshl_b32 s37, s58, 15
    s_add_u32 s37, s37, 8192
    s_and_b32 s81, s3, 30
    s_lshl_b32 s81, s81, 2
    s_load_dwordx2 s[40:41], s[24:25], s81
    v_lshlrev_b32 v22, 2, v1
    v_add_u32 v22, 114688, v22
    v_mov_b32 v53, 0
    ds_write_b32 v22, v53 offset:0
    ds_write_b32 v22, v53 offset:256
    ds_write_b32 v22, v53 offset:512
    ds_write_b32 v22, v53 offset:768
    ds_write_b32 v22, v53 offset:1024
    ds_write_b32 v22, v53 offset:1280
    ds_write_b32 v22, v53 offset:1536
    ds_write_b32 v22, v53 offset:1792
    s_mov_b32 s8, s20
    s_mov_b32 s9, s21
    s_mov_b32 s10, 134348800
    s_mov_b32 s11, 0x20000
    v_lshlrev_b32 v53, 2, v46
    v_xor_b32 v53, v47, v53
    v_lshl_add_u32 v12, v53, 4, v54
    v_add_u32 v13, 7168, v12
    v_add_u32 v14, 14336, v12
    v_add_u32 v15, 21504, v12
    v_min_u32 v24, 3, v1
    v_lshlrev_b32 v24, 8, v24
    v_add_u32 v59, 115712, v24
    v_add_u32 v24, 114944, v24
    v_mov_b32 v25, 0
    v_mov_b32 v62, 0
    s_waitcnt lgkmcnt(0)
    s_barrier
    s_max_i32 s40, s40, 0
    s_min_i32 s40, s40, 2048
    s_max_i32 s41, s41, 0
    s_min_i32 s41, s41, 2048
    s_bitcmp1_b32 s3, 0
    s_cselect_b32 s54, s41, s40
    s_cselect_b32 s83, s40, s41
    s_cmp_eq_u32 s54, 0
    s_cselect_b32 s60, 2048, s54
    s_bfe_u32 s82, s85, 0x2000e
    s_cmp_eq_u32 s82, 1
    s_cselect_b32 s63, s54, s83
    s_cselect_b32 s83, s83, s54
    s_cselect_b32 s52, 2, 1
    s_cselect_b32 s84, 1700, -1
    s_bitcmp1_b32 s82, 0
    s_cselect_b32 s52, s52, 0
    s_cmp_lt_u32 s63, 1800
    s_cselect_b32 s52, 0, s52
    s_sub_u32 s83, s83, 1
    s_cmp_ge_u32 s83, 1700
    s_cselect_b32 s52, 0, s52
    s_cmp_ge_u32 s60, s84
    s_cselect_b32 s60, 4096, s60
    s_mov_b32 s61, 98304
    s_xor_b32 s84, s3, 1
    s_cmp_eq_u32 s52, 2
    s_cselect_b32 s84, s3, s84
    s_lshl1_add_u32 s57, s84, s2
    s_and_b32 s57, s57, 7
    s_lshr_b32 s56, s57, 2
    s_lshl1_add_u32 s56, s84, s56
    s_bfe_u32 s55, s85, 0x3000e
    s_sub_u32 s55, s57, s55
    s_lshl_b32 s55, s55, 8
    s_lshl3_add_u32 s57, s84, s57
    s_lshl_b32 s57, s57, 14
    s_add_u32 s84, s63, -1665
    s_lshr_b32 s84, s84, 5
    s_and_b32 s84, s84, 63
    s_mul_i32 s46, s84, 171
    s_lshr_b32 s46, s46, 9
    s_mul_i32 s46, s46, 3
    s_sub_u32 s46, s84, s46
    s_add_u32 s46, s46, 53
    s_lshl_b32 s84, s46, 5
    s_sub_u32 s84, s63, s84
    s_add_u32 s84, s84, s60
    s_mul_i32 s84, s84, 312
    s_lshr_b32 s84, s84, 8
    s_cmp_eq_u32 s52, 1
    s_cselect_b32 s60, s84, s60
    s_cselect_b32 s64, s63, s54
    s_cselect_b32 s53, s46, 0
    s_cselect_b32 s61, 119808, s61
    s_cmp_eq_u32 s52, 2
    s_cselect_b32 s77, s46, s77
    s_sub_u32 s67, s77, s53
    v_lshrrev_b32 v48, 2, v47
    v_and_b32 v49, 3, v47
    v_lshl_add_u32 v48, v48, 3, v49
    v_lshlrev_b32 v48, 10, v48
    v_mov_b32 v51, v52
    v_lshl_add_u32 v52, v51, 4, v48
    v_xor_b32 v50, 4, v51
    v_lshl_add_u32 v53, v50, 4, v48
    v_xor_b32 v50, 8, v51
    v_lshl_add_u32 v54, v50, 4, v48
    v_xor_b32 v50, 12, v51
    v_lshl_add_u32 v55, v50, 4, v48
    v_lshlrev_b32 v58, 3, v1
    v_add_u32 v58, 116736, v58
    v_lshlrev_b32 v57, 4, v46
    v_add_u32 v57, 118784, v57
    v_lshlrev_b32 v60, 4, v1
    s_mov_b32 s76, 0
    s_mov_b32 s78, s85
    s_add_u32 s79, s85, 8192
    s_cmp_eq_u32 s52, 1
    s_cbranch_scc1 L_lhelp
    s_mov_b32 s12, s26
    s_mov_b32 s13, s27
L_lgo:
    s_cmp_lt_u32 s67, 4
    s_cbranch_scc1 L_lgo2
    v_mov_b32 v27, 2
    s_waitcnt vmcnt(32)
    ds_write_b32 v22, v27
L_lgo2:
    s_min_u32 s68, s67, 5
    s_add_u32 s68, s68, s53
    s_cmp_ge_u32 s60, 4096
    s_cbranch_scc1 L_var_160
    s_cmp_ge_u32 s60, 2362
    s_cbranch_scc1 L_var_136
    s_cmp_ge_u32 s60, 2332
    s_cbranch_scc1 L_var_134
    s_cmp_ge_u32 s60, 2301
    s_cbranch_scc1 L_var_132
    s_cmp_ge_u32 s60, 2271
    s_cbranch_scc1 L_var_130
    s_cmp_ge_u32 s60, 2240
    s_cbranch_scc1 L_var_128
    s_cmp_ge_u32 s60, 2210
    s_cbranch_scc1 L_var_126
    s_cmp_ge_u32 s60, 2180
    s_cbranch_scc1 L_var_124
    s_cmp_ge_u32 s60, 2149
    s_cbranch_scc1 L_var_122
    s_cmp_ge_u32 s60, 2119
    s_cbranch_scc1 L_var_120
    s_cmp_ge_u32 s60, 2088
    s_cbranch_scc1 L_var_118
    s_cmp_ge_u32 s60, 2058
    s_cbranch_scc1 L_var_116
    s_cmp_ge_u32 s60, 2027
    s_cbranch_scc1 L_var_114
    s_cmp_ge_u32 s60, 1997
    s_cbranch_scc1 L_var_112
    s_cmp_ge_u32 s60, 1966
    s_cbranch_scc1 L_var_110
    s_cmp_ge_u32 s60, 1936
    s_cbranch_scc1 L_var_108
    s_cmp_ge_u32 s60, 1905
    s_cbranch_scc1 L_var_106
    s_cmp_ge_u32 s60, 1875
    s_cbranch_scc1 L_var_104
    s_cmp_ge_u32 s60, 1844
    s_cbranch_scc1 L_var_102
    s_cmp_ge_u32 s60, 1814
    s_cbranch_scc1 L_var_100
    s_cmp_ge_u32 s60, 1783
    s_cbranch_scc1 L_var_98
    s_cmp_ge_u32 s60, 1753
    s_cbranch_scc1 L_var_96
    s_cmp_ge_u32 s60, 1722
    s_cbranch_scc1 L_var_94
    s_cmp_ge_u32 s60, 1692
    s_cbranch_scc1 L_var_92
    s_cmp_ge_u32 s60, 1661
    s_cbranch_scc1 L_var_90
    s_cmp_ge_u32 s60, 1631
    s_cbranch_scc1 L_var_88
    s_cmp_ge_u32 s60, 1601
    s_cbranch_scc1 L_var_86
    s_cmp_ge_u32 s60, 1570
    s_cbranch_scc1 L_var_84
    s_cmp_ge_u32 s60, 1540
    s_cbranch_scc1 L_var_82
    s_cmp_ge_u32 s60, 1507
    s_cbranch_scc1 L_var_80
    s_cmp_ge_u32 s60, 1473
    s_cbranch_scc1 L_var_78
    s_cmp_ge_u32 s60, 1448
    s_cbranch_scc1 L_var_76
    s_cmp_ge_u32 s60, 1432
    s_cbranch_scc1 L_var_75
    s_cmp_ge_u32 s60, 1415
    s_cbranch_scc1 L_var_74
    s_cmp_ge_u32 s60, 1399
    s_cbranch_scc1 L_var_73
    s_cmp_ge_u32 s60, 1382
    s_cbranch_scc1 L_var_72
    s_cmp_ge_u32 s60, 1365
    s_cbranch_scc1 L_var_71
    s_cmp_ge_u32 s60, 1349
    s_cbranch_scc1 L_var_70
    s_cmp_ge_u32 s60, 1332
    s_cbranch_scc1 L_var_69
    s_cmp_ge_u32 s60, 1315
    s_cbranch_scc1 L_var_68
    s_cmp_ge_u32 s60, 1299
    s_cbranch_scc1 L_var_67
    s_cmp_ge_u32 s60, 1282
    s_cbranch_scc1 L_var_66
    s_cmp_ge_u32 s60, 1266
    s_cbranch_scc1 L_var_65
    s_cmp_ge_u32 s60, 1249
    s_cbranch_scc1 L_var_64
    s_cmp_ge_u32 s60, 1232
    s_cbranch_scc1 L_var_63
    s_cmp_ge_u32 s60, 1216
    s_cbranch_scc1 L_var_62
    s_cmp_ge_u32 s60, 1199
    s_cbranch_scc1 L_var_61
    s_cmp_ge_u32 s60, 1182
    s_cbranch_scc1 L_var_60
    s_cmp_ge_u32 s60, 1166
    s_cbranch_scc1 L_var_59
    s_cmp_ge_u32 s60, 1149
    s_cbranch_scc1 L_var_58
    s_cmp_ge_u32 s60, 1133
    s_cbranch_scc1 L_var_57
    s_cmp_ge_u32 s60, 1116
    s_cbranch_scc1 L_var_56
    s_cmp_ge_u32 s60, 1099
    s_cbranch_scc1 L_var_55
    s_cmp_ge_u32 s60, 1083
    s_cbranch_scc1 L_var_54
    s_cmp_ge_u32 s60, 1066
    s_cbranch_scc1 L_var_53
    s_cmp_ge_u32 s60, 1049
    s_cbranch_scc1 L_var_52
    s_cmp_ge_u32 s60, 1033
    s_cbranch_scc1 L_var_51
L_var_50:
    s_cmp_ge_u32 s36, s68
    s_cbranch_scc1 L_lp_50
L_pk_50:
    v_readlane_b32 s80, v20, s36
    v_readlane_b32 s81, v21, s36
    s_nop 2
    s_add_u32 m0, s74, 0
    s_waitcnt vmcnt(12)
    buffer_load_dwordx4 v8, s[4:7], s80 offen offset:0 nt lds
    s_waitcnt vmcnt(12)
    buffer_load_dwordx4 v9, s[4:7], s80 offen offset:1024 nt lds
    s_waitcnt vmcnt(12)
    buffer_load_dwordx4 v10, s[4:7], s80 offen offset:2048 nt lds
    s_waitcnt vmcnt(12)
    buffer_load_dwordx4 v11, s[4:7], s80 offen offset:3072 nt lds
    s_add_u32 m0, s74, 4096
    s_waitcnt vmcnt(12)
    buffer_load_dwordx4 v8, s[4:7], s81 offen offset:0 nt lds
    v_subrev_u32 v27, 1, v23
    ds_write_b32 v22, v27
    s_waitcnt vmcnt(12)
    buffer_load_dwordx4 v9, s[4:7], s81 offen offset:1024 nt lds
    s_waitcnt vmcnt(12)
    buffer_load_dwordx4 v10, s[4:7], s81 offen offset:2048 nt lds
    s_waitcnt vmcnt(12)
    buffer_load_dwordx4 v11, s[4:7], s81 offen offset:3072 nt lds
    v_add_u32 v23, 1, v23
    s_add_u32 s36, s36, 1
    s_add_u32 s87, s87, 1
    s_add_u32 s74, s74, 32768
    s_add_u32 s83, s70, 2
    s_lshl_b32 s84, s83, 13
    s_and_b32 s84, s84, 16384
    s_cmp_eq_u32 s87, 3
    s_cselect_b32 s87, 0, s87
    s_cselect_b32 s70, s83, s70
    s_cselect_b32 s74, s84, s74
    s_cmp_lt_u32 s36, s68
    s_cbranch_scc1 L_pk_50
L_lp_50:
    s_cmp_ge_u32 s36, s77
    s_cbranch_scc1 L_tl_50
L_lp2_50:
    v_readlane_b32 s34, v20, s75
    v_readlane_b32 s35, v21, s75
    v_readlane_b32 s80, v20, s36
    v_readlane_b32 s81, v21, s36
L_chk_50:
    s_waitcnt lgkmcnt(0)
    v_readlane_b32 s83, v25, s87
    v_readlane_b32 s84, v25, s38
    ds_read_b32 v25, v24
    s_cmp_lt_u32 s39, 4
    s_cselect_b32 s84, s39, s84
    s_cmp_lt_u32 s84, s39
    s_cbranch_scc1 L_chk_50
    s_add_u32 s83, s83, 3
    s_cmp_lt_u32 s83, s70
    s_cbranch_scc1 L_chk_50
    s_add_u32 m0, s74, 0
    s_waitcnt vmcnt(12)
    buffer_load_dwordx4 v8, s[4:7], s80 offen offset:0 nt lds
    s_waitcnt vmcnt(12)
    buffer_load_dwordx4 v9, s[4:7], s80 offen offset:1024 nt lds
    s_waitcnt vmcnt(12)
    buffer_load_dwordx4 v10, s[4:7], s80 offen offset:2048 nt lds
    s_waitcnt vmcnt(12)
    buffer_load_dwordx4 v11, s[4:7], s80 offen offset:3072 nt lds
    s_add_u32 m0, s74, 4096
    s_waitcnt vmcnt(12)
    buffer_load_dwordx4 v8, s[4:7], s81 offen offset:0 nt lds
    v_subrev_u32 v27, 1, v23
    ds_write_b32 v22, v27
    s_waitcnt vmcnt(12)
    buffer_load_dwordx4 v9, s[4:7], s81 offen offset:1024 nt lds
    s_waitcnt vmcnt(12)
    buffer_load_dwordx4 v10, s[4:7], s81 offen offset:2048 nt lds
    s_waitcnt vmcnt(12)
    buffer_load_dwordx4 v11, s[4:7], s81 offen offset:3072 nt lds
    v_add_u32 v23, 1, v23
    s_add_u32 s36, s36, 1
    s_add_u32 s87, s87, 1
    s_add_u32 s74, s74, 32768
    s_add_u32 s83, s70, 2
    s_lshl_b32 s84, s83, 13
    s_and_b32 s84, s84, 16384
    s_cmp_eq_u32 s87, 3
    s_cselect_b32 s87, 0, s87
    s_cselect_b32 s70, s83, s70
    s_cselect_b32 s74, s84, s74
    s_add_u32 m0, s37, 0
    s_waitcnt vmcnt(11)
    buffer_load_dwordx4 v12, s[8:11], s34 offen offset:0 nt lds
    s_waitcnt vmcnt(11)
    buffer_load_dwordx4 v13, s[8:11], s34 offen offset:1024 nt lds
    s_waitcnt vmcnt(11)
    buffer_load_dwordx4 v14, s[8:11], s34 offen offset:2048 nt lds
    s_waitcnt vmcnt(11)
    buffer_load_dwordx4 v15, s[8:11], s34 offen offset:3072 nt lds
    v_subrev_u32 v27, 1, v23
    ds_write_b32 v22, v27
    s_add_u32 m0, s37, 4096
    s_waitcnt vmcnt(11)
    buffer_load_dwordx4 v12, s[8:11], s35 offen offset:0 nt lds
    s_waitcnt vmcnt(11)
    buffer_load_dwordx4 v13, s[8:11], s35 offen offset:1024 nt lds
    s_waitcnt vmcnt(11)
    buffer_load_dwordx4 v14, s[8:11], s35 offen offset:2048 nt lds
    s_waitcnt vmcnt(11)
    buffer_load_dwordx4 v15, s[8:11], s35 offen offset:3072 nt lds
    v_add_u32 v23, 1, v23
    s_add_u32 s75, s75, 1
    s_add_u32 s38, s38, 1
    s_add_u32 s37, s37, 32768
    s_add_u32 s83, s39, 2
    s_lshl_b32 s84, s83, 13
    s_and_b32 s84, s84, 16384
    s_add_u32 s84, s84, 8192
    s_cmp_eq_u32 s38, 3
    s_cselect_b32 s38, 0, s38
    s_cselect_b32 s39, s83, s39
    s_cselect_b32 s37, s84, s37
    s_cmp_lt_u32 s36, s77
    s_cbranch_scc1 L_lp2_50
L_tl_50:
    v_readlane_b32 s34, v20, s75
    v_readlane_b32 s35, v21, s75
L_chv_50:
    s_waitcnt lgkmcnt(0)
    v_readlane_b32 s84, v25, s38
    ds_read_b32 v25, v24
    s_cmp_lt_u32 s39, 4
    s_cselect_b32 s84, s39, s84
    s_cmp_lt_u32 s84, s39
    s_cbranch_scc1 L_chv_50
    s_add_u32 m0, s37, 0
    s_waitcnt vmcnt(11)
    buffer_load_dwordx4 v12, s[8:11], s34 offen offset:0 nt lds
    s_waitcnt vmcnt(11)
    buffer_load_dwordx4 v13, s[8:11], s34 offen offset:1024 nt lds
    s_waitcnt vmcnt(11)
    buffer_load_dwordx4 v14, s[8:11], s34 offen offset:2048 nt lds
    s_waitcnt vmcnt(11)
    buffer_load_dwordx4 v15, s[8:11], s34 offen offset:3072 nt lds
    v_subrev_u32 v27, 1, v23
    ds_write_b32 v22, v27
    s_add_u32 m0, s37, 4096
    s_waitcnt vmcnt(11)
    buffer_load_dwordx4 v12, s[8:11], s35 offen offset:0 nt lds
    s_waitcnt vmcnt(11)
    buffer_load_dwordx4 v13, s[8:11], s35 offen offset:1024 nt lds
    s_waitcnt vmcnt(11)
    buffer_load_dwordx4 v14, s[8:11], s35 offen offset:2048 nt lds
    s_waitcnt vmcnt(11)
    buffer_load_dwordx4 v15, s[8:11], s35 offen offset:3072 nt lds
    v_add_u32 v23, 1, v23
    s_add_u32 s75, s75, 1
    s_add_u32 s38, s38, 1
    s_add_u32 s37, s37, 32768
    s_add_u32 s83, s39, 2
    s_lshl_b32 s84, s83, 13
    s_and_b32 s84, s84, 16384
    s_add_u32 s84, s84, 8192
    s_cmp_eq_u32 s38, 3
    s_cselect_b32 s38, 0, s38
    s_cselect_b32 s39, s83, s39
    s_cselect_b32 s37, s84, s37
    s_cmp_lt_u32 s75, s77
    s_cbranch_scc1 L_tl_50
    s_waitcnt vmcnt(8)
    v_subrev_u32 v27, 1, v23
    ds_write_b32 v22, v27
    s_waitcnt vmcnt(0)
    ds_write_b32 v22, v23
    s_branch L_ldone
L_var_51:
    s_cmp_ge_u32 s36, s68
    s_cbranch_scc1 L_lp_51
L_pk_51:
    v_readlane_b32 s80, v20, s36
    v_readlane_b32 s81, v21, s36
    s_nop 2
    s_add_u32 m0, s74, 0
    s_waitcnt vmcnt(12)
    buffer_load_dwordx4 v8, s[4:7], s80 offen offset:0 nt lds
    s_waitcnt vmcnt(12)
    buffer_load_dwordx4 v9, s[4:7], s80 offen offset:1024 nt lds
    s_waitcnt vmcnt(12)
    buffer_load_dwordx4 v10, s[4:7], s80 offen offset:2048 nt lds
    s_waitcnt vmcnt(12)
    buffer_load_dwordx4 v11, s[4:7], s80 offen offset:3072 nt lds
    s_add_u32 m0, s74, 4096
    s_waitcnt vmcnt(12)
    buffer_load_dwordx4 v8, s[4:7], s81 offen offset:0 nt lds
    v_subrev_u32 v27, 1, v23
    ds_write_b32 v22, v27
    s_waitcnt vmcnt(12)
    buffer_load_dwordx4 v9, s[4:7], s81 offen offset:1024 nt lds
    s_waitcnt vmcnt(12)
    buffer_load_dwordx4 v10, s[4:7], s81 offen offset:2048 nt lds
    s_waitcnt vmcnt(12)
    buffer_load_dwordx4 v11, s[4:7], s81 offen offset:3072 nt lds
    v_add_u32 v23, 1, v23
    s_add_u32 s36, s36, 1
    s_add_u32 s87, s87, 1
    s_add_u32 s74, s74, 32768
    s_add_u32 s83, s70, 2
    s_lshl_b32 s84, s83, 13
    s_and_b32 s84, s84, 16384
    s_cmp_eq_u32 s87, 3
    s_cselect_b32 s87, 0, s87
    s_cselect_b32 s70, s83, s70
    s_cselect_b32 s74, s84, s74
    s_cmp_lt_u32 s36, s68
    s_cbranch_scc1 L_pk_51
L_lp_51:
    s_cmp_ge_u32 s36, s77
    s_cbranch_scc1 L_tl_51
L_lp2_51:
    v_readlane_b32 s34, v20, s75
    v_readlane_b32 s35, v21, s75
    v_readlane_b32 s80, v20, s36
    v_readlane_b32 s81, v21, s36
L_chk_51:
    s_waitcnt lgkmcnt(0)
    v_readlane_b32 s83, v25, s87
    v_readlane_b32 s84, v25, s38
    ds_read_b32 v25, v24
    s_cmp_lt_u32 s39, 4
    s_cselect_b32 s84, s39, s84
    s_cmp_lt_u32 s84, s39
    s_cbranch_scc1 L_chk_51
    s_add_u32 s83, s83, 3
    s_cmp_lt_u32 s83, s70
    s_cbranch_scc1 L_chk_51
    s_add_u32 m0, s74, 0
    s_waitcnt vmcnt(12)
    buffer_load_dwordx4 v8, s[4:7], s80 offen offset:0 nt lds
    s_waitcnt vmcnt(12)
    buffer_load_dwordx4 v9, s[4:7], s80 offen offset:1024 nt lds
    s_waitcnt vmcnt(12)
    buffer_load_dwordx4 v10, s[4:7], s80 offen offset:2048 nt lds
    s_waitcnt vmcnt(12)
    buffer_load_dwordx4 v11, s[4:7], s80 offen offset:3072 nt lds
    s_add_u32 m0, s74, 4096
    s_waitcnt vmcnt(12)
    buffer_load_dwordx4 v8, s[4:7], s81 offen offset:0 nt lds
    v_subrev_u32 v27, 1, v23
    ds_write_b32 v22, v27
    s_waitcnt vmcnt(12)
    buffer_load_dwordx4 v9, s[4:7], s81 offen offset:1024 nt lds
    s_waitcnt vmcnt(12)
    buffer_load_dwordx4 v10, s[4:7], s81 offen offset:2048 nt lds
    s_waitcnt vmcnt(12)
    buffer_load_dwordx4 v11, s[4:7], s81 offen offset:3072 nt lds
    v_add_u32 v23, 1, v23
    s_add_u32 s36, s36, 1
    s_add_u32 s87, s87, 1
    s_add_u32 s74, s74, 32768
    s_add_u32 s83, s70, 2
    s_lshl_b32 s84, s83, 13
    s_and_b32 s84, s84, 16384
    s_cmp_eq_u32 s87, 3
    s_cselect_b32 s87, 0, s87
    s_cselect_b32 s70, s83, s70
    s_cselect_b32 s74, s84, s74
    s_add_u32 m0, s37, 0
    s_waitcnt vmcnt(12)
    buffer_load_dwordx4 v12, s[8:11], s34 offen offset:0 nt lds
    s_waitcnt vmcnt(12)
    buffer_load_dwordx4 v13, s[8:11], s34 offen offset:1024 nt lds
    s_waitcnt vmcnt(12)
    buffer_load_dwordx4 v14, s[8:11], s34 offen offset:2048 nt lds
    s_waitcnt vmcnt(12)
    buffer_load_dwordx4 v15, s[8:11], s34 offen offset:3072 nt lds
    s_add_u32 m0, s37, 4096
    s_waitcnt vmcnt(11)
    buffer_load_dwordx4 v12, s[8:11], s35 offen offset:0 nt lds
    v_subrev_u32 v27, 1, v23
    ds_write_b32 v22, v27
    s_waitcnt vmcnt(11)
    buffer_load_dwordx4 v13, s[8:11], s35 offen offset:1024 nt lds
    s_waitcnt vmcnt(11)
    buffer_load_dwordx4 v14, s[8:11], s35 offen offset:2048 nt lds
    s_waitcnt vmcnt(11)
    buffer_load_dwordx4 v15, s[8:11], s35 offen offset:3072 nt lds
    v_add_u32 v23, 1, v23
    s_add_u32 s75, s75, 1
    s_add_u32 s38, s38, 1
    s_add_u32 s37, s37, 32768
    s_add_u32 s83, s39, 2
    s_lshl_b32 s84, s83, 13
    s_and_b32 s84, s84, 16384
    s_add_u32 s84, s84, 8192
    s_cmp_eq_u32 s38, 3
    s_cselect_b32 s38, 0, s38
    s_cselect_b32 s39, s83, s39
    s_cselect_b32 s37, s84, s37
    s_cmp_lt_u32 s36, s77
    s_cbranch_scc1 L_lp2_51
L_tl_51:
    v_readlane_b32 s34, v20, s75
    v_readlane_b32 s35, v21, s75
L_chv_51:
    s_waitcnt lgkmcnt(0)
    v_readlane_b32 s84, v25, s38
    ds_read_b32 v25, v24
    s_cmp_lt_u32 s39, 4
    s_cselect_b32 s84, s39, s84
    s_cmp_lt_u32 s84, s39
    s_cbranch_scc1 L_chv_51
    s_add_u32 m0, s37, 0
    s_waitcnt vmcnt(12)
    buffer_load_dwordx4 v12, s[8:11], s34 offen offset:0 nt lds
    s_waitcnt vmcnt(12)
    buffer_load_dwordx4 v13, s[8:11], s34 offen offset:1024 nt lds
    s_waitcnt vmcnt(12)
    buffer_load_dwordx4 v14, s[8:11], s34 offen offset:2048 nt lds
    s_waitcnt vmcnt(12)
    buffer_load_dwordx4 v15, s[8:11], s34 offen offset:3072 nt lds
    s_add_u32 m0, s37, 4096
    s_waitcnt vmcnt(12)
    buffer_load_dwordx4 v12, s[8:11], s35 offen offset:0 nt lds
    v_subrev_u32 v27, 1, v23
    ds_write_b32 v22, v27
    s_waitcnt vmcnt(12)
    buffer_load_dwordx4 v13, s[8:11], s35 offen offset:1024 nt lds
    s_waitcnt vmcnt(12)
    buffer_load_dwordx4 v14, s[8:11], s35 offen offset:2048 nt lds
    s_waitcnt vmcnt(12)
    buffer_load_dwordx4 v15, s[8:11], s35 offen offset:3072 nt lds
    v_add_u32 v23, 1, v23
    s_add_u32 s75, s75, 1
    s_add_u32 s38, s38, 1
    s_add_u32 s37, s37, 32768
    s_add_u32 s83, s39, 2
    s_lshl_b32 s84, s83, 13
    s_and_b32 s84, s84, 16384
    s_add_u32 s84, s84, 8192
    s_cmp_eq_u32 s38, 3
    s_cselect_b32 s38, 0, s38
    s_cselect_b32 s39, s83, s39
    s_cselect_b32 s37, s84, s37
    s_cmp_lt_u32 s75, s77
    s_cbranch_scc1 L_tl_51
    s_waitcnt vmcnt(8)
    v_subrev_u32 v27, 1, v23
    ds_write_b32 v22, v27
    s_waitcnt vmcnt(0)
    ds_write_b32 v22, v23
    s_branch L_ldone
L_var_52:
    s_cmp_ge_u32 s36, s68
    s_cbranch_scc1 L_lp_52
L_pk_52:
    v_readlane_b32 s80, v20, s36
    v_readlane_b32 s81, v21, s36
    s_nop 2
    s_add_u32 m0, s74, 0
    s_waitcnt vmcnt(12)
    buffer_load_dwordx4 v8, s[4:7], s80 offen offset:0 nt lds
    s_waitcnt vmcnt(12)
    buffer_load_dwordx4 v9, s[4:7], s80 offen offset:1024 nt lds
    s_waitcnt vmcnt(12)
    buffer_load_dwordx4 v10, s[4:7], s80 offen offset:2048 nt lds
    s_waitcnt vmcnt(12)
    buffer_load_dwordx4 v11, s[4:7], s80 offen offset:3072 nt lds
    s_add_u32 m0, s74, 4096
    s_waitcnt vmcnt(12)
    buffer_load_dwordx4 v8, s[4:7], s81 offen offset:0 nt lds
    v_subrev_u32 v27, 1, v23
    ds_write_b32 v22, v27
    s_waitcnt vmcnt(12)
    buffer_load_dwordx4 v9, s[4:7], s81 offen offset:1024 nt lds
    s_waitcnt vmcnt(12)
    buffer_load_dwordx4 v10, s[4:7], s81 offen offset:2048 nt lds
    s_waitcnt vmcnt(12)
    buffer_load_dwordx4 v11, s[4:7], s81 offen offset:3072 nt lds
    v_add_u32 v23, 1, v23
    s_add_u32 s36, s36, 1
    s_add_u32 s87, s87, 1
    s_add_u32 s74, s74, 32768
    s_add_u32 s83, s70, 2
    s_lshl_b32 s84, s83, 13
    s_and_b32 s84, s84, 16384
    s_cmp_eq_u32 s87, 3
    s_cselect_b32 s87, 0, s87
    s_cselect_b32 s70, s83, s70
    s_cselect_b32 s74, s84, s74
    s_cmp_lt_u32 s36, s68
    s_cbranch_scc1 L_pk_52
L_lp_52:
    s_cmp_ge_u32 s36, s77
    s_cbranch_scc1 L_tl_52
L_lp2_52:
    v_readlane_b32 s34, v20, s75
    v_readlane_b32 s35, v21, s75
    v_readlane_b32 s80, v20, s36
    v_readlane_b32 s81, v21, s36
L_chk_52:
    s_waitcnt lgkmcnt(0)
    v_readlane_b32 s83, v25, s87
    v_readlane_b32 s84, v25, s38
    ds_read_b32 v25, v24
    s_cmp_lt_u32 s39, 4
    s_cselect_b32 s84, s39, s84
    s_cmp_lt_u32 s84, s39
    s_cbranch_scc1 L_chk_52
    s_add_u32 s83, s83, 3
    s_cmp_lt_u32 s83, s70
    s_cbranch_scc1 L_chk_52
    s_add_u32 m0, s74, 0
    s_waitcnt vmcnt(12)
    buffer_load_dwordx4 v8, s[4:7], s80 offen offset:0 nt lds
    s_waitcnt vmcnt(12)
    buffer_load_dwordx4 v9, s[4:7], s80 offen offset:1024 nt lds
    s_waitcnt vmcnt(12)
    buffer_load_dwordx4 v10, s[4:7], s80 offen offset:2048 nt lds
    s_waitcnt vmcnt(12)
    buffer_load_dwordx4 v11, s[4:7], s80 offen offset:3072 nt lds
    s_add_u32 m0, s74, 4096
    s_waitcnt vmcnt(12)
    buffer_load_dwordx4 v8, s[4:7], s81 offen offset:0 nt lds
    v_subrev_u32 v27, 1, v23
    ds_write_b32 v22, v27
    s_waitcnt vmcnt(12)
    buffer_load_dwordx4 v9, s[4:7], s81 offen offset:1024 nt lds
    s_waitcnt vmcnt(12)
    buffer_load_dwordx4 v10, s[4:7], s81 offen offset:2048 nt lds
    s_waitcnt vmcnt(12)
    buffer_load_dwordx4 v11, s[4:7], s81 offen offset:3072 nt lds
    v_add_u32 v23, 1, v23
    s_add_u32 s36, s36, 1
    s_add_u32 s87, s87, 1
    s_add_u32 s74, s74, 32768
    s_add_u32 s83, s70, 2
    s_lshl_b32 s84, s83, 13
    s_and_b32 s84, s84, 16384
    s_cmp_eq_u32 s87, 3
    s_cselect_b32 s87, 0, s87
    s_cselect_b32 s70, s83, s70
    s_cselect_b32 s74, s84, s74
    s_add_u32 m0, s37, 0
    s_waitcnt vmcnt(12)
    buffer_load_dwordx4 v12, s[8:11], s34 offen offset:0 nt lds
    s_waitcnt vmcnt(12)
    buffer_load_dwordx4 v13, s[8:11], s34 offen offset:1024 nt lds
    s_waitcnt vmcnt(12)
    buffer_load_dwordx4 v14, s[8:11], s34 offen offset:2048 nt lds
    s_waitcnt vmcnt(12)
    buffer_load_dwordx4 v15, s[8:11], s34 offen offset:3072 nt lds
    s_add_u32 m0, s37, 4096
    s_waitcnt vmcnt(12)
    buffer_load_dwordx4 v12, s[8:11], s35 offen offset:0 nt lds
    v_subrev_u32 v27, 1, v23
    ds_write_b32 v22, v27
    s_waitcnt vmcnt(12)
    buffer_load_dwordx4 v13, s[8:11], s35 offen offset:1024 nt lds
    s_waitcnt vmcnt(12)
    buffer_load_dwordx4 v14, s[8:11], s35 offen offset:2048 nt lds
    s_waitcnt vmcnt(12)
    buffer_load_dwordx4 v15, s[8:11], s35 offen offset:3072 nt lds
    v_add_u32 v23, 1, v23
    s_add_u32 s75, s75, 1
    s_add_u32 s38, s38, 1
    s_add_u32 s37, s37, 32768
    s_add_u32 s83, s39, 2
    s_lshl_b32 s84, s83, 13
    s_and_b32 s84, s84, 16384
    s_add_u32 s84, s84, 8192
    s_cmp_eq_u32 s38, 3
    s_cselect_b32 s38, 0, s38
    s_cselect_b32 s39, s83, s39
    s_cselect_b32 s37, s84, s37
    s_cmp_lt_u32 s36, s77
    s_cbranch_scc1 L_lp2_52
L_tl_52:
    v_readlane_b32 s34, v20, s75
    v_readlane_b32 s35, v21, s75
L_chv_52:
    s_waitcnt lgkmcnt(0)
    v_readlane_b32 s84, v25, s38
    ds_read_b32 v25, v24
    s_cmp_lt_u32 s39, 4
    s_cselect_b32 s84, s39, s84
    s_cmp_lt_u32 s84, s39
    s_cbranch_scc1 L_chv_52
    s_add_u32 m0, s37, 0
    s_waitcnt vmcnt(12)
    buffer_load_dwordx4 v12, s[8:11], s34 offen offset:0 nt lds
    s_waitcnt vmcnt(12)
    buffer_load_dwordx4 v13, s[8:11], s34 offen offset:1024 nt lds
    s_waitcnt vmcnt(12)
    buffer_load_dwordx4 v14, s[8:11], s34 offen offset:2048 nt lds
    s_waitcnt vmcnt(12)
    buffer_load_dwordx4 v15, s[8:11], s34 offen offset:3072 nt lds
    s_add_u32 m0, s37, 4096
    s_waitcnt vmcnt(12)
    buffer_load_dwordx4 v12, s[8:11], s35 offen offset:0 nt lds
    v_subrev_u32 v27, 1, v23
    ds_write_b32 v22, v27
    s_waitcnt vmcnt(12)
    buffer_load_dwordx4 v13, s[8:11], s35 offen offset:1024 nt lds
    s_waitcnt vmcnt(12)
    buffer_load_dwordx4 v14, s[8:11], s35 offen offset:2048 nt lds
    s_waitcnt vmcnt(12)
    buffer_load_dwordx4 v15, s[8:11], s35 offen offset:3072 nt lds
    v_add_u32 v23, 1, v23
    s_add_u32 s75, s75, 1
    s_add_u32 s38, s38, 1
    s_add_u32 s37, s37, 32768
    s_add_u32 s83, s39, 2
    s_lshl_b32 s84, s83, 13
    s_and_b32 s84, s84, 16384
    s_add_u32 s84, s84, 8192
    s_cmp_eq_u32 s38, 3
    s_cselect_b32 s38, 0, s38
    s_cselect_b32 s39, s83, s39
    s_cselect_b32 s37, s84, s37
    s_cmp_lt_u32 s75, s77
    s_cbranch_scc1 L_tl_52
    s_waitcnt vmcnt(8)
    v_subrev_u32 v27, 1, v23
    ds_write_b32 v22, v27
    s_waitcnt vmcnt(0)
    ds_write_b32 v22, v23
    s_branch L_ldone
L_var_53:
    s_cmp_ge_u32 s36, s68
    s_cbranch_scc1 L_lp_53
L_pk_53:
    v_readlane_b32 s80, v20, s36
    v_readlane_b32 s81, v21, s36
    s_nop 2
    s_add_u32 m0, s74, 0
    s_waitcnt vmcnt(13)
    buffer_load_dwordx4 v8, s[4:7], s80 offen offset:0 nt lds
    s_waitcnt vmcnt(13)
    buffer_load_dwordx4 v9, s[4:7], s80 offen offset:1024 nt lds
    s_waitcnt vmcnt(13)
    buffer_load_dwordx4 v10, s[4:7], s80 offen offset:2048 nt lds
    s_waitcnt vmcnt(13)
    buffer_load_dwordx4 v11, s[4:7], s80 offen offset:3072 nt lds
    s_add_u32 m0, s74, 4096
    s_waitcnt vmcnt(12)
    buffer_load_dwordx4 v8, s[4:7], s81 offen offset:0 nt lds
    v_subrev_u32 v27, 1, v23
    ds_write_b32 v22, v27
    s_waitcnt vmcnt(12)
    buffer_load_dwordx4 v9, s[4:7], s81 offen offset:1024 nt lds
    s_waitcnt vmcnt(12)
    buffer_load_dwordx4 v10, s[4:7], s81 offen offset:2048 nt lds
    s_waitcnt vmcnt(12)
    buffer_load_dwordx4 v11, s[4:7], s81 offen offset:3072 nt lds
    v_add_u32 v23, 1, v23
    s_add_u32 s36, s36, 1
    s_add_u32 s87, s87, 1
    s_add_u32 s74, s74, 32768
    s_add_u32 s83, s70, 2
    s_lshl_b32 s84, s83, 13
    s_and_b32 s84, s84, 16384
    s_cmp_eq_u32 s87, 3
    s_cselect_b32 s87, 0, s87
    s_cselect_b32 s70, s83, s70
    s_cselect_b32 s74, s84, s74
    s_cmp_lt_u32 s36, s68
    s_cbranch_scc1 L_pk_53
L_lp_53:
    s_cmp_ge_u32 s36, s77
    s_cbranch_scc1 L_tl_53
L_lp2_53:
    v_readlane_b32 s34, v20, s75
    v_readlane_b32 s35, v21, s75
    v_readlane_b32 s80, v20, s36
    v_readlane_b32 s81, v21, s36
L_chk_53:
    s_waitcnt lgkmcnt(0)
    v_readlane_b32 s83, v25, s87
    v_readlane_b32 s84, v25, s38
    ds_read_b32 v25, v24
    s_cmp_lt_u32 s39, 4
    s_cselect_b32 s84, s39, s84
    s_cmp_lt_u32 s84, s39
    s_cbranch_scc1 L_chk_53
    s_add_u32 s83, s83, 3
    s_cmp_lt_u32 s83, s70
    s_cbranch_scc1 L_chk_53
    s_add_u32 m0, s74, 0
    s_waitcnt vmcnt(13)
    buffer_load_dwordx4 v8, s[4:7], s80 offen offset:0 nt lds
    s_waitcnt vmcnt(13)
    buffer_load_dwordx4 v9, s[4:7], s80 offen offset:1024 nt lds
    s_waitcnt vmcnt(13)
    buffer_load_dwordx4 v10, s[4:7], s80 offen offset:2048 nt lds
    s_waitcnt vmcnt(13)
    buffer_load_dwordx4 v11, s[4:7], s80 offen offset:3072 nt lds
    s_add_u32 m0, s74, 4096
    s_waitcnt vmcnt(12)
    buffer_load_dwordx4 v8, s[4:7], s81 offen offset:0 nt lds
    v_subrev_u32 v27, 1, v23
    ds_write_b32 v22, v27
    s_waitcnt vmcnt(12)
    buffer_load_dwordx4 v9, s[4:7], s81 offen offset:1024 nt lds
    s_waitcnt vmcnt(12)
    buffer_load_dwordx4 v10, s[4:7], s81 offen offset:2048 nt lds
    s_waitcnt vmcnt(12)
    buffer_load_dwordx4 v11, s[4:7], s81 offen offset:3072 nt lds
    v_add_u32 v23, 1, v23
    s_add_u32 s36, s36, 1
    s_add_u32 s87, s87, 1
    s_add_u32 s74, s74, 32768
    s_add_u32 s83, s70, 2
    s_lshl_b32 s84, s83, 13
    s_and_b32 s84, s84, 16384
    s_cmp_eq_u32 s87, 3
    s_cselect_b32 s87, 0, s87
    s_cselect_b32 s70, s83, s70
    s_cselect_b32 s74, s84, s74
    s_add_u32 m0, s37, 0
    s_waitcnt vmcnt(12)
    buffer_load_dwordx4 v12, s[8:11], s34 offen offset:0 nt lds
    s_waitcnt vmcnt(12)
    buffer_load_dwordx4 v13, s[8:11], s34 offen offset:1024 nt lds
    s_waitcnt vmcnt(12)
    buffer_load_dwordx4 v14, s[8:11], s34 offen offset:2048 nt lds
    s_waitcnt vmcnt(12)
    buffer_load_dwordx4 v15, s[8:11], s34 offen offset:3072 nt lds
    s_add_u32 m0, s37, 4096
    s_waitcnt vmcnt(12)
    buffer_load_dwordx4 v12, s[8:11], s35 offen offset:0 nt lds
    v_subrev_u32 v27, 1, v23
    ds_write_b32 v22, v27
    s_waitcnt vmcnt(12)
    buffer_load_dwordx4 v13, s[8:11], s35 offen offset:1024 nt lds
    s_waitcnt vmcnt(12)
    buffer_load_dwordx4 v14, s[8:11], s35 offen offset:2048 nt lds
    s_waitcnt vmcnt(12)
    buffer_load_dwordx4 v15, s[8:11], s35 offen offset:3072 nt lds
    v_add_u32 v23, 1, v23
    s_add_u32 s75, s75, 1
    s_add_u32 s38, s38, 1
    s_add_u32 s37, s37, 32768
    s_add_u32 s83, s39, 2
    s_lshl_b32 s84, s83, 13
    s_and_b32 s84, s84, 16384
    s_add_u32 s84, s84, 8192
    s_cmp_eq_u32 s38, 3
    s_cselect_b32 s38, 0, s38
    s_cselect_b32 s39, s83, s39
    s_cselect_b32 s37, s84, s37
    s_cmp_lt_u32 s36, s77
    s_cbranch_scc1 L_lp2_53
L_tl_53:
    v_readlane_b32 s34, v20, s75
    v_readlane_b32 s35, v21, s75
L_chv_53:
    s_waitcnt lgkmcnt(0)
    v_readlane_b32 s84, v25, s38
    ds_read_b32 v25, v24
    s_cmp_lt_u32 s39, 4
    s_cselect_b32 s84, s39, s84
    s_cmp_lt_u32 s84, s39
    s_cbranch_scc1 L_chv_53
    s_add_u32 m0, s37, 0
    s_waitcnt vmcnt(12)
    buffer_load_dwordx4 v12, s[8:11], s34 offen offset:0 nt lds
    s_waitcnt vmcnt(12)
    buffer_load_dwordx4 v13, s[8:11], s34 offen offset:1024 nt lds
    s_waitcnt vmcnt(12)
    buffer_load_dwordx4 v14, s[8:11], s34 offen offset:2048 nt lds
    s_waitcnt vmcnt(12)
    buffer_load_dwordx4 v15, s[8:11], s34 offen offset:3072 nt lds
    s_add_u32 m0, s37, 4096
    s_waitcnt vmcnt(12)
    buffer_load_dwordx4 v12, s[8:11], s35 offen offset:0 nt lds
    v_subrev_u32 v27, 1, v23
    ds_write_b32 v22, v27
    s_waitcnt vmcnt(12)
    buffer_load_dwordx4 v13, s[8:11], s35 offen offset:1024 nt lds
    s_waitcnt vmcnt(12)
    buffer_load_dwordx4 v14, s[8:11], s35 offen offset:2048 nt lds
    s_waitcnt vmcnt(12)
    buffer_load_dwordx4 v15, s[8:11], s35 offen offset:3072 nt lds
    v_add_u32 v23, 1, v23
    s_add_u32 s75, s75, 1
    s_add_u32 s38, s38, 1
    s_add_u32 s37, s37, 32768
    s_add_u32 s83, s39, 2
    s_lshl_b32 s84, s83, 13
    s_and_b32 s84, s84, 16384
    s_add_u32 s84, s84, 8192
    s_cmp_eq_u32 s38, 3
    s_cselect_b32 s38, 0, s38
    s_cselect_b32 s39, s83, s39
    s_cselect_b32 s37, s84, s37
    s_cmp_lt_u32 s75, s77
    s_cbranch_scc1 L_tl_53
    s_waitcnt vmcnt(8)
    v_subrev_u32 v27, 1, v23
    ds_write_b32 v22, v27
    s_waitcnt vmcnt(0)
    ds_write_b32 v22, v23
    s_branch L_ldone
L_var_54:
    s_cmp_ge_u32 s36, s68
    s_cbranch_scc1 L_lp_54
L_pk_54:
    v_readlane_b32 s80, v20, s36
    v_readlane_b32 s81, v21, s36
    s_nop 2
    s_add_u32 m0, s74, 0
    s_waitcnt vmcnt(13)
    buffer_load_dwordx4 v8, s[4:7], s80 offen offset:0 nt lds
    s_waitcnt vmcnt(13)
    buffer_load_dwordx4 v9, s[4:7], s80 offen offset:1024 nt lds
    s_waitcnt vmcnt(13)
    buffer_load_dwordx4 v10, s[4:7], s80 offen offset:2048 nt lds
    s_waitcnt vmcnt(13)
    buffer_load_dwordx4 v11, s[4:7], s80 offen offset:3072 nt lds
    s_add_u32 m0, s74, 4096
    s_waitcnt vmcnt(13)
    buffer_load_dwordx4 v8, s[4:7], s81 offen offset:0 nt lds
    s_waitcnt vmcnt(13)
    buffer_load_dwordx4 v9, s[4:7], s81 offen offset:1024 nt lds
    v_subrev_u32 v27, 1, v23
    ds_write_b32 v22, v27
    s_waitcnt vmcnt(13)
    buffer_load_dwordx4 v10, s[4:7], s81 offen offset:2048 nt lds
    s_waitcnt vmcnt(13)
    buffer_load_dwordx4 v11, s[4:7], s81 offen offset:3072 nt lds
    v_add_u32 v23, 1, v23
    s_add_u32 s36, s36, 1
    s_add_u32 s87, s87, 1
    s_add_u32 s74, s74, 32768
    s_add_u32 s83, s70, 2
    s_lshl_b32 s84, s83, 13
    s_and_b32 s84, s84, 16384
    s_cmp_eq_u32 s87, 3
    s_cselect_b32 s87, 0, s87
    s_cselect_b32 s70, s83, s70
    s_cselect_b32 s74, s84, s74
    s_cmp_lt_u32 s36, s68
    s_cbranch_scc1 L_pk_54
L_lp_54:
    s_cmp_ge_u32 s36, s77
    s_cbranch_scc1 L_tl_54
L_lp2_54:
    v_readlane_b32 s34, v20, s75
    v_readlane_b32 s35, v21, s75
    v_readlane_b32 s80, v20, s36
    v_readlane_b32 s81, v21, s36
L_chk_54:
    s_waitcnt lgkmcnt(0)
    v_readlane_b32 s83, v25, s87
    v_readlane_b32 s84, v25, s38
    ds_read_b32 v25, v24
    s_cmp_lt_u32 s39, 4
    s_cselect_b32 s84, s39, s84
    s_cmp_lt_u32 s84, s39
    s_cbranch_scc1 L_chk_54
    s_add_u32 s83, s83, 3
    s_cmp_lt_u32 s83, s70
    s_cbranch_scc1 L_chk_54
    s_add_u32 m0, s74, 0
    s_waitcnt vmcnt(13)
    buffer_load_dwordx4 v8, s[4:7], s80 offen offset:0 nt lds
    s_waitcnt vmcnt(13)
    buffer_load_dwordx4 v9, s[4:7], s80 offen offset:1024 nt lds
    s_waitcnt vmcnt(13)
    buffer_load_dwordx4 v10, s[4:7], s80 offen offset:2048 nt lds
    s_waitcnt vmcnt(13)
    buffer_load_dwordx4 v11, s[4:7], s80 offen offset:3072 nt lds
    s_add_u32 m0, s74, 4096
    s_waitcnt vmcnt(13)
    buffer_load_dwordx4 v8, s[4:7], s81 offen offset:0 nt lds
    s_waitcnt vmcnt(13)
    buffer_load_dwordx4 v9, s[4:7], s81 offen offset:1024 nt lds
    v_subrev_u32 v27, 1, v23
    ds_write_b32 v22, v27
    s_waitcnt vmcnt(13)
    buffer_load_dwordx4 v10, s[4:7], s81 offen offset:2048 nt lds
    s_waitcnt vmcnt(13)
    buffer_load_dwordx4 v11, s[4:7], s81 offen offset:3072 nt lds
    v_add_u32 v23, 1, v23
    s_add_u32 s36, s36, 1
    s_add_u32 s87, s87, 1
    s_add_u32 s74, s74, 32768
    s_add_u32 s83, s70, 2
    s_lshl_b32 s84, s83, 13
    s_and_b32 s84, s84, 16384
    s_cmp_eq_u32 s87, 3
    s_cselect_b32 s87, 0, s87
    s_cselect_b32 s70, s83, s70
    s_cselect_b32 s74, s84, s74
    s_add_u32 m0, s37, 0
    s_waitcnt vmcnt(12)
    buffer_load_dwordx4 v12, s[8:11], s34 offen offset:0 nt lds
    s_waitcnt vmcnt(12)
    buffer_load_dwordx4 v13, s[8:11], s34 offen offset:1024 nt lds
    s_waitcnt vmcnt(12)
    buffer_load_dwordx4 v14, s[8:11], s34 offen offset:2048 nt lds
    s_waitcnt vmcnt(12)
    buffer_load_dwordx4 v15, s[8:11], s34 offen offset:3072 nt lds
    s_add_u32 m0, s37, 4096
    s_waitcnt vmcnt(12)
    buffer_load_dwordx4 v12, s[8:11], s35 offen offset:0 nt lds
    v_subrev_u32 v27, 1, v23
    ds_write_b32 v22, v27
    s_waitcnt vmcnt(12)
    buffer_load_dwordx4 v13, s[8:11], s35 offen offset:1024 nt lds
    s_waitcnt vmcnt(12)
    buffer_load_dwordx4 v14, s[8:11], s35 offen offset:2048 nt lds
    s_waitcnt vmcnt(12)
    buffer_load_dwordx4 v15, s[8:11], s35 offen offset:3072 nt lds
    v_add_u32 v23, 1, v23
    s_add_u32 s75, s75, 1
    s_add_u32 s38, s38, 1
    s_add_u32 s37, s37, 32768
    s_add_u32 s83, s39, 2
    s_lshl_b32 s84, s83, 13
    s_and_b32 s84, s84, 16384
    s_add_u32 s84, s84, 8192
    s_cmp_eq_u32 s38, 3
    s_cselect_b32 s38, 0, s38
    s_cselect_b32 s39, s83, s39
    s_cselect_b32 s37, s84, s37
    s_cmp_lt_u32 s36, s77
    s_cbranch_scc1 L_lp2_54
L_tl_54:
    v_readlane_b32 s34, v20, s75
    v_readlane_b32 s35, v21, s75
L_chv_54:
    s_waitcnt lgkmcnt(0)
    v_readlane_b32 s84, v25, s38
    ds_read_b32 v25, v24
    s_cmp_lt_u32 s39, 4
    s_cselect_b32 s84, s39, s84
    s_cmp_lt_u32 s84, s39
    s_cbranch_scc1 L_chv_54
    s_add_u32 m0, s37, 0
    s_waitcnt vmcnt(13)
    buffer_load_dwordx4 v12, s[8:11], s34 offen offset:0 nt lds
    s_waitcnt vmcnt(13)
    buffer_load_dwordx4 v13, s[8:11], s34 offen offset:1024 nt lds
    s_waitcnt vmcnt(13)
    buffer_load_dwordx4 v14, s[8:11], s34 offen offset:2048 nt lds
    s_waitcnt vmcnt(13)
    buffer_load_dwordx4 v15, s[8:11], s34 offen offset:3072 nt lds
    s_add_u32 m0, s37, 4096
    s_waitcnt vmcnt(13)
    buffer_load_dwordx4 v12, s[8:11], s35 offen offset:0 nt lds
    s_waitcnt vmcnt(13)
    buffer_load_dwordx4 v13, s[8:11], s35 offen offset:1024 nt lds
    v_subrev_u32 v27, 1, v23
    ds_write_b32 v22, v27
    s_waitcnt vmcnt(13)
    buffer_load_dwordx4 v14, s[8:11], s35 offen offset:2048 nt lds
    s_waitcnt vmcnt(13)
    buffer_load_dwordx4 v15, s[8:11], s35 offen offset:3072 nt lds
    v_add_u32 v23, 1, v23
    s_add_u32 s75, s75, 1
    s_add_u32 s38, s38, 1
    s_add_u32 s37, s37, 32768
    s_add_u32 s83, s39, 2
    s_lshl_b32 s84, s83, 13
    s_and_b32 s84, s84, 16384
    s_add_u32 s84, s84, 8192
    s_cmp_eq_u32 s38, 3
    s_cselect_b32 s38, 0, s38
    s_cselect_b32 s39, s83, s39
    s_cselect_b32 s37, s84, s37
    s_cmp_lt_u32 s75, s77
    s_cbranch_scc1 L_tl_54
    s_waitcnt vmcnt(8)
    v_subrev_u32 v27, 1, v23
    ds_write_b32 v22, v27
    s_waitcnt vmcnt(0)
    ds_write_b32 v22, v23
    s_branch L_ldone
L_var_55:
    s_cmp_ge_u32 s36, s68
    s_cbranch_scc1 L_lp_55
L_pk_55:
    v_readlane_b32 s80, v20, s36
    v_readlane_b32 s81, v21, s36
    s_nop 2
    s_add_u32 m0, s74, 0
    s_waitcnt vmcnt(13)
    buffer_load_dwordx4 v8, s[4:7], s80 offen offset:0 nt lds
    s_waitcnt vmcnt(13)
    buffer_load_dwordx4 v9, s[4:7], s80 offen offset:1024 nt lds
    s_waitcnt vmcnt(13)
    buffer_load_dwordx4 v10, s[4:7], s80 offen offset:2048 nt lds
    s_waitcnt vmcnt(13)
    buffer_load_dwordx4 v11, s[4:7], s80 offen offset:3072 nt lds
    s_add_u32 m0, s74, 4096
    s_waitcnt vmcnt(13)
    buffer_load_dwordx4 v8, s[4:7], s81 offen offset:0 nt lds
    s_waitcnt vmcnt(13)
    buffer_load_dwordx4 v9, s[4:7], s81 offen offset:1024 nt lds
    v_subrev_u32 v27, 1, v23
    ds_write_b32 v22, v27
    s_waitcnt vmcnt(13)
    buffer_load_dwordx4 v10, s[4:7], s81 offen offset:2048 nt lds
    s_waitcnt vmcnt(13)
    buffer_load_dwordx4 v11, s[4:7], s81 offen offset:3072 nt lds
    v_add_u32 v23, 1, v23
    s_add_u32 s36, s36, 1
    s_add_u32 s87, s87, 1
    s_add_u32 s74, s74, 32768
    s_add_u32 s83, s70, 2
    s_lshl_b32 s84, s83, 13
    s_and_b32 s84, s84, 16384
    s_cmp_eq_u32 s87, 3
    s_cselect_b32 s87, 0, s87
    s_cselect_b32 s70, s83, s70
    s_cselect_b32 s74, s84, s74
    s_cmp_lt_u32 s36, s68
    s_cbranch_scc1 L_pk_55
L_lp_55:
    s_cmp_ge_u32 s36, s77
    s_cbranch_scc1 L_tl_55
L_lp2_55:
    v_readlane_b32 s34, v20, s75
    v_readlane_b32 s35, v21, s75
    v_readlane_b32 s80, v20, s36
    v_readlane_b32 s81, v21, s36
L_chk_55:
    s_waitcnt lgkmcnt(0)
    v_readlane_b32 s83, v25, s87
    v_readlane_b32 s84, v25, s38
    ds_read_b32 v25, v24
    s_cmp_lt_u32 s39, 4
    s_cselect_b32 s84, s39, s84
    s_cmp_lt_u32 s84, s39
    s_cbranch_scc1 L_chk_55
    s_add_u32 s83, s83, 3
    s_cmp_lt_u32 s83, s70
    s_cbranch_scc1 L_chk_55
    s_add_u32 m0, s74, 0
    s_waitcnt vmcnt(13)
    buffer_load_dwordx4 v8, s[4:7], s80 offen offset:0 nt lds
    s_waitcnt vmcnt(13)
    buffer_load_dwordx4 v9, s[4:7], s80 offen offset:1024 nt lds
    s_waitcnt vmcnt(13)
    buffer_load_dwordx4 v10, s[4:7], s80 offen offset:2048 nt lds
    s_waitcnt vmcnt(13)
    buffer_load_dwordx4 v11, s[4:7], s80 offen offset:3072 nt lds
    s_add_u32 m0, s74, 4096
    s_waitcnt vmcnt(13)
    buffer_load_dwordx4 v8, s[4:7], s81 offen offset:0 nt lds
    s_waitcnt vmcnt(13)
    buffer_load_dwordx4 v9, s[4:7], s81 offen offset:1024 nt lds
    v_subrev_u32 v27, 1, v23
    ds_write_b32 v22, v27
    s_waitcnt vmcnt(13)
    buffer_load_dwordx4 v10, s[4:7], s81 offen offset:2048 nt lds
    s_waitcnt vmcnt(13)
    buffer_load_dwordx4 v11, s[4:7], s81 offen offset:3072 nt lds
    v_add_u32 v23, 1, v23
    s_add_u32 s36, s36, 1
    s_add_u32 s87, s87, 1
    s_add_u32 s74, s74, 32768
    s_add_u32 s83, s70, 2
    s_lshl_b32 s84, s83, 13
    s_and_b32 s84, s84, 16384
    s_cmp_eq_u32 s87, 3
    s_cselect_b32 s87, 0, s87
    s_cselect_b32 s70, s83, s70
    s_cselect_b32 s74, s84, s74
    s_add_u32 m0, s37, 0
    s_waitcnt vmcnt(13)
    buffer_load_dwordx4 v12, s[8:11], s34 offen offset:0 nt lds
    s_waitcnt vmcnt(13)
    buffer_load_dwordx4 v13, s[8:11], s34 offen offset:1024 nt lds
    s_waitcnt vmcnt(13)
    buffer_load_dwordx4 v14, s[8:11], s34 offen offset:2048 nt lds
    s_waitcnt vmcnt(13)
    buffer_load_dwordx4 v15, s[8:11], s34 offen offset:3072 nt lds
    s_add_u32 m0, s37, 4096
    s_waitcnt vmcnt(12)
    buffer_load_dwordx4 v12, s[8:11], s35 offen offset:0 nt lds
    v_subrev_u32 v27, 1, v23
    ds_write_b32 v22, v27
    s_waitcnt vmcnt(12)
    buffer_load_dwordx4 v13, s[8:11], s35 offen offset:1024 nt lds
    s_waitcnt vmcnt(12)
    buffer_load_dwordx4 v14, s[8:11], s35 offen offset:2048 nt lds
    s_waitcnt vmcnt(12)
    buffer_load_dwordx4 v15, s[8:11], s35 offen offset:3072 nt lds
    v_add_u32 v23, 1, v23
    s_add_u32 s75, s75, 1
    s_add_u32 s38, s38, 1
    s_add_u32 s37, s37, 32768
    s_add_u32 s83, s39, 2
    s_lshl_b32 s84, s83, 13
    s_and_b32 s84, s84, 16384
    s_add_u32 s84, s84, 8192
    s_cmp_eq_u32 s38, 3
    s_cselect_b32 s38, 0, s38
    s_cselect_b32 s39, s83, s39
    s_cselect_b32 s37, s84, s37
    s_cmp_lt_u32 s36, s77
    s_cbranch_scc1 L_lp2_55
L_tl_55:
    v_readlane_b32 s34, v20, s75
    v_readlane_b32 s35, v21, s75
L_chv_55:
    s_waitcnt lgkmcnt(0)
    v_readlane_b32 s84, v25, s38
    ds_read_b32 v25, v24
    s_cmp_lt_u32 s39, 4
    s_cselect_b32 s84, s39, s84
    s_cmp_lt_u32 s84, s39
    s_cbranch_scc1 L_chv_55
    s_add_u32 m0, s37, 0
    s_waitcnt vmcnt(13)
    buffer_load_dwordx4 v12, s[8:11], s34 offen offset:0 nt lds
    s_waitcnt vmcnt(13)
    buffer_load_dwordx4 v13, s[8:11], s34 offen offset:1024 nt lds
    s_waitcnt vmcnt(13)
    buffer_load_dwordx4 v14, s[8:11], s34 offen offset:2048 nt lds
    s_waitcnt vmcnt(13)
    buffer_load_dwordx4 v15, s[8:11], s34 offen offset:3072 nt lds
    s_add_u32 m0, s37, 4096
    s_waitcnt vmcnt(13)
    buffer_load_dwordx4 v12, s[8:11], s35 offen offset:0 nt lds
    s_waitcnt vmcnt(13)
    buffer_load_dwordx4 v13, s[8:11], s35 offen offset:1024 nt lds
    v_subrev_u32 v27, 1, v23
    ds_write_b32 v22, v27
    s_waitcnt vmcnt(13)
    buffer_load_dwordx4 v14, s[8:11], s35 offen offset:2048 nt lds
    s_waitcnt vmcnt(13)
    buffer_load_dwordx4 v15, s[8:11], s35 offen offset:3072 nt lds
    v_add_u32 v23, 1, v23
    s_add_u32 s75, s75, 1
    s_add_u32 s38, s38, 1
    s_add_u32 s37, s37, 32768
    s_add_u32 s83, s39, 2
    s_lshl_b32 s84, s83, 13
    s_and_b32 s84, s84, 16384
    s_add_u32 s84, s84, 8192
    s_cmp_eq_u32 s38, 3
    s_cselect_b32 s38, 0, s38
    s_cselect_b32 s39, s83, s39
    s_cselect_b32 s37, s84, s37
    s_cmp_lt_u32 s75, s77
    s_cbranch_scc1 L_tl_55
    s_waitcnt vmcnt(8)
    v_subrev_u32 v27, 1, v23
    ds_write_b32 v22, v27
    s_waitcnt vmcnt(0)
    ds_write_b32 v22, v23
    s_branch L_ldone
L_var_56:
    s_cmp_ge_u32 s36, s68
    s_cbranch_scc1 L_lp_56
L_pk_56:
    v_readlane_b32 s80, v20, s36
    v_readlane_b32 s81, v21, s36
    s_nop 2
    s_add_u32 m0, s74, 0
    s_waitcnt vmcnt(13)
    buffer_load_dwordx4 v8, s[4:7], s80 offen offset:0 nt lds
    s_waitcnt vmcnt(13)
    buffer_load_dwordx4 v9, s[4:7], s80 offen offset:1024 nt lds
    s_waitcnt vmcnt(13)
    buffer_load_dwordx4 v10, s[4:7], s80 offen offset:2048 nt lds
    s_waitcnt vmcnt(13)
    buffer_load_dwordx4 v11, s[4:7], s80 offen offset:3072 nt lds
    s_add_u32 m0, s74, 4096
    s_waitcnt vmcnt(13)
    buffer_load_dwordx4 v8, s[4:7], s81 offen offset:0 nt lds
    s_waitcnt vmcnt(13)
    buffer_load_dwordx4 v9, s[4:7], s81 offen offset:1024 nt lds
    v_subrev_u32 v27, 1, v23
    ds_write_b32 v22, v27
    s_waitcnt vmcnt(13)
    buffer_load_dwordx4 v10, s[4:7], s81 offen offset:2048 nt lds
    s_waitcnt vmcnt(13)
    buffer_load_dwordx4 v11, s[4:7], s81 offen offset:3072 nt lds
    v_add_u32 v23, 1, v23
    s_add_u32 s36, s36, 1
    s_add_u32 s87, s87, 1
    s_add_u32 s74, s74, 32768
    s_add_u32 s83, s70, 2
    s_lshl_b32 s84, s83, 13
    s_and_b32 s84, s84, 16384
    s_cmp_eq_u32 s87, 3
    s_cselect_b32 s87, 0, s87
    s_cselect_b32 s70, s83, s70
    s_cselect_b32 s74, s84, s74
    s_cmp_lt_u32 s36, s68
    s_cbranch_scc1 L_pk_56
L_lp_56:
    s_cmp_ge_u32 s36, s77
    s_cbranch_scc1 L_tl_56
L_lp2_56:
    v_readlane_b32 s34, v20, s75
    v_readlane_b32 s35, v21, s75
    v_readlane_b32 s80, v20, s36
    v_readlane_b32 s81, v21, s36
L_chk_56:
    s_waitcnt lgkmcnt(0)
    v_readlane_b32 s83, v25, s87
    v_readlane_b32 s84, v25, s38
    ds_read_b32 v25, v24
    s_cmp_lt_u32 s39, 4
    s_cselect_b32 s84, s39, s84
    s_cmp_lt_u32 s84, s39
    s_cbranch_scc1 L_chk_56
    s_add_u32 s83, s83, 3
    s_cmp_lt_u32 s83, s70
    s_cbranch_scc1 L_chk_56
    s_add_u32 m0, s74, 0
    s_waitcnt vmcnt(13)
    buffer_load_dwordx4 v8, s[4:7], s80 offen offset:0 nt lds
    s_waitcnt vmcnt(13)
    buffer_load_dwordx4 v9, s[4:7], s80 offen offset:1024 nt lds
    s_waitcnt vmcnt(13)
    buffer_load_dwordx4 v10, s[4:7], s80 offen offset:2048 nt lds
    s_waitcnt vmcnt(13)
    buffer_load_dwordx4 v11, s[4:7], s80 offen offset:3072 nt lds
    s_add_u32 m0, s74, 4096
    s_waitcnt vmcnt(13)
    buffer_load_dwordx4 v8, s[4:7], s81 offen offset:0 nt lds
    s_waitcnt vmcnt(13)
    buffer_load_dwordx4 v9, s[4:7], s81 offen offset:1024 nt lds
    v_subrev_u32 v27, 1, v23
    ds_write_b32 v22, v27
    s_waitcnt vmcnt(13)
    buffer_load_dwordx4 v10, s[4:7], s81 offen offset:2048 nt lds
    s_waitcnt vmcnt(13)
    buffer_load_dwordx4 v11, s[4:7], s81 offen offset:3072 nt lds
    v_add_u32 v23, 1, v23
    s_add_u32 s36, s36, 1
    s_add_u32 s87, s87, 1
    s_add_u32 s74, s74, 32768
    s_add_u32 s83, s70, 2
    s_lshl_b32 s84, s83, 13
    s_and_b32 s84, s84, 16384
    s_cmp_eq_u32 s87, 3
    s_cselect_b32 s87, 0, s87
    s_cselect_b32 s70, s83, s70
    s_cselect_b32 s74, s84, s74
    s_add_u32 m0, s37, 0
    s_waitcnt vmcnt(13)
    buffer_load_dwordx4 v12, s[8:11], s34 offen offset:0 nt lds
    s_waitcnt vmcnt(13)
    buffer_load_dwordx4 v13, s[8:11], s34 offen offset:1024 nt lds
    s_waitcnt vmcnt(13)
    buffer_load_dwordx4 v14, s[8:11], s34 offen offset:2048 nt lds
    s_waitcnt vmcnt(13)
    buffer_load_dwordx4 v15, s[8:11], s34 offen offset:3072 nt lds
    s_add_u32 m0, s37, 4096
    s_waitcnt vmcnt(13)
    buffer_load_dwordx4 v12, s[8:11], s35 offen offset:0 nt lds
    s_waitcnt vmcnt(13)
    buffer_load_dwordx4 v13, s[8:11], s35 offen offset:1024 nt lds
    v_subrev_u32 v27, 1, v23
    ds_write_b32 v22, v27
    s_waitcnt vmcnt(13)
    buffer_load_dwordx4 v14, s[8:11], s35 offen offset:2048 nt lds
    s_waitcnt vmcnt(13)
    buffer_load_dwordx4 v15, s[8:11], s35 offen offset:3072 nt lds
    v_add_u32 v23, 1, v23
    s_add_u32 s75, s75, 1
    s_add_u32 s38, s38, 1
    s_add_u32 s37, s37, 32768
    s_add_u32 s83, s39, 2
    s_lshl_b32 s84, s83, 13
    s_and_b32 s84, s84, 16384
    s_add_u32 s84, s84, 8192
    s_cmp_eq_u32 s38, 3
    s_cselect_b32 s38, 0, s38
    s_cselect_b32 s39, s83, s39
    s_cselect_b32 s37, s84, s37
    s_cmp_lt_u32 s36, s77
    s_cbranch_scc1 L_lp2_56
L_tl_56:
    v_readlane_b32 s34, v20, s75
    v_readlane_b32 s35, v21, s75
L_chv_56:
    s_waitcnt lgkmcnt(0)
    v_readlane_b32 s84, v25, s38
    ds_read_b32 v25, v24
    s_cmp_lt_u32 s39, 4
    s_cselect_b32 s84, s39, s84
    s_cmp_lt_u32 s84, s39
    s_cbranch_scc1 L_chv_56
    s_add_u32 m0, s37, 0
    s_waitcnt vmcnt(13)
    buffer_load_dwordx4 v12, s[8:11], s34 offen offset:0 nt lds
    s_waitcnt vmcnt(13)
    buffer_load_dwordx4 v13, s[8:11], s34 offen offset:1024 nt lds
    s_waitcnt vmcnt(13)
    buffer_load_dwordx4 v14, s[8:11], s34 offen offset:2048 nt lds
    s_waitcnt vmcnt(13)
    buffer_load_dwordx4 v15, s[8:11], s34 offen offset:3072 nt lds
    s_add_u32 m0, s37, 4096
    s_waitcnt vmcnt(13)
    buffer_load_dwordx4 v12, s[8:11], s35 offen offset:0 nt lds
    s_waitcnt vmcnt(13)
    buffer_load_dwordx4 v13, s[8:11], s35 offen offset:1024 nt lds
    v_subrev_u32 v27, 1, v23
    ds_write_b32 v22, v27
    s_waitcnt vmcnt(13)
    buffer_load_dwordx4 v14, s[8:11], s35 offen offset:2048 nt lds
    s_waitcnt vmcnt(13)
    buffer_load_dwordx4 v15, s[8:11], s35 offen offset:3072 nt lds
    v_add_u32 v23, 1, v23
    s_add_u32 s75, s75, 1
    s_add_u32 s38, s38, 1
    s_add_u32 s37, s37, 32768
    s_add_u32 s83, s39, 2
    s_lshl_b32 s84, s83, 13
    s_and_b32 s84, s84, 16384
    s_add_u32 s84, s84, 8192
    s_cmp_eq_u32 s38, 3
    s_cselect_b32 s38, 0, s38
    s_cselect_b32 s39, s83, s39
    s_cselect_b32 s37, s84, s37
    s_cmp_lt_u32 s75, s77
    s_cbranch_scc1 L_tl_56
    s_waitcnt vmcnt(8)
    v_subrev_u32 v27, 1, v23
    ds_write_b32 v22, v27
    s_waitcnt vmcnt(0)
    ds_write_b32 v22, v23
    s_branch L_ldone
L_var_57:
    s_cmp_ge_u32 s36, s68
    s_cbranch_scc1 L_lp_57
L_pk_57:
    v_readlane_b32 s80, v20, s36
    v_readlane_b32 s81, v21, s36
    s_nop 2
    s_add_u32 m0, s74, 0
    s_waitcnt vmcnt(14)
    buffer_load_dwordx4 v8, s[4:7], s80 offen offset:0 nt lds
    s_waitcnt vmcnt(14)
    buffer_load_dwordx4 v9, s[4:7], s80 offen offset:1024 nt lds
    s_waitcnt vmcnt(14)
    buffer_load_dwordx4 v10, s[4:7], s80 offen offset:2048 nt lds
    s_waitcnt vmcnt(14)
    buffer_load_dwordx4 v11, s[4:7], s80 offen offset:3072 nt lds
    s_add_u32 m0, s74, 4096
    s_waitcnt vmcnt(13)
    buffer_load_dwordx4 v8, s[4:7], s81 offen offset:0 nt lds
    s_waitcnt vmcnt(13)
    buffer_load_dwordx4 v9, s[4:7], s81 offen offset:1024 nt lds
    v_subrev_u32 v27, 1, v23
    ds_write_b32 v22, v27
    s_waitcnt vmcnt(13)
    buffer_load_dwordx4 v10, s[4:7], s81 offen offset:2048 nt lds
    s_waitcnt vmcnt(13)
    buffer_load_dwordx4 v11, s[4:7], s81 offen offset:3072 nt lds
    v_add_u32 v23, 1, v23
    s_add_u32 s36, s36, 1
    s_add_u32 s87, s87, 1
    s_add_u32 s74, s74, 32768
    s_add_u32 s83, s70, 2
    s_lshl_b32 s84, s83, 13
    s_and_b32 s84, s84, 16384
    s_cmp_eq_u32 s87, 3
    s_cselect_b32 s87, 0, s87
    s_cselect_b32 s70, s83, s70
    s_cselect_b32 s74, s84, s74
    s_cmp_lt_u32 s36, s68
    s_cbranch_scc1 L_pk_57
L_lp_57:
    s_cmp_ge_u32 s36, s77
    s_cbranch_scc1 L_tl_57
L_lp2_57:
    v_readlane_b32 s34, v20, s75
    v_readlane_b32 s35, v21, s75
    v_readlane_b32 s80, v20, s36
    v_readlane_b32 s81, v21, s36
L_chk_57:
    s_waitcnt lgkmcnt(0)
    v_readlane_b32 s83, v25, s87
    v_readlane_b32 s84, v25, s38
    ds_read_b32 v25, v24
    s_cmp_lt_u32 s39, 4
    s_cselect_b32 s84, s39, s84
    s_cmp_lt_u32 s84, s39
    s_cbranch_scc1 L_chk_57
    s_add_u32 s83, s83, 3
    s_cmp_lt_u32 s83, s70
    s_cbranch_scc1 L_chk_57
    s_add_u32 m0, s74, 0
    s_waitcnt vmcnt(14)
    buffer_load_dwordx4 v8, s[4:7], s80 offen offset:0 nt lds
    s_waitcnt vmcnt(14)
    buffer_load_dwordx4 v9, s[4:7], s80 offen offset:1024 nt lds
    s_waitcnt vmcnt(14)
    buffer_load_dwordx4 v10, s[4:7], s80 offen offset:2048 nt lds
    s_waitcnt vmcnt(14)
    buffer_load_dwordx4 v11, s[4:7], s80 offen offset:3072 nt lds
    s_add_u32 m0, s74, 4096
    s_waitcnt vmcnt(13)
    buffer_load_dwordx4 v8, s[4:7], s81 offen offset:0 nt lds
    s_waitcnt vmcnt(13)
    buffer_load_dwordx4 v9, s[4:7], s81 offen offset:1024 nt lds
    v_subrev_u32 v27, 1, v23
    ds_write_b32 v22, v27
    s_waitcnt vmcnt(13)
    buffer_load_dwordx4 v10, s[4:7], s81 offen offset:2048 nt lds
    s_waitcnt vmcnt(13)
    buffer_load_dwordx4 v11, s[4:7], s81 offen offset:3072 nt lds
    v_add_u32 v23, 1, v23
    s_add_u32 s36, s36, 1
    s_add_u32 s87, s87, 1
    s_add_u32 s74, s74, 32768
    s_add_u32 s83, s70, 2
    s_lshl_b32 s84, s83, 13
    s_and_b32 s84, s84, 16384
    s_cmp_eq_u32 s87, 3
    s_cselect_b32 s87, 0, s87
    s_cselect_b32 s70, s83, s70
    s_cselect_b32 s74, s84, s74
    s_add_u32 m0, s37, 0
    s_waitcnt vmcnt(13)
    buffer_load_dwordx4 v12, s[8:11], s34 offen offset:0 nt lds
    s_waitcnt vmcnt(13)
    buffer_load_dwordx4 v13, s[8:11], s34 offen offset:1024 nt lds
    s_waitcnt vmcnt(13)
    buffer_load_dwordx4 v14, s[8:11], s34 offen offset:2048 nt lds
    s_waitcnt vmcnt(13)
    buffer_load_dwordx4 v15, s[8:11], s34 offen offset:3072 nt lds
    s_add_u32 m0, s37, 4096
    s_waitcnt vmcnt(13)
    buffer_load_dwordx4 v12, s[8:11], s35 offen offset:0 nt lds
    s_waitcnt vmcnt(13)
    buffer_load_dwordx4 v13, s[8:11], s35 offen offset:1024 nt lds
    v_subrev_u32 v27, 1, v23
    ds_write_b32 v22, v27
    s_waitcnt vmcnt(13)
    buffer_load_dwordx4 v14, s[8:11], s35 offen offset:2048 nt lds
    s_waitcnt vmcnt(13)
    buffer_load_dwordx4 v15, s[8:11], s35 offen offset:3072 nt lds
    v_add_u32 v23, 1, v23
    s_add_u32 s75, s75, 1
    s_add_u32 s38, s38, 1
    s_add_u32 s37, s37, 32768
    s_add_u32 s83, s39, 2
    s_lshl_b32 s84, s83, 13
    s_and_b32 s84, s84, 16384
    s_add_u32 s84, s84, 8192
    s_cmp_eq_u32 s38, 3
    s_cselect_b32 s38, 0, s38
    s_cselect_b32 s39, s83, s39
    s_cselect_b32 s37, s84, s37
    s_cmp_lt_u32 s36, s77
    s_cbranch_scc1 L_lp2_57
L_tl_57:
    v_readlane_b32 s34, v20, s75
    v_readlane_b32 s35, v21, s75
L_chv_57:
    s_waitcnt lgkmcnt(0)
    v_readlane_b32 s84, v25, s38
    ds_read_b32 v25, v24
    s_cmp_lt_u32 s39, 4
    s_cselect_b32 s84, s39, s84
    s_cmp_lt_u32 s84, s39
    s_cbranch_scc1 L_chv_57
    s_add_u32 m0, s37, 0
    s_waitcnt vmcnt(13)
    buffer_load_dwordx4 v12, s[8:11], s34 offen offset:0 nt lds
    s_waitcnt vmcnt(13)
    buffer_load_dwordx4 v13, s[8:11], s34 offen offset:1024 nt lds
    s_waitcnt vmcnt(13)
    buffer_load_dwordx4 v14, s[8:11], s34 offen offset:2048 nt lds
    s_waitcnt vmcnt(13)
    buffer_load_dwordx4 v15, s[8:11], s34 offen offset:3072 nt lds
    s_add_u32 m0, s37, 4096
    s_waitcnt vmcnt(13)
    buffer_load_dwordx4 v12, s[8:11], s35 offen offset:0 nt lds
    s_waitcnt vmcnt(13)
    buffer_load_dwordx4 v13, s[8:11], s35 offen offset:1024 nt lds
    v_subrev_u32 v27, 1, v23
    ds_write_b32 v22, v27
    s_waitcnt vmcnt(13)
    buffer_load_dwordx4 v14, s[8:11], s35 offen offset:2048 nt lds
    s_waitcnt vmcnt(13)
    buffer_load_dwordx4 v15, s[8:11], s35 offen offset:3072 nt lds
    v_add_u32 v23, 1, v23
    s_add_u32 s75, s75, 1
    s_add_u32 s38, s38, 1
    s_add_u32 s37, s37, 32768
    s_add_u32 s83, s39, 2
    s_lshl_b32 s84, s83, 13
    s_and_b32 s84, s84, 16384
    s_add_u32 s84, s84, 8192
    s_cmp_eq_u32 s38, 3
    s_cselect_b32 s38, 0, s38
    s_cselect_b32 s39, s83, s39
    s_cselect_b32 s37, s84, s37
    s_cmp_lt_u32 s75, s77
    s_cbranch_scc1 L_tl_57
    s_waitcnt vmcnt(8)
    v_subrev_u32 v27, 1, v23
    ds_write_b32 v22, v27
    s_waitcnt vmcnt(0)
    ds_write_b32 v22, v23
    s_branch L_ldone
L_var_58:
    s_cmp_ge_u32 s36, s68
    s_cbranch_scc1 L_lp_58
L_pk_58:
    v_readlane_b32 s80, v20, s36
    v_readlane_b32 s81, v21, s36
    s_nop 2
    s_add_u32 m0, s74, 0
    s_waitcnt vmcnt(14)
    buffer_load_dwordx4 v8, s[4:7], s80 offen offset:0 nt lds
    s_waitcnt vmcnt(14)
    buffer_load_dwordx4 v9, s[4:7], s80 offen offset:1024 nt lds
    s_waitcnt vmcnt(14)
    buffer_load_dwordx4 v10, s[4:7], s80 offen offset:2048 nt lds
    s_waitcnt vmcnt(14)
    buffer_load_dwordx4 v11, s[4:7], s80 offen offset:3072 nt lds
    s_add_u32 m0, s74, 4096
    s_waitcnt vmcnt(14)
    buffer_load_dwordx4 v8, s[4:7], s81 offen offset:0 nt lds
    s_waitcnt vmcnt(14)
    buffer_load_dwordx4 v9, s[4:7], s81 offen offset:1024 nt lds
    s_waitcnt vmcnt(14)
    buffer_load_dwordx4 v10, s[4:7], s81 offen offset:2048 nt lds
    v_subrev_u32 v27, 1, v23
    ds_write_b32 v22, v27
    s_waitcnt vmcnt(14)
    buffer_load_dwordx4 v11, s[4:7], s81 offen offset:3072 nt lds
    v_add_u32 v23, 1, v23
    s_add_u32 s36, s36, 1
    s_add_u32 s87, s87, 1
    s_add_u32 s74, s74, 32768
    s_add_u32 s83, s70, 2
    s_lshl_b32 s84, s83, 13
    s_and_b32 s84, s84, 16384
    s_cmp_eq_u32 s87, 3
    s_cselect_b32 s87, 0, s87
    s_cselect_b32 s70, s83, s70
    s_cselect_b32 s74, s84, s74
    s_cmp_lt_u32 s36, s68
    s_cbranch_scc1 L_pk_58
L_lp_58:
    s_cmp_ge_u32 s36, s77
    s_cbranch_scc1 L_tl_58
L_lp2_58:
    v_readlane_b32 s34, v20, s75
    v_readlane_b32 s35, v21, s75
    v_readlane_b32 s80, v20, s36
    v_readlane_b32 s81, v21, s36
L_chk_58:
    s_waitcnt lgkmcnt(0)
    v_readlane_b32 s83, v25, s87
    v_readlane_b32 s84, v25, s38
    ds_read_b32 v25, v24
    s_cmp_lt_u32 s39, 4
    s_cselect_b32 s84, s39, s84
    s_cmp_lt_u32 s84, s39
    s_cbranch_scc1 L_chk_58
    s_add_u32 s83, s83, 3
    s_cmp_lt_u32 s83, s70
    s_cbranch_scc1 L_chk_58
    s_add_u32 m0, s74, 0
    s_waitcnt vmcnt(14)
    buffer_load_dwordx4 v8, s[4:7], s80 offen offset:0 nt lds
    s_waitcnt vmcnt(14)
    buffer_load_dwordx4 v9, s[4:7], s80 offen offset:1024 nt lds
    s_waitcnt vmcnt(14)
    buffer_load_dwordx4 v10, s[4:7], s80 offen offset:2048 nt lds
    s_waitcnt vmcnt(14)
    buffer_load_dwordx4 v11, s[4:7], s80 offen offset:3072 nt lds
    s_add_u32 m0, s74, 4096
    s_waitcnt vmcnt(14)
    buffer_load_dwordx4 v8, s[4:7], s81 offen offset:0 nt lds
    s_waitcnt vmcnt(14)
    buffer_load_dwordx4 v9, s[4:7], s81 offen offset:1024 nt lds
    s_waitcnt vmcnt(14)
    buffer_load_dwordx4 v10, s[4:7], s81 offen offset:2048 nt lds
    v_subrev_u32 v27, 1, v23
    ds_write_b32 v22, v27
    s_waitcnt vmcnt(14)
    buffer_load_dwordx4 v11, s[4:7], s81 offen offset:3072 nt lds
    v_add_u32 v23, 1, v23
    s_add_u32 s36, s36, 1
    s_add_u32 s87, s87, 1
    s_add_u32 s74, s74, 32768
    s_add_u32 s83, s70, 2
    s_lshl_b32 s84, s83, 13
    s_and_b32 s84, s84, 16384
    s_cmp_eq_u32 s87, 3
    s_cselect_b32 s87, 0, s87
    s_cselect_b32 s70, s83, s70
    s_cselect_b32 s74, s84, s74
    s_add_u32 m0, s37, 0
    s_waitcnt vmcnt(13)
    buffer_load_dwordx4 v12, s[8:11], s34 offen offset:0 nt lds
    s_waitcnt vmcnt(13)
    buffer_load_dwordx4 v13, s[8:11], s34 offen offset:1024 nt lds
    s_waitcnt vmcnt(13)
    buffer_load_dwordx4 v14, s[8:11], s34 offen offset:2048 nt lds
    s_waitcnt vmcnt(13)
    buffer_load_dwordx4 v15, s[8:11], s34 offen offset:3072 nt lds
    s_add_u32 m0, s37, 4096
    s_waitcnt vmcnt(13)
    buffer_load_dwordx4 v12, s[8:11], s35 offen offset:0 nt lds
    s_waitcnt vmcnt(13)
    buffer_load_dwordx4 v13, s[8:11], s35 offen offset:1024 nt lds
    v_subrev_u32 v27, 1, v23
    ds_write_b32 v22, v27
    s_waitcnt vmcnt(13)
    buffer_load_dwordx4 v14, s[8:11], s35 offen offset:2048 nt lds
    s_waitcnt vmcnt(13)
    buffer_load_dwordx4 v15, s[8:11], s35 offen offset:3072 nt lds
    v_add_u32 v23, 1, v23
    s_add_u32 s75, s75, 1
    s_add_u32 s38, s38, 1
    s_add_u32 s37, s37, 32768
    s_add_u32 s83, s39, 2
    s_lshl_b32 s84, s83, 13
    s_and_b32 s84, s84, 16384
    s_add_u32 s84, s84, 8192
    s_cmp_eq_u32 s38, 3
    s_cselect_b32 s38, 0, s38
    s_cselect_b32 s39, s83, s39
    s_cselect_b32 s37, s84, s37
    s_cmp_lt_u32 s36, s77
    s_cbranch_scc1 L_lp2_58
L_tl_58:
    v_readlane_b32 s34, v20, s75
    v_readlane_b32 s35, v21, s75
L_chv_58:
    s_waitcnt lgkmcnt(0)
    v_readlane_b32 s84, v25, s38
    ds_read_b32 v25, v24
    s_cmp_lt_u32 s39, 4
    s_cselect_b32 s84, s39, s84
    s_cmp_lt_u32 s84, s39
    s_cbranch_scc1 L_chv_58
    s_add_u32 m0, s37, 0
    s_waitcnt vmcnt(13)
    buffer_load_dwordx4 v12, s[8:11], s34 offen offset:0 nt lds
    s_waitcnt vmcnt(13)
    buffer_load_dwordx4 v13, s[8:11], s34 offen offset:1024 nt lds
    s_waitcnt vmcnt(13)
    buffer_load_dwordx4 v14, s[8:11], s34 offen offset:2048 nt lds
    s_waitcnt vmcnt(13)
    buffer_load_dwordx4 v15, s[8:11], s34 offen offset:3072 nt lds
    s_add_u32 m0, s37, 4096
    s_waitcnt vmcnt(13)
    buffer_load_dwordx4 v12, s[8:11], s35 offen offset:0 nt lds
    s_waitcnt vmcnt(13)
    buffer_load_dwordx4 v13, s[8:11], s35 offen offset:1024 nt lds
    v_subrev_u32 v27, 1, v23
    ds_write_b32 v22, v27
    s_waitcnt vmcnt(13)
    buffer_load_dwordx4 v14, s[8:11], s35 offen offset:2048 nt lds
    s_waitcnt vmcnt(13)
    buffer_load_dwordx4 v15, s[8:11], s35 offen offset:3072 nt lds
    v_add_u32 v23, 1, v23
    s_add_u32 s75, s75, 1
    s_add_u32 s38, s38, 1
    s_add_u32 s37, s37, 32768
    s_add_u32 s83, s39, 2
    s_lshl_b32 s84, s83, 13
    s_and_b32 s84, s84, 16384
    s_add_u32 s84, s84, 8192
    s_cmp_eq_u32 s38, 3
    s_cselect_b32 s38, 0, s38
    s_cselect_b32 s39, s83, s39
    s_cselect_b32 s37, s84, s37
    s_cmp_lt_u32 s75, s77
    s_cbranch_scc1 L_tl_58
    s_waitcnt vmcnt(8)
    v_subrev_u32 v27, 1, v23
    ds_write_b32 v22, v27
    s_waitcnt vmcnt(0)
    ds_write_b32 v22, v23
    s_branch L_ldone
L_var_59:
    s_cmp_ge_u32 s36, s68
    s_cbranch_scc1 L_lp_59
L_pk_59:
    v_readlane_b32 s80, v20, s36
    v_readlane_b32 s81, v21, s36
    s_nop 2
    s_add_u32 m0, s74, 0
    s_waitcnt vmcnt(14)
    buffer_load_dwordx4 v8, s[4:7], s80 offen offset:0 nt lds
    s_waitcnt vmcnt(14)
    buffer_load_dwordx4 v9, s[4:7], s80 offen offset:1024 nt lds
    s_waitcnt vmcnt(14)
    buffer_load_dwordx4 v10, s[4:7], s80 offen offset:2048 nt lds
    s_waitcnt vmcnt(14)
    buffer_load_dwordx4 v11, s[4:7], s80 offen offset:3072 nt lds
    s_add_u32 m0, s74, 4096
    s_waitcnt vmcnt(14)
    buffer_load_dwordx4 v8, s[4:7], s81 offen offset:0 nt lds
    s_waitcnt vmcnt(14)
    buffer_load_dwordx4 v9, s[4:7], s81 offen offset:1024 nt lds
    s_waitcnt vmcnt(14)
    buffer_load_dwordx4 v10, s[4:7], s81 offen offset:2048 nt lds
    v_subrev_u32 v27, 1, v23
    ds_write_b32 v22, v27
    s_waitcnt vmcnt(14)
    buffer_load_dwordx4 v11, s[4:7], s81 offen offset:3072 nt lds
    v_add_u32 v23, 1, v23
    s_add_u32 s36, s36, 1
    s_add_u32 s87, s87, 1
    s_add_u32 s74, s74, 32768
    s_add_u32 s83, s70, 2
    s_lshl_b32 s84, s83, 13
    s_and_b32 s84, s84, 16384
    s_cmp_eq_u32 s87, 3
    s_cselect_b32 s87, 0, s87
    s_cselect_b32 s70, s83, s70
    s_cselect_b32 s74, s84, s74
    s_cmp_lt_u32 s36, s68
    s_cbranch_scc1 L_pk_59
L_lp_59:
    s_cmp_ge_u32 s36, s77
    s_cbranch_scc1 L_tl_59
L_lp2_59:
    v_readlane_b32 s34, v20, s75
    v_readlane_b32 s35, v21, s75
    v_readlane_b32 s80, v20, s36
    v_readlane_b32 s81, v21, s36
L_chk_59:
    s_waitcnt lgkmcnt(0)
    v_readlane_b32 s83, v25, s87
    v_readlane_b32 s84, v25, s38
    ds_read_b32 v25, v24
    s_cmp_lt_u32 s39, 4
    s_cselect_b32 s84, s39, s84
    s_cmp_lt_u32 s84, s39
    s_cbranch_scc1 L_chk_59
    s_add_u32 s83, s83, 3
    s_cmp_lt_u32 s83, s70
    s_cbranch_scc1 L_chk_59
    s_add_u32 m0, s74, 0
    s_waitcnt vmcnt(14)
    buffer_load_dwordx4 v8, s[4:7], s80 offen offset:0 nt lds
    s_waitcnt vmcnt(14)
    buffer_load_dwordx4 v9, s[4:7], s80 offen offset:1024 nt lds
    s_waitcnt vmcnt(14)
    buffer_load_dwordx4 v10, s[4:7], s80 offen offset:2048 nt lds
    s_waitcnt vmcnt(14)
    buffer_load_dwordx4 v11, s[4:7], s80 offen offset:3072 nt lds
    s_add_u32 m0, s74, 4096
    s_waitcnt vmcnt(14)
    buffer_load_dwordx4 v8, s[4:7], s81 offen offset:0 nt lds
    s_waitcnt vmcnt(14)
    buffer_load_dwordx4 v9, s[4:7], s81 offen offset:1024 nt lds
    s_waitcnt vmcnt(14)
    buffer_load_dwordx4 v10, s[4:7], s81 offen offset:2048 nt lds
    v_subrev_u32 v27, 1, v23
    ds_write_b32 v22, v27
    s_waitcnt vmcnt(14)
    buffer_load_dwordx4 v11, s[4:7], s81 offen offset:3072 nt lds
    v_add_u32 v23, 1, v23
    s_add_u32 s36, s36, 1
    s_add_u32 s87, s87, 1
    s_add_u32 s74, s74, 32768
    s_add_u32 s83, s70, 2
    s_lshl_b32 s84, s83, 13
    s_and_b32 s84, s84, 16384
    s_cmp_eq_u32 s87, 3
    s_cselect_b32 s87, 0, s87
    s_cselect_b32 s70, s83, s70
    s_cselect_b32 s74, s84, s74
    s_add_u32 m0, s37, 0
    s_waitcnt vmcnt(14)
    buffer_load_dwordx4 v12, s[8:11], s34 offen offset:0 nt lds
    s_waitcnt vmcnt(14)
    buffer_load_dwordx4 v13, s[8:11], s34 offen offset:1024 nt lds
    s_waitcnt vmcnt(14)
    buffer_load_dwordx4 v14, s[8:11], s34 offen offset:2048 nt lds
    s_waitcnt vmcnt(14)
    buffer_load_dwordx4 v15, s[8:11], s34 offen offset:3072 nt lds
    s_add_u32 m0, s37, 4096
    s_waitcnt vmcnt(13)
    buffer_load_dwordx4 v12, s[8:11], s35 offen offset:0 nt lds
    s_waitcnt vmcnt(13)
    buffer_load_dwordx4 v13, s[8:11], s35 offen offset:1024 nt lds
    v_subrev_u32 v27, 1, v23
    ds_write_b32 v22, v27
    s_waitcnt vmcnt(13)
    buffer_load_dwordx4 v14, s[8:11], s35 offen offset:2048 nt lds
    s_waitcnt vmcnt(13)
    buffer_load_dwordx4 v15, s[8:11], s35 offen offset:3072 nt lds
    v_add_u32 v23, 1, v23
    s_add_u32 s75, s75, 1
    s_add_u32 s38, s38, 1
    s_add_u32 s37, s37, 32768
    s_add_u32 s83, s39, 2
    s_lshl_b32 s84, s83, 13
    s_and_b32 s84, s84, 16384
    s_add_u32 s84, s84, 8192
    s_cmp_eq_u32 s38, 3
    s_cselect_b32 s38, 0, s38
    s_cselect_b32 s39, s83, s39
    s_cselect_b32 s37, s84, s37
    s_cmp_lt_u32 s36, s77
    s_cbranch_scc1 L_lp2_59
L_tl_59:
    v_readlane_b32 s34, v20, s75
    v_readlane_b32 s35, v21, s75
L_chv_59:
    s_waitcnt lgkmcnt(0)
    v_readlane_b32 s84, v25, s38
    ds_read_b32 v25, v24
    s_cmp_lt_u32 s39, 4
    s_cselect_b32 s84, s39, s84
    s_cmp_lt_u32 s84, s39
    s_cbranch_scc1 L_chv_59
    s_add_u32 m0, s37, 0
    s_waitcnt vmcnt(14)
    buffer_load_dwordx4 v12, s[8:11], s34 offen offset:0 nt lds
    s_waitcnt vmcnt(14)
    buffer_load_dwordx4 v13, s[8:11], s34 offen offset:1024 nt lds
    s_waitcnt vmcnt(14)
    buffer_load_dwordx4 v14, s[8:11], s34 offen offset:2048 nt lds
    s_waitcnt vmcnt(14)
    buffer_load_dwordx4 v15, s[8:11], s34 offen offset:3072 nt lds
    s_add_u32 m0, s37, 4096
    s_waitcnt vmcnt(14)
    buffer_load_dwordx4 v12, s[8:11], s35 offen offset:0 nt lds
    s_waitcnt vmcnt(14)
    buffer_load_dwordx4 v13, s[8:11], s35 offen offset:1024 nt lds
    s_waitcnt vmcnt(14)
    buffer_load_dwordx4 v14, s[8:11], s35 offen offset:2048 nt lds
    v_subrev_u32 v27, 1, v23
    ds_write_b32 v22, v27
    s_waitcnt vmcnt(14)
    buffer_load_dwordx4 v15, s[8:11], s35 offen offset:3072 nt lds
    v_add_u32 v23, 1, v23
    s_add_u32 s75, s75, 1
    s_add_u32 s38, s38, 1
    s_add_u32 s37, s37, 32768
    s_add_u32 s83, s39, 2
    s_lshl_b32 s84, s83, 13
    s_and_b32 s84, s84, 16384
    s_add_u32 s84, s84, 8192
    s_cmp_eq_u32 s38, 3
    s_cselect_b32 s38, 0, s38
    s_cselect_b32 s39, s83, s39
    s_cselect_b32 s37, s84, s37
    s_cmp_lt_u32 s75, s77
    s_cbranch_scc1 L_tl_59
    s_waitcnt vmcnt(8)
    v_subrev_u32 v27, 1, v23
    ds_write_b32 v22, v27
    s_waitcnt vmcnt(0)
    ds_write_b32 v22, v23
    s_branch L_ldone
L_var_60:
    s_cmp_ge_u32 s36, s68
    s_cbranch_scc1 L_lp_60
L_pk_60:
    v_readlane_b32 s80, v20, s36
    v_readlane_b32 s81, v21, s36
    s_nop 2
    s_add_u32 m0, s74, 0
    s_waitcnt vmcnt(14)
    buffer_load_dwordx4 v8, s[4:7], s80 offen offset:0 nt lds
    s_waitcnt vmcnt(14)
    buffer_load_dwordx4 v9, s[4:7], s80 offen offset:1024 nt lds
    s_waitcnt vmcnt(14)
    buffer_load_dwordx4 v10, s[4:7], s80 offen offset:2048 nt lds
    s_waitcnt vmcnt(14)
    buffer_load_dwordx4 v11, s[4:7], s80 offen offset:3072 nt lds
    s_add_u32 m0, s74, 4096
    s_waitcnt vmcnt(14)
    buffer_load_dwordx4 v8, s[4:7], s81 offen offset:0 nt lds
    s_waitcnt vmcnt(14)
    buffer_load_dwordx4 v9, s[4:7], s81 offen offset:1024 nt lds
    s_waitcnt vmcnt(14)
    buffer_load_dwordx4 v10, s[4:7], s81 offen offset:2048 nt lds
    v_subrev_u32 v27, 1, v23
    ds_write_b32 v22, v27
    s_waitcnt vmcnt(14)
    buffer_load_dwordx4 v11, s[4:7], s81 offen offset:3072 nt lds
    v_add_u32 v23, 1, v23
    s_add_u32 s36, s36, 1
    s_add_u32 s87, s87, 1
    s_add_u32 s74, s74, 32768
    s_add_u32 s83, s70, 2
    s_lshl_b32 s84, s83, 13
    s_and_b32 s84, s84, 16384
    s_cmp_eq_u32 s87, 3
    s_cselect_b32 s87, 0, s87
    s_cselect_b32 s70, s83, s70
    s_cselect_b32 s74, s84, s74
    s_cmp_lt_u32 s36, s68
    s_cbranch_scc1 L_pk_60
L_lp_60:
    s_cmp_ge_u32 s36, s77
    s_cbranch_scc1 L_tl_60
L_lp2_60:
    v_readlane_b32 s34, v20, s75
    v_readlane_b32 s35, v21, s75
    v_readlane_b32 s80, v20, s36
    v_readlane_b32 s81, v21, s36
L_chk_60:
    s_waitcnt lgkmcnt(0)
    v_readlane_b32 s83, v25, s87
    v_readlane_b32 s84, v25, s38
    ds_read_b32 v25, v24
    s_cmp_lt_u32 s39, 4
    s_cselect_b32 s84, s39, s84
    s_cmp_lt_u32 s84, s39
    s_cbranch_scc1 L_chk_60
    s_add_u32 s83, s83, 3
    s_cmp_lt_u32 s83, s70
    s_cbranch_scc1 L_chk_60
    s_add_u32 m0, s74, 0
    s_waitcnt vmcnt(14)
    buffer_load_dwordx4 v8, s[4:7], s80 offen offset:0 nt lds
    s_waitcnt vmcnt(14)
    buffer_load_dwordx4 v9, s[4:7], s80 offen offset:1024 nt lds
    s_waitcnt vmcnt(14)
    buffer_load_dwordx4 v10, s[4:7], s80 offen offset:2048 nt lds
    s_waitcnt vmcnt(14)
    buffer_load_dwordx4 v11, s[4:7], s80 offen offset:3072 nt lds
    s_add_u32 m0, s74, 4096
    s_waitcnt vmcnt(14)
    buffer_load_dwordx4 v8, s[4:7], s81 offen offset:0 nt lds
    s_waitcnt vmcnt(14)
    buffer_load_dwordx4 v9, s[4:7], s81 offen offset:1024 nt lds
    s_waitcnt vmcnt(14)
    buffer_load_dwordx4 v10, s[4:7], s81 offen offset:2048 nt lds
    v_subrev_u32 v27, 1, v23
    ds_write_b32 v22, v27
    s_waitcnt vmcnt(14)
    buffer_load_dwordx4 v11, s[4:7], s81 offen offset:3072 nt lds
    v_add_u32 v23, 1, v23
    s_add_u32 s36, s36, 1
    s_add_u32 s87, s87, 1
    s_add_u32 s74, s74, 32768
    s_add_u32 s83, s70, 2
    s_lshl_b32 s84, s83, 13
    s_and_b32 s84, s84, 16384
    s_cmp_eq_u32 s87, 3
    s_cselect_b32 s87, 0, s87
    s_cselect_b32 s70, s83, s70
    s_cselect_b32 s74, s84, s74
    s_add_u32 m0, s37, 0
    s_waitcnt vmcnt(14)
    buffer_load_dwordx4 v12, s[8:11], s34 offen offset:0 nt lds
    s_waitcnt vmcnt(14)
    buffer_load_dwordx4 v13, s[8:11], s34 offen offset:1024 nt lds
    s_waitcnt vmcnt(14)
    buffer_load_dwordx4 v14, s[8:11], s34 offen offset:2048 nt lds
    s_waitcnt vmcnt(14)
    buffer_load_dwordx4 v15, s[8:11], s34 offen offset:3072 nt lds
    s_add_u32 m0, s37, 4096
    s_waitcnt vmcnt(14)
    buffer_load_dwordx4 v12, s[8:11], s35 offen offset:0 nt lds
    s_waitcnt vmcnt(14)
    buffer_load_dwordx4 v13, s[8:11], s35 offen offset:1024 nt lds
    s_waitcnt vmcnt(14)
    buffer_load_dwordx4 v14, s[8:11], s35 offen offset:2048 nt lds
    v_subrev_u32 v27, 1, v23
    ds_write_b32 v22, v27
    s_waitcnt vmcnt(14)
    buffer_load_dwordx4 v15, s[8:11], s35 offen offset:3072 nt lds
    v_add_u32 v23, 1, v23
    s_add_u32 s75, s75, 1
    s_add_u32 s38, s38, 1
    s_add_u32 s37, s37, 32768
    s_add_u32 s83, s39, 2
    s_lshl_b32 s84, s83, 13
    s_and_b32 s84, s84, 16384
    s_add_u32 s84, s84, 8192
    s_cmp_eq_u32 s38, 3
    s_cselect_b32 s38, 0, s38
    s_cselect_b32 s39, s83, s39
    s_cselect_b32 s37, s84, s37
    s_cmp_lt_u32 s36, s77
    s_cbranch_scc1 L_lp2_60
L_tl_60:
    v_readlane_b32 s34, v20, s75
    v_readlane_b32 s35, v21, s75
L_chv_60:
    s_waitcnt lgkmcnt(0)
    v_readlane_b32 s84, v25, s38
    ds_read_b32 v25, v24
    s_cmp_lt_u32 s39, 4
    s_cselect_b32 s84, s39, s84
    s_cmp_lt_u32 s84, s39
    s_cbranch_scc1 L_chv_60
    s_add_u32 m0, s37, 0
    s_waitcnt vmcnt(14)
    buffer_load_dwordx4 v12, s[8:11], s34 offen offset:0 nt lds
    s_waitcnt vmcnt(14)
    buffer_load_dwordx4 v13, s[8:11], s34 offen offset:1024 nt lds
    s_waitcnt vmcnt(14)
    buffer_load_dwordx4 v14, s[8:11], s34 offen offset:2048 nt lds
    s_waitcnt vmcnt(14)
    buffer_load_dwordx4 v15, s[8:11], s34 offen offset:3072 nt lds
    s_add_u32 m0, s37, 4096
    s_waitcnt vmcnt(14)
    buffer_load_dwordx4 v12, s[8:11], s35 offen offset:0 nt lds
    s_waitcnt vmcnt(14)
    buffer_load_dwordx4 v13, s[8:11], s35 offen offset:1024 nt lds
    s_waitcnt vmcnt(14)
    buffer_load_dwordx4 v14, s[8:11], s35 offen offset:2048 nt lds
    v_subrev_u32 v27, 1, v23
    ds_write_b32 v22, v27
    s_waitcnt vmcnt(14)
    buffer_load_dwordx4 v15, s[8:11], s35 offen offset:3072 nt lds
    v_add_u32 v23, 1, v23
    s_add_u32 s75, s75, 1
    s_add_u32 s38, s38, 1
    s_add_u32 s37, s37, 32768
    s_add_u32 s83, s39, 2
    s_lshl_b32 s84, s83, 13
    s_and_b32 s84, s84, 16384
    s_add_u32 s84, s84, 8192
    s_cmp_eq_u32 s38, 3
    s_cselect_b32 s38, 0, s38
    s_cselect_b32 s39, s83, s39
    s_cselect_b32 s37, s84, s37
    s_cmp_lt_u32 s75, s77
    s_cbranch_scc1 L_tl_60
    s_waitcnt vmcnt(8)
    v_subrev_u32 v27, 1, v23
    ds_write_b32 v22, v27
    s_waitcnt vmcnt(0)
    ds_write_b32 v22, v23
    s_branch L_ldone
L_var_61:
    s_cmp_ge_u32 s36, s68
    s_cbranch_scc1 L_lp_61
L_pk_61:
    v_readlane_b32 s80, v20, s36
    v_readlane_b32 s81, v21, s36
    s_nop 2
    s_add_u32 m0, s74, 0
    s_waitcnt vmcnt(15)
    buffer_load_dwordx4 v8, s[4:7], s80 offen offset:0 nt lds
    s_waitcnt vmcnt(15)
    buffer_load_dwordx4 v9, s[4:7], s80 offen offset:1024 nt lds
    s_waitcnt vmcnt(15)
    buffer_load_dwordx4 v10, s[4:7], s80 offen offset:2048 nt lds
    s_waitcnt vmcnt(15)
    buffer_load_dwordx4 v11, s[4:7], s80 offen offset:3072 nt lds
    s_add_u32 m0, s74, 4096
    s_waitcnt vmcnt(14)
    buffer_load_dwordx4 v8, s[4:7], s81 offen offset:0 nt lds
    s_waitcnt vmcnt(14)
    buffer_load_dwordx4 v9, s[4:7], s81 offen offset:1024 nt lds
    s_waitcnt vmcnt(14)
    buffer_load_dwordx4 v10, s[4:7], s81 offen offset:2048 nt lds
    v_subrev_u32 v27, 1, v23
    ds_write_b32 v22, v27
    s_waitcnt vmcnt(14)
    buffer_load_dwordx4 v11, s[4:7], s81 offen offset:3072 nt lds
    v_add_u32 v23, 1, v23
    s_add_u32 s36, s36, 1
    s_add_u32 s87, s87, 1
    s_add_u32 s74, s74, 32768
    s_add_u32 s83, s70, 2
    s_lshl_b32 s84, s83, 13
    s_and_b32 s84, s84, 16384
    s_cmp_eq_u32 s87, 3
    s_cselect_b32 s87, 0, s87
    s_cselect_b32 s70, s83, s70
    s_cselect_b32 s74, s84, s74
    s_cmp_lt_u32 s36, s68
    s_cbranch_scc1 L_pk_61
L_lp_61:
    s_cmp_ge_u32 s36, s77
    s_cbranch_scc1 L_tl_61
L_lp2_61:
    v_readlane_b32 s34, v20, s75
    v_readlane_b32 s35, v21, s75
    v_readlane_b32 s80, v20, s36
    v_readlane_b32 s81, v21, s36
L_chk_61:
    s_waitcnt lgkmcnt(0)
    v_readlane_b32 s83, v25, s87
    v_readlane_b32 s84, v25, s38
    ds_read_b32 v25, v24
    s_cmp_lt_u32 s39, 4
    s_cselect_b32 s84, s39, s84
    s_cmp_lt_u32 s84, s39
    s_cbranch_scc1 L_chk_61
    s_add_u32 s83, s83, 3
    s_cmp_lt_u32 s83, s70
    s_cbranch_scc1 L_chk_61
    s_add_u32 m0, s74, 0
    s_waitcnt vmcnt(15)
    buffer_load_dwordx4 v8, s[4:7], s80 offen offset:0 nt lds
    s_waitcnt vmcnt(15)
    buffer_load_dwordx4 v9, s[4:7], s80 offen offset:1024 nt lds
    s_waitcnt vmcnt(15)
    buffer_load_dwordx4 v10, s[4:7], s80 offen offset:2048 nt lds
    s_waitcnt vmcnt(15)
    buffer_load_dwordx4 v11, s[4:7], s80 offen offset:3072 nt lds
    s_add_u32 m0, s74, 4096
    s_waitcnt vmcnt(14)
    buffer_load_dwordx4 v8, s[4:7], s81 offen offset:0 nt lds
    s_waitcnt vmcnt(14)
    buffer_load_dwordx4 v9, s[4:7], s81 offen offset:1024 nt lds
    s_waitcnt vmcnt(14)
    buffer_load_dwordx4 v10, s[4:7], s81 offen offset:2048 nt lds
    v_subrev_u32 v27, 1, v23
    ds_write_b32 v22, v27
    s_waitcnt vmcnt(14)
    buffer_load_dwordx4 v11, s[4:7], s81 offen offset:3072 nt lds
    v_add_u32 v23, 1, v23
    s_add_u32 s36, s36, 1
    s_add_u32 s87, s87, 1
    s_add_u32 s74, s74, 32768
    s_add_u32 s83, s70, 2
    s_lshl_b32 s84, s83, 13
    s_and_b32 s84, s84, 16384
    s_cmp_eq_u32 s87, 3
    s_cselect_b32 s87, 0, s87
    s_cselect_b32 s70, s83, s70
    s_cselect_b32 s74, s84, s74
    s_add_u32 m0, s37, 0
    s_waitcnt vmcnt(14)
    buffer_load_dwordx4 v12, s[8:11], s34 offen offset:0 nt lds
    s_waitcnt vmcnt(14)
    buffer_load_dwordx4 v13, s[8:11], s34 offen offset:1024 nt lds
    s_waitcnt vmcnt(14)
    buffer_load_dwordx4 v14, s[8:11], s34 offen offset:2048 nt lds
    s_waitcnt vmcnt(14)
    buffer_load_dwordx4 v15, s[8:11], s34 offen offset:3072 nt lds
    s_add_u32 m0, s37, 4096
    s_waitcnt vmcnt(14)
    buffer_load_dwordx4 v12, s[8:11], s35 offen offset:0 nt lds
    s_waitcnt vmcnt(14)
    buffer_load_dwordx4 v13, s[8:11], s35 offen offset:1024 nt lds
    s_waitcnt vmcnt(14)
    buffer_load_dwordx4 v14, s[8:11], s35 offen offset:2048 nt lds
    v_subrev_u32 v27, 1, v23
    ds_write_b32 v22, v27
    s_waitcnt vmcnt(14)
    buffer_load_dwordx4 v15, s[8:11], s35 offen offset:3072 nt lds
    v_add_u32 v23, 1, v23
    s_add_u32 s75, s75, 1
    s_add_u32 s38, s38, 1
    s_add_u32 s37, s37, 32768
    s_add_u32 s83, s39, 2
    s_lshl_b32 s84, s83, 13
    s_and_b32 s84, s84, 16384
    s_add_u32 s84, s84, 8192
    s_cmp_eq_u32 s38, 3
    s_cselect_b32 s38, 0, s38
    s_cselect_b32 s39, s83, s39
    s_cselect_b32 s37, s84, s37
    s_cmp_lt_u32 s36, s77
    s_cbranch_scc1 L_lp2_61
L_tl_61:
    v_readlane_b32 s34, v20, s75
    v_readlane_b32 s35, v21, s75
L_chv_61:
    s_waitcnt lgkmcnt(0)
    v_readlane_b32 s84, v25, s38
    ds_read_b32 v25, v24
    s_cmp_lt_u32 s39, 4
    s_cselect_b32 s84, s39, s84
    s_cmp_lt_u32 s84, s39
    s_cbranch_scc1 L_chv_61
    s_add_u32 m0, s37, 0
    s_waitcnt vmcnt(14)
    buffer_load_dwordx4 v12, s[8:11], s34 offen offset:0 nt lds
    s_waitcnt vmcnt(14)
    buffer_load_dwordx4 v13, s[8:11], s34 offen offset:1024 nt lds
    s_waitcnt vmcnt(14)
    buffer_load_dwordx4 v14, s[8:11], s34 offen offset:2048 nt lds
    s_waitcnt vmcnt(14)
    buffer_load_dwordx4 v15, s[8:11], s34 offen offset:3072 nt lds
    s_add_u32 m0, s37, 4096
    s_waitcnt vmcnt(14)
    buffer_load_dwordx4 v12, s[8:11], s35 offen offset:0 nt lds
    s_waitcnt vmcnt(14)
    buffer_load_dwordx4 v13, s[8:11], s35 offen offset:1024 nt lds
    s_waitcnt vmcnt(14)
    buffer_load_dwordx4 v14, s[8:11], s35 offen offset:2048 nt lds
    v_subrev_u32 v27, 1, v23
    ds_write_b32 v22, v27
    s_waitcnt vmcnt(14)
    buffer_load_dwordx4 v15, s[8:11], s35 offen offset:3072 nt lds
    v_add_u32 v23, 1, v23
    s_add_u32 s75, s75, 1
    s_add_u32 s38, s38, 1
    s_add_u32 s37, s37, 32768
    s_add_u32 s83, s39, 2
    s_lshl_b32 s84, s83, 13
    s_and_b32 s84, s84, 16384
    s_add_u32 s84, s84, 8192
    s_cmp_eq_u32 s38, 3
    s_cselect_b32 s38, 0, s38
    s_cselect_b32 s39, s83, s39
    s_cselect_b32 s37, s84, s37
    s_cmp_lt_u32 s75, s77
    s_cbranch_scc1 L_tl_61
    s_waitcnt vmcnt(8)
    v_subrev_u32 v27, 1, v23
    ds_write_b32 v22, v27
    s_waitcnt vmcnt(0)
    ds_write_b32 v22, v23
    s_branch L_ldone
L_var_62:
    s_cmp_ge_u32 s36, s68
    s_cbranch_scc1 L_lp_62
L_pk_62:
    v_readlane_b32 s80, v20, s36
    v_readlane_b32 s81, v21, s36
    s_nop 2
    s_add_u32 m0, s74, 0
    s_waitcnt vmcnt(15)
    buffer_load_dwordx4 v8, s[4:7], s80 offen offset:0 nt lds
    s_waitcnt vmcnt(15)
    buffer_load_dwordx4 v9, s[4:7], s80 offen offset:1024 nt lds
    s_waitcnt vmcnt(15)
    buffer_load_dwordx4 v10, s[4:7], s80 offen offset:2048 nt lds
    s_waitcnt vmcnt(15)
    buffer_load_dwordx4 v11, s[4:7], s80 offen offset:3072 nt lds
    s_add_u32 m0, s74, 4096
    s_waitcnt vmcnt(15)
    buffer_load_dwordx4 v8, s[4:7], s81 offen offset:0 nt lds
    s_waitcnt vmcnt(15)
    buffer_load_dwordx4 v9, s[4:7], s81 offen offset:1024 nt lds
    s_waitcnt vmcnt(15)
    buffer_load_dwordx4 v10, s[4:7], s81 offen offset:2048 nt lds
    s_waitcnt vmcnt(15)
    buffer_load_dwordx4 v11, s[4:7], s81 offen offset:3072 nt lds
    v_subrev_u32 v27, 1, v23
    ds_write_b32 v22, v27
    v_add_u32 v23, 1, v23
    s_add_u32 s36, s36, 1
    s_add_u32 s87, s87, 1
    s_add_u32 s74, s74, 32768
    s_add_u32 s83, s70, 2
    s_lshl_b32 s84, s83, 13
    s_and_b32 s84, s84, 16384
    s_cmp_eq_u32 s87, 3
    s_cselect_b32 s87, 0, s87
    s_cselect_b32 s70, s83, s70
    s_cselect_b32 s74, s84, s74
    s_cmp_lt_u32 s36, s68
    s_cbranch_scc1 L_pk_62
L_lp_62:
    s_cmp_ge_u32 s36, s77
    s_cbranch_scc1 L_tl_62
L_lp2_62:
    v_readlane_b32 s34, v20, s75
    v_readlane_b32 s35, v21, s75
    v_readlane_b32 s80, v20, s36
    v_readlane_b32 s81, v21, s36
L_chk_62:
    s_waitcnt lgkmcnt(0)
    v_readlane_b32 s83, v25, s87
    v_readlane_b32 s84, v25, s38
    ds_read_b32 v25, v24
    s_cmp_lt_u32 s39, 4
    s_cselect_b32 s84, s39, s84
    s_cmp_lt_u32 s84, s39
    s_cbranch_scc1 L_chk_62
    s_add_u32 s83, s83, 3
    s_cmp_lt_u32 s83, s70
    s_cbranch_scc1 L_chk_62
    s_add_u32 m0, s74, 0
    s_waitcnt vmcnt(15)
    buffer_load_dwordx4 v8, s[4:7], s80 offen offset:0 nt lds
    s_waitcnt vmcnt(15)
    buffer_load_dwordx4 v9, s[4:7], s80 offen offset:1024 nt lds
    s_waitcnt vmcnt(15)
    buffer_load_dwordx4 v10, s[4:7], s80 offen offset:2048 nt lds
    s_waitcnt vmcnt(15)
    buffer_load_dwordx4 v11, s[4:7], s80 offen offset:3072 nt lds
    s_add_u32 m0, s74, 4096
    s_waitcnt vmcnt(15)
    buffer_load_dwordx4 v8, s[4:7], s81 offen offset:0 nt lds
    s_waitcnt vmcnt(15)
    buffer_load_dwordx4 v9, s[4:7], s81 offen offset:1024 nt lds
    s_waitcnt vmcnt(15)
    buffer_load_dwordx4 v10, s[4:7], s81 offen offset:2048 nt lds
    s_waitcnt vmcnt(15)
    buffer_load_dwordx4 v11, s[4:7], s81 offen offset:3072 nt lds
    v_subrev_u32 v27, 1, v23
    ds_write_b32 v22, v27
    v_add_u32 v23, 1, v23
    s_add_u32 s36, s36, 1
    s_add_u32 s87, s87, 1
    s_add_u32 s74, s74, 32768
    s_add_u32 s83, s70, 2
    s_lshl_b32 s84, s83, 13
    s_and_b32 s84, s84, 16384
    s_cmp_eq_u32 s87, 3
    s_cselect_b32 s87, 0, s87
    s_cselect_b32 s70, s83, s70
    s_cselect_b32 s74, s84, s74
    s_add_u32 m0, s37, 0
    s_waitcnt vmcnt(14)
    buffer_load_dwordx4 v12, s[8:11], s34 offen offset:0 nt lds
    s_waitcnt vmcnt(14)
    buffer_load_dwordx4 v13, s[8:11], s34 offen offset:1024 nt lds
    s_waitcnt vmcnt(14)
    buffer_load_dwordx4 v14, s[8:11], s34 offen offset:2048 nt lds
    s_waitcnt vmcnt(14)
    buffer_load_dwordx4 v15, s[8:11], s34 offen offset:3072 nt lds
    s_add_u32 m0, s37, 4096
    s_waitcnt vmcnt(14)
    buffer_load_dwordx4 v12, s[8:11], s35 offen offset:0 nt lds
    s_waitcnt vmcnt(14)
    buffer_load_dwordx4 v13, s[8:11], s35 offen offset:1024 nt lds
    s_waitcnt vmcnt(14)
    buffer_load_dwordx4 v14, s[8:11], s35 offen offset:2048 nt lds
    v_subrev_u32 v27, 1, v23
    ds_write_b32 v22, v27
    s_waitcnt vmcnt(14)
    buffer_load_dwordx4 v15, s[8:11], s35 offen offset:3072 nt lds
    v_add_u32 v23, 1, v23
    s_add_u32 s75, s75, 1
    s_add_u32 s38, s38, 1
    s_add_u32 s37, s37, 32768
    s_add_u32 s83, s39, 2
    s_lshl_b32 s84, s83, 13
    s_and_b32 s84, s84, 16384
    s_add_u32 s84, s84, 8192
    s_cmp_eq_u32 s38, 3
    s_cselect_b32 s38, 0, s38
    s_cselect_b32 s39, s83, s39
    s_cselect_b32 s37, s84, s37
    s_cmp_lt_u32 s36, s77
    s_cbranch_scc1 L_lp2_62
L_tl_62:
    v_readlane_b32 s34, v20, s75
    v_readlane_b32 s35, v21, s75
L_chv_62:
    s_waitcnt lgkmcnt(0)
    v_readlane_b32 s84, v25, s38
    ds_read_b32 v25, v24
    s_cmp_lt_u32 s39, 4
    s_cselect_b32 s84, s39, s84
    s_cmp_lt_u32 s84, s39
    s_cbranch_scc1 L_chv_62
    s_add_u32 m0, s37, 0
    s_waitcnt vmcnt(15)
    buffer_load_dwordx4 v12, s[8:11], s34 offen offset:0 nt lds
    s_waitcnt vmcnt(15)
    buffer_load_dwordx4 v13, s[8:11], s34 offen offset:1024 nt lds
    s_waitcnt vmcnt(15)
    buffer_load_dwordx4 v14, s[8:11], s34 offen offset:2048 nt lds
    s_waitcnt vmcnt(15)
    buffer_load_dwordx4 v15, s[8:11], s34 offen offset:3072 nt lds
    s_add_u32 m0, s37, 4096
    s_waitcnt vmcnt(15)
    buffer_load_dwordx4 v12, s[8:11], s35 offen offset:0 nt lds
    s_waitcnt vmcnt(15)
    buffer_load_dwordx4 v13, s[8:11], s35 offen offset:1024 nt lds
    s_waitcnt vmcnt(15)
    buffer_load_dwordx4 v14, s[8:11], s35 offen offset:2048 nt lds
    s_waitcnt vmcnt(15)
    buffer_load_dwordx4 v15, s[8:11], s35 offen offset:3072 nt lds
    v_subrev_u32 v27, 1, v23
    ds_write_b32 v22, v27
    v_add_u32 v23, 1, v23
    s_add_u32 s75, s75, 1
    s_add_u32 s38, s38, 1
    s_add_u32 s37, s37, 32768
    s_add_u32 s83, s39, 2
    s_lshl_b32 s84, s83, 13
    s_and_b32 s84, s84, 16384
    s_add_u32 s84, s84, 8192
    s_cmp_eq_u32 s38, 3
    s_cselect_b32 s38, 0, s38
    s_cselect_b32 s39, s83, s39
    s_cselect_b32 s37, s84, s37
    s_cmp_lt_u32 s75, s77
    s_cbranch_scc1 L_tl_62
    s_waitcnt vmcnt(8)
    v_subrev_u32 v27, 1, v23
    ds_write_b32 v22, v27
    s_waitcnt vmcnt(0)
    ds_write_b32 v22, v23
    s_branch L_ldone
L_var_63:
    s_cmp_ge_u32 s36, s68
    s_cbranch_scc1 L_lp_63
L_pk_63:
    v_readlane_b32 s80, v20, s36
    v_readlane_b32 s81, v21, s36
    s_nop 2
    s_add_u32 m0, s74, 0
    s_waitcnt vmcnt(15)
    buffer_load_dwordx4 v8, s[4:7], s80 offen offset:0 nt lds
    s_waitcnt vmcnt(15)
    buffer_load_dwordx4 v9, s[4:7], s80 offen offset:1024 nt lds
    s_waitcnt vmcnt(15)
    buffer_load_dwordx4 v10, s[4:7], s80 offen offset:2048 nt lds
    s_waitcnt vmcnt(15)
    buffer_load_dwordx4 v11, s[4:7], s80 offen offset:3072 nt lds
    s_add_u32 m0, s74, 4096
    s_waitcnt vmcnt(15)
    buffer_load_dwordx4 v8, s[4:7], s81 offen offset:0 nt lds
    s_waitcnt vmcnt(15)
    buffer_load_dwordx4 v9, s[4:7], s81 offen offset:1024 nt lds
    s_waitcnt vmcnt(15)
    buffer_load_dwordx4 v10, s[4:7], s81 offen offset:2048 nt lds
    s_waitcnt vmcnt(15)
    buffer_load_dwordx4 v11, s[4:7], s81 offen offset:3072 nt lds
    v_subrev_u32 v27, 1, v23
    ds_write_b32 v22, v27
    v_add_u32 v23, 1, v23
    s_add_u32 s36, s36, 1
    s_add_u32 s87, s87, 1
    s_add_u32 s74, s74, 32768
    s_add_u32 s83, s70, 2
    s_lshl_b32 s84, s83, 13
    s_and_b32 s84, s84, 16384
    s_cmp_eq_u32 s87, 3
    s_cselect_b32 s87, 0, s87
    s_cselect_b32 s70, s83, s70
    s_cselect_b32 s74, s84, s74
    s_cmp_lt_u32 s36, s68
    s_cbranch_scc1 L_pk_63
L_lp_63:
    s_cmp_ge_u32 s36, s77
    s_cbranch_scc1 L_tl_63
L_lp2_63:
    v_readlane_b32 s34, v20, s75
    v_readlane_b32 s35, v21, s75
    v_readlane_b32 s80, v20, s36
    v_readlane_b32 s81, v21, s36
L_chk_63:
    s_waitcnt lgkmcnt(0)
    v_readlane_b32 s83, v25, s87
    v_readlane_b32 s84, v25, s38
    ds_read_b32 v25, v24
    s_cmp_lt_u32 s39, 4
    s_cselect_b32 s84, s39, s84
    s_cmp_lt_u32 s84, s39
    s_cbranch_scc1 L_chk_63
    s_add_u32 s83, s83, 3
    s_cmp_lt_u32 s83, s70
    s_cbranch_scc1 L_chk_63
    s_add_u32 m0, s74, 0
    s_waitcnt vmcnt(15)
    buffer_load_dwordx4 v8, s[4:7], s80 offen offset:0 nt lds
    s_waitcnt vmcnt(15)
    buffer_load_dwordx4 v9, s[4:7], s80 offen offset:1024 nt lds
    s_waitcnt vmcnt(15)
    buffer_load_dwordx4 v10, s[4:7], s80 offen offset:2048 nt lds
    s_waitcnt vmcnt(15)
    buffer_load_dwordx4 v11, s[4:7], s80 offen offset:3072 nt lds
    s_add_u32 m0, s74, 4096
    s_waitcnt vmcnt(15)
    buffer_load_dwordx4 v8, s[4:7], s81 offen offset:0 nt lds
    s_waitcnt vmcnt(15)
    buffer_load_dwordx4 v9, s[4:7], s81 offen offset:1024 nt lds
    s_waitcnt vmcnt(15)
    buffer_load_dwordx4 v10, s[4:7], s81 offen offset:2048 nt lds
    s_waitcnt vmcnt(15)
    buffer_load_dwordx4 v11, s[4:7], s81 offen offset:3072 nt lds
    v_subrev_u32 v27, 1, v23
    ds_write_b32 v22, v27
    v_add_u32 v23, 1, v23
    s_add_u32 s36, s36, 1
    s_add_u32 s87, s87, 1
    s_add_u32 s74, s74, 32768
    s_add_u32 s83, s70, 2
    s_lshl_b32 s84, s83, 13
    s_and_b32 s84, s84, 16384
    s_cmp_eq_u32 s87, 3
    s_cselect_b32 s87, 0, s87
    s_cselect_b32 s70, s83, s70
    s_cselect_b32 s74, s84, s74
    s_add_u32 m0, s37, 0
    s_waitcnt vmcnt(15)
    buffer_load_dwordx4 v12, s[8:11], s34 offen offset:0 nt lds
    s_waitcnt vmcnt(15)
    buffer_load_dwordx4 v13, s[8:11], s34 offen offset:1024 nt lds
    s_waitcnt vmcnt(15)
    buffer_load_dwordx4 v14, s[8:11], s34 offen offset:2048 nt lds
    s_waitcnt vmcnt(15)
    buffer_load_dwordx4 v15, s[8:11], s34 offen offset:3072 nt lds
    s_add_u32 m0, s37, 4096
    s_waitcnt vmcnt(14)
    buffer_load_dwordx4 v12, s[8:11], s35 offen offset:0 nt lds
    s_waitcnt vmcnt(14)
    buffer_load_dwordx4 v13, s[8:11], s35 offen offset:1024 nt lds
    s_waitcnt vmcnt(14)
    buffer_load_dwordx4 v14, s[8:11], s35 offen offset:2048 nt lds
    v_subrev_u32 v27, 1, v23
    ds_write_b32 v22, v27
    s_waitcnt vmcnt(14)
    buffer_load_dwordx4 v15, s[8:11], s35 offen offset:3072 nt lds
    v_add_u32 v23, 1, v23
    s_add_u32 s75, s75, 1
    s_add_u32 s38, s38, 1
    s_add_u32 s37, s37, 32768
    s_add_u32 s83, s39, 2
    s_lshl_b32 s84, s83, 13
    s_and_b32 s84, s84, 16384
    s_add_u32 s84, s84, 8192
    s_cmp_eq_u32 s38, 3
    s_cselect_b32 s38, 0, s38
    s_cselect_b32 s39, s83, s39
    s_cselect_b32 s37, s84, s37
    s_cmp_lt_u32 s36, s77
    s_cbranch_scc1 L_lp2_63
L_tl_63:
    v_readlane_b32 s34, v20, s75
    v_readlane_b32 s35, v21, s75
L_chv_63:
    s_waitcnt lgkmcnt(0)
    v_readlane_b32 s84, v25, s38
    ds_read_b32 v25, v24
    s_cmp_lt_u32 s39, 4
    s_cselect_b32 s84, s39, s84
    s_cmp_lt_u32 s84, s39
    s_cbranch_scc1 L_chv_63
    s_add_u32 m0, s37, 0
    s_waitcnt vmcnt(15)
    buffer_load_dwordx4 v12, s[8:11], s34 offen offset:0 nt lds
    s_waitcnt vmcnt(15)
    buffer_load_dwordx4 v13, s[8:11], s34 offen offset:1024 nt lds
    s_waitcnt vmcnt(15)
    buffer_load_dwordx4 v14, s[8:11], s34 offen offset:2048 nt lds
    s_waitcnt vmcnt(15)
    buffer_load_dwordx4 v15, s[8:11], s34 offen offset:3072 nt lds
    s_add_u32 m0, s37, 4096
    s_waitcnt vmcnt(15)
    buffer_load_dwordx4 v12, s[8:11], s35 offen offset:0 nt lds
    s_waitcnt vmcnt(15)
    buffer_load_dwordx4 v13, s[8:11], s35 offen offset:1024 nt lds
    s_waitcnt vmcnt(15)
    buffer_load_dwordx4 v14, s[8:11], s35 offen offset:2048 nt lds
    s_waitcnt vmcnt(15)
    buffer_load_dwordx4 v15, s[8:11], s35 offen offset:3072 nt lds
    v_subrev_u32 v27, 1, v23
    ds_write_b32 v22, v27
    v_add_u32 v23, 1, v23
    s_add_u32 s75, s75, 1
    s_add_u32 s38, s38, 1
    s_add_u32 s37, s37, 32768
    s_add_u32 s83, s39, 2
    s_lshl_b32 s84, s83, 13
    s_and_b32 s84, s84, 16384
    s_add_u32 s84, s84, 8192
    s_cmp_eq_u32 s38, 3
    s_cselect_b32 s38, 0, s38
    s_cselect_b32 s39, s83, s39
    s_cselect_b32 s37, s84, s37
    s_cmp_lt_u32 s75, s77
    s_cbranch_scc1 L_tl_63
    s_waitcnt vmcnt(8)
    v_subrev_u32 v27, 1, v23
    ds_write_b32 v22, v27
    s_waitcnt vmcnt(0)
    ds_write_b32 v22, v23
    s_branch L_ldone
L_var_64:
    s_cmp_ge_u32 s36, s68
    s_cbranch_scc1 L_lp_64
L_pk_64:
    v_readlane_b32 s80, v20, s36
    v_readlane_b32 s81, v21, s36
    s_nop 2
    s_add_u32 m0, s74, 0
    s_waitcnt vmcnt(15)
    buffer_load_dwordx4 v8, s[4:7], s80 offen offset:0 nt lds
    s_waitcnt vmcnt(15)
    buffer_load_dwordx4 v9, s[4:7], s80 offen offset:1024 nt lds
    s_waitcnt vmcnt(15)
    buffer_load_dwordx4 v10, s[4:7], s80 offen offset:2048 nt lds
    s_waitcnt vmcnt(15)
    buffer_load_dwordx4 v11, s[4:7], s80 offen offset:3072 nt lds
    s_add_u32 m0, s74, 4096
    s_waitcnt vmcnt(15)
    buffer_load_dwordx4 v8, s[4:7], s81 offen offset:0 nt lds
    s_waitcnt vmcnt(15)
    buffer_load_dwordx4 v9, s[4:7], s81 offen offset:1024 nt lds
    s_waitcnt vmcnt(15)
    buffer_load_dwordx4 v10, s[4:7], s81 offen offset:2048 nt lds
    s_waitcnt vmcnt(15)
    buffer_load_dwordx4 v11, s[4:7], s81 offen offset:3072 nt lds
    v_subrev_u32 v27, 1, v23
    ds_write_b32 v22, v27
    v_add_u32 v23, 1, v23
    s_add_u32 s36, s36, 1
    s_add_u32 s87, s87, 1
    s_add_u32 s74, s74, 32768
    s_add_u32 s83, s70, 2
    s_lshl_b32 s84, s83, 13
    s_and_b32 s84, s84, 16384
    s_cmp_eq_u32 s87, 3
    s_cselect_b32 s87, 0, s87
    s_cselect_b32 s70, s83, s70
    s_cselect_b32 s74, s84, s74
    s_cmp_lt_u32 s36, s68
    s_cbranch_scc1 L_pk_64
L_lp_64:
    s_cmp_ge_u32 s36, s77
    s_cbranch_scc1 L_tl_64
L_lp2_64:
    v_readlane_b32 s34, v20, s75
    v_readlane_b32 s35, v21, s75
    v_readlane_b32 s80, v20, s36
    v_readlane_b32 s81, v21, s36
L_chk_64:
    s_waitcnt lgkmcnt(0)
    v_readlane_b32 s83, v25, s87
    v_readlane_b32 s84, v25, s38
    ds_read_b32 v25, v24
    s_cmp_lt_u32 s39, 4
    s_cselect_b32 s84, s39, s84
    s_cmp_lt_u32 s84, s39
    s_cbranch_scc1 L_chk_64
    s_add_u32 s83, s83, 3
    s_cmp_lt_u32 s83, s70
    s_cbranch_scc1 L_chk_64
    s_add_u32 m0, s74, 0
    s_waitcnt vmcnt(15)
    buffer_load_dwordx4 v8, s[4:7], s80 offen offset:0 nt lds
    s_waitcnt vmcnt(15)
    buffer_load_dwordx4 v9, s[4:7], s80 offen offset:1024 nt lds
    s_waitcnt vmcnt(15)
    buffer_load_dwordx4 v10, s[4:7], s80 offen offset:2048 nt lds
    s_waitcnt vmcnt(15)
    buffer_load_dwordx4 v11, s[4:7], s80 offen offset:3072 nt lds
    s_add_u32 m0, s74, 4096
    s_waitcnt vmcnt(15)
    buffer_load_dwordx4 v8, s[4:7], s81 offen offset:0 nt lds
    s_waitcnt vmcnt(15)
    buffer_load_dwordx4 v9, s[4:7], s81 offen offset:1024 nt lds
    s_waitcnt vmcnt(15)
    buffer_load_dwordx4 v10, s[4:7], s81 offen offset:2048 nt lds
    s_waitcnt vmcnt(15)
    buffer_load_dwordx4 v11, s[4:7], s81 offen offset:3072 nt lds
    v_subrev_u32 v27, 1, v23
    ds_write_b32 v22, v27
    v_add_u32 v23, 1, v23
    s_add_u32 s36, s36, 1
    s_add_u32 s87, s87, 1
    s_add_u32 s74, s74, 32768
    s_add_u32 s83, s70, 2
    s_lshl_b32 s84, s83, 13
    s_and_b32 s84, s84, 16384
    s_cmp_eq_u32 s87, 3
    s_cselect_b32 s87, 0, s87
    s_cselect_b32 s70, s83, s70
    s_cselect_b32 s74, s84, s74
    s_add_u32 m0, s37, 0
    s_waitcnt vmcnt(15)
    buffer_load_dwordx4 v12, s[8:11], s34 offen offset:0 nt lds
    s_waitcnt vmcnt(15)
    buffer_load_dwordx4 v13, s[8:11], s34 offen offset:1024 nt lds
    s_waitcnt vmcnt(15)
    buffer_load_dwordx4 v14, s[8:11], s34 offen offset:2048 nt lds
    s_waitcnt vmcnt(15)
    buffer_load_dwordx4 v15, s[8:11], s34 offen offset:3072 nt lds
    s_add_u32 m0, s37, 4096
    s_waitcnt vmcnt(15)
    buffer_load_dwordx4 v12, s[8:11], s35 offen offset:0 nt lds
    s_waitcnt vmcnt(15)
    buffer_load_dwordx4 v13, s[8:11], s35 offen offset:1024 nt lds
    s_waitcnt vmcnt(15)
    buffer_load_dwordx4 v14, s[8:11], s35 offen offset:2048 nt lds
    s_waitcnt vmcnt(15)
    buffer_load_dwordx4 v15, s[8:11], s35 offen offset:3072 nt lds
    v_subrev_u32 v27, 1, v23
    ds_write_b32 v22, v27
    v_add_u32 v23, 1, v23
    s_add_u32 s75, s75, 1
    s_add_u32 s38, s38, 1
    s_add_u32 s37, s37, 32768
    s_add_u32 s83, s39, 2
    s_lshl_b32 s84, s83, 13
    s_and_b32 s84, s84, 16384
    s_add_u32 s84, s84, 8192
    s_cmp_eq_u32 s38, 3
    s_cselect_b32 s38, 0, s38
    s_cselect_b32 s39, s83, s39
    s_cselect_b32 s37, s84, s37
    s_cmp_lt_u32 s36, s77
    s_cbranch_scc1 L_lp2_64
L_tl_64:
    v_readlane_b32 s34, v20, s75
    v_readlane_b32 s35, v21, s75
L_chv_64:
    s_waitcnt lgkmcnt(0)
    v_readlane_b32 s84, v25, s38
    ds_read_b32 v25, v24
    s_cmp_lt_u32 s39, 4
    s_cselect_b32 s84, s39, s84
    s_cmp_lt_u32 s84, s39
    s_cbranch_scc1 L_chv_64
    s_add_u32 m0, s37, 0
    s_waitcnt vmcnt(15)
    buffer_load_dwordx4 v12, s[8:11], s34 offen offset:0 nt lds
    s_waitcnt vmcnt(15)
    buffer_load_dwordx4 v13, s[8:11], s34 offen offset:1024 nt lds
    s_waitcnt vmcnt(15)
    buffer_load_dwordx4 v14, s[8:11], s34 offen offset:2048 nt lds
    s_waitcnt vmcnt(15)
    buffer_load_dwordx4 v15, s[8:11], s34 offen offset:3072 nt lds
    s_add_u32 m0, s37, 4096
    s_waitcnt vmcnt(15)
    buffer_load_dwordx4 v12, s[8:11], s35 offen offset:0 nt lds
    s_waitcnt vmcnt(15)
    buffer_load_dwordx4 v13, s[8:11], s35 offen offset:1024 nt lds
    s_waitcnt vmcnt(15)
    buffer_load_dwordx4 v14, s[8:11], s35 offen offset:2048 nt lds
    s_waitcnt vmcnt(15)
    buffer_load_dwordx4 v15, s[8:11], s35 offen offset:3072 nt lds
    v_subrev_u32 v27, 1, v23
    ds_write_b32 v22, v27
    v_add_u32 v23, 1, v23
    s_add_u32 s75, s75, 1
    s_add_u32 s38, s38, 1
    s_add_u32 s37, s37, 32768
    s_add_u32 s83, s39, 2
    s_lshl_b32 s84, s83, 13
    s_and_b32 s84, s84, 16384
    s_add_u32 s84, s84, 8192
    s_cmp_eq_u32 s38, 3
    s_cselect_b32 s38, 0, s38
    s_cselect_b32 s39, s83, s39
    s_cselect_b32 s37, s84, s37
    s_cmp_lt_u32 s75, s77
    s_cbranch_scc1 L_tl_64
    s_waitcnt vmcnt(8)
    v_subrev_u32 v27, 1, v23
    ds_write_b32 v22, v27
    s_waitcnt vmcnt(0)
    ds_write_b32 v22, v23
    s_branch L_ldone
L_var_65:
    s_cmp_ge_u32 s36, s68
    s_cbranch_scc1 L_lp_65
L_pk_65:
    v_readlane_b32 s80, v20, s36
    v_readlane_b32 s81, v21, s36
    s_nop 2
    s_add_u32 m0, s74, 0
    s_waitcnt vmcnt(16)
    buffer_load_dwordx4 v8, s[4:7], s80 offen offset:0 nt lds
    s_waitcnt vmcnt(16)
    buffer_load_dwordx4 v9, s[4:7], s80 offen offset:1024 nt lds
    s_waitcnt vmcnt(16)
    buffer_load_dwordx4 v10, s[4:7], s80 offen offset:2048 nt lds
    s_waitcnt vmcnt(16)
    buffer_load_dwordx4 v11, s[4:7], s80 offen offset:3072 nt lds
    s_add_u32 m0, s74, 4096
    s_waitcnt vmcnt(15)
    buffer_load_dwordx4 v8, s[4:7], s81 offen offset:0 nt lds
    s_waitcnt vmcnt(15)
    buffer_load_dwordx4 v9, s[4:7], s81 offen offset:1024 nt lds
    s_waitcnt vmcnt(15)
    buffer_load_dwordx4 v10, s[4:7], s81 offen offset:2048 nt lds
    s_waitcnt vmcnt(15)
    buffer_load_dwordx4 v11, s[4:7], s81 offen offset:3072 nt lds
    v_subrev_u32 v27, 1, v23
    ds_write_b32 v22, v27
    v_add_u32 v23, 1, v23
    s_add_u32 s36, s36, 1
    s_add_u32 s87, s87, 1
    s_add_u32 s74, s74, 32768
    s_add_u32 s83, s70, 2
    s_lshl_b32 s84, s83, 13
    s_and_b32 s84, s84, 16384
    s_cmp_eq_u32 s87, 3
    s_cselect_b32 s87, 0, s87
    s_cselect_b32 s70, s83, s70
    s_cselect_b32 s74, s84, s74
    s_cmp_lt_u32 s36, s68
    s_cbranch_scc1 L_pk_65
L_lp_65:
    s_cmp_ge_u32 s36, s77
    s_cbranch_scc1 L_tl_65
L_lp2_65:
    v_readlane_b32 s34, v20, s75
    v_readlane_b32 s35, v21, s75
    v_readlane_b32 s80, v20, s36
    v_readlane_b32 s81, v21, s36
L_chk_65:
    s_waitcnt lgkmcnt(0)
    v_readlane_b32 s83, v25, s87
    v_readlane_b32 s84, v25, s38
    ds_read_b32 v25, v24
    s_cmp_lt_u32 s39, 4
    s_cselect_b32 s84, s39, s84
    s_cmp_lt_u32 s84, s39
    s_cbranch_scc1 L_chk_65
    s_add_u32 s83, s83, 3
    s_cmp_lt_u32 s83, s70
    s_cbranch_scc1 L_chk_65
    s_add_u32 m0, s74, 0
    s_waitcnt vmcnt(16)
    buffer_load_dwordx4 v8, s[4:7], s80 offen offset:0 nt lds
    s_waitcnt vmcnt(16)
    buffer_load_dwordx4 v9, s[4:7], s80 offen offset:1024 nt lds
    s_waitcnt vmcnt(16)
    buffer_load_dwordx4 v10, s[4:7], s80 offen offset:2048 nt lds
    s_waitcnt vmcnt(16)
    buffer_load_dwordx4 v11, s[4:7], s80 offen offset:3072 nt lds
    s_add_u32 m0, s74, 4096
    s_waitcnt vmcnt(15)
    buffer_load_dwordx4 v8, s[4:7], s81 offen offset:0 nt lds
    s_waitcnt vmcnt(15)
    buffer_load_dwordx4 v9, s[4:7], s81 offen offset:1024 nt lds
    s_waitcnt vmcnt(15)
    buffer_load_dwordx4 v10, s[4:7], s81 offen offset:2048 nt lds
    s_waitcnt vmcnt(15)
    buffer_load_dwordx4 v11, s[4:7], s81 offen offset:3072 nt lds
    v_subrev_u32 v27, 1, v23
    ds_write_b32 v22, v27
    v_add_u32 v23, 1, v23
    s_add_u32 s36, s36, 1
    s_add_u32 s87, s87, 1
    s_add_u32 s74, s74, 32768
    s_add_u32 s83, s70, 2
    s_lshl_b32 s84, s83, 13
    s_and_b32 s84, s84, 16384
    s_cmp_eq_u32 s87, 3
    s_cselect_b32 s87, 0, s87
    s_cselect_b32 s70, s83, s70
    s_cselect_b32 s74, s84, s74
    s_add_u32 m0, s37, 0
    s_waitcnt vmcnt(15)
    buffer_load_dwordx4 v12, s[8:11], s34 offen offset:0 nt lds
    s_waitcnt vmcnt(15)
    buffer_load_dwordx4 v13, s[8:11], s34 offen offset:1024 nt lds
    s_waitcnt vmcnt(15)
    buffer_load_dwordx4 v14, s[8:11], s34 offen offset:2048 nt lds
    s_waitcnt vmcnt(15)
    buffer_load_dwordx4 v15, s[8:11], s34 offen offset:3072 nt lds
    s_add_u32 m0, s37, 4096
    s_waitcnt vmcnt(15)
    buffer_load_dwordx4 v12, s[8:11], s35 offen offset:0 nt lds
    s_waitcnt vmcnt(15)
    buffer_load_dwordx4 v13, s[8:11], s35 offen offset:1024 nt lds
    s_waitcnt vmcnt(15)
    buffer_load_dwordx4 v14, s[8:11], s35 offen offset:2048 nt lds
    s_waitcnt vmcnt(15)
    buffer_load_dwordx4 v15, s[8:11], s35 offen offset:3072 nt lds
    v_subrev_u32 v27, 1, v23
    ds_write_b32 v22, v27
    v_add_u32 v23, 1, v23
    s_add_u32 s75, s75, 1
    s_add_u32 s38, s38, 1
    s_add_u32 s37, s37, 32768
    s_add_u32 s83, s39, 2
    s_lshl_b32 s84, s83, 13
    s_and_b32 s84, s84, 16384
    s_add_u32 s84, s84, 8192
    s_cmp_eq_u32 s38, 3
    s_cselect_b32 s38, 0, s38
    s_cselect_b32 s39, s83, s39
    s_cselect_b32 s37, s84, s37
    s_cmp_lt_u32 s36, s77
    s_cbranch_scc1 L_lp2_65
L_tl_65:
    v_readlane_b32 s34, v20, s75
    v_readlane_b32 s35, v21, s75
L_chv_65:
    s_waitcnt lgkmcnt(0)
    v_readlane_b32 s84, v25, s38
    ds_read_b32 v25, v24
    s_cmp_lt_u32 s39, 4
    s_cselect_b32 s84, s39, s84
    s_cmp_lt_u32 s84, s39
    s_cbranch_scc1 L_chv_65
    s_add_u32 m0, s37, 0
    s_waitcnt vmcnt(15)
    buffer_load_dwordx4 v12, s[8:11], s34 offen offset:0 nt lds
    s_waitcnt vmcnt(15)
    buffer_load_dwordx4 v13, s[8:11], s34 offen offset:1024 nt lds
    s_waitcnt vmcnt(15)
    buffer_load_dwordx4 v14, s[8:11], s34 offen offset:2048 nt lds
    s_waitcnt vmcnt(15)
    buffer_load_dwordx4 v15, s[8:11], s34 offen offset:3072 nt lds
    s_add_u32 m0, s37, 4096
    s_waitcnt vmcnt(15)
    buffer_load_dwordx4 v12, s[8:11], s35 offen offset:0 nt lds
    s_waitcnt vmcnt(15)
    buffer_load_dwordx4 v13, s[8:11], s35 offen offset:1024 nt lds
    s_waitcnt vmcnt(15)
    buffer_load_dwordx4 v14, s[8:11], s35 offen offset:2048 nt lds
    s_waitcnt vmcnt(15)
    buffer_load_dwordx4 v15, s[8:11], s35 offen offset:3072 nt lds
    v_subrev_u32 v27, 1, v23
    ds_write_b32 v22, v27
    v_add_u32 v23, 1, v23
    s_add_u32 s75, s75, 1
    s_add_u32 s38, s38, 1
    s_add_u32 s37, s37, 32768
    s_add_u32 s83, s39, 2
    s_lshl_b32 s84, s83, 13
    s_and_b32 s84, s84, 16384
    s_add_u32 s84, s84, 8192
    s_cmp_eq_u32 s38, 3
    s_cselect_b32 s38, 0, s38
    s_cselect_b32 s39, s83, s39
    s_cselect_b32 s37, s84, s37
    s_cmp_lt_u32 s75, s77
    s_cbranch_scc1 L_tl_65
    s_waitcnt vmcnt(8)
    v_subrev_u32 v27, 1, v23
    ds_write_b32 v22, v27
    s_waitcnt vmcnt(0)
    ds_write_b32 v22, v23
    s_branch L_ldone
L_var_66:
    s_cmp_ge_u32 s36, s68
    s_cbranch_scc1 L_lp_66
L_pk_66:
    v_readlane_b32 s80, v20, s36
    v_readlane_b32 s81, v21, s36
    s_nop 2
    s_add_u32 m0, s74, 0
    s_waitcnt vmcnt(16)
    buffer_load_dwordx4 v8, s[4:7], s80 offen offset:0 nt lds
    v_subrev_u32 v27, 2, v23
    ds_write_b32 v22, v27
    s_waitcnt vmcnt(16)
    buffer_load_dwordx4 v9, s[4:7], s80 offen offset:1024 nt lds
    s_waitcnt vmcnt(16)
    buffer_load_dwordx4 v10, s[4:7], s80 offen offset:2048 nt lds
    s_waitcnt vmcnt(16)
    buffer_load_dwordx4 v11, s[4:7], s80 offen offset:3072 nt lds
    s_add_u32 m0, s74, 4096
    s_waitcnt vmcnt(16)
    buffer_load_dwordx4 v8, s[4:7], s81 offen offset:0 nt lds
    s_waitcnt vmcnt(16)
    buffer_load_dwordx4 v9, s[4:7], s81 offen offset:1024 nt lds
    s_waitcnt vmcnt(16)
    buffer_load_dwordx4 v10, s[4:7], s81 offen offset:2048 nt lds
    s_waitcnt vmcnt(16)
    buffer_load_dwordx4 v11, s[4:7], s81 offen offset:3072 nt lds
    v_add_u32 v23, 1, v23
    s_add_u32 s36, s36, 1
    s_add_u32 s87, s87, 1
    s_add_u32 s74, s74, 32768
    s_add_u32 s83, s70, 2
    s_lshl_b32 s84, s83, 13
    s_and_b32 s84, s84, 16384
    s_cmp_eq_u32 s87, 3
    s_cselect_b32 s87, 0, s87
    s_cselect_b32 s70, s83, s70
    s_cselect_b32 s74, s84, s74
    s_cmp_lt_u32 s36, s68
    s_cbranch_scc1 L_pk_66
L_lp_66:
    s_cmp_ge_u32 s36, s77
    s_cbranch_scc1 L_tl_66
L_lp2_66:
    v_readlane_b32 s34, v20, s75
    v_readlane_b32 s35, v21, s75
    v_readlane_b32 s80, v20, s36
    v_readlane_b32 s81, v21, s36
L_chk_66:
    s_waitcnt lgkmcnt(0)
    v_readlane_b32 s83, v25, s87
    v_readlane_b32 s84, v25, s38
    ds_read_b32 v25, v24
    s_cmp_lt_u32 s39, 4
    s_cselect_b32 s84, s39, s84
    s_cmp_lt_u32 s84, s39
    s_cbranch_scc1 L_chk_66
    s_add_u32 s83, s83, 3
    s_cmp_lt_u32 s83, s70
    s_cbranch_scc1 L_chk_66
    s_add_u32 m0, s74, 0
    s_waitcnt vmcnt(16)
    buffer_load_dwordx4 v8, s[4:7], s80 offen offset:0 nt lds
    v_subrev_u32 v27, 2, v23
    ds_write_b32 v22, v27
    s_waitcnt vmcnt(16)
    buffer_load_dwordx4 v9, s[4:7], s80 offen offset:1024 nt lds
    s_waitcnt vmcnt(16)
    buffer_load_dwordx4 v10, s[4:7], s80 offen offset:2048 nt lds
    s_waitcnt vmcnt(16)
    buffer_load_dwordx4 v11, s[4:7], s80 offen offset:3072 nt lds
    s_add_u32 m0, s74, 4096
    s_waitcnt vmcnt(16)
    buffer_load_dwordx4 v8, s[4:7], s81 offen offset:0 nt lds
    s_waitcnt vmcnt(16)
    buffer_load_dwordx4 v9, s[4:7], s81 offen offset:1024 nt lds
    s_waitcnt vmcnt(16)
    buffer_load_dwordx4 v10, s[4:7], s81 offen offset:2048 nt lds
    s_waitcnt vmcnt(16)
    buffer_load_dwordx4 v11, s[4:7], s81 offen offset:3072 nt lds
    v_add_u32 v23, 1, v23
    s_add_u32 s36, s36, 1
    s_add_u32 s87, s87, 1
    s_add_u32 s74, s74, 32768
    s_add_u32 s83, s70, 2
    s_lshl_b32 s84, s83, 13
    s_and_b32 s84, s84, 16384
    s_cmp_eq_u32 s87, 3
    s_cselect_b32 s87, 0, s87
    s_cselect_b32 s70, s83, s70
    s_cselect_b32 s74, s84, s74
    s_add_u32 m0, s37, 0
    s_waitcnt vmcnt(15)
    buffer_load_dwordx4 v12, s[8:11], s34 offen offset:0 nt lds
    s_waitcnt vmcnt(15)
    buffer_load_dwordx4 v13, s[8:11], s34 offen offset:1024 nt lds
    s_waitcnt vmcnt(15)
    buffer_load_dwordx4 v14, s[8:11], s34 offen offset:2048 nt lds
    s_waitcnt vmcnt(15)
    buffer_load_dwordx4 v15, s[8:11], s34 offen offset:3072 nt lds
    s_add_u32 m0, s37, 4096
    s_waitcnt vmcnt(15)
    buffer_load_dwordx4 v12, s[8:11], s35 offen offset:0 nt lds
    s_waitcnt vmcnt(15)
    buffer_load_dwordx4 v13, s[8:11], s35 offen offset:1024 nt lds
    s_waitcnt vmcnt(15)
    buffer_load_dwordx4 v14, s[8:11], s35 offen offset:2048 nt lds
    s_waitcnt vmcnt(15)
    buffer_load_dwordx4 v15, s[8:11], s35 offen offset:3072 nt lds
    v_subrev_u32 v27, 1, v23
    ds_write_b32 v22, v27
    v_add_u32 v23, 1, v23
    s_add_u32 s75, s75, 1
    s_add_u32 s38, s38, 1
    s_add_u32 s37, s37, 32768
    s_add_u32 s83, s39, 2
    s_lshl_b32 s84, s83, 13
    s_and_b32 s84, s84, 16384
    s_add_u32 s84, s84, 8192
    s_cmp_eq_u32 s38, 3
    s_cselect_b32 s38, 0, s38
    s_cselect_b32 s39, s83, s39
    s_cselect_b32 s37, s84, s37
    s_cmp_lt_u32 s36, s77
    s_cbranch_scc1 L_lp2_66
L_tl_66:
    v_readlane_b32 s34, v20, s75
    v_readlane_b32 s35, v21, s75
L_chv_66:
    s_waitcnt lgkmcnt(0)
    v_readlane_b32 s84, v25, s38
    ds_read_b32 v25, v24
    s_cmp_lt_u32 s39, 4
    s_cselect_b32 s84, s39, s84
    s_cmp_lt_u32 s84, s39
    s_cbranch_scc1 L_chv_66
    s_add_u32 m0, s37, 0
    s_waitcnt vmcnt(15)
    buffer_load_dwordx4 v12, s[8:11], s34 offen offset:0 nt lds
    s_waitcnt vmcnt(15)
    buffer_load_dwordx4 v13, s[8:11], s34 offen offset:1024 nt lds
    s_waitcnt vmcnt(15)
    buffer_load_dwordx4 v14, s[8:11], s34 offen offset:2048 nt lds
    s_waitcnt vmcnt(15)
    buffer_load_dwordx4 v15, s[8:11], s34 offen offset:3072 nt lds
    s_add_u32 m0, s37, 4096
    s_waitcnt vmcnt(15)
    buffer_load_dwordx4 v12, s[8:11], s35 offen offset:0 nt lds
    s_waitcnt vmcnt(15)
    buffer_load_dwordx4 v13, s[8:11], s35 offen offset:1024 nt lds
    s_waitcnt vmcnt(15)
    buffer_load_dwordx4 v14, s[8:11], s35 offen offset:2048 nt lds
    s_waitcnt vmcnt(15)
    buffer_load_dwordx4 v15, s[8:11], s35 offen offset:3072 nt lds
    v_subrev_u32 v27, 1, v23
    ds_write_b32 v22, v27
    v_add_u32 v23, 1, v23
    s_add_u32 s75, s75, 1
    s_add_u32 s38, s38, 1
    s_add_u32 s37, s37, 32768
    s_add_u32 s83, s39, 2
    s_lshl_b32 s84, s83, 13
    s_and_b32 s84, s84, 16384
    s_add_u32 s84, s84, 8192
    s_cmp_eq_u32 s38, 3
    s_cselect_b32 s38, 0, s38
    s_cselect_b32 s39, s83, s39
    s_cselect_b32 s37, s84, s37
    s_cmp_lt_u32 s75, s77
    s_cbranch_scc1 L_tl_66
    s_waitcnt vmcnt(8)
    v_subrev_u32 v27, 1, v23
    ds_write_b32 v22, v27
    s_waitcnt vmcnt(0)
    ds_write_b32 v22, v23
    s_branch L_ldone
L_var_67:
    s_cmp_ge_u32 s36, s68
    s_cbranch_scc1 L_lp_67
L_pk_67:
    v_readlane_b32 s80, v20, s36
    v_readlane_b32 s81, v21, s36
    s_nop 2
    s_add_u32 m0, s74, 0
    s_waitcnt vmcnt(16)
    buffer_load_dwordx4 v8, s[4:7], s80 offen offset:0 nt lds
    v_subrev_u32 v27, 2, v23
    ds_write_b32 v22, v27
    s_waitcnt vmcnt(16)
    buffer_load_dwordx4 v9, s[4:7], s80 offen offset:1024 nt lds
    s_waitcnt vmcnt(16)
    buffer_load_dwordx4 v10, s[4:7], s80 offen offset:2048 nt lds
    s_waitcnt vmcnt(16)
    buffer_load_dwordx4 v11, s[4:7], s80 offen offset:3072 nt lds
    s_add_u32 m0, s74, 4096
    s_waitcnt vmcnt(16)
    buffer_load_dwordx4 v8, s[4:7], s81 offen offset:0 nt lds
    s_waitcnt vmcnt(16)
    buffer_load_dwordx4 v9, s[4:7], s81 offen offset:1024 nt lds
    s_waitcnt vmcnt(16)
    buffer_load_dwordx4 v10, s[4:7], s81 offen offset:2048 nt lds
    s_waitcnt vmcnt(16)
    buffer_load_dwordx4 v11, s[4:7], s81 offen offset:3072 nt lds
    v_add_u32 v23, 1, v23
    s_add_u32 s36, s36, 1
    s_add_u32 s87, s87, 1
    s_add_u32 s74, s74, 32768
    s_add_u32 s83, s70, 2
    s_lshl_b32 s84, s83, 13
    s_and_b32 s84, s84, 16384
    s_cmp_eq_u32 s87, 3
    s_cselect_b32 s87, 0, s87
    s_cselect_b32 s70, s83, s70
    s_cselect_b32 s74, s84, s74
    s_cmp_lt_u32 s36, s68
    s_cbranch_scc1 L_pk_67
L_lp_67:
    s_cmp_ge_u32 s36, s77
    s_cbranch_scc1 L_tl_67
L_lp2_67:
    v_readlane_b32 s34, v20, s75
    v_readlane_b32 s35, v21, s75
    v_readlane_b32 s80, v20, s36
    v_readlane_b32 s81, v21, s36
L_chk_67:
    s_waitcnt lgkmcnt(0)
    v_readlane_b32 s83, v25, s87
    v_readlane_b32 s84, v25, s38
    ds_read_b32 v25, v24
    s_cmp_lt_u32 s39, 4
    s_cselect_b32 s84, s39, s84
    s_cmp_lt_u32 s84, s39
    s_cbranch_scc1 L_chk_67
    s_add_u32 s83, s83, 3
    s_cmp_lt_u32 s83, s70
    s_cbranch_scc1 L_chk_67
    s_add_u32 m0, s74, 0
    s_waitcnt vmcnt(16)
    buffer_load_dwordx4 v8, s[4:7], s80 offen offset:0 nt lds
    v_subrev_u32 v27, 2, v23
    ds_write_b32 v22, v27
    s_waitcnt vmcnt(16)
    buffer_load_dwordx4 v9, s[4:7], s80 offen offset:1024 nt lds
    s_waitcnt vmcnt(16)
    buffer_load_dwordx4 v10, s[4:7], s80 offen offset:2048 nt lds
    s_waitcnt vmcnt(16)
    buffer_load_dwordx4 v11, s[4:7], s80 offen offset:3072 nt lds
    s_add_u32 m0, s74, 4096
    s_waitcnt vmcnt(16)
    buffer_load_dwordx4 v8, s[4:7], s81 offen offset:0 nt lds
    s_waitcnt vmcnt(16)
    buffer_load_dwordx4 v9, s[4:7], s81 offen offset:1024 nt lds
    s_waitcnt vmcnt(16)
    buffer_load_dwordx4 v10, s[4:7], s81 offen offset:2048 nt lds
    s_waitcnt vmcnt(16)
    buffer_load_dwordx4 v11, s[4:7], s81 offen offset:3072 nt lds
    v_add_u32 v23, 1, v23
    s_add_u32 s36, s36, 1
    s_add_u32 s87, s87, 1
    s_add_u32 s74, s74, 32768
    s_add_u32 s83, s70, 2
    s_lshl_b32 s84, s83, 13
    s_and_b32 s84, s84, 16384
    s_cmp_eq_u32 s87, 3
    s_cselect_b32 s87, 0, s87
    s_cselect_b32 s70, s83, s70
    s_cselect_b32 s74, s84, s74
    s_add_u32 m0, s37, 0
    s_waitcnt vmcnt(16)
    buffer_load_dwordx4 v12, s[8:11], s34 offen offset:0 nt lds
    s_waitcnt vmcnt(16)
    buffer_load_dwordx4 v13, s[8:11], s34 offen offset:1024 nt lds
    s_waitcnt vmcnt(16)
    buffer_load_dwordx4 v14, s[8:11], s34 offen offset:2048 nt lds
    s_waitcnt vmcnt(16)
    buffer_load_dwordx4 v15, s[8:11], s34 offen offset:3072 nt lds
    s_add_u32 m0, s37, 4096
    s_waitcnt vmcnt(15)
    buffer_load_dwordx4 v12, s[8:11], s35 offen offset:0 nt lds
    s_waitcnt vmcnt(15)
    buffer_load_dwordx4 v13, s[8:11], s35 offen offset:1024 nt lds
    s_waitcnt vmcnt(15)
    buffer_load_dwordx4 v14, s[8:11], s35 offen offset:2048 nt lds
    s_waitcnt vmcnt(15)
    buffer_load_dwordx4 v15, s[8:11], s35 offen offset:3072 nt lds
    v_subrev_u32 v27, 1, v23
    ds_write_b32 v22, v27
    v_add_u32 v23, 1, v23
    s_add_u32 s75, s75, 1
    s_add_u32 s38, s38, 1
    s_add_u32 s37, s37, 32768
    s_add_u32 s83, s39, 2
    s_lshl_b32 s84, s83, 13
    s_and_b32 s84, s84, 16384
    s_add_u32 s84, s84, 8192
    s_cmp_eq_u32 s38, 3
    s_cselect_b32 s38, 0, s38
    s_cselect_b32 s39, s83, s39
    s_cselect_b32 s37, s84, s37
    s_cmp_lt_u32 s36, s77
    s_cbranch_scc1 L_lp2_67
L_tl_67:
    v_readlane_b32 s34, v20, s75
    v_readlane_b32 s35, v21, s75
L_chv_67:
    s_waitcnt lgkmcnt(0)
    v_readlane_b32 s84, v25, s38
    ds_read_b32 v25, v24
    s_cmp_lt_u32 s39, 4
    s_cselect_b32 s84, s39, s84
    s_cmp_lt_u32 s84, s39
    s_cbranch_scc1 L_chv_67
    s_add_u32 m0, s37, 0
    s_waitcnt vmcnt(16)
    buffer_load_dwordx4 v12, s[8:11], s34 offen offset:0 nt lds
    v_subrev_u32 v27, 2, v23
    ds_write_b32 v22, v27
    s_waitcnt vmcnt(16)
    buffer_load_dwordx4 v13, s[8:11], s34 offen offset:1024 nt lds
    s_waitcnt vmcnt(16)
    buffer_load_dwordx4 v14, s[8:11], s34 offen offset:2048 nt lds
    s_waitcnt vmcnt(16)
    buffer_load_dwordx4 v15, s[8:11], s34 offen offset:3072 nt lds
    s_add_u32 m0, s37, 4096
    s_waitcnt vmcnt(16)
    buffer_load_dwordx4 v12, s[8:11], s35 offen offset:0 nt lds
    s_waitcnt vmcnt(16)
    buffer_load_dwordx4 v13, s[8:11], s35 offen offset:1024 nt lds
    s_waitcnt vmcnt(16)
    buffer_load_dwordx4 v14, s[8:11], s35 offen offset:2048 nt lds
    s_waitcnt vmcnt(16)
    buffer_load_dwordx4 v15, s[8:11], s35 offen offset:3072 nt lds
    v_add_u32 v23, 1, v23
    s_add_u32 s75, s75, 1
    s_add_u32 s38, s38, 1
    s_add_u32 s37, s37, 32768
    s_add_u32 s83, s39, 2
    s_lshl_b32 s84, s83, 13
    s_and_b32 s84, s84, 16384
    s_add_u32 s84, s84, 8192
    s_cmp_eq_u32 s38, 3
    s_cselect_b32 s38, 0, s38
    s_cselect_b32 s39, s83, s39
    s_cselect_b32 s37, s84, s37
    s_cmp_lt_u32 s75, s77
    s_cbranch_scc1 L_tl_67
    s_waitcnt vmcnt(16)
    v_subrev_u32 v27, 2, v23
    ds_write_b32 v22, v27
    s_waitcnt vmcnt(8)
    v_subrev_u32 v27, 1, v23
    ds_write_b32 v22, v27
    s_waitcnt vmcnt(0)
    ds_write_b32 v22, v23
    s_branch L_ldone
L_var_68:
    s_cmp_ge_u32 s36, s68
    s_cbranch_scc1 L_lp_68
L_pk_68:
    v_readlane_b32 s80, v20, s36
    v_readlane_b32 s81, v21, s36
    s_nop 2
    s_add_u32 m0, s74, 0
    s_waitcnt vmcnt(16)
    buffer_load_dwordx4 v8, s[4:7], s80 offen offset:0 nt lds
    v_subrev_u32 v27, 2, v23
    ds_write_b32 v22, v27
    s_waitcnt vmcnt(16)
    buffer_load_dwordx4 v9, s[4:7], s80 offen offset:1024 nt lds
    s_waitcnt vmcnt(16)
    buffer_load_dwordx4 v10, s[4:7], s80 offen offset:2048 nt lds
    s_waitcnt vmcnt(16)
    buffer_load_dwordx4 v11, s[4:7], s80 offen offset:3072 nt lds
    s_add_u32 m0, s74, 4096
    s_waitcnt vmcnt(16)
    buffer_load_dwordx4 v8, s[4:7], s81 offen offset:0 nt lds
    s_waitcnt vmcnt(16)
    buffer_load_dwordx4 v9, s[4:7], s81 offen offset:1024 nt lds
    s_waitcnt vmcnt(16)
    buffer_load_dwordx4 v10, s[4:7], s81 offen offset:2048 nt lds
    s_waitcnt vmcnt(16)
    buffer_load_dwordx4 v11, s[4:7], s81 offen offset:3072 nt lds
    v_add_u32 v23, 1, v23
    s_add_u32 s36, s36, 1
    s_add_u32 s87, s87, 1
    s_add_u32 s74, s74, 32768
    s_add_u32 s83, s70, 2
    s_lshl_b32 s84, s83, 13
    s_and_b32 s84, s84, 16384
    s_cmp_eq_u32 s87, 3
    s_cselect_b32 s87, 0, s87
    s_cselect_b32 s70, s83, s70
    s_cselect_b32 s74, s84, s74
    s_cmp_lt_u32 s36, s68
    s_cbranch_scc1 L_pk_68
L_lp_68:
    s_cmp_ge_u32 s36, s77
    s_cbranch_scc1 L_tl_68
L_lp2_68:
    v_readlane_b32 s34, v20, s75
    v_readlane_b32 s35, v21, s75
    v_readlane_b32 s80, v20, s36
    v_readlane_b32 s81, v21, s36
L_chk_68:
    s_waitcnt lgkmcnt(0)
    v_readlane_b32 s83, v25, s87
    v_readlane_b32 s84, v25, s38
    ds_read_b32 v25, v24
    s_cmp_lt_u32 s39, 4
    s_cselect_b32 s84, s39, s84
    s_cmp_lt_u32 s84, s39
    s_cbranch_scc1 L_chk_68
    s_add_u32 s83, s83, 3
    s_cmp_lt_u32 s83, s70
    s_cbranch_scc1 L_chk_68
    s_add_u32 m0, s74, 0
    s_waitcnt vmcnt(16)
    buffer_load_dwordx4 v8, s[4:7], s80 offen offset:0 nt lds
    v_subrev_u32 v27, 2, v23
    ds_write_b32 v22, v27
    s_waitcnt vmcnt(16)
    buffer_load_dwordx4 v9, s[4:7], s80 offen offset:1024 nt lds
    s_waitcnt vmcnt(16)
    buffer_load_dwordx4 v10, s[4:7], s80 offen offset:2048 nt lds
    s_waitcnt vmcnt(16)
    buffer_load_dwordx4 v11, s[4:7], s80 offen offset:3072 nt lds
    s_add_u32 m0, s74, 4096
    s_waitcnt vmcnt(16)
    buffer_load_dwordx4 v8, s[4:7], s81 offen offset:0 nt lds
    s_waitcnt vmcnt(16)
    buffer_load_dwordx4 v9, s[4:7], s81 offen offset:1024 nt lds
    s_waitcnt vmcnt(16)
    buffer_load_dwordx4 v10, s[4:7], s81 offen offset:2048 nt lds
    s_waitcnt vmcnt(16)
    buffer_load_dwordx4 v11, s[4:7], s81 offen offset:3072 nt lds
    v_add_u32 v23, 1, v23
    s_add_u32 s36, s36, 1
    s_add_u32 s87, s87, 1
    s_add_u32 s74, s74, 32768
    s_add_u32 s83, s70, 2
    s_lshl_b32 s84, s83, 13
    s_and_b32 s84, s84, 16384
    s_cmp_eq_u32 s87, 3
    s_cselect_b32 s87, 0, s87
    s_cselect_b32 s70, s83, s70
    s_cselect_b32 s74, s84, s74
    s_add_u32 m0, s37, 0
    s_waitcnt vmcnt(16)
    buffer_load_dwordx4 v12, s[8:11], s34 offen offset:0 nt lds
    v_subrev_u32 v27, 2, v23
    ds_write_b32 v22, v27
    s_waitcnt vmcnt(16)
    buffer_load_dwordx4 v13, s[8:11], s34 offen offset:1024 nt lds
    s_waitcnt vmcnt(16)
    buffer_load_dwordx4 v14, s[8:11], s34 offen offset:2048 nt lds
    s_waitcnt vmcnt(16)
    buffer_load_dwordx4 v15, s[8:11], s34 offen offset:3072 nt lds
    s_add_u32 m0, s37, 4096
    s_waitcnt vmcnt(16)
    buffer_load_dwordx4 v12, s[8:11], s35 offen offset:0 nt lds
    s_waitcnt vmcnt(16)
    buffer_load_dwordx4 v13, s[8:11], s35 offen offset:1024 nt lds
    s_waitcnt vmcnt(16)
    buffer_load_dwordx4 v14, s[8:11], s35 offen offset:2048 nt lds
    s_waitcnt vmcnt(16)
    buffer_load_dwordx4 v15, s[8:11], s35 offen offset:3072 nt lds
    v_add_u32 v23, 1, v23
    s_add_u32 s75, s75, 1
    s_add_u32 s38, s38, 1
    s_add_u32 s37, s37, 32768
    s_add_u32 s83, s39, 2
    s_lshl_b32 s84, s83, 13
    s_and_b32 s84, s84, 16384
    s_add_u32 s84, s84, 8192
    s_cmp_eq_u32 s38, 3
    s_cselect_b32 s38, 0, s38
    s_cselect_b32 s39, s83, s39
    s_cselect_b32 s37, s84, s37
    s_cmp_lt_u32 s36, s77
    s_cbranch_scc1 L_lp2_68
L_tl_68:
    v_readlane_b32 s34, v20, s75
    v_readlane_b32 s35, v21, s75
L_chv_68:
    s_waitcnt lgkmcnt(0)
    v_readlane_b32 s84, v25, s38
    ds_read_b32 v25, v24
    s_cmp_lt_u32 s39, 4
    s_cselect_b32 s84, s39, s84
    s_cmp_lt_u32 s84, s39
    s_cbranch_scc1 L_chv_68
    s_add_u32 m0, s37, 0
    s_waitcnt vmcnt(16)
    buffer_load_dwordx4 v12, s[8:11], s34 offen offset:0 nt lds
    v_subrev_u32 v27, 2, v23
    ds_write_b32 v22, v27
    s_waitcnt vmcnt(16)
    buffer_load_dwordx4 v13, s[8:11], s34 offen offset:1024 nt lds
    s_waitcnt vmcnt(16)
    buffer_load_dwordx4 v14, s[8:11], s34 offen offset:2048 nt lds
    s_waitcnt vmcnt(16)
    buffer_load_dwordx4 v15, s[8:11], s34 offen offset:3072 nt lds
    s_add_u32 m0, s37, 4096
    s_waitcnt vmcnt(16)
    buffer_load_dwordx4 v12, s[8:11], s35 offen offset:0 nt lds
    s_waitcnt vmcnt(16)
    buffer_load_dwordx4 v13, s[8:11], s35 offen offset:1024 nt lds
    s_waitcnt vmcnt(16)
    buffer_load_dwordx4 v14, s[8:11], s35 offen offset:2048 nt lds
    s_waitcnt vmcnt(16)
    buffer_load_dwordx4 v15, s[8:11], s35 offen offset:3072 nt lds
    v_add_u32 v23, 1, v23
    s_add_u32 s75, s75, 1
    s_add_u32 s38, s38, 1
    s_add_u32 s37, s37, 32768
    s_add_u32 s83, s39, 2
    s_lshl_b32 s84, s83, 13
    s_and_b32 s84, s84, 16384
    s_add_u32 s84, s84, 8192
    s_cmp_eq_u32 s38, 3
    s_cselect_b32 s38, 0, s38
    s_cselect_b32 s39, s83, s39
    s_cselect_b32 s37, s84, s37
    s_cmp_lt_u32 s75, s77
    s_cbranch_scc1 L_tl_68
    s_waitcnt vmcnt(16)
    v_subrev_u32 v27, 2, v23
    ds_write_b32 v22, v27
    s_waitcnt vmcnt(8)
    v_subrev_u32 v27, 1, v23
    ds_write_b32 v22, v27
    s_waitcnt vmcnt(0)
    ds_write_b32 v22, v23
    s_branch L_ldone
L_var_69:
    s_cmp_ge_u32 s36, s68
    s_cbranch_scc1 L_lp_69
L_pk_69:
    v_readlane_b32 s80, v20, s36
    v_readlane_b32 s81, v21, s36
    s_nop 2
    s_add_u32 m0, s74, 0
    s_waitcnt vmcnt(17)
    buffer_load_dwordx4 v8, s[4:7], s80 offen offset:0 nt lds
    s_waitcnt vmcnt(17)
    buffer_load_dwordx4 v9, s[4:7], s80 offen offset:1024 nt lds
    v_subrev_u32 v27, 2, v23
    ds_write_b32 v22, v27
    s_waitcnt vmcnt(17)
    buffer_load_dwordx4 v10, s[4:7], s80 offen offset:2048 nt lds
    s_waitcnt vmcnt(17)
    buffer_load_dwordx4 v11, s[4:7], s80 offen offset:3072 nt lds
    s_add_u32 m0, s74, 4096
    s_waitcnt vmcnt(16)
    buffer_load_dwordx4 v8, s[4:7], s81 offen offset:0 nt lds
    s_waitcnt vmcnt(16)
    buffer_load_dwordx4 v9, s[4:7], s81 offen offset:1024 nt lds
    s_waitcnt vmcnt(16)
    buffer_load_dwordx4 v10, s[4:7], s81 offen offset:2048 nt lds
    s_waitcnt vmcnt(16)
    buffer_load_dwordx4 v11, s[4:7], s81 offen offset:3072 nt lds
    v_add_u32 v23, 1, v23
    s_add_u32 s36, s36, 1
    s_add_u32 s87, s87, 1
    s_add_u32 s74, s74, 32768
    s_add_u32 s83, s70, 2
    s_lshl_b32 s84, s83, 13
    s_and_b32 s84, s84, 16384
    s_cmp_eq_u32 s87, 3
    s_cselect_b32 s87, 0, s87
    s_cselect_b32 s70, s83, s70
    s_cselect_b32 s74, s84, s74
    s_cmp_lt_u32 s36, s68
    s_cbranch_scc1 L_pk_69
L_lp_69:
    s_cmp_ge_u32 s36, s77
    s_cbranch_scc1 L_tl_69
L_lp2_69:
    v_readlane_b32 s34, v20, s75
    v_readlane_b32 s35, v21, s75
    v_readlane_b32 s80, v20, s36
    v_readlane_b32 s81, v21, s36
L_chk_69:
    s_waitcnt lgkmcnt(0)
    v_readlane_b32 s83, v25, s87
    v_readlane_b32 s84, v25, s38
    ds_read_b32 v25, v24
    s_cmp_lt_u32 s39, 4
    s_cselect_b32 s84, s39, s84
    s_cmp_lt_u32 s84, s39
    s_cbranch_scc1 L_chk_69
    s_add_u32 s83, s83, 3
    s_cmp_lt_u32 s83, s70
    s_cbranch_scc1 L_chk_69
    s_add_u32 m0, s74, 0
    s_waitcnt vmcnt(17)
    buffer_load_dwordx4 v8, s[4:7], s80 offen offset:0 nt lds
    s_waitcnt vmcnt(17)
    buffer_load_dwordx4 v9, s[4:7], s80 offen offset:1024 nt lds
    v_subrev_u32 v27, 2, v23
    ds_write_b32 v22, v27
    s_waitcnt vmcnt(17)
    buffer_load_dwordx4 v10, s[4:7], s80 offen offset:2048 nt lds
    s_waitcnt vmcnt(17)
    buffer_load_dwordx4 v11, s[4:7], s80 offen offset:3072 nt lds
    s_add_u32 m0, s74, 4096
    s_waitcnt vmcnt(16)
    buffer_load_dwordx4 v8, s[4:7], s81 offen offset:0 nt lds
    s_waitcnt vmcnt(16)
    buffer_load_dwordx4 v9, s[4:7], s81 offen offset:1024 nt lds
    s_waitcnt vmcnt(16)
    buffer_load_dwordx4 v10, s[4:7], s81 offen offset:2048 nt lds
    s_waitcnt vmcnt(16)
    buffer_load_dwordx4 v11, s[4:7], s81 offen offset:3072 nt lds
    v_add_u32 v23, 1, v23
    s_add_u32 s36, s36, 1
    s_add_u32 s87, s87, 1
    s_add_u32 s74, s74, 32768
    s_add_u32 s83, s70, 2
    s_lshl_b32 s84, s83, 13
    s_and_b32 s84, s84, 16384
    s_cmp_eq_u32 s87, 3
    s_cselect_b32 s87, 0, s87
    s_cselect_b32 s70, s83, s70
    s_cselect_b32 s74, s84, s74
    s_add_u32 m0, s37, 0
    s_waitcnt vmcnt(16)
    buffer_load_dwordx4 v12, s[8:11], s34 offen offset:0 nt lds
    v_subrev_u32 v27, 2, v23
    ds_write_b32 v22, v27
    s_waitcnt vmcnt(16)
    buffer_load_dwordx4 v13, s[8:11], s34 offen offset:1024 nt lds
    s_waitcnt vmcnt(16)
    buffer_load_dwordx4 v14, s[8:11], s34 offen offset:2048 nt lds
    s_waitcnt vmcnt(16)
    buffer_load_dwordx4 v15, s[8:11], s34 offen offset:3072 nt lds
    s_add_u32 m0, s37, 4096
    s_waitcnt vmcnt(16)
    buffer_load_dwordx4 v12, s[8:11], s35 offen offset:0 nt lds
    s_waitcnt vmcnt(16)
    buffer_load_dwordx4 v13, s[8:11], s35 offen offset:1024 nt lds
    s_waitcnt vmcnt(16)
    buffer_load_dwordx4 v14, s[8:11], s35 offen offset:2048 nt lds
    s_waitcnt vmcnt(16)
    buffer_load_dwordx4 v15, s[8:11], s35 offen offset:3072 nt lds
    v_add_u32 v23, 1, v23
    s_add_u32 s75, s75, 1
    s_add_u32 s38, s38, 1
    s_add_u32 s37, s37, 32768
    s_add_u32 s83, s39, 2
    s_lshl_b32 s84, s83, 13
    s_and_b32 s84, s84, 16384
    s_add_u32 s84, s84, 8192
    s_cmp_eq_u32 s38, 3
    s_cselect_b32 s38, 0, s38
    s_cselect_b32 s39, s83, s39
    s_cselect_b32 s37, s84, s37
    s_cmp_lt_u32 s36, s77
    s_cbranch_scc1 L_lp2_69
L_tl_69:
    v_readlane_b32 s34, v20, s75
    v_readlane_b32 s35, v21, s75
L_chv_69:
    s_waitcnt lgkmcnt(0)
    v_readlane_b32 s84, v25, s38
    ds_read_b32 v25, v24
    s_cmp_lt_u32 s39, 4
    s_cselect_b32 s84, s39, s84
    s_cmp_lt_u32 s84, s39
    s_cbranch_scc1 L_chv_69
    s_add_u32 m0, s37, 0
    s_waitcnt vmcnt(16)
    buffer_load_dwordx4 v12, s[8:11], s34 offen offset:0 nt lds
    v_subrev_u32 v27, 2, v23
    ds_write_b32 v22, v27
    s_waitcnt vmcnt(16)
    buffer_load_dwordx4 v13, s[8:11], s34 offen offset:1024 nt lds
    s_waitcnt vmcnt(16)
    buffer_load_dwordx4 v14, s[8:11], s34 offen offset:2048 nt lds
    s_waitcnt vmcnt(16)
    buffer_load_dwordx4 v15, s[8:11], s34 offen offset:3072 nt lds
    s_add_u32 m0, s37, 4096
    s_waitcnt vmcnt(16)
    buffer_load_dwordx4 v12, s[8:11], s35 offen offset:0 nt lds
    s_waitcnt vmcnt(16)
    buffer_load_dwordx4 v13, s[8:11], s35 offen offset:1024 nt lds
    s_waitcnt vmcnt(16)
    buffer_load_dwordx4 v14, s[8:11], s35 offen offset:2048 nt lds
    s_waitcnt vmcnt(16)
    buffer_load_dwordx4 v15, s[8:11], s35 offen offset:3072 nt lds
    v_add_u32 v23, 1, v23
    s_add_u32 s75, s75, 1
    s_add_u32 s38, s38, 1
    s_add_u32 s37, s37, 32768
    s_add_u32 s83, s39, 2
    s_lshl_b32 s84, s83, 13
    s_and_b32 s84, s84, 16384
    s_add_u32 s84, s84, 8192
    s_cmp_eq_u32 s38, 3
    s_cselect_b32 s38, 0, s38
    s_cselect_b32 s39, s83, s39
    s_cselect_b32 s37, s84, s37
    s_cmp_lt_u32 s75, s77
    s_cbranch_scc1 L_tl_69
    s_waitcnt vmcnt(16)
    v_subrev_u32 v27, 2, v23
    ds_write_b32 v22, v27
    s_waitcnt vmcnt(8)
    v_subrev_u32 v27, 1, v23
    ds_write_b32 v22, v27
    s_waitcnt vmcnt(0)
    ds_write_b32 v22, v23
    s_branch L_ldone
L_var_70:
    s_cmp_ge_u32 s36, s68
    s_cbranch_scc1 L_lp_70
L_pk_70:
    v_readlane_b32 s80, v20, s36
    v_readlane_b32 s81, v21, s36
    s_nop 2
    s_add_u32 m0, s74, 0
    s_waitcnt vmcnt(17)
    buffer_load_dwordx4 v8, s[4:7], s80 offen offset:0 nt lds
    s_waitcnt vmcnt(17)
    buffer_load_dwordx4 v9, s[4:7], s80 offen offset:1024 nt lds
    v_subrev_u32 v27, 2, v23
    ds_write_b32 v22, v27
    s_waitcnt vmcnt(17)
    buffer_load_dwordx4 v10, s[4:7], s80 offen offset:2048 nt lds
    s_waitcnt vmcnt(17)
    buffer_load_dwordx4 v11, s[4:7], s80 offen offset:3072 nt lds
    s_add_u32 m0, s74, 4096
    s_waitcnt vmcnt(17)
    buffer_load_dwordx4 v8, s[4:7], s81 offen offset:0 nt lds
    s_waitcnt vmcnt(17)
    buffer_load_dwordx4 v9, s[4:7], s81 offen offset:1024 nt lds
    s_waitcnt vmcnt(17)
    buffer_load_dwordx4 v10, s[4:7], s81 offen offset:2048 nt lds
    s_waitcnt vmcnt(17)
    buffer_load_dwordx4 v11, s[4:7], s81 offen offset:3072 nt lds
    v_add_u32 v23, 1, v23
    s_add_u32 s36, s36, 1
    s_add_u32 s87, s87, 1
    s_add_u32 s74, s74, 32768
    s_add_u32 s83, s70, 2
    s_lshl_b32 s84, s83, 13
    s_and_b32 s84, s84, 16384
    s_cmp_eq_u32 s87, 3
    s_cselect_b32 s87, 0, s87
    s_cselect_b32 s70, s83, s70
    s_cselect_b32 s74, s84, s74
    s_cmp_lt_u32 s36, s68
    s_cbranch_scc1 L_pk_70
L_lp_70:
    s_cmp_ge_u32 s36, s77
    s_cbranch_scc1 L_tl_70
L_lp2_70:
    v_readlane_b32 s34, v20, s75
    v_readlane_b32 s35, v21, s75
    v_readlane_b32 s80, v20, s36
    v_readlane_b32 s81, v21, s36
L_chk_70:
    s_waitcnt lgkmcnt(0)
    v_readlane_b32 s83, v25, s87
    v_readlane_b32 s84, v25, s38
    ds_read_b32 v25, v24
    s_cmp_lt_u32 s39, 4
    s_cselect_b32 s84, s39, s84
    s_cmp_lt_u32 s84, s39
    s_cbranch_scc1 L_chk_70
    s_add_u32 s83, s83, 3
    s_cmp_lt_u32 s83, s70
    s_cbranch_scc1 L_chk_70
    s_add_u32 m0, s74, 0
    s_waitcnt vmcnt(17)
    buffer_load_dwordx4 v8, s[4:7], s80 offen offset:0 nt lds
    s_waitcnt vmcnt(17)
    buffer_load_dwordx4 v9, s[4:7], s80 offen offset:1024 nt lds
    v_subrev_u32 v27, 2, v23
    ds_write_b32 v22, v27
    s_waitcnt vmcnt(17)
    buffer_load_dwordx4 v10, s[4:7], s80 offen offset:2048 nt lds
    s_waitcnt vmcnt(17)
    buffer_load_dwordx4 v11, s[4:7], s80 offen offset:3072 nt lds
    s_add_u32 m0, s74, 4096
    s_waitcnt vmcnt(17)
    buffer_load_dwordx4 v8, s[4:7], s81 offen offset:0 nt lds
    s_waitcnt vmcnt(17)
    buffer_load_dwordx4 v9, s[4:7], s81 offen offset:1024 nt lds
    s_waitcnt vmcnt(17)
    buffer_load_dwordx4 v10, s[4:7], s81 offen offset:2048 nt lds
    s_waitcnt vmcnt(17)
    buffer_load_dwordx4 v11, s[4:7], s81 offen offset:3072 nt lds
    v_add_u32 v23, 1, v23
    s_add_u32 s36, s36, 1
    s_add_u32 s87, s87, 1
    s_add_u32 s74, s74, 32768
    s_add_u32 s83, s70, 2
    s_lshl_b32 s84, s83, 13
    s_and_b32 s84, s84, 16384
    s_cmp_eq_u32 s87, 3
    s_cselect_b32 s87, 0, s87
    s_cselect_b32 s70, s83, s70
    s_cselect_b32 s74, s84, s74
    s_add_u32 m0, s37, 0
    s_waitcnt vmcnt(16)
    buffer_load_dwordx4 v12, s[8:11], s34 offen offset:0 nt lds
    v_subrev_u32 v27, 2, v23
    ds_write_b32 v22, v27
    s_waitcnt vmcnt(16)
    buffer_load_dwordx4 v13, s[8:11], s34 offen offset:1024 nt lds
    s_waitcnt vmcnt(16)
    buffer_load_dwordx4 v14, s[8:11], s34 offen offset:2048 nt lds
    s_waitcnt vmcnt(16)
    buffer_load_dwordx4 v15, s[8:11], s34 offen offset:3072 nt lds
    s_add_u32 m0, s37, 4096
    s_waitcnt vmcnt(16)
    buffer_load_dwordx4 v12, s[8:11], s35 offen offset:0 nt lds
    s_waitcnt vmcnt(16)
    buffer_load_dwordx4 v13, s[8:11], s35 offen offset:1024 nt lds
    s_waitcnt vmcnt(16)
    buffer_load_dwordx4 v14, s[8:11], s35 offen offset:2048 nt lds
    s_waitcnt vmcnt(16)
    buffer_load_dwordx4 v15, s[8:11], s35 offen offset:3072 nt lds
    v_add_u32 v23, 1, v23
    s_add_u32 s75, s75, 1
    s_add_u32 s38, s38, 1
    s_add_u32 s37, s37, 32768
    s_add_u32 s83, s39, 2
    s_lshl_b32 s84, s83, 13
    s_and_b32 s84, s84, 16384
    s_add_u32 s84, s84, 8192
    s_cmp_eq_u32 s38, 3
    s_cselect_b32 s38, 0, s38
    s_cselect_b32 s39, s83, s39
    s_cselect_b32 s37, s84, s37
    s_cmp_lt_u32 s36, s77
    s_cbranch_scc1 L_lp2_70
L_tl_70:
    v_readlane_b32 s34, v20, s75
    v_readlane_b32 s35, v21, s75
L_chv_70:
    s_waitcnt lgkmcnt(0)
    v_readlane_b32 s84, v25, s38
    ds_read_b32 v25, v24
    s_cmp_lt_u32 s39, 4
    s_cselect_b32 s84, s39, s84
    s_cmp_lt_u32 s84, s39
    s_cbranch_scc1 L_chv_70
    s_add_u32 m0, s37, 0
    s_waitcnt vmcnt(17)
    buffer_load_dwordx4 v12, s[8:11], s34 offen offset:0 nt lds
    s_waitcnt vmcnt(17)
    buffer_load_dwordx4 v13, s[8:11], s34 offen offset:1024 nt lds
    v_subrev_u32 v27, 2, v23
    ds_write_b32 v22, v27
    s_waitcnt vmcnt(17)
    buffer_load_dwordx4 v14, s[8:11], s34 offen offset:2048 nt lds
    s_waitcnt vmcnt(17)
    buffer_load_dwordx4 v15, s[8:11], s34 offen offset:3072 nt lds
    s_add_u32 m0, s37, 4096
    s_waitcnt vmcnt(17)
    buffer_load_dwordx4 v12, s[8:11], s35 offen offset:0 nt lds
    s_waitcnt vmcnt(17)
    buffer_load_dwordx4 v13, s[8:11], s35 offen offset:1024 nt lds
    s_waitcnt vmcnt(17)
    buffer_load_dwordx4 v14, s[8:11], s35 offen offset:2048 nt lds
    s_waitcnt vmcnt(17)
    buffer_load_dwordx4 v15, s[8:11], s35 offen offset:3072 nt lds
    v_add_u32 v23, 1, v23
    s_add_u32 s75, s75, 1
    s_add_u32 s38, s38, 1
    s_add_u32 s37, s37, 32768
    s_add_u32 s83, s39, 2
    s_lshl_b32 s84, s83, 13
    s_and_b32 s84, s84, 16384
    s_add_u32 s84, s84, 8192
    s_cmp_eq_u32 s38, 3
    s_cselect_b32 s38, 0, s38
    s_cselect_b32 s39, s83, s39
    s_cselect_b32 s37, s84, s37
    s_cmp_lt_u32 s75, s77
    s_cbranch_scc1 L_tl_70
    s_waitcnt vmcnt(16)
    v_subrev_u32 v27, 2, v23
    ds_write_b32 v22, v27
    s_waitcnt vmcnt(8)
    v_subrev_u32 v27, 1, v23
    ds_write_b32 v22, v27
    s_waitcnt vmcnt(0)
    ds_write_b32 v22, v23
    s_branch L_ldone
L_var_71:
    s_cmp_ge_u32 s36, s68
    s_cbranch_scc1 L_lp_71
L_pk_71:
    v_readlane_b32 s80, v20, s36
    v_readlane_b32 s81, v21, s36
    s_nop 2
    s_add_u32 m0, s74, 0
    s_waitcnt vmcnt(17)
    buffer_load_dwordx4 v8, s[4:7], s80 offen offset:0 nt lds
    s_waitcnt vmcnt(17)
    buffer_load_dwordx4 v9, s[4:7], s80 offen offset:1024 nt lds
    v_subrev_u32 v27, 2, v23
    ds_write_b32 v22, v27
    s_waitcnt vmcnt(17)
    buffer_load_dwordx4 v10, s[4:7], s80 offen offset:2048 nt lds
    s_waitcnt vmcnt(17)
    buffer_load_dwordx4 v11, s[4:7], s80 offen offset:3072 nt lds
    s_add_u32 m0, s74, 4096
    s_waitcnt vmcnt(17)
    buffer_load_dwordx4 v8, s[4:7], s81 offen offset:0 nt lds
    s_waitcnt vmcnt(17)
    buffer_load_dwordx4 v9, s[4:7], s81 offen offset:1024 nt lds
    s_waitcnt vmcnt(17)
    buffer_load_dwordx4 v10, s[4:7], s81 offen offset:2048 nt lds
    s_waitcnt vmcnt(17)
    buffer_load_dwordx4 v11, s[4:7], s81 offen offset:3072 nt lds
    v_add_u32 v23, 1, v23
    s_add_u32 s36, s36, 1
    s_add_u32 s87, s87, 1
    s_add_u32 s74, s74, 32768
    s_add_u32 s83, s70, 2
    s_lshl_b32 s84, s83, 13
    s_and_b32 s84, s84, 16384
    s_cmp_eq_u32 s87, 3
    s_cselect_b32 s87, 0, s87
    s_cselect_b32 s70, s83, s70
    s_cselect_b32 s74, s84, s74
    s_cmp_lt_u32 s36, s68
    s_cbranch_scc1 L_pk_71
L_lp_71:
    s_cmp_ge_u32 s36, s77
    s_cbranch_scc1 L_tl_71
L_lp2_71:
    v_readlane_b32 s34, v20, s75
    v_readlane_b32 s35, v21, s75
    v_readlane_b32 s80, v20, s36
    v_readlane_b32 s81, v21, s36
L_chk_71:
    s_waitcnt lgkmcnt(0)
    v_readlane_b32 s83, v25, s87
    v_readlane_b32 s84, v25, s38
    ds_read_b32 v25, v24
    s_cmp_lt_u32 s39, 4
    s_cselect_b32 s84, s39, s84
    s_cmp_lt_u32 s84, s39
    s_cbranch_scc1 L_chk_71
    s_add_u32 s83, s83, 3
    s_cmp_lt_u32 s83, s70
    s_cbranch_scc1 L_chk_71
    s_add_u32 m0, s74, 0
    s_waitcnt vmcnt(17)
    buffer_load_dwordx4 v8, s[4:7], s80 offen offset:0 nt lds
    s_waitcnt vmcnt(17)
    buffer_load_dwordx4 v9, s[4:7], s80 offen offset:1024 nt lds
    v_subrev_u32 v27, 2, v23
    ds_write_b32 v22, v27
    s_waitcnt vmcnt(17)
    buffer_load_dwordx4 v10, s[4:7], s80 offen offset:2048 nt lds
    s_waitcnt vmcnt(17)
    buffer_load_dwordx4 v11, s[4:7], s80 offen offset:3072 nt lds
    s_add_u32 m0, s74, 4096
    s_waitcnt vmcnt(17)
    buffer_load_dwordx4 v8, s[4:7], s81 offen offset:0 nt lds
    s_waitcnt vmcnt(17)
    buffer_load_dwordx4 v9, s[4:7], s81 offen offset:1024 nt lds
    s_waitcnt vmcnt(17)
    buffer_load_dwordx4 v10, s[4:7], s81 offen offset:2048 nt lds
    s_waitcnt vmcnt(17)
    buffer_load_dwordx4 v11, s[4:7], s81 offen offset:3072 nt lds
    v_add_u32 v23, 1, v23
    s_add_u32 s36, s36, 1
    s_add_u32 s87, s87, 1
    s_add_u32 s74, s74, 32768
    s_add_u32 s83, s70, 2
    s_lshl_b32 s84, s83, 13
    s_and_b32 s84, s84, 16384
    s_cmp_eq_u32 s87, 3
    s_cselect_b32 s87, 0, s87
    s_cselect_b32 s70, s83, s70
    s_cselect_b32 s74, s84, s74
    s_add_u32 m0, s37, 0
    s_waitcnt vmcnt(17)
    buffer_load_dwordx4 v12, s[8:11], s34 offen offset:0 nt lds
    s_waitcnt vmcnt(17)
    buffer_load_dwordx4 v13, s[8:11], s34 offen offset:1024 nt lds
    v_subrev_u32 v27, 2, v23
    ds_write_b32 v22, v27
    s_waitcnt vmcnt(17)
    buffer_load_dwordx4 v14, s[8:11], s34 offen offset:2048 nt lds
    s_waitcnt vmcnt(17)
    buffer_load_dwordx4 v15, s[8:11], s34 offen offset:3072 nt lds
    s_add_u32 m0, s37, 4096
    s_waitcnt vmcnt(16)
    buffer_load_dwordx4 v12, s[8:11], s35 offen offset:0 nt lds
    s_waitcnt vmcnt(16)
    buffer_load_dwordx4 v13, s[8:11], s35 offen offset:1024 nt lds
    s_waitcnt vmcnt(16)
    buffer_load_dwordx4 v14, s[8:11], s35 offen offset:2048 nt lds
    s_waitcnt vmcnt(16)
    buffer_load_dwordx4 v15, s[8:11], s35 offen offset:3072 nt lds
    v_add_u32 v23, 1, v23
    s_add_u32 s75, s75, 1
    s_add_u32 s38, s38, 1
    s_add_u32 s37, s37, 32768
    s_add_u32 s83, s39, 2
    s_lshl_b32 s84, s83, 13
    s_and_b32 s84, s84, 16384
    s_add_u32 s84, s84, 8192
    s_cmp_eq_u32 s38, 3
    s_cselect_b32 s38, 0, s38
    s_cselect_b32 s39, s83, s39
    s_cselect_b32 s37, s84, s37
    s_cmp_lt_u32 s36, s77
    s_cbranch_scc1 L_lp2_71
L_tl_71:
    v_readlane_b32 s34, v20, s75
    v_readlane_b32 s35, v21, s75
L_chv_71:
    s_waitcnt lgkmcnt(0)
    v_readlane_b32 s84, v25, s38
    ds_read_b32 v25, v24
    s_cmp_lt_u32 s39, 4
    s_cselect_b32 s84, s39, s84
    s_cmp_lt_u32 s84, s39
    s_cbranch_scc1 L_chv_71
    s_add_u32 m0, s37, 0
    s_waitcnt vmcnt(17)
    buffer_load_dwordx4 v12, s[8:11], s34 offen offset:0 nt lds
    s_waitcnt vmcnt(17)
    buffer_load_dwordx4 v13, s[8:11], s34 offen offset:1024 nt lds
    v_subrev_u32 v27, 2, v23
    ds_write_b32 v22, v27
    s_waitcnt vmcnt(17)
    buffer_load_dwordx4 v14, s[8:11], s34 offen offset:2048 nt lds
    s_waitcnt vmcnt(17)
    buffer_load_dwordx4 v15, s[8:11], s34 offen offset:3072 nt lds
    s_add_u32 m0, s37, 4096
    s_waitcnt vmcnt(17)
    buffer_load_dwordx4 v12, s[8:11], s35 offen offset:0 nt lds
    s_waitcnt vmcnt(17)
    buffer_load_dwordx4 v13, s[8:11], s35 offen offset:1024 nt lds
    s_waitcnt vmcnt(17)
    buffer_load_dwordx4 v14, s[8:11], s35 offen offset:2048 nt lds
    s_waitcnt vmcnt(17)
    buffer_load_dwordx4 v15, s[8:11], s35 offen offset:3072 nt lds
    v_add_u32 v23, 1, v23
    s_add_u32 s75, s75, 1
    s_add_u32 s38, s38, 1
    s_add_u32 s37, s37, 32768
    s_add_u32 s83, s39, 2
    s_lshl_b32 s84, s83, 13
    s_and_b32 s84, s84, 16384
    s_add_u32 s84, s84, 8192
    s_cmp_eq_u32 s38, 3
    s_cselect_b32 s38, 0, s38
    s_cselect_b32 s39, s83, s39
    s_cselect_b32 s37, s84, s37
    s_cmp_lt_u32 s75, s77
    s_cbranch_scc1 L_tl_71
    s_waitcnt vmcnt(16)
    v_subrev_u32 v27, 2, v23
    ds_write_b32 v22, v27
    s_waitcnt vmcnt(8)
    v_subrev_u32 v27, 1, v23
    ds_write_b32 v22, v27
    s_waitcnt vmcnt(0)
    ds_write_b32 v22, v23
    s_branch L_ldone
L_var_72:
    s_cmp_ge_u32 s36, s68
    s_cbranch_scc1 L_lp_72
L_pk_72:
    v_readlane_b32 s80, v20, s36
    v_readlane_b32 s81, v21, s36
    s_nop 2
    s_add_u32 m0, s74, 0
    s_waitcnt vmcnt(17)
    buffer_load_dwordx4 v8, s[4:7], s80 offen offset:0 nt lds
    s_waitcnt vmcnt(17)
    buffer_load_dwordx4 v9, s[4:7], s80 offen offset:1024 nt lds
    v_subrev_u32 v27, 2, v23
    ds_write_b32 v22, v27
    s_waitcnt vmcnt(17)
    buffer_load_dwordx4 v10, s[4:7], s80 offen offset:2048 nt lds
    s_waitcnt vmcnt(17)
    buffer_load_dwordx4 v11, s[4:7], s80 offen offset:3072 nt lds
    s_add_u32 m0, s74, 4096
    s_waitcnt vmcnt(17)
    buffer_load_dwordx4 v8, s[4:7], s81 offen offset:0 nt lds
    s_waitcnt vmcnt(17)
    buffer_load_dwordx4 v9, s[4:7], s81 offen offset:1024 nt lds
    s_waitcnt vmcnt(17)
    buffer_load_dwordx4 v10, s[4:7], s81 offen offset:2048 nt lds
    s_waitcnt vmcnt(17)
    buffer_load_dwordx4 v11, s[4:7], s81 offen offset:3072 nt lds
    v_add_u32 v23, 1, v23
    s_add_u32 s36, s36, 1
    s_add_u32 s87, s87, 1
    s_add_u32 s74, s74, 32768
    s_add_u32 s83, s70, 2
    s_lshl_b32 s84, s83, 13
    s_and_b32 s84, s84, 16384
    s_cmp_eq_u32 s87, 3
    s_cselect_b32 s87, 0, s87
    s_cselect_b32 s70, s83, s70
    s_cselect_b32 s74, s84, s74
    s_cmp_lt_u32 s36, s68
    s_cbranch_scc1 L_pk_72
L_lp_72:
    s_cmp_ge_u32 s36, s77
    s_cbranch_scc1 L_tl_72
L_lp2_72:
    v_readlane_b32 s34, v20, s75
    v_readlane_b32 s35, v21, s75
    v_readlane_b32 s80, v20, s36
    v_readlane_b32 s81, v21, s36
L_chk_72:
    s_waitcnt lgkmcnt(0)
    v_readlane_b32 s83, v25, s87
    v_readlane_b32 s84, v25, s38
    ds_read_b32 v25, v24
    s_cmp_lt_u32 s39, 4
    s_cselect_b32 s84, s39, s84
    s_cmp_lt_u32 s84, s39
    s_cbranch_scc1 L_chk_72
    s_add_u32 s83, s83, 3
    s_cmp_lt_u32 s83, s70
    s_cbranch_scc1 L_chk_72
    s_add_u32 m0, s74, 0
    s_waitcnt vmcnt(17)
    buffer_load_dwordx4 v8, s[4:7], s80 offen offset:0 nt lds
    s_waitcnt vmcnt(17)
    buffer_load_dwordx4 v9, s[4:7], s80 offen offset:1024 nt lds
    v_subrev_u32 v27, 2, v23
    ds_write_b32 v22, v27
    s_waitcnt vmcnt(17)
    buffer_load_dwordx4 v10, s[4:7], s80 offen offset:2048 nt lds
    s_waitcnt vmcnt(17)
    buffer_load_dwordx4 v11, s[4:7], s80 offen offset:3072 nt lds
    s_add_u32 m0, s74, 4096
    s_waitcnt vmcnt(17)
    buffer_load_dwordx4 v8, s[4:7], s81 offen offset:0 nt lds
    s_waitcnt vmcnt(17)
    buffer_load_dwordx4 v9, s[4:7], s81 offen offset:1024 nt lds
    s_waitcnt vmcnt(17)
    buffer_load_dwordx4 v10, s[4:7], s81 offen offset:2048 nt lds
    s_waitcnt vmcnt(17)
    buffer_load_dwordx4 v11, s[4:7], s81 offen offset:3072 nt lds
    v_add_u32 v23, 1, v23
    s_add_u32 s36, s36, 1
    s_add_u32 s87, s87, 1
    s_add_u32 s74, s74, 32768
    s_add_u32 s83, s70, 2
    s_lshl_b32 s84, s83, 13
    s_and_b32 s84, s84, 16384
    s_cmp_eq_u32 s87, 3
    s_cselect_b32 s87, 0, s87
    s_cselect_b32 s70, s83, s70
    s_cselect_b32 s74, s84, s74
    s_add_u32 m0, s37, 0
    s_waitcnt vmcnt(17)
    buffer_load_dwordx4 v12, s[8:11], s34 offen offset:0 nt lds
    s_waitcnt vmcnt(17)
    buffer_load_dwordx4 v13, s[8:11], s34 offen offset:1024 nt lds
    v_subrev_u32 v27, 2, v23
    ds_write_b32 v22, v27
    s_waitcnt vmcnt(17)
    buffer_load_dwordx4 v14, s[8:11], s34 offen offset:2048 nt lds
    s_waitcnt vmcnt(17)
    buffer_load_dwordx4 v15, s[8:11], s34 offen offset:3072 nt lds
    s_add_u32 m0, s37, 4096
    s_waitcnt vmcnt(17)
    buffer_load_dwordx4 v12, s[8:11], s35 offen offset:0 nt lds
    s_waitcnt vmcnt(17)
    buffer_load_dwordx4 v13, s[8:11], s35 offen offset:1024 nt lds
    s_waitcnt vmcnt(17)
    buffer_load_dwordx4 v14, s[8:11], s35 offen offset:2048 nt lds
    s_waitcnt vmcnt(17)
    buffer_load_dwordx4 v15, s[8:11], s35 offen offset:3072 nt lds
    v_add_u32 v23, 1, v23
    s_add_u32 s75, s75, 1
    s_add_u32 s38, s38, 1
    s_add_u32 s37, s37, 32768
    s_add_u32 s83, s39, 2
    s_lshl_b32 s84, s83, 13
    s_and_b32 s84, s84, 16384
    s_add_u32 s84, s84, 8192
    s_cmp_eq_u32 s38, 3
    s_cselect_b32 s38, 0, s38
    s_cselect_b32 s39, s83, s39
    s_cselect_b32 s37, s84, s37
    s_cmp_lt_u32 s36, s77
    s_cbranch_scc1 L_lp2_72
L_tl_72:
    v_readlane_b32 s34, v20, s75
    v_readlane_b32 s35, v21, s75
L_chv_72:
    s_waitcnt lgkmcnt(0)
    v_readlane_b32 s84, v25, s38
    ds_read_b32 v25, v24
    s_cmp_lt_u32 s39, 4
    s_cselect_b32 s84, s39, s84
    s_cmp_lt_u32 s84, s39
    s_cbranch_scc1 L_chv_72
    s_add_u32 m0, s37, 0
    s_waitcnt vmcnt(17)
    buffer_load_dwordx4 v12, s[8:11], s34 offen offset:0 nt lds
    s_waitcnt vmcnt(17)
    buffer_load_dwordx4 v13, s[8:11], s34 offen offset:1024 nt lds
    v_subrev_u32 v27, 2, v23
    ds_write_b32 v22, v27
    s_waitcnt vmcnt(17)
    buffer_load_dwordx4 v14, s[8:11], s34 offen offset:2048 nt lds
    s_waitcnt vmcnt(17)
    buffer_load_dwordx4 v15, s[8:11], s34 offen offset:3072 nt lds
    s_add_u32 m0, s37, 4096
    s_waitcnt vmcnt(17)
    buffer_load_dwordx4 v12, s[8:11], s35 offen offset:0 nt lds
    s_waitcnt vmcnt(17)
    buffer_load_dwordx4 v13, s[8:11], s35 offen offset:1024 nt lds
    s_waitcnt vmcnt(17)
    buffer_load_dwordx4 v14, s[8:11], s35 offen offset:2048 nt lds
    s_waitcnt vmcnt(17)
    buffer_load_dwordx4 v15, s[8:11], s35 offen offset:3072 nt lds
    v_add_u32 v23, 1, v23
    s_add_u32 s75, s75, 1
    s_add_u32 s38, s38, 1
    s_add_u32 s37, s37, 32768
    s_add_u32 s83, s39, 2
    s_lshl_b32 s84, s83, 13
    s_and_b32 s84, s84, 16384
    s_add_u32 s84, s84, 8192
    s_cmp_eq_u32 s38, 3
    s_cselect_b32 s38, 0, s38
    s_cselect_b32 s39, s83, s39
    s_cselect_b32 s37, s84, s37
    s_cmp_lt_u32 s75, s77
    s_cbranch_scc1 L_tl_72
    s_waitcnt vmcnt(16)
    v_subrev_u32 v27, 2, v23
    ds_write_b32 v22, v27
    s_waitcnt vmcnt(8)
    v_subrev_u32 v27, 1, v23
    ds_write_b32 v22, v27
    s_waitcnt vmcnt(0)
    ds_write_b32 v22, v23
    s_branch L_ldone
L_var_73:
    s_cmp_ge_u32 s36, s68
    s_cbranch_scc1 L_lp_73
L_pk_73:
    v_readlane_b32 s80, v20, s36
    v_readlane_b32 s81, v21, s36
    s_nop 2
    s_add_u32 m0, s74, 0
    s_waitcnt vmcnt(18)
    buffer_load_dwordx4 v8, s[4:7], s80 offen offset:0 nt lds
    s_waitcnt vmcnt(18)
    buffer_load_dwordx4 v9, s[4:7], s80 offen offset:1024 nt lds
    s_waitcnt vmcnt(18)
    buffer_load_dwordx4 v10, s[4:7], s80 offen offset:2048 nt lds
    v_subrev_u32 v27, 2, v23
    ds_write_b32 v22, v27
    s_waitcnt vmcnt(18)
    buffer_load_dwordx4 v11, s[4:7], s80 offen offset:3072 nt lds
    s_add_u32 m0, s74, 4096
    s_waitcnt vmcnt(17)
    buffer_load_dwordx4 v8, s[4:7], s81 offen offset:0 nt lds
    s_waitcnt vmcnt(17)
    buffer_load_dwordx4 v9, s[4:7], s81 offen offset:1024 nt lds
    s_waitcnt vmcnt(17)
    buffer_load_dwordx4 v10, s[4:7], s81 offen offset:2048 nt lds
    s_waitcnt vmcnt(17)
    buffer_load_dwordx4 v11, s[4:7], s81 offen offset:3072 nt lds
    v_add_u32 v23, 1, v23
    s_add_u32 s36, s36, 1
    s_add_u32 s87, s87, 1
    s_add_u32 s74, s74, 32768
    s_add_u32 s83, s70, 2
    s_lshl_b32 s84, s83, 13
    s_and_b32 s84, s84, 16384
    s_cmp_eq_u32 s87, 3
    s_cselect_b32 s87, 0, s87
    s_cselect_b32 s70, s83, s70
    s_cselect_b32 s74, s84, s74
    s_cmp_lt_u32 s36, s68
    s_cbranch_scc1 L_pk_73
L_lp_73:
    s_cmp_ge_u32 s36, s77
    s_cbranch_scc1 L_tl_73
L_lp2_73:
    v_readlane_b32 s34, v20, s75
    v_readlane_b32 s35, v21, s75
    v_readlane_b32 s80, v20, s36
    v_readlane_b32 s81, v21, s36
L_chk_73:
    s_waitcnt lgkmcnt(0)
    v_readlane_b32 s83, v25, s87
    v_readlane_b32 s84, v25, s38
    ds_read_b32 v25, v24
    s_cmp_lt_u32 s39, 4
    s_cselect_b32 s84, s39, s84
    s_cmp_lt_u32 s84, s39
    s_cbranch_scc1 L_chk_73
    s_add_u32 s83, s83, 3
    s_cmp_lt_u32 s83, s70
    s_cbranch_scc1 L_chk_73
    s_add_u32 m0, s74, 0
    s_waitcnt vmcnt(18)
    buffer_load_dwordx4 v8, s[4:7], s80 offen offset:0 nt lds
    s_waitcnt vmcnt(18)
    buffer_load_dwordx4 v9, s[4:7], s80 offen offset:1024 nt lds
    s_waitcnt vmcnt(18)
    buffer_load_dwordx4 v10, s[4:7], s80 offen offset:2048 nt lds
    v_subrev_u32 v27, 2, v23
    ds_write_b32 v22, v27
    s_waitcnt vmcnt(18)
    buffer_load_dwordx4 v11, s[4:7], s80 offen offset:3072 nt lds
    s_add_u32 m0, s74, 4096
    s_waitcnt vmcnt(17)
    buffer_load_dwordx4 v8, s[4:7], s81 offen offset:0 nt lds
    s_waitcnt vmcnt(17)
    buffer_load_dwordx4 v9, s[4:7], s81 offen offset:1024 nt lds
    s_waitcnt vmcnt(17)
    buffer_load_dwordx4 v10, s[4:7], s81 offen offset:2048 nt lds
    s_waitcnt vmcnt(17)
    buffer_load_dwordx4 v11, s[4:7], s81 offen offset:3072 nt lds
    v_add_u32 v23, 1, v23
    s_add_u32 s36, s36, 1
    s_add_u32 s87, s87, 1
    s_add_u32 s74, s74, 32768
    s_add_u32 s83, s70, 2
    s_lshl_b32 s84, s83, 13
    s_and_b32 s84, s84, 16384
    s_cmp_eq_u32 s87, 3
    s_cselect_b32 s87, 0, s87
    s_cselect_b32 s70, s83, s70
    s_cselect_b32 s74, s84, s74
    s_add_u32 m0, s37, 0
    s_waitcnt vmcnt(17)
    buffer_load_dwordx4 v12, s[8:11], s34 offen offset:0 nt lds
    s_waitcnt vmcnt(17)
    buffer_load_dwordx4 v13, s[8:11], s34 offen offset:1024 nt lds
    v_subrev_u32 v27, 2, v23
    ds_write_b32 v22, v27
    s_waitcnt vmcnt(17)
    buffer_load_dwordx4 v14, s[8:11], s34 offen offset:2048 nt lds
    s_waitcnt vmcnt(17)
    buffer_load_dwordx4 v15, s[8:11], s34 offen offset:3072 nt lds
    s_add_u32 m0, s37, 4096
    s_waitcnt vmcnt(17)
    buffer_load_dwordx4 v12, s[8:11], s35 offen offset:0 nt lds
    s_waitcnt vmcnt(17)
    buffer_load_dwordx4 v13, s[8:11], s35 offen offset:1024 nt lds
    s_waitcnt vmcnt(17)
    buffer_load_dwordx4 v14, s[8:11], s35 offen offset:2048 nt lds
    s_waitcnt vmcnt(17)
    buffer_load_dwordx4 v15, s[8:11], s35 offen offset:3072 nt lds
    v_add_u32 v23, 1, v23
    s_add_u32 s75, s75, 1
    s_add_u32 s38, s38, 1
    s_add_u32 s37, s37, 32768
    s_add_u32 s83, s39, 2
    s_lshl_b32 s84, s83, 13
    s_and_b32 s84, s84, 16384
    s_add_u32 s84, s84, 8192
    s_cmp_eq_u32 s38, 3
    s_cselect_b32 s38, 0, s38
    s_cselect_b32 s39, s83, s39
    s_cselect_b32 s37, s84, s37
    s_cmp_lt_u32 s36, s77
    s_cbranch_scc1 L_lp2_73
L_tl_73:
    v_readlane_b32 s34, v20, s75
    v_readlane_b32 s35, v21, s75
L_chv_73:
    s_waitcnt lgkmcnt(0)
    v_readlane_b32 s84, v25, s38
    ds_read_b32 v25, v24
    s_cmp_lt_u32 s39, 4
    s_cselect_b32 s84, s39, s84
    s_cmp_lt_u32 s84, s39
    s_cbranch_scc1 L_chv_73
    s_add_u32 m0, s37, 0
    s_waitcnt vmcnt(17)
    buffer_load_dwordx4 v12, s[8:11], s34 offen offset:0 nt lds
    s_waitcnt vmcnt(17)
    buffer_load_dwordx4 v13, s[8:11], s34 offen offset:1024 nt lds
    v_subrev_u32 v27, 2, v23
    ds_write_b32 v22, v27
    s_waitcnt vmcnt(17)
    buffer_load_dwordx4 v14, s[8:11], s34 offen offset:2048 nt lds
    s_waitcnt vmcnt(17)
    buffer_load_dwordx4 v15, s[8:11], s34 offen offset:3072 nt lds
    s_add_u32 m0, s37, 4096
    s_waitcnt vmcnt(17)
    buffer_load_dwordx4 v12, s[8:11], s35 offen offset:0 nt lds
    s_waitcnt vmcnt(17)
    buffer_load_dwordx4 v13, s[8:11], s35 offen offset:1024 nt lds
    s_waitcnt vmcnt(17)
    buffer_load_dwordx4 v14, s[8:11], s35 offen offset:2048 nt lds
    s_waitcnt vmcnt(17)
    buffer_load_dwordx4 v15, s[8:11], s35 offen offset:3072 nt lds
    v_add_u32 v23, 1, v23
    s_add_u32 s75, s75, 1
    s_add_u32 s38, s38, 1
    s_add_u32 s37, s37, 32768
    s_add_u32 s83, s39, 2
    s_lshl_b32 s84, s83, 13
    s_and_b32 s84, s84, 16384
    s_add_u32 s84, s84, 8192
    s_cmp_eq_u32 s38, 3
    s_cselect_b32 s38, 0, s38
    s_cselect_b32 s39, s83, s39
    s_cselect_b32 s37, s84, s37
    s_cmp_lt_u32 s75, s77
    s_cbranch_scc1 L_tl_73
    s_waitcnt vmcnt(16)
    v_subrev_u32 v27, 2, v23
    ds_write_b32 v22, v27
    s_waitcnt vmcnt(8)
    v_subrev_u32 v27, 1, v23
    ds_write_b32 v22, v27
    s_waitcnt vmcnt(0)
    ds_write_b32 v22, v23
    s_branch L_ldone
L_var_74:
    s_cmp_ge_u32 s36, s68
    s_cbranch_scc1 L_lp_74
L_pk_74:
    v_readlane_b32 s80, v20, s36
    v_readlane_b32 s81, v21, s36
    s_nop 2
    s_add_u32 m0, s74, 0
    s_waitcnt vmcnt(18)
    buffer_load_dwordx4 v8, s[4:7], s80 offen offset:0 nt lds
    s_waitcnt vmcnt(18)
    buffer_load_dwordx4 v9, s[4:7], s80 offen offset:1024 nt lds
    s_waitcnt vmcnt(18)
    buffer_load_dwordx4 v10, s[4:7], s80 offen offset:2048 nt lds
    v_subrev_u32 v27, 2, v23
    ds_write_b32 v22, v27
    s_waitcnt vmcnt(18)
    buffer_load_dwordx4 v11, s[4:7], s80 offen offset:3072 nt lds
    s_add_u32 m0, s74, 4096
    s_waitcnt vmcnt(18)
    buffer_load_dwordx4 v8, s[4:7], s81 offen offset:0 nt lds
    s_waitcnt vmcnt(18)
    buffer_load_dwordx4 v9, s[4:7], s81 offen offset:1024 nt lds
    s_waitcnt vmcnt(18)
    buffer_load_dwordx4 v10, s[4:7], s81 offen offset:2048 nt lds
    s_waitcnt vmcnt(18)
    buffer_load_dwordx4 v11, s[4:7], s81 offen offset:3072 nt lds
    v_add_u32 v23, 1, v23
    s_add_u32 s36, s36, 1
    s_add_u32 s87, s87, 1
    s_add_u32 s74, s74, 32768
    s_add_u32 s83, s70, 2
    s_lshl_b32 s84, s83, 13
    s_and_b32 s84, s84, 16384
    s_cmp_eq_u32 s87, 3
    s_cselect_b32 s87, 0, s87
    s_cselect_b32 s70, s83, s70
    s_cselect_b32 s74, s84, s74
    s_cmp_lt_u32 s36, s68
    s_cbranch_scc1 L_pk_74
L_lp_74:
    s_cmp_ge_u32 s36, s77
    s_cbranch_scc1 L_tl_74
L_lp2_74:
    v_readlane_b32 s34, v20, s75
    v_readlane_b32 s35, v21, s75
    v_readlane_b32 s80, v20, s36
    v_readlane_b32 s81, v21, s36
L_chk_74:
    s_waitcnt lgkmcnt(0)
    v_readlane_b32 s83, v25, s87
    v_readlane_b32 s84, v25, s38
    ds_read_b32 v25, v24
    s_cmp_lt_u32 s39, 4
    s_cselect_b32 s84, s39, s84
    s_cmp_lt_u32 s84, s39
    s_cbranch_scc1 L_chk_74
    s_add_u32 s83, s83, 3
    s_cmp_lt_u32 s83, s70
    s_cbranch_scc1 L_chk_74
    s_add_u32 m0, s74, 0
    s_waitcnt vmcnt(18)
    buffer_load_dwordx4 v8, s[4:7], s80 offen offset:0 nt lds
    s_waitcnt vmcnt(18)
    buffer_load_dwordx4 v9, s[4:7], s80 offen offset:1024 nt lds
    s_waitcnt vmcnt(18)
    buffer_load_dwordx4 v10, s[4:7], s80 offen offset:2048 nt lds
    v_subrev_u32 v27, 2, v23
    ds_write_b32 v22, v27
    s_waitcnt vmcnt(18)
    buffer_load_dwordx4 v11, s[4:7], s80 offen offset:3072 nt lds
    s_add_u32 m0, s74, 4096
    s_waitcnt vmcnt(18)
    buffer_load_dwordx4 v8, s[4:7], s81 offen offset:0 nt lds
    s_waitcnt vmcnt(18)
    buffer_load_dwordx4 v9, s[4:7], s81 offen offset:1024 nt lds
    s_waitcnt vmcnt(18)
    buffer_load_dwordx4 v10, s[4:7], s81 offen offset:2048 nt lds
    s_waitcnt vmcnt(18)
    buffer_load_dwordx4 v11, s[4:7], s81 offen offset:3072 nt lds
    v_add_u32 v23, 1, v23
    s_add_u32 s36, s36, 1
    s_add_u32 s87, s87, 1
    s_add_u32 s74, s74, 32768
    s_add_u32 s83, s70, 2
    s_lshl_b32 s84, s83, 13
    s_and_b32 s84, s84, 16384
    s_cmp_eq_u32 s87, 3
    s_cselect_b32 s87, 0, s87
    s_cselect_b32 s70, s83, s70
    s_cselect_b32 s74, s84, s74
    s_add_u32 m0, s37, 0
    s_waitcnt vmcnt(17)
    buffer_load_dwordx4 v12, s[8:11], s34 offen offset:0 nt lds
    s_waitcnt vmcnt(17)
    buffer_load_dwordx4 v13, s[8:11], s34 offen offset:1024 nt lds
    v_subrev_u32 v27, 2, v23
    ds_write_b32 v22, v27
    s_waitcnt vmcnt(17)
    buffer_load_dwordx4 v14, s[8:11], s34 offen offset:2048 nt lds
    s_waitcnt vmcnt(17)
    buffer_load_dwordx4 v15, s[8:11], s34 offen offset:3072 nt lds
    s_add_u32 m0, s37, 4096
    s_waitcnt vmcnt(17)
    buffer_load_dwordx4 v12, s[8:11], s35 offen offset:0 nt lds
    s_waitcnt vmcnt(17)
    buffer_load_dwordx4 v13, s[8:11], s35 offen offset:1024 nt lds
    s_waitcnt vmcnt(17)
    buffer_load_dwordx4 v14, s[8:11], s35 offen offset:2048 nt lds
    s_waitcnt vmcnt(17)
    buffer_load_dwordx4 v15, s[8:11], s35 offen offset:3072 nt lds
    v_add_u32 v23, 1, v23
    s_add_u32 s75, s75, 1
    s_add_u32 s38, s38, 1
    s_add_u32 s37, s37, 32768
    s_add_u32 s83, s39, 2
    s_lshl_b32 s84, s83, 13
    s_and_b32 s84, s84, 16384
    s_add_u32 s84, s84, 8192
    s_cmp_eq_u32 s38, 3
    s_cselect_b32 s38, 0, s38
    s_cselect_b32 s39, s83, s39
    s_cselect_b32 s37, s84, s37
    s_cmp_lt_u32 s36, s77
    s_cbranch_scc1 L_lp2_74
L_tl_74:
    v_readlane_b32 s34, v20, s75
    v_readlane_b32 s35, v21, s75
L_chv_74:
    s_waitcnt lgkmcnt(0)
    v_readlane_b32 s84, v25, s38
    ds_read_b32 v25, v24
    s_cmp_lt_u32 s39, 4
    s_cselect_b32 s84, s39, s84
    s_cmp_lt_u32 s84, s39
    s_cbranch_scc1 L_chv_74
    s_add_u32 m0, s37, 0
    s_waitcnt vmcnt(17)
    buffer_load_dwordx4 v12, s[8:11], s34 offen offset:0 nt lds
    s_waitcnt vmcnt(17)
    buffer_load_dwordx4 v13, s[8:11], s34 offen offset:1024 nt lds
    v_subrev_u32 v27, 2, v23
    ds_write_b32 v22, v27
    s_waitcnt vmcnt(17)
    buffer_load_dwordx4 v14, s[8:11], s34 offen offset:2048 nt lds
    s_waitcnt vmcnt(17)
    buffer_load_dwordx4 v15, s[8:11], s34 offen offset:3072 nt lds
    s_add_u32 m0, s37, 4096
    s_waitcnt vmcnt(17)
    buffer_load_dwordx4 v12, s[8:11], s35 offen offset:0 nt lds
    s_waitcnt vmcnt(17)
    buffer_load_dwordx4 v13, s[8:11], s35 offen offset:1024 nt lds
    s_waitcnt vmcnt(17)
    buffer_load_dwordx4 v14, s[8:11], s35 offen offset:2048 nt lds
    s_waitcnt vmcnt(17)
    buffer_load_dwordx4 v15, s[8:11], s35 offen offset:3072 nt lds
    v_add_u32 v23, 1, v23
    s_add_u32 s75, s75, 1
    s_add_u32 s38, s38, 1
    s_add_u32 s37, s37, 32768
    s_add_u32 s83, s39, 2
    s_lshl_b32 s84, s83, 13
    s_and_b32 s84, s84, 16384
    s_add_u32 s84, s84, 8192
    s_cmp_eq_u32 s38, 3
    s_cselect_b32 s38, 0, s38
    s_cselect_b32 s39, s83, s39
    s_cselect_b32 s37, s84, s37
    s_cmp_lt_u32 s75, s77
    s_cbranch_scc1 L_tl_74
    s_waitcnt vmcnt(16)
    v_subrev_u32 v27, 2, v23
    ds_write_b32 v22, v27
    s_waitcnt vmcnt(8)
    v_subrev_u32 v27, 1, v23
    ds_write_b32 v22, v27
    s_waitcnt vmcnt(0)
    ds_write_b32 v22, v23
    s_branch L_ldone
L_var_75:
    s_cmp_ge_u32 s36, s68
    s_cbranch_scc1 L_lp_75
L_pk_75:
    v_readlane_b32 s80, v20, s36
    v_readlane_b32 s81, v21, s36
    s_nop 2
    s_add_u32 m0, s74, 0
    s_waitcnt vmcnt(18)
    buffer_load_dwordx4 v8, s[4:7], s80 offen offset:0 nt lds
    s_waitcnt vmcnt(18)
    buffer_load_dwordx4 v9, s[4:7], s80 offen offset:1024 nt lds
    s_waitcnt vmcnt(18)
    buffer_load_dwordx4 v10, s[4:7], s80 offen offset:2048 nt lds
    v_subrev_u32 v27, 2, v23
    ds_write_b32 v22, v27
    s_waitcnt vmcnt(18)
    buffer_load_dwordx4 v11, s[4:7], s80 offen offset:3072 nt lds
    s_add_u32 m0, s74, 4096
    s_waitcnt vmcnt(18)
    buffer_load_dwordx4 v8, s[4:7], s81 offen offset:0 nt lds
    s_waitcnt vmcnt(18)
    buffer_load_dwordx4 v9, s[4:7], s81 offen offset:1024 nt lds
    s_waitcnt vmcnt(18)
    buffer_load_dwordx4 v10, s[4:7], s81 offen offset:2048 nt lds
    s_waitcnt vmcnt(18)
    buffer_load_dwordx4 v11, s[4:7], s81 offen offset:3072 nt lds
    v_add_u32 v23, 1, v23
    s_add_u32 s36, s36, 1
    s_add_u32 s87, s87, 1
    s_add_u32 s74, s74, 32768
    s_add_u32 s83, s70, 2
    s_lshl_b32 s84, s83, 13
    s_and_b32 s84, s84, 16384
    s_cmp_eq_u32 s87, 3
    s_cselect_b32 s87, 0, s87
    s_cselect_b32 s70, s83, s70
    s_cselect_b32 s74, s84, s74
    s_cmp_lt_u32 s36, s68
    s_cbranch_scc1 L_pk_75
L_lp_75:
    s_cmp_ge_u32 s36, s77
    s_cbranch_scc1 L_tl_75
L_lp2_75:
    v_readlane_b32 s34, v20, s75
    v_readlane_b32 s35, v21, s75
    v_readlane_b32 s80, v20, s36
    v_readlane_b32 s81, v21, s36
L_chk_75:
    s_waitcnt lgkmcnt(0)
    v_readlane_b32 s83, v25, s87
    v_readlane_b32 s84, v25, s38
    ds_read_b32 v25, v24
    s_cmp_lt_u32 s39, 4
    s_cselect_b32 s84, s39, s84
    s_cmp_lt_u32 s84, s39
    s_cbranch_scc1 L_chk_75
    s_add_u32 s83, s83, 3
    s_cmp_lt_u32 s83, s70
    s_cbranch_scc1 L_chk_75
    s_add_u32 m0, s74, 0
    s_waitcnt vmcnt(18)
    buffer_load_dwordx4 v8, s[4:7], s80 offen offset:0 nt lds
    s_waitcnt vmcnt(18)
    buffer_load_dwordx4 v9, s[4:7], s80 offen offset:1024 nt lds
    s_waitcnt vmcnt(18)
    buffer_load_dwordx4 v10, s[4:7], s80 offen offset:2048 nt lds
    v_subrev_u32 v27, 2, v23
    ds_write_b32 v22, v27
    s_waitcnt vmcnt(18)
    buffer_load_dwordx4 v11, s[4:7], s80 offen offset:3072 nt lds
    s_add_u32 m0, s74, 4096
    s_waitcnt vmcnt(18)
    buffer_load_dwordx4 v8, s[4:7], s81 offen offset:0 nt lds
    s_waitcnt vmcnt(18)
    buffer_load_dwordx4 v9, s[4:7], s81 offen offset:1024 nt lds
    s_waitcnt vmcnt(18)
    buffer_load_dwordx4 v10, s[4:7], s81 offen offset:2048 nt lds
    s_waitcnt vmcnt(18)
    buffer_load_dwordx4 v11, s[4:7], s81 offen offset:3072 nt lds
    v_add_u32 v23, 1, v23
    s_add_u32 s36, s36, 1
    s_add_u32 s87, s87, 1
    s_add_u32 s74, s74, 32768
    s_add_u32 s83, s70, 2
    s_lshl_b32 s84, s83, 13
    s_and_b32 s84, s84, 16384
    s_cmp_eq_u32 s87, 3
    s_cselect_b32 s87, 0, s87
    s_cselect_b32 s70, s83, s70
    s_cselect_b32 s74, s84, s74
    s_add_u32 m0, s37, 0
    s_waitcnt vmcnt(18)
    buffer_load_dwordx4 v12, s[8:11], s34 offen offset:0 nt lds
    s_waitcnt vmcnt(18)
    buffer_load_dwordx4 v13, s[8:11], s34 offen offset:1024 nt lds
    s_waitcnt vmcnt(18)
    buffer_load_dwordx4 v14, s[8:11], s34 offen offset:2048 nt lds
    v_subrev_u32 v27, 2, v23
    ds_write_b32 v22, v27
    s_waitcnt vmcnt(18)
    buffer_load_dwordx4 v15, s[8:11], s34 offen offset:3072 nt lds
    s_add_u32 m0, s37, 4096
    s_waitcnt vmcnt(17)
    buffer_load_dwordx4 v12, s[8:11], s35 offen offset:0 nt lds
    s_waitcnt vmcnt(17)
    buffer_load_dwordx4 v13, s[8:11], s35 offen offset:1024 nt lds
    s_waitcnt vmcnt(17)
    buffer_load_dwordx4 v14, s[8:11], s35 offen offset:2048 nt lds
    s_waitcnt vmcnt(17)
    buffer_load_dwordx4 v15, s[8:11], s35 offen offset:3072 nt lds
    v_add_u32 v23, 1, v23
    s_add_u32 s75, s75, 1
    s_add_u32 s38, s38, 1
    s_add_u32 s37, s37, 32768
    s_add_u32 s83, s39, 2
    s_lshl_b32 s84, s83, 13
    s_and_b32 s84, s84, 16384
    s_add_u32 s84, s84, 8192
    s_cmp_eq_u32 s38, 3
    s_cselect_b32 s38, 0, s38
    s_cselect_b32 s39, s83, s39
    s_cselect_b32 s37, s84, s37
    s_cmp_lt_u32 s36, s77
    s_cbranch_scc1 L_lp2_75
L_tl_75:
    v_readlane_b32 s34, v20, s75
    v_readlane_b32 s35, v21, s75
L_chv_75:
    s_waitcnt lgkmcnt(0)
    v_readlane_b32 s84, v25, s38
    ds_read_b32 v25, v24
    s_cmp_lt_u32 s39, 4
    s_cselect_b32 s84, s39, s84
    s_cmp_lt_u32 s84, s39
    s_cbranch_scc1 L_chv_75
    s_add_u32 m0, s37, 0
    s_waitcnt vmcnt(18)
    buffer_load_dwordx4 v12, s[8:11], s34 offen offset:0 nt lds
    s_waitcnt vmcnt(18)
    buffer_load_dwordx4 v13, s[8:11], s34 offen offset:1024 nt lds
    s_waitcnt vmcnt(18)
    buffer_load_dwordx4 v14, s[8:11], s34 offen offset:2048 nt lds
    v_subrev_u32 v27, 2, v23
    ds_write_b32 v22, v27
    s_waitcnt vmcnt(18)
    buffer_load_dwordx4 v15, s[8:11], s34 offen offset:3072 nt lds
    s_add_u32 m0, s37, 4096
    s_waitcnt vmcnt(18)
    buffer_load_dwordx4 v12, s[8:11], s35 offen offset:0 nt lds
    s_waitcnt vmcnt(18)
    buffer_load_dwordx4 v13, s[8:11], s35 offen offset:1024 nt lds
    s_waitcnt vmcnt(18)
    buffer_load_dwordx4 v14, s[8:11], s35 offen offset:2048 nt lds
    s_waitcnt vmcnt(18)
    buffer_load_dwordx4 v15, s[8:11], s35 offen offset:3072 nt lds
    v_add_u32 v23, 1, v23
    s_add_u32 s75, s75, 1
    s_add_u32 s38, s38, 1
    s_add_u32 s37, s37, 32768
    s_add_u32 s83, s39, 2
    s_lshl_b32 s84, s83, 13
    s_and_b32 s84, s84, 16384
    s_add_u32 s84, s84, 8192
    s_cmp_eq_u32 s38, 3
    s_cselect_b32 s38, 0, s38
    s_cselect_b32 s39, s83, s39
    s_cselect_b32 s37, s84, s37
    s_cmp_lt_u32 s75, s77
    s_cbranch_scc1 L_tl_75
    s_waitcnt vmcnt(16)
    v_subrev_u32 v27, 2, v23
    ds_write_b32 v22, v27
    s_waitcnt vmcnt(8)
    v_subrev_u32 v27, 1, v23
    ds_write_b32 v22, v27
    s_waitcnt vmcnt(0)
    ds_write_b32 v22, v23
    s_branch L_ldone
L_var_76:
    s_cmp_ge_u32 s36, s68
    s_cbranch_scc1 L_lp_76
L_pk_76:
    v_readlane_b32 s80, v20, s36
    v_readlane_b32 s81, v21, s36
    s_nop 2
    s_add_u32 m0, s74, 0
    s_waitcnt vmcnt(18)
    buffer_load_dwordx4 v8, s[4:7], s80 offen offset:0 nt lds
    s_waitcnt vmcnt(18)
    buffer_load_dwordx4 v9, s[4:7], s80 offen offset:1024 nt lds
    s_waitcnt vmcnt(18)
    buffer_load_dwordx4 v10, s[4:7], s80 offen offset:2048 nt lds
    v_subrev_u32 v27, 2, v23
    ds_write_b32 v22, v27
    s_waitcnt vmcnt(18)
    buffer_load_dwordx4 v11, s[4:7], s80 offen offset:3072 nt lds
    s_add_u32 m0, s74, 4096
    s_waitcnt vmcnt(18)
    buffer_load_dwordx4 v8, s[4:7], s81 offen offset:0 nt lds
    s_waitcnt vmcnt(18)
    buffer_load_dwordx4 v9, s[4:7], s81 offen offset:1024 nt lds
    s_waitcnt vmcnt(18)
    buffer_load_dwordx4 v10, s[4:7], s81 offen offset:2048 nt lds
    s_waitcnt vmcnt(18)
    buffer_load_dwordx4 v11, s[4:7], s81 offen offset:3072 nt lds
    v_add_u32 v23, 1, v23
    s_add_u32 s36, s36, 1
    s_add_u32 s87, s87, 1
    s_add_u32 s74, s74, 32768
    s_add_u32 s83, s70, 2
    s_lshl_b32 s84, s83, 13
    s_and_b32 s84, s84, 16384
    s_cmp_eq_u32 s87, 3
    s_cselect_b32 s87, 0, s87
    s_cselect_b32 s70, s83, s70
    s_cselect_b32 s74, s84, s74
    s_cmp_lt_u32 s36, s68
    s_cbranch_scc1 L_pk_76
L_lp_76:
    s_cmp_ge_u32 s36, s77
    s_cbranch_scc1 L_tl_76
L_lp2_76:
    v_readlane_b32 s34, v20, s75
    v_readlane_b32 s35, v21, s75
    v_readlane_b32 s80, v20, s36
    v_readlane_b32 s81, v21, s36
L_chk_76:
    s_waitcnt lgkmcnt(0)
    v_readlane_b32 s83, v25, s87
    v_readlane_b32 s84, v25, s38
    ds_read_b32 v25, v24
    s_cmp_lt_u32 s39, 4
    s_cselect_b32 s84, s39, s84
    s_cmp_lt_u32 s84, s39
    s_cbranch_scc1 L_chk_76
    s_add_u32 s83, s83, 3
    s_cmp_lt_u32 s83, s70
    s_cbranch_scc1 L_chk_76
    s_add_u32 m0, s74, 0
    s_waitcnt vmcnt(18)
    buffer_load_dwordx4 v8, s[4:7], s80 offen offset:0 nt lds
    s_waitcnt vmcnt(18)
    buffer_load_dwordx4 v9, s[4:7], s80 offen offset:1024 nt lds
    s_waitcnt vmcnt(18)
    buffer_load_dwordx4 v10, s[4:7], s80 offen offset:2048 nt lds
    v_subrev_u32 v27, 2, v23
    ds_write_b32 v22, v27
    s_waitcnt vmcnt(18)
    buffer_load_dwordx4 v11, s[4:7], s80 offen offset:3072 nt lds
    s_add_u32 m0, s74, 4096
    s_waitcnt vmcnt(18)
    buffer_load_dwordx4 v8, s[4:7], s81 offen offset:0 nt lds
    s_waitcnt vmcnt(18)
    buffer_load_dwordx4 v9, s[4:7], s81 offen offset:1024 nt lds
    s_waitcnt vmcnt(18)
    buffer_load_dwordx4 v10, s[4:7], s81 offen offset:2048 nt lds
    s_waitcnt vmcnt(18)
    buffer_load_dwordx4 v11, s[4:7], s81 offen offset:3072 nt lds
    v_add_u32 v23, 1, v23
    s_add_u32 s36, s36, 1
    s_add_u32 s87, s87, 1
    s_add_u32 s74, s74, 32768
    s_add_u32 s83, s70, 2
    s_lshl_b32 s84, s83, 13
    s_and_b32 s84, s84, 16384
    s_cmp_eq_u32 s87, 3
    s_cselect_b32 s87, 0, s87
    s_cselect_b32 s70, s83, s70
    s_cselect_b32 s74, s84, s74
    s_add_u32 m0, s37, 0
    s_waitcnt vmcnt(18)
    buffer_load_dwordx4 v12, s[8:11], s34 offen offset:0 nt lds
    s_waitcnt vmcnt(18)
    buffer_load_dwordx4 v13, s[8:11], s34 offen offset:1024 nt lds
    s_waitcnt vmcnt(18)
    buffer_load_dwordx4 v14, s[8:11], s34 offen offset:2048 nt lds
    v_subrev_u32 v27, 2, v23
    ds_write_b32 v22, v27
    s_waitcnt vmcnt(18)
    buffer_load_dwordx4 v15, s[8:11], s34 offen offset:3072 nt lds
    s_add_u32 m0, s37, 4096
    s_waitcnt vmcnt(18)
    buffer_load_dwordx4 v12, s[8:11], s35 offen offset:0 nt lds
    s_waitcnt vmcnt(18)
    buffer_load_dwordx4 v13, s[8:11], s35 offen offset:1024 nt lds
    s_waitcnt vmcnt(18)
    buffer_load_dwordx4 v14, s[8:11], s35 offen offset:2048 nt lds
    s_waitcnt vmcnt(18)
    buffer_load_dwordx4 v15, s[8:11], s35 offen offset:3072 nt lds
    v_add_u32 v23, 1, v23
    s_add_u32 s75, s75, 1
    s_add_u32 s38, s38, 1
    s_add_u32 s37, s37, 32768
    s_add_u32 s83, s39, 2
    s_lshl_b32 s84, s83, 13
    s_and_b32 s84, s84, 16384
    s_add_u32 s84, s84, 8192
    s_cmp_eq_u32 s38, 3
    s_cselect_b32 s38, 0, s38
    s_cselect_b32 s39, s83, s39
    s_cselect_b32 s37, s84, s37
    s_cmp_lt_u32 s36, s77
    s_cbranch_scc1 L_lp2_76
L_tl_76:
    v_readlane_b32 s34, v20, s75
    v_readlane_b32 s35, v21, s75
L_chv_76:
    s_waitcnt lgkmcnt(0)
    v_readlane_b32 s84, v25, s38
    ds_read_b32 v25, v24
    s_cmp_lt_u32 s39, 4
    s_cselect_b32 s84, s39, s84
    s_cmp_lt_u32 s84, s39
    s_cbranch_scc1 L_chv_76
    s_add_u32 m0, s37, 0
    s_waitcnt vmcnt(18)
    buffer_load_dwordx4 v12, s[8:11], s34 offen offset:0 nt lds
    s_waitcnt vmcnt(18)
    buffer_load_dwordx4 v13, s[8:11], s34 offen offset:1024 nt lds
    s_waitcnt vmcnt(18)
    buffer_load_dwordx4 v14, s[8:11], s34 offen offset:2048 nt lds
    v_subrev_u32 v27, 2, v23
    ds_write_b32 v22, v27
    s_waitcnt vmcnt(18)
    buffer_load_dwordx4 v15, s[8:11], s34 offen offset:3072 nt lds
    s_add_u32 m0, s37, 4096
    s_waitcnt vmcnt(18)
    buffer_load_dwordx4 v12, s[8:11], s35 offen offset:0 nt lds
    s_waitcnt vmcnt(18)
    buffer_load_dwordx4 v13, s[8:11], s35 offen offset:1024 nt lds
    s_waitcnt vmcnt(18)
    buffer_load_dwordx4 v14, s[8:11], s35 offen offset:2048 nt lds
    s_waitcnt vmcnt(18)
    buffer_load_dwordx4 v15, s[8:11], s35 offen offset:3072 nt lds
    v_add_u32 v23, 1, v23
    s_add_u32 s75, s75, 1
    s_add_u32 s38, s38, 1
    s_add_u32 s37, s37, 32768
    s_add_u32 s83, s39, 2
    s_lshl_b32 s84, s83, 13
    s_and_b32 s84, s84, 16384
    s_add_u32 s84, s84, 8192
    s_cmp_eq_u32 s38, 3
    s_cselect_b32 s38, 0, s38
    s_cselect_b32 s39, s83, s39
    s_cselect_b32 s37, s84, s37
    s_cmp_lt_u32 s75, s77
    s_cbranch_scc1 L_tl_76
    s_waitcnt vmcnt(16)
    v_subrev_u32 v27, 2, v23
    ds_write_b32 v22, v27
    s_waitcnt vmcnt(8)
    v_subrev_u32 v27, 1, v23
    ds_write_b32 v22, v27
    s_waitcnt vmcnt(0)
    ds_write_b32 v22, v23
    s_branch L_ldone
L_var_78:
    s_cmp_ge_u32 s36, s68
    s_cbranch_scc1 L_lp_78
L_pk_78:
    v_readlane_b32 s80, v20, s36
    v_readlane_b32 s81, v21, s36
    s_nop 2
    s_add_u32 m0, s74, 0
    s_waitcnt vmcnt(19)
    buffer_load_dwordx4 v8, s[4:7], s80 offen offset:0 nt lds
    s_waitcnt vmcnt(19)
    buffer_load_dwordx4 v9, s[4:7], s80 offen offset:1024 nt lds
    s_waitcnt vmcnt(19)
    buffer_load_dwordx4 v10, s[4:7], s80 offen offset:2048 nt lds
    s_waitcnt vmcnt(19)
    buffer_load_dwordx4 v11, s[4:7], s80 offen offset:3072 nt lds
    v_subrev_u32 v27, 2, v23
    ds_write_b32 v22, v27
    s_add_u32 m0, s74, 4096
    s_waitcnt vmcnt(19)
    buffer_load_dwordx4 v8, s[4:7], s81 offen offset:0 nt lds
    s_waitcnt vmcnt(19)
    buffer_load_dwordx4 v9, s[4:7], s81 offen offset:1024 nt lds
    s_waitcnt vmcnt(19)
    buffer_load_dwordx4 v10, s[4:7], s81 offen offset:2048 nt lds
    s_waitcnt vmcnt(19)
    buffer_load_dwordx4 v11, s[4:7], s81 offen offset:3072 nt lds
    v_add_u32 v23, 1, v23
    s_add_u32 s36, s36, 1
    s_add_u32 s87, s87, 1
    s_add_u32 s74, s74, 32768
    s_add_u32 s83, s70, 2
    s_lshl_b32 s84, s83, 13
    s_and_b32 s84, s84, 16384
    s_cmp_eq_u32 s87, 3
    s_cselect_b32 s87, 0, s87
    s_cselect_b32 s70, s83, s70
    s_cselect_b32 s74, s84, s74
    s_cmp_lt_u32 s36, s68
    s_cbranch_scc1 L_pk_78
L_lp_78:
    s_cmp_ge_u32 s36, s77
    s_cbranch_scc1 L_tl_78
L_lp2_78:
    v_readlane_b32 s34, v20, s75
    v_readlane_b32 s35, v21, s75
    v_readlane_b32 s80, v20, s36
    v_readlane_b32 s81, v21, s36
L_chk_78:
    s_waitcnt lgkmcnt(0)
    v_readlane_b32 s83, v25, s87
    v_readlane_b32 s84, v25, s38
    ds_read_b32 v25, v24
    s_cmp_lt_u32 s39, 4
    s_cselect_b32 s84, s39, s84
    s_cmp_lt_u32 s84, s39
    s_cbranch_scc1 L_chk_78
    s_add_u32 s83, s83, 3
    s_cmp_lt_u32 s83, s70
    s_cbranch_scc1 L_chk_78
    s_add_u32 m0, s74, 0
    s_waitcnt vmcnt(19)
    buffer_load_dwordx4 v8, s[4:7], s80 offen offset:0 nt lds
    s_waitcnt vmcnt(19)
    buffer_load_dwordx4 v9, s[4:7], s80 offen offset:1024 nt lds
    s_waitcnt vmcnt(19)
    buffer_load_dwordx4 v10, s[4:7], s80 offen offset:2048 nt lds
    s_waitcnt vmcnt(19)
    buffer_load_dwordx4 v11, s[4:7], s80 offen offset:3072 nt lds
    v_subrev_u32 v27, 2, v23
    ds_write_b32 v22, v27
    s_add_u32 m0, s74, 4096
    s_waitcnt vmcnt(19)
    buffer_load_dwordx4 v8, s[4:7], s81 offen offset:0 nt lds
    s_waitcnt vmcnt(19)
    buffer_load_dwordx4 v9, s[4:7], s81 offen offset:1024 nt lds
    s_waitcnt vmcnt(19)
    buffer_load_dwordx4 v10, s[4:7], s81 offen offset:2048 nt lds
    s_waitcnt vmcnt(19)
    buffer_load_dwordx4 v11, s[4:7], s81 offen offset:3072 nt lds
    v_add_u32 v23, 1, v23
    s_add_u32 s36, s36, 1
    s_add_u32 s87, s87, 1
    s_add_u32 s74, s74, 32768
    s_add_u32 s83, s70, 2
    s_lshl_b32 s84, s83, 13
    s_and_b32 s84, s84, 16384
    s_cmp_eq_u32 s87, 3
    s_cselect_b32 s87, 0, s87
    s_cselect_b32 s70, s83, s70
    s_cselect_b32 s74, s84, s74
    s_add_u32 m0, s37, 0
    s_waitcnt vmcnt(18)
    buffer_load_dwordx4 v12, s[8:11], s34 offen offset:0 nt lds
    s_waitcnt vmcnt(18)
    buffer_load_dwordx4 v13, s[8:11], s34 offen offset:1024 nt lds
    s_waitcnt vmcnt(18)
    buffer_load_dwordx4 v14, s[8:11], s34 offen offset:2048 nt lds
    v_subrev_u32 v27, 2, v23
    ds_write_b32 v22, v27
    s_waitcnt vmcnt(18)
    buffer_load_dwordx4 v15, s[8:11], s34 offen offset:3072 nt lds
    s_add_u32 m0, s37, 4096
    s_waitcnt vmcnt(18)
    buffer_load_dwordx4 v12, s[8:11], s35 offen offset:0 nt lds
    s_waitcnt vmcnt(18)
    buffer_load_dwordx4 v13, s[8:11], s35 offen offset:1024 nt lds
    s_waitcnt vmcnt(18)
    buffer_load_dwordx4 v14, s[8:11], s35 offen offset:2048 nt lds
    s_waitcnt vmcnt(18)
    buffer_load_dwordx4 v15, s[8:11], s35 offen offset:3072 nt lds
    v_add_u32 v23, 1, v23
    s_add_u32 s75, s75, 1
    s_add_u32 s38, s38, 1
    s_add_u32 s37, s37, 32768
    s_add_u32 s83, s39, 2
    s_lshl_b32 s84, s83, 13
    s_and_b32 s84, s84, 16384
    s_add_u32 s84, s84, 8192
    s_cmp_eq_u32 s38, 3
    s_cselect_b32 s38, 0, s38
    s_cselect_b32 s39, s83, s39
    s_cselect_b32 s37, s84, s37
    s_cmp_lt_u32 s36, s77
    s_cbranch_scc1 L_lp2_78
L_tl_78:
    v_readlane_b32 s34, v20, s75
    v_readlane_b32 s35, v21, s75
L_chv_78:
    s_waitcnt lgkmcnt(0)
    v_readlane_b32 s84, v25, s38
    ds_read_b32 v25, v24
    s_cmp_lt_u32 s39, 4
    s_cselect_b32 s84, s39, s84
    s_cmp_lt_u32 s84, s39
    s_cbranch_scc1 L_chv_78
    s_add_u32 m0, s37, 0
    s_waitcnt vmcnt(19)
    buffer_load_dwordx4 v12, s[8:11], s34 offen offset:0 nt lds
    s_waitcnt vmcnt(19)
    buffer_load_dwordx4 v13, s[8:11], s34 offen offset:1024 nt lds
    s_waitcnt vmcnt(19)
    buffer_load_dwordx4 v14, s[8:11], s34 offen offset:2048 nt lds
    s_waitcnt vmcnt(19)
    buffer_load_dwordx4 v15, s[8:11], s34 offen offset:3072 nt lds
    v_subrev_u32 v27, 2, v23
    ds_write_b32 v22, v27
    s_add_u32 m0, s37, 4096
    s_waitcnt vmcnt(19)
    buffer_load_dwordx4 v12, s[8:11], s35 offen offset:0 nt lds
    s_waitcnt vmcnt(19)
    buffer_load_dwordx4 v13, s[8:11], s35 offen offset:1024 nt lds
    s_waitcnt vmcnt(19)
    buffer_load_dwordx4 v14, s[8:11], s35 offen offset:2048 nt lds
    s_waitcnt vmcnt(19)
    buffer_load_dwordx4 v15, s[8:11], s35 offen offset:3072 nt lds
    v_add_u32 v23, 1, v23
    s_add_u32 s75, s75, 1
    s_add_u32 s38, s38, 1
    s_add_u32 s37, s37, 32768
    s_add_u32 s83, s39, 2
    s_lshl_b32 s84, s83, 13
    s_and_b32 s84, s84, 16384
    s_add_u32 s84, s84, 8192
    s_cmp_eq_u32 s38, 3
    s_cselect_b32 s38, 0, s38
    s_cselect_b32 s39, s83, s39
    s_cselect_b32 s37, s84, s37
    s_cmp_lt_u32 s75, s77
    s_cbranch_scc1 L_tl_78
    s_waitcnt vmcnt(16)
    v_subrev_u32 v27, 2, v23
    ds_write_b32 v22, v27
    s_waitcnt vmcnt(8)
    v_subrev_u32 v27, 1, v23
    ds_write_b32 v22, v27
    s_waitcnt vmcnt(0)
    ds_write_b32 v22, v23
    s_branch L_ldone
L_var_80:
    s_cmp_ge_u32 s36, s68
    s_cbranch_scc1 L_lp_80
L_pk_80:
    v_readlane_b32 s80, v20, s36
    v_readlane_b32 s81, v21, s36
    s_nop 2
    s_add_u32 m0, s74, 0
    s_waitcnt vmcnt(19)
    buffer_load_dwordx4 v8, s[4:7], s80 offen offset:0 nt lds
    s_waitcnt vmcnt(19)
    buffer_load_dwordx4 v9, s[4:7], s80 offen offset:1024 nt lds
    s_waitcnt vmcnt(19)
    buffer_load_dwordx4 v10, s[4:7], s80 offen offset:2048 nt lds
    s_waitcnt vmcnt(19)
    buffer_load_dwordx4 v11, s[4:7], s80 offen offset:3072 nt lds
    v_subrev_u32 v27, 2, v23
    ds_write_b32 v22, v27
    s_add_u32 m0, s74, 4096
    s_waitcnt vmcnt(19)
    buffer_load_dwordx4 v8, s[4:7], s81 offen offset:0 nt lds
    s_waitcnt vmcnt(19)
    buffer_load_dwordx4 v9, s[4:7], s81 offen offset:1024 nt lds
    s_waitcnt vmcnt(19)
    buffer_load_dwordx4 v10, s[4:7], s81 offen offset:2048 nt lds
    s_waitcnt vmcnt(19)
    buffer_load_dwordx4 v11, s[4:7], s81 offen offset:3072 nt lds
    v_add_u32 v23, 1, v23
    s_add_u32 s36, s36, 1
    s_add_u32 s87, s87, 1
    s_add_u32 s74, s74, 32768
    s_add_u32 s83, s70, 2
    s_lshl_b32 s84, s83, 13
    s_and_b32 s84, s84, 16384
    s_cmp_eq_u32 s87, 3
    s_cselect_b32 s87, 0, s87
    s_cselect_b32 s70, s83, s70
    s_cselect_b32 s74, s84, s74
    s_cmp_lt_u32 s36, s68
    s_cbranch_scc1 L_pk_80
L_lp_80:
    s_cmp_ge_u32 s36, s77
    s_cbranch_scc1 L_tl_80
L_lp2_80:
    v_readlane_b32 s34, v20, s75
    v_readlane_b32 s35, v21, s75
    v_readlane_b32 s80, v20, s36
    v_readlane_b32 s81, v21, s36
L_chk_80:
    s_waitcnt lgkmcnt(0)
    v_readlane_b32 s83, v25, s87
    v_readlane_b32 s84, v25, s38
    ds_read_b32 v25, v24
    s_cmp_lt_u32 s39, 4
    s_cselect_b32 s84, s39, s84
    s_cmp_lt_u32 s84, s39
    s_cbranch_scc1 L_chk_80
    s_add_u32 s83, s83, 3
    s_cmp_lt_u32 s83, s70
    s_cbranch_scc1 L_chk_80
    s_add_u32 m0, s74, 0
    s_waitcnt vmcnt(19)
    buffer_load_dwordx4 v8, s[4:7], s80 offen offset:0 nt lds
    s_waitcnt vmcnt(19)
    buffer_load_dwordx4 v9, s[4:7], s80 offen offset:1024 nt lds
    s_waitcnt vmcnt(19)
    buffer_load_dwordx4 v10, s[4:7], s80 offen offset:2048 nt lds
    s_waitcnt vmcnt(19)
    buffer_load_dwordx4 v11, s[4:7], s80 offen offset:3072 nt lds
    v_subrev_u32 v27, 2, v23
    ds_write_b32 v22, v27
    s_add_u32 m0, s74, 4096
    s_waitcnt vmcnt(19)
    buffer_load_dwordx4 v8, s[4:7], s81 offen offset:0 nt lds
    s_waitcnt vmcnt(19)
    buffer_load_dwordx4 v9, s[4:7], s81 offen offset:1024 nt lds
    s_waitcnt vmcnt(19)
    buffer_load_dwordx4 v10, s[4:7], s81 offen offset:2048 nt lds
    s_waitcnt vmcnt(19)
    buffer_load_dwordx4 v11, s[4:7], s81 offen offset:3072 nt lds
    v_add_u32 v23, 1, v23
    s_add_u32 s36, s36, 1
    s_add_u32 s87, s87, 1
    s_add_u32 s74, s74, 32768
    s_add_u32 s83, s70, 2
    s_lshl_b32 s84, s83, 13
    s_and_b32 s84, s84, 16384
    s_cmp_eq_u32 s87, 3
    s_cselect_b32 s87, 0, s87
    s_cselect_b32 s70, s83, s70
    s_cselect_b32 s74, s84, s74
    s_add_u32 m0, s37, 0
    s_waitcnt vmcnt(19)
    buffer_load_dwordx4 v12, s[8:11], s34 offen offset:0 nt lds
    s_waitcnt vmcnt(19)
    buffer_load_dwordx4 v13, s[8:11], s34 offen offset:1024 nt lds
    s_waitcnt vmcnt(19)
    buffer_load_dwordx4 v14, s[8:11], s34 offen offset:2048 nt lds
    s_waitcnt vmcnt(19)
    buffer_load_dwordx4 v15, s[8:11], s34 offen offset:3072 nt lds
    v_subrev_u32 v27, 2, v23
    ds_write_b32 v22, v27
    s_add_u32 m0, s37, 4096
    s_waitcnt vmcnt(19)
    buffer_load_dwordx4 v12, s[8:11], s35 offen offset:0 nt lds
    s_waitcnt vmcnt(19)
    buffer_load_dwordx4 v13, s[8:11], s35 offen offset:1024 nt lds
    s_waitcnt vmcnt(19)
    buffer_load_dwordx4 v14, s[8:11], s35 offen offset:2048 nt lds
    s_waitcnt vmcnt(19)
    buffer_load_dwordx4 v15, s[8:11], s35 offen offset:3072 nt lds
    v_add_u32 v23, 1, v23
    s_add_u32 s75, s75, 1
    s_add_u32 s38, s38, 1
    s_add_u32 s37, s37, 32768
    s_add_u32 s83, s39, 2
    s_lshl_b32 s84, s83, 13
    s_and_b32 s84, s84, 16384
    s_add_u32 s84, s84, 8192
    s_cmp_eq_u32 s38, 3
    s_cselect_b32 s38, 0, s38
    s_cselect_b32 s39, s83, s39
    s_cselect_b32 s37, s84, s37
    s_cmp_lt_u32 s36, s77
    s_cbranch_scc1 L_lp2_80
L_tl_80:
    v_readlane_b32 s34, v20, s75
    v_readlane_b32 s35, v21, s75
L_chv_80:
    s_waitcnt lgkmcnt(0)
    v_readlane_b32 s84, v25, s38
    ds_read_b32 v25, v24
    s_cmp_lt_u32 s39, 4
    s_cselect_b32 s84, s39, s84
    s_cmp_lt_u32 s84, s39
    s_cbranch_scc1 L_chv_80
    s_add_u32 m0, s37, 0
    s_waitcnt vmcnt(19)
    buffer_load_dwordx4 v12, s[8:11], s34 offen offset:0 nt lds
    s_waitcnt vmcnt(19)
    buffer_load_dwordx4 v13, s[8:11], s34 offen offset:1024 nt lds
    s_waitcnt vmcnt(19)
    buffer_load_dwordx4 v14, s[8:11], s34 offen offset:2048 nt lds
    s_waitcnt vmcnt(19)
    buffer_load_dwordx4 v15, s[8:11], s34 offen offset:3072 nt lds
    v_subrev_u32 v27, 2, v23
    ds_write_b32 v22, v27
    s_add_u32 m0, s37, 4096
    s_waitcnt vmcnt(19)
    buffer_load_dwordx4 v12, s[8:11], s35 offen offset:0 nt lds
    s_waitcnt vmcnt(19)
    buffer_load_dwordx4 v13, s[8:11], s35 offen offset:1024 nt lds
    s_waitcnt vmcnt(19)
    buffer_load_dwordx4 v14, s[8:11], s35 offen offset:2048 nt lds
    s_waitcnt vmcnt(19)
    buffer_load_dwordx4 v15, s[8:11], s35 offen offset:3072 nt lds
    v_add_u32 v23, 1, v23
    s_add_u32 s75, s75, 1
    s_add_u32 s38, s38, 1
    s_add_u32 s37, s37, 32768
    s_add_u32 s83, s39, 2
    s_lshl_b32 s84, s83, 13
    s_and_b32 s84, s84, 16384
    s_add_u32 s84, s84, 8192
    s_cmp_eq_u32 s38, 3
    s_cselect_b32 s38, 0, s38
    s_cselect_b32 s39, s83, s39
    s_cselect_b32 s37, s84, s37
    s_cmp_lt_u32 s75, s77
    s_cbranch_scc1 L_tl_80
    s_waitcnt vmcnt(16)
    v_subrev_u32 v27, 2, v23
    ds_write_b32 v22, v27
    s_waitcnt vmcnt(8)
    v_subrev_u32 v27, 1, v23
    ds_write_b32 v22, v27
    s_waitcnt vmcnt(0)
    ds_write_b32 v22, v23
    s_branch L_ldone
L_var_82:
    s_cmp_ge_u32 s36, s68
    s_cbranch_scc1 L_lp_82
L_pk_82:
    v_readlane_b32 s80, v20, s36
    v_readlane_b32 s81, v21, s36
    s_nop 2
    s_add_u32 m0, s74, 0
    s_waitcnt vmcnt(20)
    buffer_load_dwordx4 v8, s[4:7], s80 offen offset:0 nt lds
    s_waitcnt vmcnt(20)
    buffer_load_dwordx4 v9, s[4:7], s80 offen offset:1024 nt lds
    s_waitcnt vmcnt(20)
    buffer_load_dwordx4 v10, s[4:7], s80 offen offset:2048 nt lds
    s_waitcnt vmcnt(20)
    buffer_load_dwordx4 v11, s[4:7], s80 offen offset:3072 nt lds
    s_add_u32 m0, s74, 4096
    s_waitcnt vmcnt(20)
    buffer_load_dwordx4 v8, s[4:7], s81 offen offset:0 nt lds
    v_subrev_u32 v27, 2, v23
    ds_write_b32 v22, v27
    s_waitcnt vmcnt(20)
    buffer_load_dwordx4 v9, s[4:7], s81 offen offset:1024 nt lds
    s_waitcnt vmcnt(20)
    buffer_load_dwordx4 v10, s[4:7], s81 offen offset:2048 nt lds
    s_waitcnt vmcnt(20)
    buffer_load_dwordx4 v11, s[4:7], s81 offen offset:3072 nt lds
    v_add_u32 v23, 1, v23
    s_add_u32 s36, s36, 1
    s_add_u32 s87, s87, 1
    s_add_u32 s74, s74, 32768
    s_add_u32 s83, s70, 2
    s_lshl_b32 s84, s83, 13
    s_and_b32 s84, s84, 16384
    s_cmp_eq_u32 s87, 3
    s_cselect_b32 s87, 0, s87
    s_cselect_b32 s70, s83, s70
    s_cselect_b32 s74, s84, s74
    s_cmp_lt_u32 s36, s68
    s_cbranch_scc1 L_pk_82
L_lp_82:
    s_cmp_ge_u32 s36, s77
    s_cbranch_scc1 L_tl_82
L_lp2_82:
    v_readlane_b32 s34, v20, s75
    v_readlane_b32 s35, v21, s75
    v_readlane_b32 s80, v20, s36
    v_readlane_b32 s81, v21, s36
L_chk_82:
    s_waitcnt lgkmcnt(0)
    v_readlane_b32 s83, v25, s87
    v_readlane_b32 s84, v25, s38
    ds_read_b32 v25, v24
    s_cmp_lt_u32 s39, 4
    s_cselect_b32 s84, s39, s84
    s_cmp_lt_u32 s84, s39
    s_cbranch_scc1 L_chk_82
    s_add_u32 s83, s83, 3
    s_cmp_lt_u32 s83, s70
    s_cbranch_scc1 L_chk_82
    s_add_u32 m0, s74, 0
    s_waitcnt vmcnt(20)
    buffer_load_dwordx4 v8, s[4:7], s80 offen offset:0 nt lds
    s_waitcnt vmcnt(20)
    buffer_load_dwordx4 v9, s[4:7], s80 offen offset:1024 nt lds
    s_waitcnt vmcnt(20)
    buffer_load_dwordx4 v10, s[4:7], s80 offen offset:2048 nt lds
    s_waitcnt vmcnt(20)
    buffer_load_dwordx4 v11, s[4:7], s80 offen offset:3072 nt lds
    s_add_u32 m0, s74, 4096
    s_waitcnt vmcnt(20)
    buffer_load_dwordx4 v8, s[4:7], s81 offen offset:0 nt lds
    v_subrev_u32 v27, 2, v23
    ds_write_b32 v22, v27
    s_waitcnt vmcnt(20)
    buffer_load_dwordx4 v9, s[4:7], s81 offen offset:1024 nt lds
    s_waitcnt vmcnt(20)
    buffer_load_dwordx4 v10, s[4:7], s81 offen offset:2048 nt lds
    s_waitcnt vmcnt(20)
    buffer_load_dwordx4 v11, s[4:7], s81 offen offset:3072 nt lds
    v_add_u32 v23, 1, v23
    s_add_u32 s36, s36, 1
    s_add_u32 s87, s87, 1
    s_add_u32 s74, s74, 32768
    s_add_u32 s83, s70, 2
    s_lshl_b32 s84, s83, 13
    s_and_b32 s84, s84, 16384
    s_cmp_eq_u32 s87, 3
    s_cselect_b32 s87, 0, s87
    s_cselect_b32 s70, s83, s70
    s_cselect_b32 s74, s84, s74
    s_add_u32 m0, s37, 0
    s_waitcnt vmcnt(19)
    buffer_load_dwordx4 v12, s[8:11], s34 offen offset:0 nt lds
    s_waitcnt vmcnt(19)
    buffer_load_dwordx4 v13, s[8:11], s34 offen offset:1024 nt lds
    s_waitcnt vmcnt(19)
    buffer_load_dwordx4 v14, s[8:11], s34 offen offset:2048 nt lds
    s_waitcnt vmcnt(19)
    buffer_load_dwordx4 v15, s[8:11], s34 offen offset:3072 nt lds
    v_subrev_u32 v27, 2, v23
    ds_write_b32 v22, v27
    s_add_u32 m0, s37, 4096
    s_waitcnt vmcnt(19)
    buffer_load_dwordx4 v12, s[8:11], s35 offen offset:0 nt lds
    s_waitcnt vmcnt(19)
    buffer_load_dwordx4 v13, s[8:11], s35 offen offset:1024 nt lds
    s_waitcnt vmcnt(19)
    buffer_load_dwordx4 v14, s[8:11], s35 offen offset:2048 nt lds
    s_waitcnt vmcnt(19)
    buffer_load_dwordx4 v15, s[8:11], s35 offen offset:3072 nt lds
    v_add_u32 v23, 1, v23
    s_add_u32 s75, s75, 1
    s_add_u32 s38, s38, 1
    s_add_u32 s37, s37, 32768
    s_add_u32 s83, s39, 2
    s_lshl_b32 s84, s83, 13
    s_and_b32 s84, s84, 16384
    s_add_u32 s84, s84, 8192
    s_cmp_eq_u32 s38, 3
    s_cselect_b32 s38, 0, s38
    s_cselect_b32 s39, s83, s39
    s_cselect_b32 s37, s84, s37
    s_cmp_lt_u32 s36, s77
    s_cbranch_scc1 L_lp2_82
L_tl_82:
    v_readlane_b32 s34, v20, s75
    v_readlane_b32 s35, v21, s75
L_chv_82:
    s_waitcnt lgkmcnt(0)
    v_readlane_b32 s84, v25, s38
    ds_read_b32 v25, v24
    s_cmp_lt_u32 s39, 4
    s_cselect_b32 s84, s39, s84
    s_cmp_lt_u32 s84, s39
    s_cbranch_scc1 L_chv_82
    s_add_u32 m0, s37, 0
    s_waitcnt vmcnt(19)
    buffer_load_dwordx4 v12, s[8:11], s34 offen offset:0 nt lds
    s_waitcnt vmcnt(19)
    buffer_load_dwordx4 v13, s[8:11], s34 offen offset:1024 nt lds
    s_waitcnt vmcnt(19)
    buffer_load_dwordx4 v14, s[8:11], s34 offen offset:2048 nt lds
    s_waitcnt vmcnt(19)
    buffer_load_dwordx4 v15, s[8:11], s34 offen offset:3072 nt lds
    v_subrev_u32 v27, 2, v23
    ds_write_b32 v22, v27
    s_add_u32 m0, s37, 4096
    s_waitcnt vmcnt(19)
    buffer_load_dwordx4 v12, s[8:11], s35 offen offset:0 nt lds
    s_waitcnt vmcnt(19)
    buffer_load_dwordx4 v13, s[8:11], s35 offen offset:1024 nt lds
    s_waitcnt vmcnt(19)
    buffer_load_dwordx4 v14, s[8:11], s35 offen offset:2048 nt lds
    s_waitcnt vmcnt(19)
    buffer_load_dwordx4 v15, s[8:11], s35 offen offset:3072 nt lds
    v_add_u32 v23, 1, v23
    s_add_u32 s75, s75, 1
    s_add_u32 s38, s38, 1
    s_add_u32 s37, s37, 32768
    s_add_u32 s83, s39, 2
    s_lshl_b32 s84, s83, 13
    s_and_b32 s84, s84, 16384
    s_add_u32 s84, s84, 8192
    s_cmp_eq_u32 s38, 3
    s_cselect_b32 s38, 0, s38
    s_cselect_b32 s39, s83, s39
    s_cselect_b32 s37, s84, s37
    s_cmp_lt_u32 s75, s77
    s_cbranch_scc1 L_tl_82
    s_waitcnt vmcnt(16)
    v_subrev_u32 v27, 2, v23
    ds_write_b32 v22, v27
    s_waitcnt vmcnt(8)
    v_subrev_u32 v27, 1, v23
    ds_write_b32 v22, v27
    s_waitcnt vmcnt(0)
    ds_write_b32 v22, v23
    s_branch L_ldone
L_var_84:
    s_cmp_ge_u32 s36, s68
    s_cbranch_scc1 L_lp_84
L_pk_84:
    v_readlane_b32 s80, v20, s36
    v_readlane_b32 s81, v21, s36
    s_nop 2
    s_add_u32 m0, s74, 0
    s_waitcnt vmcnt(20)
    buffer_load_dwordx4 v8, s[4:7], s80 offen offset:0 nt lds
    s_waitcnt vmcnt(20)
    buffer_load_dwordx4 v9, s[4:7], s80 offen offset:1024 nt lds
    s_waitcnt vmcnt(20)
    buffer_load_dwordx4 v10, s[4:7], s80 offen offset:2048 nt lds
    s_waitcnt vmcnt(20)
    buffer_load_dwordx4 v11, s[4:7], s80 offen offset:3072 nt lds
    s_add_u32 m0, s74, 4096
    s_waitcnt vmcnt(20)
    buffer_load_dwordx4 v8, s[4:7], s81 offen offset:0 nt lds
    v_subrev_u32 v27, 2, v23
    ds_write_b32 v22, v27
    s_waitcnt vmcnt(20)
    buffer_load_dwordx4 v9, s[4:7], s81 offen offset:1024 nt lds
    s_waitcnt vmcnt(20)
    buffer_load_dwordx4 v10, s[4:7], s81 offen offset:2048 nt lds
    s_waitcnt vmcnt(20)
    buffer_load_dwordx4 v11, s[4:7], s81 offen offset:3072 nt lds
    v_add_u32 v23, 1, v23
    s_add_u32 s36, s36, 1
    s_add_u32 s87, s87, 1
    s_add_u32 s74, s74, 32768
    s_add_u32 s83, s70, 2
    s_lshl_b32 s84, s83, 13
    s_and_b32 s84, s84, 16384
    s_cmp_eq_u32 s87, 3
    s_cselect_b32 s87, 0, s87
    s_cselect_b32 s70, s83, s70
    s_cselect_b32 s74, s84, s74
    s_cmp_lt_u32 s36, s68
    s_cbranch_scc1 L_pk_84
L_lp_84:
    s_cmp_ge_u32 s36, s77
    s_cbranch_scc1 L_tl_84
L_lp2_84:
    v_readlane_b32 s34, v20, s75
    v_readlane_b32 s35, v21, s75
    v_readlane_b32 s80, v20, s36
    v_readlane_b32 s81, v21, s36
L_chk_84:
    s_waitcnt lgkmcnt(0)
    v_readlane_b32 s83, v25, s87
    v_readlane_b32 s84, v25, s38
    ds_read_b32 v25, v24
    s_cmp_lt_u32 s39, 4
    s_cselect_b32 s84, s39, s84
    s_cmp_lt_u32 s84, s39
    s_cbranch_scc1 L_chk_84
    s_add_u32 s83, s83, 3
    s_cmp_lt_u32 s83, s70
    s_cbranch_scc1 L_chk_84
    s_add_u32 m0, s74, 0
    s_waitcnt vmcnt(20)
    buffer_load_dwordx4 v8, s[4:7], s80 offen offset:0 nt lds
    s_waitcnt vmcnt(20)
    buffer_load_dwordx4 v9, s[4:7], s80 offen offset:1024 nt lds
    s_waitcnt vmcnt(20)
    buffer_load_dwordx4 v10, s[4:7], s80 offen offset:2048 nt lds
    s_waitcnt vmcnt(20)
    buffer_load_dwordx4 v11, s[4:7], s80 offen offset:3072 nt lds
    s_add_u32 m0, s74, 4096
    s_waitcnt vmcnt(20)
    buffer_load_dwordx4 v8, s[4:7], s81 offen offset:0 nt lds
    v_subrev_u32 v27, 2, v23
    ds_write_b32 v22, v27
    s_waitcnt vmcnt(20)
    buffer_load_dwordx4 v9, s[4:7], s81 offen offset:1024 nt lds
    s_waitcnt vmcnt(20)
    buffer_load_dwordx4 v10, s[4:7], s81 offen offset:2048 nt lds
    s_waitcnt vmcnt(20)
    buffer_load_dwordx4 v11, s[4:7], s81 offen offset:3072 nt lds
    v_add_u32 v23, 1, v23
    s_add_u32 s36, s36, 1
    s_add_u32 s87, s87, 1
    s_add_u32 s74, s74, 32768
    s_add_u32 s83, s70, 2
    s_lshl_b32 s84, s83, 13
    s_and_b32 s84, s84, 16384
    s_cmp_eq_u32 s87, 3
    s_cselect_b32 s87, 0, s87
    s_cselect_b32 s70, s83, s70
    s_cselect_b32 s74, s84, s74
    s_add_u32 m0, s37, 0
    s_waitcnt vmcnt(20)
    buffer_load_dwordx4 v12, s[8:11], s34 offen offset:0 nt lds
    s_waitcnt vmcnt(20)
    buffer_load_dwordx4 v13, s[8:11], s34 offen offset:1024 nt lds
    s_waitcnt vmcnt(20)
    buffer_load_dwordx4 v14, s[8:11], s34 offen offset:2048 nt lds
    s_waitcnt vmcnt(20)
    buffer_load_dwordx4 v15, s[8:11], s34 offen offset:3072 nt lds
    s_add_u32 m0, s37, 4096
    s_waitcnt vmcnt(20)
    buffer_load_dwordx4 v12, s[8:11], s35 offen offset:0 nt lds
    v_subrev_u32 v27, 2, v23
    ds_write_b32 v22, v27
    s_waitcnt vmcnt(20)
    buffer_load_dwordx4 v13, s[8:11], s35 offen offset:1024 nt lds
    s_waitcnt vmcnt(20)
    buffer_load_dwordx4 v14, s[8:11], s35 offen offset:2048 nt lds
    s_waitcnt vmcnt(20)
    buffer_load_dwordx4 v15, s[8:11], s35 offen offset:3072 nt lds
    v_add_u32 v23, 1, v23
    s_add_u32 s75, s75, 1
    s_add_u32 s38, s38, 1
    s_add_u32 s37, s37, 32768
    s_add_u32 s83, s39, 2
    s_lshl_b32 s84, s83, 13
    s_and_b32 s84, s84, 16384
    s_add_u32 s84, s84, 8192
    s_cmp_eq_u32 s38, 3
    s_cselect_b32 s38, 0, s38
    s_cselect_b32 s39, s83, s39
    s_cselect_b32 s37, s84, s37
    s_cmp_lt_u32 s36, s77
    s_cbranch_scc1 L_lp2_84
L_tl_84:
    v_readlane_b32 s34, v20, s75
    v_readlane_b32 s35, v21, s75
L_chv_84:
    s_waitcnt lgkmcnt(0)
    v_readlane_b32 s84, v25, s38
    ds_read_b32 v25, v24
    s_cmp_lt_u32 s39, 4
    s_cselect_b32 s84, s39, s84
    s_cmp_lt_u32 s84, s39
    s_cbranch_scc1 L_chv_84
    s_add_u32 m0, s37, 0
    s_waitcnt vmcnt(20)
    buffer_load_dwordx4 v12, s[8:11], s34 offen offset:0 nt lds
    s_waitcnt vmcnt(20)
    buffer_load_dwordx4 v13, s[8:11], s34 offen offset:1024 nt lds
    s_waitcnt vmcnt(20)
    buffer_load_dwordx4 v14, s[8:11], s34 offen offset:2048 nt lds
    s_waitcnt vmcnt(20)
    buffer_load_dwordx4 v15, s[8:11], s34 offen offset:3072 nt lds
    s_add_u32 m0, s37, 4096
    s_waitcnt vmcnt(20)
    buffer_load_dwordx4 v12, s[8:11], s35 offen offset:0 nt lds
    v_subrev_u32 v27, 2, v23
    ds_write_b32 v22, v27
    s_waitcnt vmcnt(20)
    buffer_load_dwordx4 v13, s[8:11], s35 offen offset:1024 nt lds
    s_waitcnt vmcnt(20)
    buffer_load_dwordx4 v14, s[8:11], s35 offen offset:2048 nt lds
    s_waitcnt vmcnt(20)
    buffer_load_dwordx4 v15, s[8:11], s35 offen offset:3072 nt lds
    v_add_u32 v23, 1, v23
    s_add_u32 s75, s75, 1
    s_add_u32 s38, s38, 1
    s_add_u32 s37, s37, 32768
    s_add_u32 s83, s39, 2
    s_lshl_b32 s84, s83, 13
    s_and_b32 s84, s84, 16384
    s_add_u32 s84, s84, 8192
    s_cmp_eq_u32 s38, 3
    s_cselect_b32 s38, 0, s38
    s_cselect_b32 s39, s83, s39
    s_cselect_b32 s37, s84, s37
    s_cmp_lt_u32 s75, s77
    s_cbranch_scc1 L_tl_84
    s_waitcnt vmcnt(16)
    v_subrev_u32 v27, 2, v23
    ds_write_b32 v22, v27
    s_waitcnt vmcnt(8)
    v_subrev_u32 v27, 1, v23
    ds_write_b32 v22, v27
    s_waitcnt vmcnt(0)
    ds_write_b32 v22, v23
    s_branch L_ldone
L_var_86:
    s_cmp_ge_u32 s36, s68
    s_cbranch_scc1 L_lp_86
L_pk_86:
    v_readlane_b32 s80, v20, s36
    v_readlane_b32 s81, v21, s36
    s_nop 2
    s_add_u32 m0, s74, 0
    s_waitcnt vmcnt(21)
    buffer_load_dwordx4 v8, s[4:7], s80 offen offset:0 nt lds
    s_waitcnt vmcnt(21)
    buffer_load_dwordx4 v9, s[4:7], s80 offen offset:1024 nt lds
    s_waitcnt vmcnt(21)
    buffer_load_dwordx4 v10, s[4:7], s80 offen offset:2048 nt lds
    s_waitcnt vmcnt(21)
    buffer_load_dwordx4 v11, s[4:7], s80 offen offset:3072 nt lds
    s_add_u32 m0, s74, 4096
    s_waitcnt vmcnt(21)
    buffer_load_dwordx4 v8, s[4:7], s81 offen offset:0 nt lds
    s_waitcnt vmcnt(21)
    buffer_load_dwordx4 v9, s[4:7], s81 offen offset:1024 nt lds
    v_subrev_u32 v27, 2, v23
    ds_write_b32 v22, v27
    s_waitcnt vmcnt(21)
    buffer_load_dwordx4 v10, s[4:7], s81 offen offset:2048 nt lds
    s_waitcnt vmcnt(21)
    buffer_load_dwordx4 v11, s[4:7], s81 offen offset:3072 nt lds
    v_add_u32 v23, 1, v23
    s_add_u32 s36, s36, 1
    s_add_u32 s87, s87, 1
    s_add_u32 s74, s74, 32768
    s_add_u32 s83, s70, 2
    s_lshl_b32 s84, s83, 13
    s_and_b32 s84, s84, 16384
    s_cmp_eq_u32 s87, 3
    s_cselect_b32 s87, 0, s87
    s_cselect_b32 s70, s83, s70
    s_cselect_b32 s74, s84, s74
    s_cmp_lt_u32 s36, s68
    s_cbranch_scc1 L_pk_86
L_lp_86:
    s_cmp_ge_u32 s36, s77
    s_cbranch_scc1 L_tl_86
L_lp2_86:
    v_readlane_b32 s34, v20, s75
    v_readlane_b32 s35, v21, s75
    v_readlane_b32 s80, v20, s36
    v_readlane_b32 s81, v21, s36
L_chk_86:
    s_waitcnt lgkmcnt(0)
    v_readlane_b32 s83, v25, s87
    v_readlane_b32 s84, v25, s38
    ds_read_b32 v25, v24
    s_cmp_lt_u32 s39, 4
    s_cselect_b32 s84, s39, s84
    s_cmp_lt_u32 s84, s39
    s_cbranch_scc1 L_chk_86
    s_add_u32 s83, s83, 3
    s_cmp_lt_u32 s83, s70
    s_cbranch_scc1 L_chk_86
    s_add_u32 m0, s74, 0
    s_waitcnt vmcnt(21)
    buffer_load_dwordx4 v8, s[4:7], s80 offen offset:0 nt lds
    s_waitcnt vmcnt(21)
    buffer_load_dwordx4 v9, s[4:7], s80 offen offset:1024 nt lds
    s_waitcnt vmcnt(21)
    buffer_load_dwordx4 v10, s[4:7], s80 offen offset:2048 nt lds
    s_waitcnt vmcnt(21)
    buffer_load_dwordx4 v11, s[4:7], s80 offen offset:3072 nt lds
    s_add_u32 m0, s74, 4096
    s_waitcnt vmcnt(21)
    buffer_load_dwordx4 v8, s[4:7], s81 offen offset:0 nt lds
    s_waitcnt vmcnt(21)
    buffer_load_dwordx4 v9, s[4:7], s81 offen offset:1024 nt lds
    v_subrev_u32 v27, 2, v23
    ds_write_b32 v22, v27
    s_waitcnt vmcnt(21)
    buffer_load_dwordx4 v10, s[4:7], s81 offen offset:2048 nt lds
    s_waitcnt vmcnt(21)
    buffer_load_dwordx4 v11, s[4:7], s81 offen offset:3072 nt lds
    v_add_u32 v23, 1, v23
    s_add_u32 s36, s36, 1
    s_add_u32 s87, s87, 1
    s_add_u32 s74, s74, 32768
    s_add_u32 s83, s70, 2
    s_lshl_b32 s84, s83, 13
    s_and_b32 s84, s84, 16384
    s_cmp_eq_u32 s87, 3
    s_cselect_b32 s87, 0, s87
    s_cselect_b32 s70, s83, s70
    s_cselect_b32 s74, s84, s74
    s_add_u32 m0, s37, 0
    s_waitcnt vmcnt(20)
    buffer_load_dwordx4 v12, s[8:11], s34 offen offset:0 nt lds
    s_waitcnt vmcnt(20)
    buffer_load_dwordx4 v13, s[8:11], s34 offen offset:1024 nt lds
    s_waitcnt vmcnt(20)
    buffer_load_dwordx4 v14, s[8:11], s34 offen offset:2048 nt lds
    s_waitcnt vmcnt(20)
    buffer_load_dwordx4 v15, s[8:11], s34 offen offset:3072 nt lds
    s_add_u32 m0, s37, 4096
    s_waitcnt vmcnt(20)
    buffer_load_dwordx4 v12, s[8:11], s35 offen offset:0 nt lds
    v_subrev_u32 v27, 2, v23
    ds_write_b32 v22, v27
    s_waitcnt vmcnt(20)
    buffer_load_dwordx4 v13, s[8:11], s35 offen offset:1024 nt lds
    s_waitcnt vmcnt(20)
    buffer_load_dwordx4 v14, s[8:11], s35 offen offset:2048 nt lds
    s_waitcnt vmcnt(20)
    buffer_load_dwordx4 v15, s[8:11], s35 offen offset:3072 nt lds
    v_add_u32 v23, 1, v23
    s_add_u32 s75, s75, 1
    s_add_u32 s38, s38, 1
    s_add_u32 s37, s37, 32768
    s_add_u32 s83, s39, 2
    s_lshl_b32 s84, s83, 13
    s_and_b32 s84, s84, 16384
    s_add_u32 s84, s84, 8192
    s_cmp_eq_u32 s38, 3
    s_cselect_b32 s38, 0, s38
    s_cselect_b32 s39, s83, s39
    s_cselect_b32 s37, s84, s37
    s_cmp_lt_u32 s36, s77
    s_cbranch_scc1 L_lp2_86
L_tl_86:
    v_readlane_b32 s34, v20, s75
    v_readlane_b32 s35, v21, s75
L_chv_86:
    s_waitcnt lgkmcnt(0)
    v_readlane_b32 s84, v25, s38
    ds_read_b32 v25, v24
    s_cmp_lt_u32 s39, 4
    s_cselect_b32 s84, s39, s84
    s_cmp_lt_u32 s84, s39
    s_cbranch_scc1 L_chv_86
    s_add_u32 m0, s37, 0
    s_waitcnt vmcnt(21)
    buffer_load_dwordx4 v12, s[8:11], s34 offen offset:0 nt lds
    s_waitcnt vmcnt(21)
    buffer_load_dwordx4 v13, s[8:11], s34 offen offset:1024 nt lds
    s_waitcnt vmcnt(21)
    buffer_load_dwordx4 v14, s[8:11], s34 offen offset:2048 nt lds
    s_waitcnt vmcnt(21)
    buffer_load_dwordx4 v15, s[8:11], s34 offen offset:3072 nt lds
    s_add_u32 m0, s37, 4096
    s_waitcnt vmcnt(21)
    buffer_load_dwordx4 v12, s[8:11], s35 offen offset:0 nt lds
    s_waitcnt vmcnt(21)
    buffer_load_dwordx4 v13, s[8:11], s35 offen offset:1024 nt lds
    v_subrev_u32 v27, 2, v23
    ds_write_b32 v22, v27
    s_waitcnt vmcnt(21)
    buffer_load_dwordx4 v14, s[8:11], s35 offen offset:2048 nt lds
    s_waitcnt vmcnt(21)
    buffer_load_dwordx4 v15, s[8:11], s35 offen offset:3072 nt lds
    v_add_u32 v23, 1, v23
    s_add_u32 s75, s75, 1
    s_add_u32 s38, s38, 1
    s_add_u32 s37, s37, 32768
    s_add_u32 s83, s39, 2
    s_lshl_b32 s84, s83, 13
    s_and_b32 s84, s84, 16384
    s_add_u32 s84, s84, 8192
    s_cmp_eq_u32 s38, 3
    s_cselect_b32 s38, 0, s38
    s_cselect_b32 s39, s83, s39
    s_cselect_b32 s37, s84, s37
    s_cmp_lt_u32 s75, s77
    s_cbranch_scc1 L_tl_86
    s_waitcnt vmcnt(16)
    v_subrev_u32 v27, 2, v23
    ds_write_b32 v22, v27
    s_waitcnt vmcnt(8)
    v_subrev_u32 v27, 1, v23
    ds_write_b32 v22, v27
    s_waitcnt vmcnt(0)
    ds_write_b32 v22, v23
    s_branch L_ldone
L_var_88:
    s_cmp_ge_u32 s36, s68
    s_cbranch_scc1 L_lp_88
L_pk_88:
    v_readlane_b32 s80, v20, s36
    v_readlane_b32 s81, v21, s36
    s_nop 2
    s_add_u32 m0, s74, 0
    s_waitcnt vmcnt(21)
    buffer_load_dwordx4 v8, s[4:7], s80 offen offset:0 nt lds
    s_waitcnt vmcnt(21)
    buffer_load_dwordx4 v9, s[4:7], s80 offen offset:1024 nt lds
    s_waitcnt vmcnt(21)
    buffer_load_dwordx4 v10, s[4:7], s80 offen offset:2048 nt lds
    s_waitcnt vmcnt(21)
    buffer_load_dwordx4 v11, s[4:7], s80 offen offset:3072 nt lds
    s_add_u32 m0, s74, 4096
    s_waitcnt vmcnt(21)
    buffer_load_dwordx4 v8, s[4:7], s81 offen offset:0 nt lds
    s_waitcnt vmcnt(21)
    buffer_load_dwordx4 v9, s[4:7], s81 offen offset:1024 nt lds
    v_subrev_u32 v27, 2, v23
    ds_write_b32 v22, v27
    s_waitcnt vmcnt(21)
    buffer_load_dwordx4 v10, s[4:7], s81 offen offset:2048 nt lds
    s_waitcnt vmcnt(21)
    buffer_load_dwordx4 v11, s[4:7], s81 offen offset:3072 nt lds
    v_add_u32 v23, 1, v23
    s_add_u32 s36, s36, 1
    s_add_u32 s87, s87, 1
    s_add_u32 s74, s74, 32768
    s_add_u32 s83, s70, 2
    s_lshl_b32 s84, s83, 13
    s_and_b32 s84, s84, 16384
    s_cmp_eq_u32 s87, 3
    s_cselect_b32 s87, 0, s87
    s_cselect_b32 s70, s83, s70
    s_cselect_b32 s74, s84, s74
    s_cmp_lt_u32 s36, s68
    s_cbranch_scc1 L_pk_88
L_lp_88:
    s_cmp_ge_u32 s36, s77
    s_cbranch_scc1 L_tl_88
L_lp2_88:
    v_readlane_b32 s34, v20, s75
    v_readlane_b32 s35, v21, s75
    v_readlane_b32 s80, v20, s36
    v_readlane_b32 s81, v21, s36
L_chk_88:
    s_waitcnt lgkmcnt(0)
    v_readlane_b32 s83, v25, s87
    v_readlane_b32 s84, v25, s38
    ds_read_b32 v25, v24
    s_cmp_lt_u32 s39, 4
    s_cselect_b32 s84, s39, s84
    s_cmp_lt_u32 s84, s39
    s_cbranch_scc1 L_chk_88
    s_add_u32 s83, s83, 3
    s_cmp_lt_u32 s83, s70
    s_cbranch_scc1 L_chk_88
    s_add_u32 m0, s74, 0
    s_waitcnt vmcnt(21)
    buffer_load_dwordx4 v8, s[4:7], s80 offen offset:0 nt lds
    s_waitcnt vmcnt(21)
    buffer_load_dwordx4 v9, s[4:7], s80 offen offset:1024 nt lds
    s_waitcnt vmcnt(21)
    buffer_load_dwordx4 v10, s[4:7], s80 offen offset:2048 nt lds
    s_waitcnt vmcnt(21)
    buffer_load_dwordx4 v11, s[4:7], s80 offen offset:3072 nt lds
    s_add_u32 m0, s74, 4096
    s_waitcnt vmcnt(21)
    buffer_load_dwordx4 v8, s[4:7], s81 offen offset:0 nt lds
    s_waitcnt vmcnt(21)
    buffer_load_dwordx4 v9, s[4:7], s81 offen offset:1024 nt lds
    v_subrev_u32 v27, 2, v23
    ds_write_b32 v22, v27
    s_waitcnt vmcnt(21)
    buffer_load_dwordx4 v10, s[4:7], s81 offen offset:2048 nt lds
    s_waitcnt vmcnt(21)
    buffer_load_dwordx4 v11, s[4:7], s81 offen offset:3072 nt lds
    v_add_u32 v23, 1, v23
    s_add_u32 s36, s36, 1
    s_add_u32 s87, s87, 1
    s_add_u32 s74, s74, 32768
    s_add_u32 s83, s70, 2
    s_lshl_b32 s84, s83, 13
    s_and_b32 s84, s84, 16384
    s_cmp_eq_u32 s87, 3
    s_cselect_b32 s87, 0, s87
    s_cselect_b32 s70, s83, s70
    s_cselect_b32 s74, s84, s74
    s_add_u32 m0, s37, 0
    s_waitcnt vmcnt(21)
    buffer_load_dwordx4 v12, s[8:11], s34 offen offset:0 nt lds
    s_waitcnt vmcnt(21)
    buffer_load_dwordx4 v13, s[8:11], s34 offen offset:1024 nt lds
    s_waitcnt vmcnt(21)
    buffer_load_dwordx4 v14, s[8:11], s34 offen offset:2048 nt lds
    s_waitcnt vmcnt(21)
    buffer_load_dwordx4 v15, s[8:11], s34 offen offset:3072 nt lds
    s_add_u32 m0, s37, 4096
    s_waitcnt vmcnt(21)
    buffer_load_dwordx4 v12, s[8:11], s35 offen offset:0 nt lds
    s_waitcnt vmcnt(21)
    buffer_load_dwordx4 v13, s[8:11], s35 offen offset:1024 nt lds
    v_subrev_u32 v27, 2, v23
    ds_write_b32 v22, v27
    s_waitcnt vmcnt(21)
    buffer_load_dwordx4 v14, s[8:11], s35 offen offset:2048 nt lds
    s_waitcnt vmcnt(21)
    buffer_load_dwordx4 v15, s[8:11], s35 offen offset:3072 nt lds
    v_add_u32 v23, 1, v23
    s_add_u32 s75, s75, 1
    s_add_u32 s38, s38, 1
    s_add_u32 s37, s37, 32768
    s_add_u32 s83, s39, 2
    s_lshl_b32 s84, s83, 13
    s_and_b32 s84, s84, 16384
    s_add_u32 s84, s84, 8192
    s_cmp_eq_u32 s38, 3
    s_cselect_b32 s38, 0, s38
    s_cselect_b32 s39, s83, s39
    s_cselect_b32 s37, s84, s37
    s_cmp_lt_u32 s36, s77
    s_cbranch_scc1 L_lp2_88
L_tl_88:
    v_readlane_b32 s34, v20, s75
    v_readlane_b32 s35, v21, s75
L_chv_88:
    s_waitcnt lgkmcnt(0)
    v_readlane_b32 s84, v25, s38
    ds_read_b32 v25, v24
    s_cmp_lt_u32 s39, 4
    s_cselect_b32 s84, s39, s84
    s_cmp_lt_u32 s84, s39
    s_cbranch_scc1 L_chv_88
    s_add_u32 m0, s37, 0
    s_waitcnt vmcnt(21)
    buffer_load_dwordx4 v12, s[8:11], s34 offen offset:0 nt lds
    s_waitcnt vmcnt(21)
    buffer_load_dwordx4 v13, s[8:11], s34 offen offset:1024 nt lds
    s_waitcnt vmcnt(21)
    buffer_load_dwordx4 v14, s[8:11], s34 offen offset:2048 nt lds
    s_waitcnt vmcnt(21)
    buffer_load_dwordx4 v15, s[8:11], s34 offen offset:3072 nt lds
    s_add_u32 m0, s37, 4096
    s_waitcnt vmcnt(21)
    buffer_load_dwordx4 v12, s[8:11], s35 offen offset:0 nt lds
    s_waitcnt vmcnt(21)
    buffer_load_dwordx4 v13, s[8:11], s35 offen offset:1024 nt lds
    v_subrev_u32 v27, 2, v23
    ds_write_b32 v22, v27
    s_waitcnt vmcnt(21)
    buffer_load_dwordx4 v14, s[8:11], s35 offen offset:2048 nt lds
    s_waitcnt vmcnt(21)
    buffer_load_dwordx4 v15, s[8:11], s35 offen offset:3072 nt lds
    v_add_u32 v23, 1, v23
    s_add_u32 s75, s75, 1
    s_add_u32 s38, s38, 1
    s_add_u32 s37, s37, 32768
    s_add_u32 s83, s39, 2
    s_lshl_b32 s84, s83, 13
    s_and_b32 s84, s84, 16384
    s_add_u32 s84, s84, 8192
    s_cmp_eq_u32 s38, 3
    s_cselect_b32 s38, 0, s38
    s_cselect_b32 s39, s83, s39
    s_cselect_b32 s37, s84, s37
    s_cmp_lt_u32 s75, s77
    s_cbranch_scc1 L_tl_88
    s_waitcnt vmcnt(16)
    v_subrev_u32 v27, 2, v23
    ds_write_b32 v22, v27
    s_waitcnt vmcnt(8)
    v_subrev_u32 v27, 1, v23
    ds_write_b32 v22, v27
    s_waitcnt vmcnt(0)
    ds_write_b32 v22, v23
    s_branch L_ldone
L_var_90:
    s_cmp_ge_u32 s36, s68
    s_cbranch_scc1 L_lp_90
L_pk_90:
    v_readlane_b32 s80, v20, s36
    v_readlane_b32 s81, v21, s36
    s_nop 2
    s_add_u32 m0, s74, 0
    s_waitcnt vmcnt(22)
    buffer_load_dwordx4 v8, s[4:7], s80 offen offset:0 nt lds
    s_waitcnt vmcnt(22)
    buffer_load_dwordx4 v9, s[4:7], s80 offen offset:1024 nt lds
    s_waitcnt vmcnt(22)
    buffer_load_dwordx4 v10, s[4:7], s80 offen offset:2048 nt lds
    s_waitcnt vmcnt(22)
    buffer_load_dwordx4 v11, s[4:7], s80 offen offset:3072 nt lds
    s_add_u32 m0, s74, 4096
    s_waitcnt vmcnt(22)
    buffer_load_dwordx4 v8, s[4:7], s81 offen offset:0 nt lds
    s_waitcnt vmcnt(22)
    buffer_load_dwordx4 v9, s[4:7], s81 offen offset:1024 nt lds
    s_waitcnt vmcnt(22)
    buffer_load_dwordx4 v10, s[4:7], s81 offen offset:2048 nt lds
    v_subrev_u32 v27, 2, v23
    ds_write_b32 v22, v27
    s_waitcnt vmcnt(22)
    buffer_load_dwordx4 v11, s[4:7], s81 offen offset:3072 nt lds
    v_add_u32 v23, 1, v23
    s_add_u32 s36, s36, 1
    s_add_u32 s87, s87, 1
    s_add_u32 s74, s74, 32768
    s_add_u32 s83, s70, 2
    s_lshl_b32 s84, s83, 13
    s_and_b32 s84, s84, 16384
    s_cmp_eq_u32 s87, 3
    s_cselect_b32 s87, 0, s87
    s_cselect_b32 s70, s83, s70
    s_cselect_b32 s74, s84, s74
    s_cmp_lt_u32 s36, s68
    s_cbranch_scc1 L_pk_90
L_lp_90:
    s_cmp_ge_u32 s36, s77
    s_cbranch_scc1 L_tl_90
L_lp2_90:
    v_readlane_b32 s34, v20, s75
    v_readlane_b32 s35, v21, s75
    v_readlane_b32 s80, v20, s36
    v_readlane_b32 s81, v21, s36
L_chk_90:
    s_waitcnt lgkmcnt(0)
    v_readlane_b32 s83, v25, s87
    v_readlane_b32 s84, v25, s38
    ds_read_b32 v25, v24
    s_cmp_lt_u32 s39, 4
    s_cselect_b32 s84, s39, s84
    s_cmp_lt_u32 s84, s39
    s_cbranch_scc1 L_chk_90
    s_add_u32 s83, s83, 3
    s_cmp_lt_u32 s83, s70
    s_cbranch_scc1 L_chk_90
    s_add_u32 m0, s74, 0
    s_waitcnt vmcnt(22)
    buffer_load_dwordx4 v8, s[4:7], s80 offen offset:0 nt lds
    s_waitcnt vmcnt(22)
    buffer_load_dwordx4 v9, s[4:7], s80 offen offset:1024 nt lds
    s_waitcnt vmcnt(22)
    buffer_load_dwordx4 v10, s[4:7], s80 offen offset:2048 nt lds
    s_waitcnt vmcnt(22)
    buffer_load_dwordx4 v11, s[4:7], s80 offen offset:3072 nt lds
    s_add_u32 m0, s74, 4096
    s_waitcnt vmcnt(22)
    buffer_load_dwordx4 v8, s[4:7], s81 offen offset:0 nt lds
    s_waitcnt vmcnt(22)
    buffer_load_dwordx4 v9, s[4:7], s81 offen offset:1024 nt lds
    s_waitcnt vmcnt(22)
    buffer_load_dwordx4 v10, s[4:7], s81 offen offset:2048 nt lds
    v_subrev_u32 v27, 2, v23
    ds_write_b32 v22, v27
    s_waitcnt vmcnt(22)
    buffer_load_dwordx4 v11, s[4:7], s81 offen offset:3072 nt lds
    v_add_u32 v23, 1, v23
    s_add_u32 s36, s36, 1
    s_add_u32 s87, s87, 1
    s_add_u32 s74, s74, 32768
    s_add_u32 s83, s70, 2
    s_lshl_b32 s84, s83, 13
    s_and_b32 s84, s84, 16384
    s_cmp_eq_u32 s87, 3
    s_cselect_b32 s87, 0, s87
    s_cselect_b32 s70, s83, s70
    s_cselect_b32 s74, s84, s74
    s_add_u32 m0, s37, 0
    s_waitcnt vmcnt(21)
    buffer_load_dwordx4 v12, s[8:11], s34 offen offset:0 nt lds
    s_waitcnt vmcnt(21)
    buffer_load_dwordx4 v13, s[8:11], s34 offen offset:1024 nt lds
    s_waitcnt vmcnt(21)
    buffer_load_dwordx4 v14, s[8:11], s34 offen offset:2048 nt lds
    s_waitcnt vmcnt(21)
    buffer_load_dwordx4 v15, s[8:11], s34 offen offset:3072 nt lds
    s_add_u32 m0, s37, 4096
    s_waitcnt vmcnt(21)
    buffer_load_dwordx4 v12, s[8:11], s35 offen offset:0 nt lds
    s_waitcnt vmcnt(21)
    buffer_load_dwordx4 v13, s[8:11], s35 offen offset:1024 nt lds
    v_subrev_u32 v27, 2, v23
    ds_write_b32 v22, v27
    s_waitcnt vmcnt(21)
    buffer_load_dwordx4 v14, s[8:11], s35 offen offset:2048 nt lds
    s_waitcnt vmcnt(21)
    buffer_load_dwordx4 v15, s[8:11], s35 offen offset:3072 nt lds
    v_add_u32 v23, 1, v23
    s_add_u32 s75, s75, 1
    s_add_u32 s38, s38, 1
    s_add_u32 s37, s37, 32768
    s_add_u32 s83, s39, 2
    s_lshl_b32 s84, s83, 13
    s_and_b32 s84, s84, 16384
    s_add_u32 s84, s84, 8192
    s_cmp_eq_u32 s38, 3
    s_cselect_b32 s38, 0, s38
    s_cselect_b32 s39, s83, s39
    s_cselect_b32 s37, s84, s37
    s_cmp_lt_u32 s36, s77
    s_cbranch_scc1 L_lp2_90
L_tl_90:
    v_readlane_b32 s34, v20, s75
    v_readlane_b32 s35, v21, s75
L_chv_90:
    s_waitcnt lgkmcnt(0)
    v_readlane_b32 s84, v25, s38
    ds_read_b32 v25, v24
    s_cmp_lt_u32 s39, 4
    s_cselect_b32 s84, s39, s84
    s_cmp_lt_u32 s84, s39
    s_cbranch_scc1 L_chv_90
    s_add_u32 m0, s37, 0
    s_waitcnt vmcnt(21)
    buffer_load_dwordx4 v12, s[8:11], s34 offen offset:0 nt lds
    s_waitcnt vmcnt(21)
    buffer_load_dwordx4 v13, s[8:11], s34 offen offset:1024 nt lds
    s_waitcnt vmcnt(21)
    buffer_load_dwordx4 v14, s[8:11], s34 offen offset:2048 nt lds
    s_waitcnt vmcnt(21)
    buffer_load_dwordx4 v15, s[8:11], s34 offen offset:3072 nt lds
    s_add_u32 m0, s37, 4096
    s_waitcnt vmcnt(21)
    buffer_load_dwordx4 v12, s[8:11], s35 offen offset:0 nt lds
    s_waitcnt vmcnt(21)
    buffer_load_dwordx4 v13, s[8:11], s35 offen offset:1024 nt lds
    v_subrev_u32 v27, 2, v23
    ds_write_b32 v22, v27
    s_waitcnt vmcnt(21)
    buffer_load_dwordx4 v14, s[8:11], s35 offen offset:2048 nt lds
    s_waitcnt vmcnt(21)
    buffer_load_dwordx4 v15, s[8:11], s35 offen offset:3072 nt lds
    v_add_u32 v23, 1, v23
    s_add_u32 s75, s75, 1
    s_add_u32 s38, s38, 1
    s_add_u32 s37, s37, 32768
    s_add_u32 s83, s39, 2
    s_lshl_b32 s84, s83, 13
    s_and_b32 s84, s84, 16384
    s_add_u32 s84, s84, 8192
    s_cmp_eq_u32 s38, 3
    s_cselect_b32 s38, 0, s38
    s_cselect_b32 s39, s83, s39
    s_cselect_b32 s37, s84, s37
    s_cmp_lt_u32 s75, s77
    s_cbranch_scc1 L_tl_90
    s_waitcnt vmcnt(16)
    v_subrev_u32 v27, 2, v23
    ds_write_b32 v22, v27
    s_waitcnt vmcnt(8)
    v_subrev_u32 v27, 1, v23
    ds_write_b32 v22, v27
    s_waitcnt vmcnt(0)
    ds_write_b32 v22, v23
    s_branch L_ldone
L_var_92:
    s_cmp_ge_u32 s36, s68
    s_cbranch_scc1 L_lp_92
L_pk_92:
    v_readlane_b32 s80, v20, s36
    v_readlane_b32 s81, v21, s36
    s_nop 2
    s_add_u32 m0, s74, 0
    s_waitcnt vmcnt(22)
    buffer_load_dwordx4 v8, s[4:7], s80 offen offset:0 nt lds
    s_waitcnt vmcnt(22)
    buffer_load_dwordx4 v9, s[4:7], s80 offen offset:1024 nt lds
    s_waitcnt vmcnt(22)
    buffer_load_dwordx4 v10, s[4:7], s80 offen offset:2048 nt lds
    s_waitcnt vmcnt(22)
    buffer_load_dwordx4 v11, s[4:7], s80 offen offset:3072 nt lds
    s_add_u32 m0, s74, 4096
    s_waitcnt vmcnt(22)
    buffer_load_dwordx4 v8, s[4:7], s81 offen offset:0 nt lds
    s_waitcnt vmcnt(22)
    buffer_load_dwordx4 v9, s[4:7], s81 offen offset:1024 nt lds
    s_waitcnt vmcnt(22)
    buffer_load_dwordx4 v10, s[4:7], s81 offen offset:2048 nt lds
    v_subrev_u32 v27, 2, v23
    ds_write_b32 v22, v27
    s_waitcnt vmcnt(22)
    buffer_load_dwordx4 v11, s[4:7], s81 offen offset:3072 nt lds
    v_add_u32 v23, 1, v23
    s_add_u32 s36, s36, 1
    s_add_u32 s87, s87, 1
    s_add_u32 s74, s74, 32768
    s_add_u32 s83, s70, 2
    s_lshl_b32 s84, s83, 13
    s_and_b32 s84, s84, 16384
    s_cmp_eq_u32 s87, 3
    s_cselect_b32 s87, 0, s87
    s_cselect_b32 s70, s83, s70
    s_cselect_b32 s74, s84, s74
    s_cmp_lt_u32 s36, s68
    s_cbranch_scc1 L_pk_92
L_lp_92:
    s_cmp_ge_u32 s36, s77
    s_cbranch_scc1 L_tl_92
L_lp2_92:
    v_readlane_b32 s34, v20, s75
    v_readlane_b32 s35, v21, s75
    v_readlane_b32 s80, v20, s36
    v_readlane_b32 s81, v21, s36
L_chk_92:
    s_waitcnt lgkmcnt(0)
    v_readlane_b32 s83, v25, s87
    v_readlane_b32 s84, v25, s38
    ds_read_b32 v25, v24
    s_cmp_lt_u32 s39, 4
    s_cselect_b32 s84, s39, s84
    s_cmp_lt_u32 s84, s39
    s_cbranch_scc1 L_chk_92
    s_add_u32 s83, s83, 3
    s_cmp_lt_u32 s83, s70
    s_cbranch_scc1 L_chk_92
    s_add_u32 m0, s74, 0
    s_waitcnt vmcnt(22)
    buffer_load_dwordx4 v8, s[4:7], s80 offen offset:0 nt lds
    s_waitcnt vmcnt(22)
    buffer_load_dwordx4 v9, s[4:7], s80 offen offset:1024 nt lds
    s_waitcnt vmcnt(22)
    buffer_load_dwordx4 v10, s[4:7], s80 offen offset:2048 nt lds
    s_waitcnt vmcnt(22)
    buffer_load_dwordx4 v11, s[4:7], s80 offen offset:3072 nt lds
    s_add_u32 m0, s74, 4096
    s_waitcnt vmcnt(22)
    buffer_load_dwordx4 v8, s[4:7], s81 offen offset:0 nt lds
    s_waitcnt vmcnt(22)
    buffer_load_dwordx4 v9, s[4:7], s81 offen offset:1024 nt lds
    s_waitcnt vmcnt(22)
    buffer_load_dwordx4 v10, s[4:7], s81 offen offset:2048 nt lds
    v_subrev_u32 v27, 2, v23
    ds_write_b32 v22, v27
    s_waitcnt vmcnt(22)
    buffer_load_dwordx4 v11, s[4:7], s81 offen offset:3072 nt lds
    v_add_u32 v23, 1, v23
    s_add_u32 s36, s36, 1
    s_add_u32 s87, s87, 1
    s_add_u32 s74, s74, 32768
    s_add_u32 s83, s70, 2
    s_lshl_b32 s84, s83, 13
    s_and_b32 s84, s84, 16384
    s_cmp_eq_u32 s87, 3
    s_cselect_b32 s87, 0, s87
    s_cselect_b32 s70, s83, s70
    s_cselect_b32 s74, s84, s74
    s_add_u32 m0, s37, 0
    s_waitcnt vmcnt(22)
    buffer_load_dwordx4 v12, s[8:11], s34 offen offset:0 nt lds
    s_waitcnt vmcnt(22)
    buffer_load_dwordx4 v13, s[8:11], s34 offen offset:1024 nt lds
    s_waitcnt vmcnt(22)
    buffer_load_dwordx4 v14, s[8:11], s34 offen offset:2048 nt lds
    s_waitcnt vmcnt(22)
    buffer_load_dwordx4 v15, s[8:11], s34 offen offset:3072 nt lds
    s_add_u32 m0, s37, 4096
    s_waitcnt vmcnt(22)
    buffer_load_dwordx4 v12, s[8:11], s35 offen offset:0 nt lds
    s_waitcnt vmcnt(22)
    buffer_load_dwordx4 v13, s[8:11], s35 offen offset:1024 nt lds
    s_waitcnt vmcnt(22)
    buffer_load_dwordx4 v14, s[8:11], s35 offen offset:2048 nt lds
    v_subrev_u32 v27, 2, v23
    ds_write_b32 v22, v27
    s_waitcnt vmcnt(22)
    buffer_load_dwordx4 v15, s[8:11], s35 offen offset:3072 nt lds
    v_add_u32 v23, 1, v23
    s_add_u32 s75, s75, 1
    s_add_u32 s38, s38, 1
    s_add_u32 s37, s37, 32768
    s_add_u32 s83, s39, 2
    s_lshl_b32 s84, s83, 13
    s_and_b32 s84, s84, 16384
    s_add_u32 s84, s84, 8192
    s_cmp_eq_u32 s38, 3
    s_cselect_b32 s38, 0, s38
    s_cselect_b32 s39, s83, s39
    s_cselect_b32 s37, s84, s37
    s_cmp_lt_u32 s36, s77
    s_cbranch_scc1 L_lp2_92
L_tl_92:
    v_readlane_b32 s34, v20, s75
    v_readlane_b32 s35, v21, s75
L_chv_92:
    s_waitcnt lgkmcnt(0)
    v_readlane_b32 s84, v25, s38
    ds_read_b32 v25, v24
    s_cmp_lt_u32 s39, 4
    s_cselect_b32 s84, s39, s84
    s_cmp_lt_u32 s84, s39
    s_cbranch_scc1 L_chv_92
    s_add_u32 m0, s37, 0
    s_waitcnt vmcnt(22)
    buffer_load_dwordx4 v12, s[8:11], s34 offen offset:0 nt lds
    s_waitcnt vmcnt(22)
    buffer_load_dwordx4 v13, s[8:11], s34 offen offset:1024 nt lds
    s_waitcnt vmcnt(22)
    buffer_load_dwordx4 v14, s[8:11], s34 offen offset:2048 nt lds
    s_waitcnt vmcnt(22)
    buffer_load_dwordx4 v15, s[8:11], s34 offen offset:3072 nt lds
    s_add_u32 m0, s37, 4096
    s_waitcnt vmcnt(22)
    buffer_load_dwordx4 v12, s[8:11], s35 offen offset:0 nt lds
    s_waitcnt vmcnt(22)
    buffer_load_dwordx4 v13, s[8:11], s35 offen offset:1024 nt lds
    s_waitcnt vmcnt(22)
    buffer_load_dwordx4 v14, s[8:11], s35 offen offset:2048 nt lds
    v_subrev_u32 v27, 2, v23
    ds_write_b32 v22, v27
    s_waitcnt vmcnt(22)
    buffer_load_dwordx4 v15, s[8:11], s35 offen offset:3072 nt lds
    v_add_u32 v23, 1, v23
    s_add_u32 s75, s75, 1
    s_add_u32 s38, s38, 1
    s_add_u32 s37, s37, 32768
    s_add_u32 s83, s39, 2
    s_lshl_b32 s84, s83, 13
    s_and_b32 s84, s84, 16384
    s_add_u32 s84, s84, 8192
    s_cmp_eq_u32 s38, 3
    s_cselect_b32 s38, 0, s38
    s_cselect_b32 s39, s83, s39
    s_cselect_b32 s37, s84, s37
    s_cmp_lt_u32 s75, s77
    s_cbranch_scc1 L_tl_92
    s_waitcnt vmcnt(16)
    v_subrev_u32 v27, 2, v23
    ds_write_b32 v22, v27
    s_waitcnt vmcnt(8)
    v_subrev_u32 v27, 1, v23
    ds_write_b32 v22, v27
    s_waitcnt vmcnt(0)
    ds_write_b32 v22, v23
    s_branch L_ldone
L_var_94:
    s_cmp_ge_u32 s36, s68
    s_cbranch_scc1 L_lp_94
L_pk_94:
    v_readlane_b32 s80, v20, s36
    v_readlane_b32 s81, v21, s36
    s_nop 2
    s_add_u32 m0, s74, 0
    s_waitcnt vmcnt(23)
    buffer_load_dwordx4 v8, s[4:7], s80 offen offset:0 nt lds
    s_waitcnt vmcnt(23)
    buffer_load_dwordx4 v9, s[4:7], s80 offen offset:1024 nt lds
    s_waitcnt vmcnt(23)
    buffer_load_dwordx4 v10, s[4:7], s80 offen offset:2048 nt lds
    s_waitcnt vmcnt(23)
    buffer_load_dwordx4 v11, s[4:7], s80 offen offset:3072 nt lds
    s_add_u32 m0, s74, 4096
    s_waitcnt vmcnt(23)
    buffer_load_dwordx4 v8, s[4:7], s81 offen offset:0 nt lds
    s_waitcnt vmcnt(23)
    buffer_load_dwordx4 v9, s[4:7], s81 offen offset:1024 nt lds
    s_waitcnt vmcnt(23)
    buffer_load_dwordx4 v10, s[4:7], s81 offen offset:2048 nt lds
    s_waitcnt vmcnt(23)
    buffer_load_dwordx4 v11, s[4:7], s81 offen offset:3072 nt lds
    v_subrev_u32 v27, 2, v23
    ds_write_b32 v22, v27
    v_add_u32 v23, 1, v23
    s_add_u32 s36, s36, 1
    s_add_u32 s87, s87, 1
    s_add_u32 s74, s74, 32768
    s_add_u32 s83, s70, 2
    s_lshl_b32 s84, s83, 13
    s_and_b32 s84, s84, 16384
    s_cmp_eq_u32 s87, 3
    s_cselect_b32 s87, 0, s87
    s_cselect_b32 s70, s83, s70
    s_cselect_b32 s74, s84, s74
    s_cmp_lt_u32 s36, s68
    s_cbranch_scc1 L_pk_94
L_lp_94:
    s_cmp_ge_u32 s36, s77
    s_cbranch_scc1 L_tl_94
L_lp2_94:
    v_readlane_b32 s34, v20, s75
    v_readlane_b32 s35, v21, s75
    v_readlane_b32 s80, v20, s36
    v_readlane_b32 s81, v21, s36
L_chk_94:
    s_waitcnt lgkmcnt(0)
    v_readlane_b32 s83, v25, s87
    v_readlane_b32 s84, v25, s38
    ds_read_b32 v25, v24
    s_cmp_lt_u32 s39, 4
    s_cselect_b32 s84, s39, s84
    s_cmp_lt_u32 s84, s39
    s_cbranch_scc1 L_chk_94
    s_add_u32 s83, s83, 3
    s_cmp_lt_u32 s83, s70
    s_cbranch_scc1 L_chk_94
    s_add_u32 m0, s74, 0
    s_waitcnt vmcnt(23)
    buffer_load_dwordx4 v8, s[4:7], s80 offen offset:0 nt lds
    s_waitcnt vmcnt(23)
    buffer_load_dwordx4 v9, s[4:7], s80 offen offset:1024 nt lds
    s_waitcnt vmcnt(23)
    buffer_load_dwordx4 v10, s[4:7], s80 offen offset:2048 nt lds
    s_waitcnt vmcnt(23)
    buffer_load_dwordx4 v11, s[4:7], s80 offen offset:3072 nt lds
    s_add_u32 m0, s74, 4096
    s_waitcnt vmcnt(23)
    buffer_load_dwordx4 v8, s[4:7], s81 offen offset:0 nt lds
    s_waitcnt vmcnt(23)
    buffer_load_dwordx4 v9, s[4:7], s81 offen offset:1024 nt lds
    s_waitcnt vmcnt(23)
    buffer_load_dwordx4 v10, s[4:7], s81 offen offset:2048 nt lds
    s_waitcnt vmcnt(23)
    buffer_load_dwordx4 v11, s[4:7], s81 offen offset:3072 nt lds
    v_subrev_u32 v27, 2, v23
    ds_write_b32 v22, v27
    v_add_u32 v23, 1, v23
    s_add_u32 s36, s36, 1
    s_add_u32 s87, s87, 1
    s_add_u32 s74, s74, 32768
    s_add_u32 s83, s70, 2
    s_lshl_b32 s84, s83, 13
    s_and_b32 s84, s84, 16384
    s_cmp_eq_u32 s87, 3
    s_cselect_b32 s87, 0, s87
    s_cselect_b32 s70, s83, s70
    s_cselect_b32 s74, s84, s74
    s_add_u32 m0, s37, 0
    s_waitcnt vmcnt(22)
    buffer_load_dwordx4 v12, s[8:11], s34 offen offset:0 nt lds
    s_waitcnt vmcnt(22)
    buffer_load_dwordx4 v13, s[8:11], s34 offen offset:1024 nt lds
    s_waitcnt vmcnt(22)
    buffer_load_dwordx4 v14, s[8:11], s34 offen offset:2048 nt lds
    s_waitcnt vmcnt(22)
    buffer_load_dwordx4 v15, s[8:11], s34 offen offset:3072 nt lds
    s_add_u32 m0, s37, 4096
    s_waitcnt vmcnt(22)
    buffer_load_dwordx4 v12, s[8:11], s35 offen offset:0 nt lds
    s_waitcnt vmcnt(22)
    buffer_load_dwordx4 v13, s[8:11], s35 offen offset:1024 nt lds
    s_waitcnt vmcnt(22)
    buffer_load_dwordx4 v14, s[8:11], s35 offen offset:2048 nt lds
    v_subrev_u32 v27, 2, v23
    ds_write_b32 v22, v27
    s_waitcnt vmcnt(22)
    buffer_load_dwordx4 v15, s[8:11], s35 offen offset:3072 nt lds
    v_add_u32 v23, 1, v23
    s_add_u32 s75, s75, 1
    s_add_u32 s38, s38, 1
    s_add_u32 s37, s37, 32768
    s_add_u32 s83, s39, 2
    s_lshl_b32 s84, s83, 13
    s_and_b32 s84, s84, 16384
    s_add_u32 s84, s84, 8192
    s_cmp_eq_u32 s38, 3
    s_cselect_b32 s38, 0, s38
    s_cselect_b32 s39, s83, s39
    s_cselect_b32 s37, s84, s37
    s_cmp_lt_u32 s36, s77
    s_cbranch_scc1 L_lp2_94
L_tl_94:
    v_readlane_b32 s34, v20, s75
    v_readlane_b32 s35, v21, s75
L_chv_94:
    s_waitcnt lgkmcnt(0)
    v_readlane_b32 s84, v25, s38
    ds_read_b32 v25, v24
    s_cmp_lt_u32 s39, 4
    s_cselect_b32 s84, s39, s84
    s_cmp_lt_u32 s84, s39
    s_cbranch_scc1 L_chv_94
    s_add_u32 m0, s37, 0
    s_waitcnt vmcnt(23)
    buffer_load_dwordx4 v12, s[8:11], s34 offen offset:0 nt lds
    s_waitcnt vmcnt(23)
    buffer_load_dwordx4 v13, s[8:11], s34 offen offset:1024 nt lds
    s_waitcnt vmcnt(23)
    buffer_load_dwordx4 v14, s[8:11], s34 offen offset:2048 nt lds
    s_waitcnt vmcnt(23)
    buffer_load_dwordx4 v15, s[8:11], s34 offen offset:3072 nt lds
    s_add_u32 m0, s37, 4096
    s_waitcnt vmcnt(23)
    buffer_load_dwordx4 v12, s[8:11], s35 offen offset:0 nt lds
    s_waitcnt vmcnt(23)
    buffer_load_dwordx4 v13, s[8:11], s35 offen offset:1024 nt lds
    s_waitcnt vmcnt(23)
    buffer_load_dwordx4 v14, s[8:11], s35 offen offset:2048 nt lds
    s_waitcnt vmcnt(23)
    buffer_load_dwordx4 v15, s[8:11], s35 offen offset:3072 nt lds
    v_subrev_u32 v27, 2, v23
    ds_write_b32 v22, v27
    v_add_u32 v23, 1, v23
    s_add_u32 s75, s75, 1
    s_add_u32 s38, s38, 1
    s_add_u32 s37, s37, 32768
    s_add_u32 s83, s39, 2
    s_lshl_b32 s84, s83, 13
    s_and_b32 s84, s84, 16384
    s_add_u32 s84, s84, 8192
    s_cmp_eq_u32 s38, 3
    s_cselect_b32 s38, 0, s38
    s_cselect_b32 s39, s83, s39
    s_cselect_b32 s37, s84, s37
    s_cmp_lt_u32 s75, s77
    s_cbranch_scc1 L_tl_94
    s_waitcnt vmcnt(16)
    v_subrev_u32 v27, 2, v23
    ds_write_b32 v22, v27
    s_waitcnt vmcnt(8)
    v_subrev_u32 v27, 1, v23
    ds_write_b32 v22, v27
    s_waitcnt vmcnt(0)
    ds_write_b32 v22, v23
    s_branch L_ldone
L_var_96:
    s_cmp_ge_u32 s36, s68
    s_cbranch_scc1 L_lp_96
L_pk_96:
    v_readlane_b32 s80, v20, s36
    v_readlane_b32 s81, v21, s36
    s_nop 2
    s_add_u32 m0, s74, 0
    s_waitcnt vmcnt(23)
    buffer_load_dwordx4 v8, s[4:7], s80 offen offset:0 nt lds
    s_waitcnt vmcnt(23)
    buffer_load_dwordx4 v9, s[4:7], s80 offen offset:1024 nt lds
    s_waitcnt vmcnt(23)
    buffer_load_dwordx4 v10, s[4:7], s80 offen offset:2048 nt lds
    s_waitcnt vmcnt(23)
    buffer_load_dwordx4 v11, s[4:7], s80 offen offset:3072 nt lds
    s_add_u32 m0, s74, 4096
    s_waitcnt vmcnt(23)
    buffer_load_dwordx4 v8, s[4:7], s81 offen offset:0 nt lds
    s_waitcnt vmcnt(23)
    buffer_load_dwordx4 v9, s[4:7], s81 offen offset:1024 nt lds
    s_waitcnt vmcnt(23)
    buffer_load_dwordx4 v10, s[4:7], s81 offen offset:2048 nt lds
    s_waitcnt vmcnt(23)
    buffer_load_dwordx4 v11, s[4:7], s81 offen offset:3072 nt lds
    v_subrev_u32 v27, 2, v23
    ds_write_b32 v22, v27
    v_add_u32 v23, 1, v23
    s_add_u32 s36, s36, 1
    s_add_u32 s87, s87, 1
    s_add_u32 s74, s74, 32768
    s_add_u32 s83, s70, 2
    s_lshl_b32 s84, s83, 13
    s_and_b32 s84, s84, 16384
    s_cmp_eq_u32 s87, 3
    s_cselect_b32 s87, 0, s87
    s_cselect_b32 s70, s83, s70
    s_cselect_b32 s74, s84, s74
    s_cmp_lt_u32 s36, s68
    s_cbranch_scc1 L_pk_96
L_lp_96:
    s_cmp_ge_u32 s36, s77
    s_cbranch_scc1 L_tl_96
L_lp2_96:
    v_readlane_b32 s34, v20, s75
    v_readlane_b32 s35, v21, s75
    v_readlane_b32 s80, v20, s36
    v_readlane_b32 s81, v21, s36
L_chk_96:
    s_waitcnt lgkmcnt(0)
    v_readlane_b32 s83, v25, s87
    v_readlane_b32 s84, v25, s38
    ds_read_b32 v25, v24
    s_cmp_lt_u32 s39, 4
    s_cselect_b32 s84, s39, s84
    s_cmp_lt_u32 s84, s39
    s_cbranch_scc1 L_chk_96
    s_add_u32 s83, s83, 3
    s_cmp_lt_u32 s83, s70
    s_cbranch_scc1 L_chk_96
    s_add_u32 m0, s74, 0
    s_waitcnt vmcnt(23)
    buffer_load_dwordx4 v8, s[4:7], s80 offen offset:0 nt lds
    s_waitcnt vmcnt(23)
    buffer_load_dwordx4 v9, s[4:7], s80 offen offset:1024 nt lds
    s_waitcnt vmcnt(23)
    buffer_load_dwordx4 v10, s[4:7], s80 offen offset:2048 nt lds
    s_waitcnt vmcnt(23)
    buffer_load_dwordx4 v11, s[4:7], s80 offen offset:3072 nt lds
    s_add_u32 m0, s74, 4096
    s_waitcnt vmcnt(23)
    buffer_load_dwordx4 v8, s[4:7], s81 offen offset:0 nt lds
    s_waitcnt vmcnt(23)
    buffer_load_dwordx4 v9, s[4:7], s81 offen offset:1024 nt lds
    s_waitcnt vmcnt(23)
    buffer_load_dwordx4 v10, s[4:7], s81 offen offset:2048 nt lds
    s_waitcnt vmcnt(23)
    buffer_load_dwordx4 v11, s[4:7], s81 offen offset:3072 nt lds
    v_subrev_u32 v27, 2, v23
    ds_write_b32 v22, v27
    v_add_u32 v23, 1, v23
    s_add_u32 s36, s36, 1
    s_add_u32 s87, s87, 1
    s_add_u32 s74, s74, 32768
    s_add_u32 s83, s70, 2
    s_lshl_b32 s84, s83, 13
    s_and_b32 s84, s84, 16384
    s_cmp_eq_u32 s87, 3
    s_cselect_b32 s87, 0, s87
    s_cselect_b32 s70, s83, s70
    s_cselect_b32 s74, s84, s74
    s_add_u32 m0, s37, 0
    s_waitcnt vmcnt(23)
    buffer_load_dwordx4 v12, s[8:11], s34 offen offset:0 nt lds
    s_waitcnt vmcnt(23)
    buffer_load_dwordx4 v13, s[8:11], s34 offen offset:1024 nt lds
    s_waitcnt vmcnt(23)
    buffer_load_dwordx4 v14, s[8:11], s34 offen offset:2048 nt lds
    s_waitcnt vmcnt(23)
    buffer_load_dwordx4 v15, s[8:11], s34 offen offset:3072 nt lds
    s_add_u32 m0, s37, 4096
    s_waitcnt vmcnt(23)
    buffer_load_dwordx4 v12, s[8:11], s35 offen offset:0 nt lds
    s_waitcnt vmcnt(23)
    buffer_load_dwordx4 v13, s[8:11], s35 offen offset:1024 nt lds
    s_waitcnt vmcnt(23)
    buffer_load_dwordx4 v14, s[8:11], s35 offen offset:2048 nt lds
    s_waitcnt vmcnt(23)
    buffer_load_dwordx4 v15, s[8:11], s35 offen offset:3072 nt lds
    v_subrev_u32 v27, 2, v23
    ds_write_b32 v22, v27
    v_add_u32 v23, 1, v23
    s_add_u32 s75, s75, 1
    s_add_u32 s38, s38, 1
    s_add_u32 s37, s37, 32768
    s_add_u32 s83, s39, 2
    s_lshl_b32 s84, s83, 13
    s_and_b32 s84, s84, 16384
    s_add_u32 s84, s84, 8192
    s_cmp_eq_u32 s38, 3
    s_cselect_b32 s38, 0, s38
    s_cselect_b32 s39, s83, s39
    s_cselect_b32 s37, s84, s37
    s_cmp_lt_u32 s36, s77
    s_cbranch_scc1 L_lp2_96
L_tl_96:
    v_readlane_b32 s34, v20, s75
    v_readlane_b32 s35, v21, s75
L_chv_96:
    s_waitcnt lgkmcnt(0)
    v_readlane_b32 s84, v25, s38
    ds_read_b32 v25, v24
    s_cmp_lt_u32 s39, 4
    s_cselect_b32 s84, s39, s84
    s_cmp_lt_u32 s84, s39
    s_cbranch_scc1 L_chv_96
    s_add_u32 m0, s37, 0
    s_waitcnt vmcnt(23)
    buffer_load_dwordx4 v12, s[8:11], s34 offen offset:0 nt lds
    s_waitcnt vmcnt(23)
    buffer_load_dwordx4 v13, s[8:11], s34 offen offset:1024 nt lds
    s_waitcnt vmcnt(23)
    buffer_load_dwordx4 v14, s[8:11], s34 offen offset:2048 nt lds
    s_waitcnt vmcnt(23)
    buffer_load_dwordx4 v15, s[8:11], s34 offen offset:3072 nt lds
    s_add_u32 m0, s37, 4096
    s_waitcnt vmcnt(23)
    buffer_load_dwordx4 v12, s[8:11], s35 offen offset:0 nt lds
    s_waitcnt vmcnt(23)
    buffer_load_dwordx4 v13, s[8:11], s35 offen offset:1024 nt lds
    s_waitcnt vmcnt(23)
    buffer_load_dwordx4 v14, s[8:11], s35 offen offset:2048 nt lds
    s_waitcnt vmcnt(23)
    buffer_load_dwordx4 v15, s[8:11], s35 offen offset:3072 nt lds
    v_subrev_u32 v27, 2, v23
    ds_write_b32 v22, v27
    v_add_u32 v23, 1, v23
    s_add_u32 s75, s75, 1
    s_add_u32 s38, s38, 1
    s_add_u32 s37, s37, 32768
    s_add_u32 s83, s39, 2
    s_lshl_b32 s84, s83, 13
    s_and_b32 s84, s84, 16384
    s_add_u32 s84, s84, 8192
    s_cmp_eq_u32 s38, 3
    s_cselect_b32 s38, 0, s38
    s_cselect_b32 s39, s83, s39
    s_cselect_b32 s37, s84, s37
    s_cmp_lt_u32 s75, s77
    s_cbranch_scc1 L_tl_96
    s_waitcnt vmcnt(16)
    v_subrev_u32 v27, 2, v23
    ds_write_b32 v22, v27
    s_waitcnt vmcnt(8)
    v_subrev_u32 v27, 1, v23
    ds_write_b32 v22, v27
    s_waitcnt vmcnt(0)
    ds_write_b32 v22, v23
    s_branch L_ldone
L_var_98:
    s_cmp_ge_u32 s36, s68
    s_cbranch_scc1 L_lp_98
L_pk_98:
    v_readlane_b32 s80, v20, s36
    v_readlane_b32 s81, v21, s36
    s_nop 2
    s_add_u32 m0, s74, 0
    s_waitcnt vmcnt(24)
    buffer_load_dwordx4 v8, s[4:7], s80 offen offset:0 nt lds
    v_subrev_u32 v27, 3, v23
    ds_write_b32 v22, v27
    s_waitcnt vmcnt(24)
    buffer_load_dwordx4 v9, s[4:7], s80 offen offset:1024 nt lds
    s_waitcnt vmcnt(24)
    buffer_load_dwordx4 v10, s[4:7], s80 offen offset:2048 nt lds
    s_waitcnt vmcnt(24)
    buffer_load_dwordx4 v11, s[4:7], s80 offen offset:3072 nt lds
    s_add_u32 m0, s74, 4096
    s_waitcnt vmcnt(24)
    buffer_load_dwordx4 v8, s[4:7], s81 offen offset:0 nt lds
    s_waitcnt vmcnt(24)
    buffer_load_dwordx4 v9, s[4:7], s81 offen offset:1024 nt lds
    s_waitcnt vmcnt(24)
    buffer_load_dwordx4 v10, s[4:7], s81 offen offset:2048 nt lds
    s_waitcnt vmcnt(24)
    buffer_load_dwordx4 v11, s[4:7], s81 offen offset:3072 nt lds
    v_add_u32 v23, 1, v23
    s_add_u32 s36, s36, 1
    s_add_u32 s87, s87, 1
    s_add_u32 s74, s74, 32768
    s_add_u32 s83, s70, 2
    s_lshl_b32 s84, s83, 13
    s_and_b32 s84, s84, 16384
    s_cmp_eq_u32 s87, 3
    s_cselect_b32 s87, 0, s87
    s_cselect_b32 s70, s83, s70
    s_cselect_b32 s74, s84, s74
    s_cmp_lt_u32 s36, s68
    s_cbranch_scc1 L_pk_98
L_lp_98:
    s_cmp_ge_u32 s36, s77
    s_cbranch_scc1 L_tl_98
L_lp2_98:
    v_readlane_b32 s34, v20, s75
    v_readlane_b32 s35, v21, s75
    v_readlane_b32 s80, v20, s36
    v_readlane_b32 s81, v21, s36
L_chk_98:
    s_waitcnt lgkmcnt(0)
    v_readlane_b32 s83, v25, s87
    v_readlane_b32 s84, v25, s38
    ds_read_b32 v25, v24
    s_cmp_lt_u32 s39, 4
    s_cselect_b32 s84, s39, s84
    s_cmp_lt_u32 s84, s39
    s_cbranch_scc1 L_chk_98
    s_add_u32 s83, s83, 3
    s_cmp_lt_u32 s83, s70
    s_cbranch_scc1 L_chk_98
    s_add_u32 m0, s74, 0
    s_waitcnt vmcnt(24)
    buffer_load_dwordx4 v8, s[4:7], s80 offen offset:0 nt lds
    v_subrev_u32 v27, 3, v23
    ds_write_b32 v22, v27
    s_waitcnt vmcnt(24)
    buffer_load_dwordx4 v9, s[4:7], s80 offen offset:1024 nt lds
    s_waitcnt vmcnt(24)
    buffer_load_dwordx4 v10, s[4:7], s80 offen offset:2048 nt lds
    s_waitcnt vmcnt(24)
    buffer_load_dwordx4 v11, s[4:7], s80 offen offset:3072 nt lds
    s_add_u32 m0, s74, 4096
    s_waitcnt vmcnt(24)
    buffer_load_dwordx4 v8, s[4:7], s81 offen offset:0 nt lds
    s_waitcnt vmcnt(24)
    buffer_load_dwordx4 v9, s[4:7], s81 offen offset:1024 nt lds
    s_waitcnt vmcnt(24)
    buffer_load_dwordx4 v10, s[4:7], s81 offen offset:2048 nt lds
    s_waitcnt vmcnt(24)
    buffer_load_dwordx4 v11, s[4:7], s81 offen offset:3072 nt lds
    v_add_u32 v23, 1, v23
    s_add_u32 s36, s36, 1
    s_add_u32 s87, s87, 1
    s_add_u32 s74, s74, 32768
    s_add_u32 s83, s70, 2
    s_lshl_b32 s84, s83, 13
    s_and_b32 s84, s84, 16384
    s_cmp_eq_u32 s87, 3
    s_cselect_b32 s87, 0, s87
    s_cselect_b32 s70, s83, s70
    s_cselect_b32 s74, s84, s74
    s_add_u32 m0, s37, 0
    s_waitcnt vmcnt(23)
    buffer_load_dwordx4 v12, s[8:11], s34 offen offset:0 nt lds
    s_waitcnt vmcnt(23)
    buffer_load_dwordx4 v13, s[8:11], s34 offen offset:1024 nt lds
    s_waitcnt vmcnt(23)
    buffer_load_dwordx4 v14, s[8:11], s34 offen offset:2048 nt lds
    s_waitcnt vmcnt(23)
    buffer_load_dwordx4 v15, s[8:11], s34 offen offset:3072 nt lds
    s_add_u32 m0, s37, 4096
    s_waitcnt vmcnt(23)
    buffer_load_dwordx4 v12, s[8:11], s35 offen offset:0 nt lds
    s_waitcnt vmcnt(23)
    buffer_load_dwordx4 v13, s[8:11], s35 offen offset:1024 nt lds
    s_waitcnt vmcnt(23)
    buffer_load_dwordx4 v14, s[8:11], s35 offen offset:2048 nt lds
    s_waitcnt vmcnt(23)
    buffer_load_dwordx4 v15, s[8:11], s35 offen offset:3072 nt lds
    v_subrev_u32 v27, 2, v23
    ds_write_b32 v22, v27
    v_add_u32 v23, 1, v23
    s_add_u32 s75, s75, 1
    s_add_u32 s38, s38, 1
    s_add_u32 s37, s37, 32768
    s_add_u32 s83, s39, 2
    s_lshl_b32 s84, s83, 13
    s_and_b32 s84, s84, 16384
    s_add_u32 s84, s84, 8192
    s_cmp_eq_u32 s38, 3
    s_cselect_b32 s38, 0, s38
    s_cselect_b32 s39, s83, s39
    s_cselect_b32 s37, s84, s37
    s_cmp_lt_u32 s36, s77
    s_cbranch_scc1 L_lp2_98
L_tl_98:
    v_readlane_b32 s34, v20, s75
    v_readlane_b32 s35, v21, s75
L_chv_98:
    s_waitcnt lgkmcnt(0)
    v_readlane_b32 s84, v25, s38
    ds_read_b32 v25, v24
    s_cmp_lt_u32 s39, 4
    s_cselect_b32 s84, s39, s84
    s_cmp_lt_u32 s84, s39
    s_cbranch_scc1 L_chv_98
    s_add_u32 m0, s37, 0
    s_waitcnt vmcnt(23)
    buffer_load_dwordx4 v12, s[8:11], s34 offen offset:0 nt lds
    s_waitcnt vmcnt(23)
    buffer_load_dwordx4 v13, s[8:11], s34 offen offset:1024 nt lds
    s_waitcnt vmcnt(23)
    buffer_load_dwordx4 v14, s[8:11], s34 offen offset:2048 nt lds
    s_waitcnt vmcnt(23)
    buffer_load_dwordx4 v15, s[8:11], s34 offen offset:3072 nt lds
    s_add_u32 m0, s37, 4096
    s_waitcnt vmcnt(23)
    buffer_load_dwordx4 v12, s[8:11], s35 offen offset:0 nt lds
    s_waitcnt vmcnt(23)
    buffer_load_dwordx4 v13, s[8:11], s35 offen offset:1024 nt lds
    s_waitcnt vmcnt(23)
    buffer_load_dwordx4 v14, s[8:11], s35 offen offset:2048 nt lds
    s_waitcnt vmcnt(23)
    buffer_load_dwordx4 v15, s[8:11], s35 offen offset:3072 nt lds
    v_subrev_u32 v27, 2, v23
    ds_write_b32 v22, v27
    v_add_u32 v23, 1, v23
    s_add_u32 s75, s75, 1
    s_add_u32 s38, s38, 1
    s_add_u32 s37, s37, 32768
    s_add_u32 s83, s39, 2
    s_lshl_b32 s84, s83, 13
    s_and_b32 s84, s84, 16384
    s_add_u32 s84, s84, 8192
    s_cmp_eq_u32 s38, 3
    s_cselect_b32 s38, 0, s38
    s_cselect_b32 s39, s83, s39
    s_cselect_b32 s37, s84, s37
    s_cmp_lt_u32 s75, s77
    s_cbranch_scc1 L_tl_98
    s_waitcnt vmcnt(16)
    v_subrev_u32 v27, 2, v23
    ds_write_b32 v22, v27
    s_waitcnt vmcnt(8)
    v_subrev_u32 v27, 1, v23
    ds_write_b32 v22, v27
    s_waitcnt vmcnt(0)
    ds_write_b32 v22, v23
    s_branch L_ldone
L_var_100:
    s_cmp_ge_u32 s36, s68
    s_cbranch_scc1 L_lp_100
L_pk_100:
    v_readlane_b32 s80, v20, s36
    v_readlane_b32 s81, v21, s36
    s_nop 2
    s_add_u32 m0, s74, 0
    s_waitcnt vmcnt(24)
    buffer_load_dwordx4 v8, s[4:7], s80 offen offset:0 nt lds
    v_subrev_u32 v27, 3, v23
    ds_write_b32 v22, v27
    s_waitcnt vmcnt(24)
    buffer_load_dwordx4 v9, s[4:7], s80 offen offset:1024 nt lds
    s_waitcnt vmcnt(24)
    buffer_load_dwordx4 v10, s[4:7], s80 offen offset:2048 nt lds
    s_waitcnt vmcnt(24)
    buffer_load_dwordx4 v11, s[4:7], s80 offen offset:3072 nt lds
    s_add_u32 m0, s74, 4096
    s_waitcnt vmcnt(24)
    buffer_load_dwordx4 v8, s[4:7], s81 offen offset:0 nt lds
    s_waitcnt vmcnt(24)
    buffer_load_dwordx4 v9, s[4:7], s81 offen offset:1024 nt lds
    s_waitcnt vmcnt(24)
    buffer_load_dwordx4 v10, s[4:7], s81 offen offset:2048 nt lds
    s_waitcnt vmcnt(24)
    buffer_load_dwordx4 v11, s[4:7], s81 offen offset:3072 nt lds
    v_add_u32 v23, 1, v23
    s_add_u32 s36, s36, 1
    s_add_u32 s87, s87, 1
    s_add_u32 s74, s74, 32768
    s_add_u32 s83, s70, 2
    s_lshl_b32 s84, s83, 13
    s_and_b32 s84, s84, 16384
    s_cmp_eq_u32 s87, 3
    s_cselect_b32 s87, 0, s87
    s_cselect_b32 s70, s83, s70
    s_cselect_b32 s74, s84, s74
    s_cmp_lt_u32 s36, s68
    s_cbranch_scc1 L_pk_100
L_lp_100:
    s_cmp_ge_u32 s36, s77
    s_cbranch_scc1 L_tl_100
L_lp2_100:
    v_readlane_b32 s34, v20, s75
    v_readlane_b32 s35, v21, s75
    v_readlane_b32 s80, v20, s36
    v_readlane_b32 s81, v21, s36
L_chk_100:
    s_waitcnt lgkmcnt(0)
    v_readlane_b32 s83, v25, s87
    v_readlane_b32 s84, v25, s38
    ds_read_b32 v25, v24
    s_cmp_lt_u32 s39, 4
    s_cselect_b32 s84, s39, s84
    s_cmp_lt_u32 s84, s39
    s_cbranch_scc1 L_chk_100
    s_add_u32 s83, s83, 3
    s_cmp_lt_u32 s83, s70
    s_cbranch_scc1 L_chk_100
    s_add_u32 m0, s74, 0
    s_waitcnt vmcnt(24)
    buffer_load_dwordx4 v8, s[4:7], s80 offen offset:0 nt lds
    v_subrev_u32 v27, 3, v23
    ds_write_b32 v22, v27
    s_waitcnt vmcnt(24)
    buffer_load_dwordx4 v9, s[4:7], s80 offen offset:1024 nt lds
    s_waitcnt vmcnt(24)
    buffer_load_dwordx4 v10, s[4:7], s80 offen offset:2048 nt lds
    s_waitcnt vmcnt(24)
    buffer_load_dwordx4 v11, s[4:7], s80 offen offset:3072 nt lds
    s_add_u32 m0, s74, 4096
    s_waitcnt vmcnt(24)
    buffer_load_dwordx4 v8, s[4:7], s81 offen offset:0 nt lds
    s_waitcnt vmcnt(24)
    buffer_load_dwordx4 v9, s[4:7], s81 offen offset:1024 nt lds
    s_waitcnt vmcnt(24)
    buffer_load_dwordx4 v10, s[4:7], s81 offen offset:2048 nt lds
    s_waitcnt vmcnt(24)
    buffer_load_dwordx4 v11, s[4:7], s81 offen offset:3072 nt lds
    v_add_u32 v23, 1, v23
    s_add_u32 s36, s36, 1
    s_add_u32 s87, s87, 1
    s_add_u32 s74, s74, 32768
    s_add_u32 s83, s70, 2
    s_lshl_b32 s84, s83, 13
    s_and_b32 s84, s84, 16384
    s_cmp_eq_u32 s87, 3
    s_cselect_b32 s87, 0, s87
    s_cselect_b32 s70, s83, s70
    s_cselect_b32 s74, s84, s74
    s_add_u32 m0, s37, 0
    s_waitcnt vmcnt(24)
    buffer_load_dwordx4 v12, s[8:11], s34 offen offset:0 nt lds
    v_subrev_u32 v27, 3, v23
    ds_write_b32 v22, v27
    s_waitcnt vmcnt(24)
    buffer_load_dwordx4 v13, s[8:11], s34 offen offset:1024 nt lds
    s_waitcnt vmcnt(24)
    buffer_load_dwordx4 v14, s[8:11], s34 offen offset:2048 nt lds
    s_waitcnt vmcnt(24)
    buffer_load_dwordx4 v15, s[8:11], s34 offen offset:3072 nt lds
    s_add_u32 m0, s37, 4096
    s_waitcnt vmcnt(24)
    buffer_load_dwordx4 v12, s[8:11], s35 offen offset:0 nt lds
    s_waitcnt vmcnt(24)
    buffer_load_dwordx4 v13, s[8:11], s35 offen offset:1024 nt lds
    s_waitcnt vmcnt(24)
    buffer_load_dwordx4 v14, s[8:11], s35 offen offset:2048 nt lds
    s_waitcnt vmcnt(24)
    buffer_load_dwordx4 v15, s[8:11], s35 offen offset:3072 nt lds
    v_add_u32 v23, 1, v23
    s_add_u32 s75, s75, 1
    s_add_u32 s38, s38, 1
    s_add_u32 s37, s37, 32768
    s_add_u32 s83, s39, 2
    s_lshl_b32 s84, s83, 13
    s_and_b32 s84, s84, 16384
    s_add_u32 s84, s84, 8192
    s_cmp_eq_u32 s38, 3
    s_cselect_b32 s38, 0, s38
    s_cselect_b32 s39, s83, s39
    s_cselect_b32 s37, s84, s37
    s_cmp_lt_u32 s36, s77
    s_cbranch_scc1 L_lp2_100
L_tl_100:
    v_readlane_b32 s34, v20, s75
    v_readlane_b32 s35, v21, s75
L_chv_100:
    s_waitcnt lgkmcnt(0)
    v_readlane_b32 s84, v25, s38
    ds_read_b32 v25, v24
    s_cmp_lt_u32 s39, 4
    s_cselect_b32 s84, s39, s84
    s_cmp_lt_u32 s84, s39
    s_cbranch_scc1 L_chv_100
    s_add_u32 m0, s37, 0
    s_waitcnt vmcnt(24)
    buffer_load_dwordx4 v12, s[8:11], s34 offen offset:0 nt lds
    v_subrev_u32 v27, 3, v23
    ds_write_b32 v22, v27
    s_waitcnt vmcnt(24)
    buffer_load_dwordx4 v13, s[8:11], s34 offen offset:1024 nt lds
    s_waitcnt vmcnt(24)
    buffer_load_dwordx4 v14, s[8:11], s34 offen offset:2048 nt lds
    s_waitcnt vmcnt(24)
    buffer_load_dwordx4 v15, s[8:11], s34 offen offset:3072 nt lds
    s_add_u32 m0, s37, 4096
    s_waitcnt vmcnt(24)
    buffer_load_dwordx4 v12, s[8:11], s35 offen offset:0 nt lds
    s_waitcnt vmcnt(24)
    buffer_load_dwordx4 v13, s[8:11], s35 offen offset:1024 nt lds
    s_waitcnt vmcnt(24)
    buffer_load_dwordx4 v14, s[8:11], s35 offen offset:2048 nt lds
    s_waitcnt vmcnt(24)
    buffer_load_dwordx4 v15, s[8:11], s35 offen offset:3072 nt lds
    v_add_u32 v23, 1, v23
    s_add_u32 s75, s75, 1
    s_add_u32 s38, s38, 1
    s_add_u32 s37, s37, 32768
    s_add_u32 s83, s39, 2
    s_lshl_b32 s84, s83, 13
    s_and_b32 s84, s84, 16384
    s_add_u32 s84, s84, 8192
    s_cmp_eq_u32 s38, 3
    s_cselect_b32 s38, 0, s38
    s_cselect_b32 s39, s83, s39
    s_cselect_b32 s37, s84, s37
    s_cmp_lt_u32 s75, s77
    s_cbranch_scc1 L_tl_100
    s_waitcnt vmcnt(24)
    v_subrev_u32 v27, 3, v23
    ds_write_b32 v22, v27
    s_waitcnt vmcnt(16)
    v_subrev_u32 v27, 2, v23
    ds_write_b32 v22, v27
    s_waitcnt vmcnt(8)
    v_subrev_u32 v27, 1, v23
    ds_write_b32 v22, v27
    s_waitcnt vmcnt(0)
    ds_write_b32 v22, v23
    s_branch L_ldone
L_var_102:
    s_cmp_ge_u32 s36, s68
    s_cbranch_scc1 L_lp_102
L_pk_102:
    v_readlane_b32 s80, v20, s36
    v_readlane_b32 s81, v21, s36
    s_nop 2
    s_add_u32 m0, s74, 0
    s_waitcnt vmcnt(25)
    buffer_load_dwordx4 v8, s[4:7], s80 offen offset:0 nt lds
    s_waitcnt vmcnt(25)
    buffer_load_dwordx4 v9, s[4:7], s80 offen offset:1024 nt lds
    v_subrev_u32 v27, 3, v23
    ds_write_b32 v22, v27
    s_waitcnt vmcnt(25)
    buffer_load_dwordx4 v10, s[4:7], s80 offen offset:2048 nt lds
    s_waitcnt vmcnt(25)
    buffer_load_dwordx4 v11, s[4:7], s80 offen offset:3072 nt lds
    s_add_u32 m0, s74, 4096
    s_waitcnt vmcnt(25)
    buffer_load_dwordx4 v8, s[4:7], s81 offen offset:0 nt lds
    s_waitcnt vmcnt(25)
    buffer_load_dwordx4 v9, s[4:7], s81 offen offset:1024 nt lds
    s_waitcnt vmcnt(25)
    buffer_load_dwordx4 v10, s[4:7], s81 offen offset:2048 nt lds
    s_waitcnt vmcnt(25)
    buffer_load_dwordx4 v11, s[4:7], s81 offen offset:3072 nt lds
    v_add_u32 v23, 1, v23
    s_add_u32 s36, s36, 1
    s_add_u32 s87, s87, 1
    s_add_u32 s74, s74, 32768
    s_add_u32 s83, s70, 2
    s_lshl_b32 s84, s83, 13
    s_and_b32 s84, s84, 16384
    s_cmp_eq_u32 s87, 3
    s_cselect_b32 s87, 0, s87
    s_cselect_b32 s70, s83, s70
    s_cselect_b32 s74, s84, s74
    s_cmp_lt_u32 s36, s68
    s_cbranch_scc1 L_pk_102
L_lp_102:
    s_cmp_ge_u32 s36, s77
    s_cbranch_scc1 L_tl_102
L_lp2_102:
    v_readlane_b32 s34, v20, s75
    v_readlane_b32 s35, v21, s75
    v_readlane_b32 s80, v20, s36
    v_readlane_b32 s81, v21, s36
L_chk_102:
    s_waitcnt lgkmcnt(0)
    v_readlane_b32 s83, v25, s87
    v_readlane_b32 s84, v25, s38
    ds_read_b32 v25, v24
    s_cmp_lt_u32 s39, 4
    s_cselect_b32 s84, s39, s84
    s_cmp_lt_u32 s84, s39
    s_cbranch_scc1 L_chk_102
    s_add_u32 s83, s83, 3
    s_cmp_lt_u32 s83, s70
    s_cbranch_scc1 L_chk_102
    s_add_u32 m0, s74, 0
    s_waitcnt vmcnt(25)
    buffer_load_dwordx4 v8, s[4:7], s80 offen offset:0 nt lds
    s_waitcnt vmcnt(25)
    buffer_load_dwordx4 v9, s[4:7], s80 offen offset:1024 nt lds
    v_subrev_u32 v27, 3, v23
    ds_write_b32 v22, v27
    s_waitcnt vmcnt(25)
    buffer_load_dwordx4 v10, s[4:7], s80 offen offset:2048 nt lds
    s_waitcnt vmcnt(25)
    buffer_load_dwordx4 v11, s[4:7], s80 offen offset:3072 nt lds
    s_add_u32 m0, s74, 4096
    s_waitcnt vmcnt(25)
    buffer_load_dwordx4 v8, s[4:7], s81 offen offset:0 nt lds
    s_waitcnt vmcnt(25)
    buffer_load_dwordx4 v9, s[4:7], s81 offen offset:1024 nt lds
    s_waitcnt vmcnt(25)
    buffer_load_dwordx4 v10, s[4:7], s81 offen offset:2048 nt lds
    s_waitcnt vmcnt(25)
    buffer_load_dwordx4 v11, s[4:7], s81 offen offset:3072 nt lds
    v_add_u32 v23, 1, v23
    s_add_u32 s36, s36, 1
    s_add_u32 s87, s87, 1
    s_add_u32 s74, s74, 32768
    s_add_u32 s83, s70, 2
    s_lshl_b32 s84, s83, 13
    s_and_b32 s84, s84, 16384
    s_cmp_eq_u32 s87, 3
    s_cselect_b32 s87, 0, s87
    s_cselect_b32 s70, s83, s70
    s_cselect_b32 s74, s84, s74
    s_add_u32 m0, s37, 0
    s_waitcnt vmcnt(24)
    buffer_load_dwordx4 v12, s[8:11], s34 offen offset:0 nt lds
    v_subrev_u32 v27, 3, v23
    ds_write_b32 v22, v27
    s_waitcnt vmcnt(24)
    buffer_load_dwordx4 v13, s[8:11], s34 offen offset:1024 nt lds
    s_waitcnt vmcnt(24)
    buffer_load_dwordx4 v14, s[8:11], s34 offen offset:2048 nt lds
    s_waitcnt vmcnt(24)
    buffer_load_dwordx4 v15, s[8:11], s34 offen offset:3072 nt lds
    s_add_u32 m0, s37, 4096
    s_waitcnt vmcnt(24)
    buffer_load_dwordx4 v12, s[8:11], s35 offen offset:0 nt lds
    s_waitcnt vmcnt(24)
    buffer_load_dwordx4 v13, s[8:11], s35 offen offset:1024 nt lds
    s_waitcnt vmcnt(24)
    buffer_load_dwordx4 v14, s[8:11], s35 offen offset:2048 nt lds
    s_waitcnt vmcnt(24)
    buffer_load_dwordx4 v15, s[8:11], s35 offen offset:3072 nt lds
    v_add_u32 v23, 1, v23
    s_add_u32 s75, s75, 1
    s_add_u32 s38, s38, 1
    s_add_u32 s37, s37, 32768
    s_add_u32 s83, s39, 2
    s_lshl_b32 s84, s83, 13
    s_and_b32 s84, s84, 16384
    s_add_u32 s84, s84, 8192
    s_cmp_eq_u32 s38, 3
    s_cselect_b32 s38, 0, s38
    s_cselect_b32 s39, s83, s39
    s_cselect_b32 s37, s84, s37
    s_cmp_lt_u32 s36, s77
    s_cbranch_scc1 L_lp2_102
L_tl_102:
    v_readlane_b32 s34, v20, s75
    v_readlane_b32 s35, v21, s75
L_chv_102:
    s_waitcnt lgkmcnt(0)
    v_readlane_b32 s84, v25, s38
    ds_read_b32 v25, v24
    s_cmp_lt_u32 s39, 4
    s_cselect_b32 s84, s39, s84
    s_cmp_lt_u32 s84, s39
    s_cbranch_scc1 L_chv_102
    s_add_u32 m0, s37, 0
    s_waitcnt vmcnt(25)
    buffer_load_dwordx4 v12, s[8:11], s34 offen offset:0 nt lds
    s_waitcnt vmcnt(25)
    buffer_load_dwordx4 v13, s[8:11], s34 offen offset:1024 nt lds
    v_subrev_u32 v27, 3, v23
    ds_write_b32 v22, v27
    s_waitcnt vmcnt(25)
    buffer_load_dwordx4 v14, s[8:11], s34 offen offset:2048 nt lds
    s_waitcnt vmcnt(25)
    buffer_load_dwordx4 v15, s[8:11], s34 offen offset:3072 nt lds
    s_add_u32 m0, s37, 4096
    s_waitcnt vmcnt(25)
    buffer_load_dwordx4 v12, s[8:11], s35 offen offset:0 nt lds
    s_waitcnt vmcnt(25)
    buffer_load_dwordx4 v13, s[8:11], s35 offen offset:1024 nt lds
    s_waitcnt vmcnt(25)
    buffer_load_dwordx4 v14, s[8:11], s35 offen offset:2048 nt lds
    s_waitcnt vmcnt(25)
    buffer_load_dwordx4 v15, s[8:11], s35 offen offset:3072 nt lds
    v_add_u32 v23, 1, v23
    s_add_u32 s75, s75, 1
    s_add_u32 s38, s38, 1
    s_add_u32 s37, s37, 32768
    s_add_u32 s83, s39, 2
    s_lshl_b32 s84, s83, 13
    s_and_b32 s84, s84, 16384
    s_add_u32 s84, s84, 8192
    s_cmp_eq_u32 s38, 3
    s_cselect_b32 s38, 0, s38
    s_cselect_b32 s39, s83, s39
    s_cselect_b32 s37, s84, s37
    s_cmp_lt_u32 s75, s77
    s_cbranch_scc1 L_tl_102
    s_waitcnt vmcnt(24)
    v_subrev_u32 v27, 3, v23
    ds_write_b32 v22, v27
    s_waitcnt vmcnt(16)
    v_subrev_u32 v27, 2, v23
    ds_write_b32 v22, v27
    s_waitcnt vmcnt(8)
    v_subrev_u32 v27, 1, v23
    ds_write_b32 v22, v27
    s_waitcnt vmcnt(0)
    ds_write_b32 v22, v23
    s_branch L_ldone
L_var_104:
    s_cmp_ge_u32 s36, s68
    s_cbranch_scc1 L_lp_104
L_pk_104:
    v_readlane_b32 s80, v20, s36
    v_readlane_b32 s81, v21, s36
    s_nop 2
    s_add_u32 m0, s74, 0
    s_waitcnt vmcnt(25)
    buffer_load_dwordx4 v8, s[4:7], s80 offen offset:0 nt lds
    s_waitcnt vmcnt(25)
    buffer_load_dwordx4 v9, s[4:7], s80 offen offset:1024 nt lds
    v_subrev_u32 v27, 3, v23
    ds_write_b32 v22, v27
    s_waitcnt vmcnt(25)
    buffer_load_dwordx4 v10, s[4:7], s80 offen offset:2048 nt lds
    s_waitcnt vmcnt(25)
    buffer_load_dwordx4 v11, s[4:7], s80 offen offset:3072 nt lds
    s_add_u32 m0, s74, 4096
    s_waitcnt vmcnt(25)
    buffer_load_dwordx4 v8, s[4:7], s81 offen offset:0 nt lds
    s_waitcnt vmcnt(25)
    buffer_load_dwordx4 v9, s[4:7], s81 offen offset:1024 nt lds
    s_waitcnt vmcnt(25)
    buffer_load_dwordx4 v10, s[4:7], s81 offen offset:2048 nt lds
    s_waitcnt vmcnt(25)
    buffer_load_dwordx4 v11, s[4:7], s81 offen offset:3072 nt lds
    v_add_u32 v23, 1, v23
    s_add_u32 s36, s36, 1
    s_add_u32 s87, s87, 1
    s_add_u32 s74, s74, 32768
    s_add_u32 s83, s70, 2
    s_lshl_b32 s84, s83, 13
    s_and_b32 s84, s84, 16384
    s_cmp_eq_u32 s87, 3
    s_cselect_b32 s87, 0, s87
    s_cselect_b32 s70, s83, s70
    s_cselect_b32 s74, s84, s74
    s_cmp_lt_u32 s36, s68
    s_cbranch_scc1 L_pk_104
L_lp_104:
    s_cmp_ge_u32 s36, s77
    s_cbranch_scc1 L_tl_104
L_lp2_104:
    v_readlane_b32 s34, v20, s75
    v_readlane_b32 s35, v21, s75
    v_readlane_b32 s80, v20, s36
    v_readlane_b32 s81, v21, s36
L_chk_104:
    s_waitcnt lgkmcnt(0)
    v_readlane_b32 s83, v25, s87
    v_readlane_b32 s84, v25, s38
    ds_read_b32 v25, v24
    s_cmp_lt_u32 s39, 4
    s_cselect_b32 s84, s39, s84
    s_cmp_lt_u32 s84, s39
    s_cbranch_scc1 L_chk_104
    s_add_u32 s83, s83, 3
    s_cmp_lt_u32 s83, s70
    s_cbranch_scc1 L_chk_104
    s_add_u32 m0, s74, 0
    s_waitcnt vmcnt(25)
    buffer_load_dwordx4 v8, s[4:7], s80 offen offset:0 nt lds
    s_waitcnt vmcnt(25)
    buffer_load_dwordx4 v9, s[4:7], s80 offen offset:1024 nt lds
    v_subrev_u32 v27, 3, v23
    ds_write_b32 v22, v27
    s_waitcnt vmcnt(25)
    buffer_load_dwordx4 v10, s[4:7], s80 offen offset:2048 nt lds
    s_waitcnt vmcnt(25)
    buffer_load_dwordx4 v11, s[4:7], s80 offen offset:3072 nt lds
    s_add_u32 m0, s74, 4096
    s_waitcnt vmcnt(25)
    buffer_load_dwordx4 v8, s[4:7], s81 offen offset:0 nt lds
    s_waitcnt vmcnt(25)
    buffer_load_dwordx4 v9, s[4:7], s81 offen offset:1024 nt lds
    s_waitcnt vmcnt(25)
    buffer_load_dwordx4 v10, s[4:7], s81 offen offset:2048 nt lds
    s_waitcnt vmcnt(25)
    buffer_load_dwordx4 v11, s[4:7], s81 offen offset:3072 nt lds
    v_add_u32 v23, 1, v23
    s_add_u32 s36, s36, 1
    s_add_u32 s87, s87, 1
    s_add_u32 s74, s74, 32768
    s_add_u32 s83, s70, 2
    s_lshl_b32 s84, s83, 13
    s_and_b32 s84, s84, 16384
    s_cmp_eq_u32 s87, 3
    s_cselect_b32 s87, 0, s87
    s_cselect_b32 s70, s83, s70
    s_cselect_b32 s74, s84, s74
    s_add_u32 m0, s37, 0
    s_waitcnt vmcnt(25)
    buffer_load_dwordx4 v12, s[8:11], s34 offen offset:0 nt lds
    s_waitcnt vmcnt(25)
    buffer_load_dwordx4 v13, s[8:11], s34 offen offset:1024 nt lds
    v_subrev_u32 v27, 3, v23
    ds_write_b32 v22, v27
    s_waitcnt vmcnt(25)
    buffer_load_dwordx4 v14, s[8:11], s34 offen offset:2048 nt lds
    s_waitcnt vmcnt(25)
    buffer_load_dwordx4 v15, s[8:11], s34 offen offset:3072 nt lds
    s_add_u32 m0, s37, 4096
    s_waitcnt vmcnt(25)
    buffer_load_dwordx4 v12, s[8:11], s35 offen offset:0 nt lds
    s_waitcnt vmcnt(25)
    buffer_load_dwordx4 v13, s[8:11], s35 offen offset:1024 nt lds
    s_waitcnt vmcnt(25)
    buffer_load_dwordx4 v14, s[8:11], s35 offen offset:2048 nt lds
    s_waitcnt vmcnt(25)
    buffer_load_dwordx4 v15, s[8:11], s35 offen offset:3072 nt lds
    v_add_u32 v23, 1, v23
    s_add_u32 s75, s75, 1
    s_add_u32 s38, s38, 1
    s_add_u32 s37, s37, 32768
    s_add_u32 s83, s39, 2
    s_lshl_b32 s84, s83, 13
    s_and_b32 s84, s84, 16384
    s_add_u32 s84, s84, 8192
    s_cmp_eq_u32 s38, 3
    s_cselect_b32 s38, 0, s38
    s_cselect_b32 s39, s83, s39
    s_cselect_b32 s37, s84, s37
    s_cmp_lt_u32 s36, s77
    s_cbranch_scc1 L_lp2_104
L_tl_104:
    v_readlane_b32 s34, v20, s75
    v_readlane_b32 s35, v21, s75
L_chv_104:
    s_waitcnt lgkmcnt(0)
    v_readlane_b32 s84, v25, s38
    ds_read_b32 v25, v24
    s_cmp_lt_u32 s39, 4
    s_cselect_b32 s84, s39, s84
    s_cmp_lt_u32 s84, s39
    s_cbranch_scc1 L_chv_104
    s_add_u32 m0, s37, 0
    s_waitcnt vmcnt(25)
    buffer_load_dwordx4 v12, s[8:11], s34 offen offset:0 nt lds
    s_waitcnt vmcnt(25)
    buffer_load_dwordx4 v13, s[8:11], s34 offen offset:1024 nt lds
    v_subrev_u32 v27, 3, v23
    ds_write_b32 v22, v27
    s_waitcnt vmcnt(25)
    buffer_load_dwordx4 v14, s[8:11], s34 offen offset:2048 nt lds
    s_waitcnt vmcnt(25)
    buffer_load_dwordx4 v15, s[8:11], s34 offen offset:3072 nt lds
    s_add_u32 m0, s37, 4096
    s_waitcnt vmcnt(25)
    buffer_load_dwordx4 v12, s[8:11], s35 offen offset:0 nt lds
    s_waitcnt vmcnt(25)
    buffer_load_dwordx4 v13, s[8:11], s35 offen offset:1024 nt lds
    s_waitcnt vmcnt(25)
    buffer_load_dwordx4 v14, s[8:11], s35 offen offset:2048 nt lds
    s_waitcnt vmcnt(25)
    buffer_load_dwordx4 v15, s[8:11], s35 offen offset:3072 nt lds
    v_add_u32 v23, 1, v23
    s_add_u32 s75, s75, 1
    s_add_u32 s38, s38, 1
    s_add_u32 s37, s37, 32768
    s_add_u32 s83, s39, 2
    s_lshl_b32 s84, s83, 13
    s_and_b32 s84, s84, 16384
    s_add_u32 s84, s84, 8192
    s_cmp_eq_u32 s38, 3
    s_cselect_b32 s38, 0, s38
    s_cselect_b32 s39, s83, s39
    s_cselect_b32 s37, s84, s37
    s_cmp_lt_u32 s75, s77
    s_cbranch_scc1 L_tl_104
    s_waitcnt vmcnt(24)
    v_subrev_u32 v27, 3, v23
    ds_write_b32 v22, v27
    s_waitcnt vmcnt(16)
    v_subrev_u32 v27, 2, v23
    ds_write_b32 v22, v27
    s_waitcnt vmcnt(8)
    v_subrev_u32 v27, 1, v23
    ds_write_b32 v22, v27
    s_waitcnt vmcnt(0)
    ds_write_b32 v22, v23
    s_branch L_ldone
L_var_106:
    s_cmp_ge_u32 s36, s68
    s_cbranch_scc1 L_lp_106
L_pk_106:
    v_readlane_b32 s80, v20, s36
    v_readlane_b32 s81, v21, s36
    s_nop 2
    s_add_u32 m0, s74, 0
    s_waitcnt vmcnt(26)
    buffer_load_dwordx4 v8, s[4:7], s80 offen offset:0 nt lds
    s_waitcnt vmcnt(26)
    buffer_load_dwordx4 v9, s[4:7], s80 offen offset:1024 nt lds
    s_waitcnt vmcnt(26)
    buffer_load_dwordx4 v10, s[4:7], s80 offen offset:2048 nt lds
    v_subrev_u32 v27, 3, v23
    ds_write_b32 v22, v27
    s_waitcnt vmcnt(26)
    buffer_load_dwordx4 v11, s[4:7], s80 offen offset:3072 nt lds
    s_add_u32 m0, s74, 4096
    s_waitcnt vmcnt(26)
    buffer_load_dwordx4 v8, s[4:7], s81 offen offset:0 nt lds
    s_waitcnt vmcnt(26)
    buffer_load_dwordx4 v9, s[4:7], s81 offen offset:1024 nt lds
    s_waitcnt vmcnt(26)
    buffer_load_dwordx4 v10, s[4:7], s81 offen offset:2048 nt lds
    s_waitcnt vmcnt(26)
    buffer_load_dwordx4 v11, s[4:7], s81 offen offset:3072 nt lds
    v_add_u32 v23, 1, v23
    s_add_u32 s36, s36, 1
    s_add_u32 s87, s87, 1
    s_add_u32 s74, s74, 32768
    s_add_u32 s83, s70, 2
    s_lshl_b32 s84, s83, 13
    s_and_b32 s84, s84, 16384
    s_cmp_eq_u32 s87, 3
    s_cselect_b32 s87, 0, s87
    s_cselect_b32 s70, s83, s70
    s_cselect_b32 s74, s84, s74
    s_cmp_lt_u32 s36, s68
    s_cbranch_scc1 L_pk_106
L_lp_106:
    s_cmp_ge_u32 s36, s77
    s_cbranch_scc1 L_tl_106
L_lp2_106:
    v_readlane_b32 s34, v20, s75
    v_readlane_b32 s35, v21, s75
    v_readlane_b32 s80, v20, s36
    v_readlane_b32 s81, v21, s36
L_chk_106:
    s_waitcnt lgkmcnt(0)
    v_readlane_b32 s83, v25, s87
    v_readlane_b32 s84, v25, s38
    ds_read_b32 v25, v24
    s_cmp_lt_u32 s39, 4
    s_cselect_b32 s84, s39, s84
    s_cmp_lt_u32 s84, s39
    s_cbranch_scc1 L_chk_106
    s_add_u32 s83, s83, 3
    s_cmp_lt_u32 s83, s70
    s_cbranch_scc1 L_chk_106
    s_add_u32 m0, s74, 0
    s_waitcnt vmcnt(26)
    buffer_load_dwordx4 v8, s[4:7], s80 offen offset:0 nt lds
    s_waitcnt vmcnt(26)
    buffer_load_dwordx4 v9, s[4:7], s80 offen offset:1024 nt lds
    s_waitcnt vmcnt(26)
    buffer_load_dwordx4 v10, s[4:7], s80 offen offset:2048 nt lds
    v_subrev_u32 v27, 3, v23
    ds_write_b32 v22, v27
    s_waitcnt vmcnt(26)
    buffer_load_dwordx4 v11, s[4:7], s80 offen offset:3072 nt lds
    s_add_u32 m0, s74, 4096
    s_waitcnt vmcnt(26)
    buffer_load_dwordx4 v8, s[4:7], s81 offen offset:0 nt lds
    s_waitcnt vmcnt(26)
    buffer_load_dwordx4 v9, s[4:7], s81 offen offset:1024 nt lds
    s_waitcnt vmcnt(26)
    buffer_load_dwordx4 v10, s[4:7], s81 offen offset:2048 nt lds
    s_waitcnt vmcnt(26)
    buffer_load_dwordx4 v11, s[4:7], s81 offen offset:3072 nt lds
    v_add_u32 v23, 1, v23
    s_add_u32 s36, s36, 1
    s_add_u32 s87, s87, 1
    s_add_u32 s74, s74, 32768
    s_add_u32 s83, s70, 2
    s_lshl_b32 s84, s83, 13
    s_and_b32 s84, s84, 16384
    s_cmp_eq_u32 s87, 3
    s_cselect_b32 s87, 0, s87
    s_cselect_b32 s70, s83, s70
    s_cselect_b32 s74, s84, s74
    s_add_u32 m0, s37, 0
    s_waitcnt vmcnt(25)
    buffer_load_dwordx4 v12, s[8:11], s34 offen offset:0 nt lds
    s_waitcnt vmcnt(25)
    buffer_load_dwordx4 v13, s[8:11], s34 offen offset:1024 nt lds
    v_subrev_u32 v27, 3, v23
    ds_write_b32 v22, v27
    s_waitcnt vmcnt(25)
    buffer_load_dwordx4 v14, s[8:11], s34 offen offset:2048 nt lds
    s_waitcnt vmcnt(25)
    buffer_load_dwordx4 v15, s[8:11], s34 offen offset:3072 nt lds
    s_add_u32 m0, s37, 4096
    s_waitcnt vmcnt(25)
    buffer_load_dwordx4 v12, s[8:11], s35 offen offset:0 nt lds
    s_waitcnt vmcnt(25)
    buffer_load_dwordx4 v13, s[8:11], s35 offen offset:1024 nt lds
    s_waitcnt vmcnt(25)
    buffer_load_dwordx4 v14, s[8:11], s35 offen offset:2048 nt lds
    s_waitcnt vmcnt(25)
    buffer_load_dwordx4 v15, s[8:11], s35 offen offset:3072 nt lds
    v_add_u32 v23, 1, v23
    s_add_u32 s75, s75, 1
    s_add_u32 s38, s38, 1
    s_add_u32 s37, s37, 32768
    s_add_u32 s83, s39, 2
    s_lshl_b32 s84, s83, 13
    s_and_b32 s84, s84, 16384
    s_add_u32 s84, s84, 8192
    s_cmp_eq_u32 s38, 3
    s_cselect_b32 s38, 0, s38
    s_cselect_b32 s39, s83, s39
    s_cselect_b32 s37, s84, s37
    s_cmp_lt_u32 s36, s77
    s_cbranch_scc1 L_lp2_106
L_tl_106:
    v_readlane_b32 s34, v20, s75
    v_readlane_b32 s35, v21, s75
L_chv_106:
    s_waitcnt lgkmcnt(0)
    v_readlane_b32 s84, v25, s38
    ds_read_b32 v25, v24
    s_cmp_lt_u32 s39, 4
    s_cselect_b32 s84, s39, s84
    s_cmp_lt_u32 s84, s39
    s_cbranch_scc1 L_chv_106
    s_add_u32 m0, s37, 0
    s_waitcnt vmcnt(25)
    buffer_load_dwordx4 v12, s[8:11], s34 offen offset:0 nt lds
    s_waitcnt vmcnt(25)
    buffer_load_dwordx4 v13, s[8:11], s34 offen offset:1024 nt lds
    v_subrev_u32 v27, 3, v23
    ds_write_b32 v22, v27
    s_waitcnt vmcnt(25)
    buffer_load_dwordx4 v14, s[8:11], s34 offen offset:2048 nt lds
    s_waitcnt vmcnt(25)
    buffer_load_dwordx4 v15, s[8:11], s34 offen offset:3072 nt lds
    s_add_u32 m0, s37, 4096
    s_waitcnt vmcnt(25)
    buffer_load_dwordx4 v12, s[8:11], s35 offen offset:0 nt lds
    s_waitcnt vmcnt(25)
    buffer_load_dwordx4 v13, s[8:11], s35 offen offset:1024 nt lds
    s_waitcnt vmcnt(25)
    buffer_load_dwordx4 v14, s[8:11], s35 offen offset:2048 nt lds
    s_waitcnt vmcnt(25)
    buffer_load_dwordx4 v15, s[8:11], s35 offen offset:3072 nt lds
    v_add_u32 v23, 1, v23
    s_add_u32 s75, s75, 1
    s_add_u32 s38, s38, 1
    s_add_u32 s37, s37, 32768
    s_add_u32 s83, s39, 2
    s_lshl_b32 s84, s83, 13
    s_and_b32 s84, s84, 16384
    s_add_u32 s84, s84, 8192
    s_cmp_eq_u32 s38, 3
    s_cselect_b32 s38, 0, s38
    s_cselect_b32 s39, s83, s39
    s_cselect_b32 s37, s84, s37
    s_cmp_lt_u32 s75, s77
    s_cbranch_scc1 L_tl_106
    s_waitcnt vmcnt(24)
    v_subrev_u32 v27, 3, v23
    ds_write_b32 v22, v27
    s_waitcnt vmcnt(16)
    v_subrev_u32 v27, 2, v23
    ds_write_b32 v22, v27
    s_waitcnt vmcnt(8)
    v_subrev_u32 v27, 1, v23
    ds_write_b32 v22, v27
    s_waitcnt vmcnt(0)
    ds_write_b32 v22, v23
    s_branch L_ldone
L_var_108:
    s_cmp_ge_u32 s36, s68
    s_cbranch_scc1 L_lp_108
L_pk_108:
    v_readlane_b32 s80, v20, s36
    v_readlane_b32 s81, v21, s36
    s_nop 2
    s_add_u32 m0, s74, 0
    s_waitcnt vmcnt(26)
    buffer_load_dwordx4 v8, s[4:7], s80 offen offset:0 nt lds
    s_waitcnt vmcnt(26)
    buffer_load_dwordx4 v9, s[4:7], s80 offen offset:1024 nt lds
    s_waitcnt vmcnt(26)
    buffer_load_dwordx4 v10, s[4:7], s80 offen offset:2048 nt lds
    v_subrev_u32 v27, 3, v23
    ds_write_b32 v22, v27
    s_waitcnt vmcnt(26)
    buffer_load_dwordx4 v11, s[4:7], s80 offen offset:3072 nt lds
    s_add_u32 m0, s74, 4096
    s_waitcnt vmcnt(26)
    buffer_load_dwordx4 v8, s[4:7], s81 offen offset:0 nt lds
    s_waitcnt vmcnt(26)
    buffer_load_dwordx4 v9, s[4:7], s81 offen offset:1024 nt lds
    s_waitcnt vmcnt(26)
    buffer_load_dwordx4 v10, s[4:7], s81 offen offset:2048 nt lds
    s_waitcnt vmcnt(26)
    buffer_load_dwordx4 v11, s[4:7], s81 offen offset:3072 nt lds
    v_add_u32 v23, 1, v23
    s_add_u32 s36, s36, 1
    s_add_u32 s87, s87, 1
    s_add_u32 s74, s74, 32768
    s_add_u32 s83, s70, 2
    s_lshl_b32 s84, s83, 13
    s_and_b32 s84, s84, 16384
    s_cmp_eq_u32 s87, 3
    s_cselect_b32 s87, 0, s87
    s_cselect_b32 s70, s83, s70
    s_cselect_b32 s74, s84, s74
    s_cmp_lt_u32 s36, s68
    s_cbranch_scc1 L_pk_108
L_lp_108:
    s_cmp_ge_u32 s36, s77
    s_cbranch_scc1 L_tl_108
L_lp2_108:
    v_readlane_b32 s34, v20, s75
    v_readlane_b32 s35, v21, s75
    v_readlane_b32 s80, v20, s36
    v_readlane_b32 s81, v21, s36
L_chk_108:
    s_waitcnt lgkmcnt(0)
    v_readlane_b32 s83, v25, s87
    v_readlane_b32 s84, v25, s38
    ds_read_b32 v25, v24
    s_cmp_lt_u32 s39, 4
    s_cselect_b32 s84, s39, s84
    s_cmp_lt_u32 s84, s39
    s_cbranch_scc1 L_chk_108
    s_add_u32 s83, s83, 3
    s_cmp_lt_u32 s83, s70
    s_cbranch_scc1 L_chk_108
    s_add_u32 m0, s74, 0
    s_waitcnt vmcnt(26)
    buffer_load_dwordx4 v8, s[4:7], s80 offen offset:0 nt lds
    s_waitcnt vmcnt(26)
    buffer_load_dwordx4 v9, s[4:7], s80 offen offset:1024 nt lds
    s_waitcnt vmcnt(26)
    buffer_load_dwordx4 v10, s[4:7], s80 offen offset:2048 nt lds
    v_subrev_u32 v27, 3, v23
    ds_write_b32 v22, v27
    s_waitcnt vmcnt(26)
    buffer_load_dwordx4 v11, s[4:7], s80 offen offset:3072 nt lds
    s_add_u32 m0, s74, 4096
    s_waitcnt vmcnt(26)
    buffer_load_dwordx4 v8, s[4:7], s81 offen offset:0 nt lds
    s_waitcnt vmcnt(26)
    buffer_load_dwordx4 v9, s[4:7], s81 offen offset:1024 nt lds
    s_waitcnt vmcnt(26)
    buffer_load_dwordx4 v10, s[4:7], s81 offen offset:2048 nt lds
    s_waitcnt vmcnt(26)
    buffer_load_dwordx4 v11, s[4:7], s81 offen offset:3072 nt lds
    v_add_u32 v23, 1, v23
    s_add_u32 s36, s36, 1
    s_add_u32 s87, s87, 1
    s_add_u32 s74, s74, 32768
    s_add_u32 s83, s70, 2
    s_lshl_b32 s84, s83, 13
    s_and_b32 s84, s84, 16384
    s_cmp_eq_u32 s87, 3
    s_cselect_b32 s87, 0, s87
    s_cselect_b32 s70, s83, s70
    s_cselect_b32 s74, s84, s74
    s_add_u32 m0, s37, 0
    s_waitcnt vmcnt(26)
    buffer_load_dwordx4 v12, s[8:11], s34 offen offset:0 nt lds
    s_waitcnt vmcnt(26)
    buffer_load_dwordx4 v13, s[8:11], s34 offen offset:1024 nt lds
    s_waitcnt vmcnt(26)
    buffer_load_dwordx4 v14, s[8:11], s34 offen offset:2048 nt lds
    v_subrev_u32 v27, 3, v23
    ds_write_b32 v22, v27
    s_waitcnt vmcnt(26)
    buffer_load_dwordx4 v15, s[8:11], s34 offen offset:3072 nt lds
    s_add_u32 m0, s37, 4096
    s_waitcnt vmcnt(26)
    buffer_load_dwordx4 v12, s[8:11], s35 offen offset:0 nt lds
    s_waitcnt vmcnt(26)
    buffer_load_dwordx4 v13, s[8:11], s35 offen offset:1024 nt lds
    s_waitcnt vmcnt(26)
    buffer_load_dwordx4 v14, s[8:11], s35 offen offset:2048 nt lds
    s_waitcnt vmcnt(26)
    buffer_load_dwordx4 v15, s[8:11], s35 offen offset:3072 nt lds
    v_add_u32 v23, 1, v23
    s_add_u32 s75, s75, 1
    s_add_u32 s38, s38, 1
    s_add_u32 s37, s37, 32768
    s_add_u32 s83, s39, 2
    s_lshl_b32 s84, s83, 13
    s_and_b32 s84, s84, 16384
    s_add_u32 s84, s84, 8192
    s_cmp_eq_u32 s38, 3
    s_cselect_b32 s38, 0, s38
    s_cselect_b32 s39, s83, s39
    s_cselect_b32 s37, s84, s37
    s_cmp_lt_u32 s36, s77
    s_cbranch_scc1 L_lp2_108
L_tl_108:
    v_readlane_b32 s34, v20, s75
    v_readlane_b32 s35, v21, s75
L_chv_108:
    s_waitcnt lgkmcnt(0)
    v_readlane_b32 s84, v25, s38
    ds_read_b32 v25, v24
    s_cmp_lt_u32 s39, 4
    s_cselect_b32 s84, s39, s84
    s_cmp_lt_u32 s84, s39
    s_cbranch_scc1 L_chv_108
    s_add_u32 m0, s37, 0
    s_waitcnt vmcnt(26)
    buffer_load_dwordx4 v12, s[8:11], s34 offen offset:0 nt lds
    s_waitcnt vmcnt(26)
    buffer_load_dwordx4 v13, s[8:11], s34 offen offset:1024 nt lds
    s_waitcnt vmcnt(26)
    buffer_load_dwordx4 v14, s[8:11], s34 offen offset:2048 nt lds
    v_subrev_u32 v27, 3, v23
    ds_write_b32 v22, v27
    s_waitcnt vmcnt(26)
    buffer_load_dwordx4 v15, s[8:11], s34 offen offset:3072 nt lds
    s_add_u32 m0, s37, 4096
    s_waitcnt vmcnt(26)
    buffer_load_dwordx4 v12, s[8:11], s35 offen offset:0 nt lds
    s_waitcnt vmcnt(26)
    buffer_load_dwordx4 v13, s[8:11], s35 offen offset:1024 nt lds
    s_waitcnt vmcnt(26)
    buffer_load_dwordx4 v14, s[8:11], s35 offen offset:2048 nt lds
    s_waitcnt vmcnt(26)
    buffer_load_dwordx4 v15, s[8:11], s35 offen offset:3072 nt lds
    v_add_u32 v23, 1, v23
    s_add_u32 s75, s75, 1
    s_add_u32 s38, s38, 1
    s_add_u32 s37, s37, 32768
    s_add_u32 s83, s39, 2
    s_lshl_b32 s84, s83, 13
    s_and_b32 s84, s84, 16384
    s_add_u32 s84, s84, 8192
    s_cmp_eq_u32 s38, 3
    s_cselect_b32 s38, 0, s38
    s_cselect_b32 s39, s83, s39
    s_cselect_b32 s37, s84, s37
    s_cmp_lt_u32 s75, s77
    s_cbranch_scc1 L_tl_108
    s_waitcnt vmcnt(24)
    v_subrev_u32 v27, 3, v23
    ds_write_b32 v22, v27
    s_waitcnt vmcnt(16)
    v_subrev_u32 v27, 2, v23
    ds_write_b32 v22, v27
    s_waitcnt vmcnt(8)
    v_subrev_u32 v27, 1, v23
    ds_write_b32 v22, v27
    s_waitcnt vmcnt(0)
    ds_write_b32 v22, v23
    s_branch L_ldone
L_var_110:
    s_cmp_ge_u32 s36, s68
    s_cbranch_scc1 L_lp_110
L_pk_110:
    v_readlane_b32 s80, v20, s36
    v_readlane_b32 s81, v21, s36
    s_nop 2
    s_add_u32 m0, s74, 0
    s_waitcnt vmcnt(27)
    buffer_load_dwordx4 v8, s[4:7], s80 offen offset:0 nt lds
    s_waitcnt vmcnt(27)
    buffer_load_dwordx4 v9, s[4:7], s80 offen offset:1024 nt lds
    s_waitcnt vmcnt(27)
    buffer_load_dwordx4 v10, s[4:7], s80 offen offset:2048 nt lds
    s_waitcnt vmcnt(27)
    buffer_load_dwordx4 v11, s[4:7], s80 offen offset:3072 nt lds
    v_subrev_u32 v27, 3, v23
    ds_write_b32 v22, v27
    s_add_u32 m0, s74, 4096
    s_waitcnt vmcnt(27)
    buffer_load_dwordx4 v8, s[4:7], s81 offen offset:0 nt lds
    s_waitcnt vmcnt(27)
    buffer_load_dwordx4 v9, s[4:7], s81 offen offset:1024 nt lds
    s_waitcnt vmcnt(27)
    buffer_load_dwordx4 v10, s[4:7], s81 offen offset:2048 nt lds
    s_waitcnt vmcnt(27)
    buffer_load_dwordx4 v11, s[4:7], s81 offen offset:3072 nt lds
    v_add_u32 v23, 1, v23
    s_add_u32 s36, s36, 1
    s_add_u32 s87, s87, 1
    s_add_u32 s74, s74, 32768
    s_add_u32 s83, s70, 2
    s_lshl_b32 s84, s83, 13
    s_and_b32 s84, s84, 16384
    s_cmp_eq_u32 s87, 3
    s_cselect_b32 s87, 0, s87
    s_cselect_b32 s70, s83, s70
    s_cselect_b32 s74, s84, s74
    s_cmp_lt_u32 s36, s68
    s_cbranch_scc1 L_pk_110
L_lp_110:
    s_cmp_ge_u32 s36, s77
    s_cbranch_scc1 L_tl_110
L_lp2_110:
    v_readlane_b32 s34, v20, s75
    v_readlane_b32 s35, v21, s75
    v_readlane_b32 s80, v20, s36
    v_readlane_b32 s81, v21, s36
L_chk_110:
    s_waitcnt lgkmcnt(0)
    v_readlane_b32 s83, v25, s87
    v_readlane_b32 s84, v25, s38
    ds_read_b32 v25, v24
    s_cmp_lt_u32 s39, 4
    s_cselect_b32 s84, s39, s84
    s_cmp_lt_u32 s84, s39
    s_cbranch_scc1 L_chk_110
    s_add_u32 s83, s83, 3
    s_cmp_lt_u32 s83, s70
    s_cbranch_scc1 L_chk_110
    s_add_u32 m0, s74, 0
    s_waitcnt vmcnt(27)
    buffer_load_dwordx4 v8, s[4:7], s80 offen offset:0 nt lds
    s_waitcnt vmcnt(27)
    buffer_load_dwordx4 v9, s[4:7], s80 offen offset:1024 nt lds
    s_waitcnt vmcnt(27)
    buffer_load_dwordx4 v10, s[4:7], s80 offen offset:2048 nt lds
    s_waitcnt vmcnt(27)
    buffer_load_dwordx4 v11, s[4:7], s80 offen offset:3072 nt lds
    v_subrev_u32 v27, 3, v23
    ds_write_b32 v22, v27
    s_add_u32 m0, s74, 4096
    s_waitcnt vmcnt(27)
    buffer_load_dwordx4 v8, s[4:7], s81 offen offset:0 nt lds
    s_waitcnt vmcnt(27)
    buffer_load_dwordx4 v9, s[4:7], s81 offen offset:1024 nt lds
    s_waitcnt vmcnt(27)
    buffer_load_dwordx4 v10, s[4:7], s81 offen offset:2048 nt lds
    s_waitcnt vmcnt(27)
    buffer_load_dwordx4 v11, s[4:7], s81 offen offset:3072 nt lds
    v_add_u32 v23, 1, v23
    s_add_u32 s36, s36, 1
    s_add_u32 s87, s87, 1
    s_add_u32 s74, s74, 32768
    s_add_u32 s83, s70, 2
    s_lshl_b32 s84, s83, 13
    s_and_b32 s84, s84, 16384
    s_cmp_eq_u32 s87, 3
    s_cselect_b32 s87, 0, s87
    s_cselect_b32 s70, s83, s70
    s_cselect_b32 s74, s84, s74
    s_add_u32 m0, s37, 0
    s_waitcnt vmcnt(26)
    buffer_load_dwordx4 v12, s[8:11], s34 offen offset:0 nt lds
    s_waitcnt vmcnt(26)
    buffer_load_dwordx4 v13, s[8:11], s34 offen offset:1024 nt lds
    s_waitcnt vmcnt(26)
    buffer_load_dwordx4 v14, s[8:11], s34 offen offset:2048 nt lds
    v_subrev_u32 v27, 3, v23
    ds_write_b32 v22, v27
    s_waitcnt vmcnt(26)
    buffer_load_dwordx4 v15, s[8:11], s34 offen offset:3072 nt lds
    s_add_u32 m0, s37, 4096
    s_waitcnt vmcnt(26)
    buffer_load_dwordx4 v12, s[8:11], s35 offen offset:0 nt lds
    s_waitcnt vmcnt(26)
    buffer_load_dwordx4 v13, s[8:11], s35 offen offset:1024 nt lds
    s_waitcnt vmcnt(26)
    buffer_load_dwordx4 v14, s[8:11], s35 offen offset:2048 nt lds
    s_waitcnt vmcnt(26)
    buffer_load_dwordx4 v15, s[8:11], s35 offen offset:3072 nt lds
    v_add_u32 v23, 1, v23
    s_add_u32 s75, s75, 1
    s_add_u32 s38, s38, 1
    s_add_u32 s37, s37, 32768
    s_add_u32 s83, s39, 2
    s_lshl_b32 s84, s83, 13
    s_and_b32 s84, s84, 16384
    s_add_u32 s84, s84, 8192
    s_cmp_eq_u32 s38, 3
    s_cselect_b32 s38, 0, s38
    s_cselect_b32 s39, s83, s39
    s_cselect_b32 s37, s84, s37
    s_cmp_lt_u32 s36, s77
    s_cbranch_scc1 L_lp2_110
L_tl_110:
    v_readlane_b32 s34, v20, s75
    v_readlane_b32 s35, v21, s75
L_chv_110:
    s_waitcnt lgkmcnt(0)
    v_readlane_b32 s84, v25, s38
    ds_read_b32 v25, v24
    s_cmp_lt_u32 s39, 4
    s_cselect_b32 s84, s39, s84
    s_cmp_lt_u32 s84, s39
    s_cbranch_scc1 L_chv_110
    s_add_u32 m0, s37, 0
    s_waitcnt vmcnt(27)
    buffer_load_dwordx4 v12, s[8:11], s34 offen offset:0 nt lds
    s_waitcnt vmcnt(27)
    buffer_load_dwordx4 v13, s[8:11], s34 offen offset:1024 nt lds
    s_waitcnt vmcnt(27)
    buffer_load_dwordx4 v14, s[8:11], s34 offen offset:2048 nt lds
    s_waitcnt vmcnt(27)
    buffer_load_dwordx4 v15, s[8:11], s34 offen offset:3072 nt lds
    v_subrev_u32 v27, 3, v23
    ds_write_b32 v22, v27
    s_add_u32 m0, s37, 4096
    s_waitcnt vmcnt(27)
    buffer_load_dwordx4 v12, s[8:11], s35 offen offset:0 nt lds
    s_waitcnt vmcnt(27)
    buffer_load_dwordx4 v13, s[8:11], s35 offen offset:1024 nt lds
    s_waitcnt vmcnt(27)
    buffer_load_dwordx4 v14, s[8:11], s35 offen offset:2048 nt lds
    s_waitcnt vmcnt(27)
    buffer_load_dwordx4 v15, s[8:11], s35 offen offset:3072 nt lds
    v_add_u32 v23, 1, v23
    s_add_u32 s75, s75, 1
    s_add_u32 s38, s38, 1
    s_add_u32 s37, s37, 32768
    s_add_u32 s83, s39, 2
    s_lshl_b32 s84, s83, 13
    s_and_b32 s84, s84, 16384
    s_add_u32 s84, s84, 8192
    s_cmp_eq_u32 s38, 3
    s_cselect_b32 s38, 0, s38
    s_cselect_b32 s39, s83, s39
    s_cselect_b32 s37, s84, s37
    s_cmp_lt_u32 s75, s77
    s_cbranch_scc1 L_tl_110
    s_waitcnt vmcnt(24)
    v_subrev_u32 v27, 3, v23
    ds_write_b32 v22, v27
    s_waitcnt vmcnt(16)
    v_subrev_u32 v27, 2, v23
    ds_write_b32 v22, v27
    s_waitcnt vmcnt(8)
    v_subrev_u32 v27, 1, v23
    ds_write_b32 v22, v27
    s_waitcnt vmcnt(0)
    ds_write_b32 v22, v23
    s_branch L_ldone
L_var_112:
    s_cmp_ge_u32 s36, s68
    s_cbranch_scc1 L_lp_112
L_pk_112:
    v_readlane_b32 s80, v20, s36
    v_readlane_b32 s81, v21, s36
    s_nop 2
    s_add_u32 m0, s74, 0
    s_waitcnt vmcnt(27)
    buffer_load_dwordx4 v8, s[4:7], s80 offen offset:0 nt lds
    s_waitcnt vmcnt(27)
    buffer_load_dwordx4 v9, s[4:7], s80 offen offset:1024 nt lds
    s_waitcnt vmcnt(27)
    buffer_load_dwordx4 v10, s[4:7], s80 offen offset:2048 nt lds
    s_waitcnt vmcnt(27)
    buffer_load_dwordx4 v11, s[4:7], s80 offen offset:3072 nt lds
    v_subrev_u32 v27, 3, v23
    ds_write_b32 v22, v27
    s_add_u32 m0, s74, 4096
    s_waitcnt vmcnt(27)
    buffer_load_dwordx4 v8, s[4:7], s81 offen offset:0 nt lds
    s_waitcnt vmcnt(27)
    buffer_load_dwordx4 v9, s[4:7], s81 offen offset:1024 nt lds
    s_waitcnt vmcnt(27)
    buffer_load_dwordx4 v10, s[4:7], s81 offen offset:2048 nt lds
    s_waitcnt vmcnt(27)
    buffer_load_dwordx4 v11, s[4:7], s81 offen offset:3072 nt lds
    v_add_u32 v23, 1, v23
    s_add_u32 s36, s36, 1
    s_add_u32 s87, s87, 1
    s_add_u32 s74, s74, 32768
    s_add_u32 s83, s70, 2
    s_lshl_b32 s84, s83, 13
    s_and_b32 s84, s84, 16384
    s_cmp_eq_u32 s87, 3
    s_cselect_b32 s87, 0, s87
    s_cselect_b32 s70, s83, s70
    s_cselect_b32 s74, s84, s74
    s_cmp_lt_u32 s36, s68
    s_cbranch_scc1 L_pk_112
L_lp_112:
    s_cmp_ge_u32 s36, s77
    s_cbranch_scc1 L_tl_112
L_lp2_112:
    v_readlane_b32 s34, v20, s75
    v_readlane_b32 s35, v21, s75
    v_readlane_b32 s80, v20, s36
    v_readlane_b32 s81, v21, s36
L_chk_112:
    s_waitcnt lgkmcnt(0)
    v_readlane_b32 s83, v25, s87
    v_readlane_b32 s84, v25, s38
    ds_read_b32 v25, v24
    s_cmp_lt_u32 s39, 4
    s_cselect_b32 s84, s39, s84
    s_cmp_lt_u32 s84, s39
    s_cbranch_scc1 L_chk_112
    s_add_u32 s83, s83, 3
    s_cmp_lt_u32 s83, s70
    s_cbranch_scc1 L_chk_112
    s_add_u32 m0, s74, 0
    s_waitcnt vmcnt(27)
    buffer_load_dwordx4 v8, s[4:7], s80 offen offset:0 nt lds
    s_waitcnt vmcnt(27)
    buffer_load_dwordx4 v9, s[4:7], s80 offen offset:1024 nt lds
    s_waitcnt vmcnt(27)
    buffer_load_dwordx4 v10, s[4:7], s80 offen offset:2048 nt lds
    s_waitcnt vmcnt(27)
    buffer_load_dwordx4 v11, s[4:7], s80 offen offset:3072 nt lds
    v_subrev_u32 v27, 3, v23
    ds_write_b32 v22, v27
    s_add_u32 m0, s74, 4096
    s_waitcnt vmcnt(27)
    buffer_load_dwordx4 v8, s[4:7], s81 offen offset:0 nt lds
    s_waitcnt vmcnt(27)
    buffer_load_dwordx4 v9, s[4:7], s81 offen offset:1024 nt lds
    s_waitcnt vmcnt(27)
    buffer_load_dwordx4 v10, s[4:7], s81 offen offset:2048 nt lds
    s_waitcnt vmcnt(27)
    buffer_load_dwordx4 v11, s[4:7], s81 offen offset:3072 nt lds
    v_add_u32 v23, 1, v23
    s_add_u32 s36, s36, 1
    s_add_u32 s87, s87, 1
    s_add_u32 s74, s74, 32768
    s_add_u32 s83, s70, 2
    s_lshl_b32 s84, s83, 13
    s_and_b32 s84, s84, 16384
    s_cmp_eq_u32 s87, 3
    s_cselect_b32 s87, 0, s87
    s_cselect_b32 s70, s83, s70
    s_cselect_b32 s74, s84, s74
    s_add_u32 m0, s37, 0
    s_waitcnt vmcnt(27)
    buffer_load_dwordx4 v12, s[8:11], s34 offen offset:0 nt lds
    s_waitcnt vmcnt(27)
    buffer_load_dwordx4 v13, s[8:11], s34 offen offset:1024 nt lds
    s_waitcnt vmcnt(27)
    buffer_load_dwordx4 v14, s[8:11], s34 offen offset:2048 nt lds
    s_waitcnt vmcnt(27)
    buffer_load_dwordx4 v15, s[8:11], s34 offen offset:3072 nt lds
    v_subrev_u32 v27, 3, v23
    ds_write_b32 v22, v27
    s_add_u32 m0, s37, 4096
    s_waitcnt vmcnt(27)
    buffer_load_dwordx4 v12, s[8:11], s35 offen offset:0 nt lds
    s_waitcnt vmcnt(27)
    buffer_load_dwordx4 v13, s[8:11], s35 offen offset:1024 nt lds
    s_waitcnt vmcnt(27)
    buffer_load_dwordx4 v14, s[8:11], s35 offen offset:2048 nt lds
    s_waitcnt vmcnt(27)
    buffer_load_dwordx4 v15, s[8:11], s35 offen offset:3072 nt lds
    v_add_u32 v23, 1, v23
    s_add_u32 s75, s75, 1
    s_add_u32 s38, s38, 1
    s_add_u32 s37, s37, 32768
    s_add_u32 s83, s39, 2
    s_lshl_b32 s84, s83, 13
    s_and_b32 s84, s84, 16384
    s_add_u32 s84, s84, 8192
    s_cmp_eq_u32 s38, 3
    s_cselect_b32 s38, 0, s38
    s_cselect_b32 s39, s83, s39
    s_cselect_b32 s37, s84, s37
    s_cmp_lt_u32 s36, s77
    s_cbranch_scc1 L_lp2_112
L_tl_112:
    v_readlane_b32 s34, v20, s75
    v_readlane_b32 s35, v21, s75
L_chv_112:
    s_waitcnt lgkmcnt(0)
    v_readlane_b32 s84, v25, s38
    ds_read_b32 v25, v24
    s_cmp_lt_u32 s39, 4
    s_cselect_b32 s84, s39, s84
    s_cmp_lt_u32 s84, s39
    s_cbranch_scc1 L_chv_112
    s_add_u32 m0, s37, 0
    s_waitcnt vmcnt(27)
    buffer_load_dwordx4 v12, s[8:11], s34 offen offset:0 nt lds
    s_waitcnt vmcnt(27)
    buffer_load_dwordx4 v13, s[8:11], s34 offen offset:1024 nt lds
    s_waitcnt vmcnt(27)
    buffer_load_dwordx4 v14, s[8:11], s34 offen offset:2048 nt lds
    s_waitcnt vmcnt(27)
    buffer_load_dwordx4 v15, s[8:11], s34 offen offset:3072 nt lds
    v_subrev_u32 v27, 3, v23
    ds_write_b32 v22, v27
    s_add_u32 m0, s37, 4096
    s_waitcnt vmcnt(27)
    buffer_load_dwordx4 v12, s[8:11], s35 offen offset:0 nt lds
    s_waitcnt vmcnt(27)
    buffer_load_dwordx4 v13, s[8:11], s35 offen offset:1024 nt lds
    s_waitcnt vmcnt(27)
    buffer_load_dwordx4 v14, s[8:11], s35 offen offset:2048 nt lds
    s_waitcnt vmcnt(27)
    buffer_load_dwordx4 v15, s[8:11], s35 offen offset:3072 nt lds
    v_add_u32 v23, 1, v23
    s_add_u32 s75, s75, 1
    s_add_u32 s38, s38, 1
    s_add_u32 s37, s37, 32768
    s_add_u32 s83, s39, 2
    s_lshl_b32 s84, s83, 13
    s_and_b32 s84, s84, 16384
    s_add_u32 s84, s84, 8192
    s_cmp_eq_u32 s38, 3
    s_cselect_b32 s38, 0, s38
    s_cselect_b32 s39, s83, s39
    s_cselect_b32 s37, s84, s37
    s_cmp_lt_u32 s75, s77
    s_cbranch_scc1 L_tl_112
    s_waitcnt vmcnt(24)
    v_subrev_u32 v27, 3, v23
    ds_write_b32 v22, v27
    s_waitcnt vmcnt(16)
    v_subrev_u32 v27, 2, v23
    ds_write_b32 v22, v27
    s_waitcnt vmcnt(8)
    v_subrev_u32 v27, 1, v23
    ds_write_b32 v22, v27
    s_waitcnt vmcnt(0)
    ds_write_b32 v22, v23
    s_branch L_ldone
L_var_114:
    s_cmp_ge_u32 s36, s68
    s_cbranch_scc1 L_lp_114
L_pk_114:
    v_readlane_b32 s80, v20, s36
    v_readlane_b32 s81, v21, s36
    s_nop 2
    s_add_u32 m0, s74, 0
    s_waitcnt vmcnt(28)
    buffer_load_dwordx4 v8, s[4:7], s80 offen offset:0 nt lds
    s_waitcnt vmcnt(28)
    buffer_load_dwordx4 v9, s[4:7], s80 offen offset:1024 nt lds
    s_waitcnt vmcnt(28)
    buffer_load_dwordx4 v10, s[4:7], s80 offen offset:2048 nt lds
    s_waitcnt vmcnt(28)
    buffer_load_dwordx4 v11, s[4:7], s80 offen offset:3072 nt lds
    s_add_u32 m0, s74, 4096
    s_waitcnt vmcnt(28)
    buffer_load_dwordx4 v8, s[4:7], s81 offen offset:0 nt lds
    v_subrev_u32 v27, 3, v23
    ds_write_b32 v22, v27
    s_waitcnt vmcnt(28)
    buffer_load_dwordx4 v9, s[4:7], s81 offen offset:1024 nt lds
    s_waitcnt vmcnt(28)
    buffer_load_dwordx4 v10, s[4:7], s81 offen offset:2048 nt lds
    s_waitcnt vmcnt(28)
    buffer_load_dwordx4 v11, s[4:7], s81 offen offset:3072 nt lds
    v_add_u32 v23, 1, v23
    s_add_u32 s36, s36, 1
    s_add_u32 s87, s87, 1
    s_add_u32 s74, s74, 32768
    s_add_u32 s83, s70, 2
    s_lshl_b32 s84, s83, 13
    s_and_b32 s84, s84, 16384
    s_cmp_eq_u32 s87, 3
    s_cselect_b32 s87, 0, s87
    s_cselect_b32 s70, s83, s70
    s_cselect_b32 s74, s84, s74
    s_cmp_lt_u32 s36, s68
    s_cbranch_scc1 L_pk_114
L_lp_114:
    s_cmp_ge_u32 s36, s77
    s_cbranch_scc1 L_tl_114
L_lp2_114:
    v_readlane_b32 s34, v20, s75
    v_readlane_b32 s35, v21, s75
    v_readlane_b32 s80, v20, s36
    v_readlane_b32 s81, v21, s36
L_chk_114:
    s_waitcnt lgkmcnt(0)
    v_readlane_b32 s83, v25, s87
    v_readlane_b32 s84, v25, s38
    ds_read_b32 v25, v24
    s_cmp_lt_u32 s39, 4
    s_cselect_b32 s84, s39, s84
    s_cmp_lt_u32 s84, s39
    s_cbranch_scc1 L_chk_114
    s_add_u32 s83, s83, 3
    s_cmp_lt_u32 s83, s70
    s_cbranch_scc1 L_chk_114
    s_add_u32 m0, s74, 0
    s_waitcnt vmcnt(28)
    buffer_load_dwordx4 v8, s[4:7], s80 offen offset:0 nt lds
    s_waitcnt vmcnt(28)
    buffer_load_dwordx4 v9, s[4:7], s80 offen offset:1024 nt lds
    s_waitcnt vmcnt(28)
    buffer_load_dwordx4 v10, s[4:7], s80 offen offset:2048 nt lds
    s_waitcnt vmcnt(28)
    buffer_load_dwordx4 v11, s[4:7], s80 offen offset:3072 nt lds
    s_add_u32 m0, s74, 4096
    s_waitcnt vmcnt(28)
    buffer_load_dwordx4 v8, s[4:7], s81 offen offset:0 nt lds
    v_subrev_u32 v27, 3, v23
    ds_write_b32 v22, v27
    s_waitcnt vmcnt(28)
    buffer_load_dwordx4 v9, s[4:7], s81 offen offset:1024 nt lds
    s_waitcnt vmcnt(28)
    buffer_load_dwordx4 v10, s[4:7], s81 offen offset:2048 nt lds
    s_waitcnt vmcnt(28)
    buffer_load_dwordx4 v11, s[4:7], s81 offen offset:3072 nt lds
    v_add_u32 v23, 1, v23
    s_add_u32 s36, s36, 1
    s_add_u32 s87, s87, 1
    s_add_u32 s74, s74, 32768
    s_add_u32 s83, s70, 2
    s_lshl_b32 s84, s83, 13
    s_and_b32 s84, s84, 16384
    s_cmp_eq_u32 s87, 3
    s_cselect_b32 s87, 0, s87
    s_cselect_b32 s70, s83, s70
    s_cselect_b32 s74, s84, s74
    s_add_u32 m0, s37, 0
    s_waitcnt vmcnt(27)
    buffer_load_dwordx4 v12, s[8:11], s34 offen offset:0 nt lds
    s_waitcnt vmcnt(27)
    buffer_load_dwordx4 v13, s[8:11], s34 offen offset:1024 nt lds
    s_waitcnt vmcnt(27)
    buffer_load_dwordx4 v14, s[8:11], s34 offen offset:2048 nt lds
    s_waitcnt vmcnt(27)
    buffer_load_dwordx4 v15, s[8:11], s34 offen offset:3072 nt lds
    v_subrev_u32 v27, 3, v23
    ds_write_b32 v22, v27
    s_add_u32 m0, s37, 4096
    s_waitcnt vmcnt(27)
    buffer_load_dwordx4 v12, s[8:11], s35 offen offset:0 nt lds
    s_waitcnt vmcnt(27)
    buffer_load_dwordx4 v13, s[8:11], s35 offen offset:1024 nt lds
    s_waitcnt vmcnt(27)
    buffer_load_dwordx4 v14, s[8:11], s35 offen offset:2048 nt lds
    s_waitcnt vmcnt(27)
    buffer_load_dwordx4 v15, s[8:11], s35 offen offset:3072 nt lds
    v_add_u32 v23, 1, v23
    s_add_u32 s75, s75, 1
    s_add_u32 s38, s38, 1
    s_add_u32 s37, s37, 32768
    s_add_u32 s83, s39, 2
    s_lshl_b32 s84, s83, 13
    s_and_b32 s84, s84, 16384
    s_add_u32 s84, s84, 8192
    s_cmp_eq_u32 s38, 3
    s_cselect_b32 s38, 0, s38
    s_cselect_b32 s39, s83, s39
    s_cselect_b32 s37, s84, s37
    s_cmp_lt_u32 s36, s77
    s_cbranch_scc1 L_lp2_114
L_tl_114:
    v_readlane_b32 s34, v20, s75
    v_readlane_b32 s35, v21, s75
L_chv_114:
    s_waitcnt lgkmcnt(0)
    v_readlane_b32 s84, v25, s38
    ds_read_b32 v25, v24
    s_cmp_lt_u32 s39, 4
    s_cselect_b32 s84, s39, s84
    s_cmp_lt_u32 s84, s39
    s_cbranch_scc1 L_chv_114
    s_add_u32 m0, s37, 0
    s_waitcnt vmcnt(27)
    buffer_load_dwordx4 v12, s[8:11], s34 offen offset:0 nt lds
    s_waitcnt vmcnt(27)
    buffer_load_dwordx4 v13, s[8:11], s34 offen offset:1024 nt lds
    s_waitcnt vmcnt(27)
    buffer_load_dwordx4 v14, s[8:11], s34 offen offset:2048 nt lds
    s_waitcnt vmcnt(27)
    buffer_load_dwordx4 v15, s[8:11], s34 offen offset:3072 nt lds
    v_subrev_u32 v27, 3, v23
    ds_write_b32 v22, v27
    s_add_u32 m0, s37, 4096
    s_waitcnt vmcnt(27)
    buffer_load_dwordx4 v12, s[8:11], s35 offen offset:0 nt lds
    s_waitcnt vmcnt(27)
    buffer_load_dwordx4 v13, s[8:11], s35 offen offset:1024 nt lds
    s_waitcnt vmcnt(27)
    buffer_load_dwordx4 v14, s[8:11], s35 offen offset:2048 nt lds
    s_waitcnt vmcnt(27)
    buffer_load_dwordx4 v15, s[8:11], s35 offen offset:3072 nt lds
    v_add_u32 v23, 1, v23
    s_add_u32 s75, s75, 1
    s_add_u32 s38, s38, 1
    s_add_u32 s37, s37, 32768
    s_add_u32 s83, s39, 2
    s_lshl_b32 s84, s83, 13
    s_and_b32 s84, s84, 16384
    s_add_u32 s84, s84, 8192
    s_cmp_eq_u32 s38, 3
    s_cselect_b32 s38, 0, s38
    s_cselect_b32 s39, s83, s39
    s_cselect_b32 s37, s84, s37
    s_cmp_lt_u32 s75, s77
    s_cbranch_scc1 L_tl_114
    s_waitcnt vmcnt(24)
    v_subrev_u32 v27, 3, v23
    ds_write_b32 v22, v27
    s_waitcnt vmcnt(16)
    v_subrev_u32 v27, 2, v23
    ds_write_b32 v22, v27
    s_waitcnt vmcnt(8)
    v_subrev_u32 v27, 1, v23
    ds_write_b32 v22, v27
    s_waitcnt vmcnt(0)
    ds_write_b32 v22, v23
    s_branch L_ldone
L_var_116:
    s_cmp_ge_u32 s36, s68
    s_cbranch_scc1 L_lp_116
L_pk_116:
    v_readlane_b32 s80, v20, s36
    v_readlane_b32 s81, v21, s36
    s_nop 2
    s_add_u32 m0, s74, 0
    s_waitcnt vmcnt(28)
    buffer_load_dwordx4 v8, s[4:7], s80 offen offset:0 nt lds
    s_waitcnt vmcnt(28)
    buffer_load_dwordx4 v9, s[4:7], s80 offen offset:1024 nt lds
    s_waitcnt vmcnt(28)
    buffer_load_dwordx4 v10, s[4:7], s80 offen offset:2048 nt lds
    s_waitcnt vmcnt(28)
    buffer_load_dwordx4 v11, s[4:7], s80 offen offset:3072 nt lds
    s_add_u32 m0, s74, 4096
    s_waitcnt vmcnt(28)
    buffer_load_dwordx4 v8, s[4:7], s81 offen offset:0 nt lds
    v_subrev_u32 v27, 3, v23
    ds_write_b32 v22, v27
    s_waitcnt vmcnt(28)
    buffer_load_dwordx4 v9, s[4:7], s81 offen offset:1024 nt lds
    s_waitcnt vmcnt(28)
    buffer_load_dwordx4 v10, s[4:7], s81 offen offset:2048 nt lds
    s_waitcnt vmcnt(28)
    buffer_load_dwordx4 v11, s[4:7], s81 offen offset:3072 nt lds
    v_add_u32 v23, 1, v23
    s_add_u32 s36, s36, 1
    s_add_u32 s87, s87, 1
    s_add_u32 s74, s74, 32768
    s_add_u32 s83, s70, 2
    s_lshl_b32 s84, s83, 13
    s_and_b32 s84, s84, 16384
    s_cmp_eq_u32 s87, 3
    s_cselect_b32 s87, 0, s87
    s_cselect_b32 s70, s83, s70
    s_cselect_b32 s74, s84, s74
    s_cmp_lt_u32 s36, s68
    s_cbranch_scc1 L_pk_116
L_lp_116:
    s_cmp_ge_u32 s36, s77
    s_cbranch_scc1 L_tl_116
L_lp2_116:
    v_readlane_b32 s34, v20, s75
    v_readlane_b32 s35, v21, s75
    v_readlane_b32 s80, v20, s36
    v_readlane_b32 s81, v21, s36
L_chk_116:
    s_waitcnt lgkmcnt(0)
    v_readlane_b32 s83, v25, s87
    v_readlane_b32 s84, v25, s38
    ds_read_b32 v25, v24
    s_cmp_lt_u32 s39, 4
    s_cselect_b32 s84, s39, s84
    s_cmp_lt_u32 s84, s39
    s_cbranch_scc1 L_chk_116
    s_add_u32 s83, s83, 3
    s_cmp_lt_u32 s83, s70
    s_cbranch_scc1 L_chk_116
    s_add_u32 m0, s74, 0
    s_waitcnt vmcnt(28)
    buffer_load_dwordx4 v8, s[4:7], s80 offen offset:0 nt lds
    s_waitcnt vmcnt(28)
    buffer_load_dwordx4 v9, s[4:7], s80 offen offset:1024 nt lds
    s_waitcnt vmcnt(28)
    buffer_load_dwordx4 v10, s[4:7], s80 offen offset:2048 nt lds
    s_waitcnt vmcnt(28)
    buffer_load_dwordx4 v11, s[4:7], s80 offen offset:3072 nt lds
    s_add_u32 m0, s74, 4096
    s_waitcnt vmcnt(28)
    buffer_load_dwordx4 v8, s[4:7], s81 offen offset:0 nt lds
    v_subrev_u32 v27, 3, v23
    ds_write_b32 v22, v27
    s_waitcnt vmcnt(28)
    buffer_load_dwordx4 v9, s[4:7], s81 offen offset:1024 nt lds
    s_waitcnt vmcnt(28)
    buffer_load_dwordx4 v10, s[4:7], s81 offen offset:2048 nt lds
    s_waitcnt vmcnt(28)
    buffer_load_dwordx4 v11, s[4:7], s81 offen offset:3072 nt lds
    v_add_u32 v23, 1, v23
    s_add_u32 s36, s36, 1
    s_add_u32 s87, s87, 1
    s_add_u32 s74, s74, 32768
    s_add_u32 s83, s70, 2
    s_lshl_b32 s84, s83, 13
    s_and_b32 s84, s84, 16384
    s_cmp_eq_u32 s87, 3
    s_cselect_b32 s87, 0, s87
    s_cselect_b32 s70, s83, s70
    s_cselect_b32 s74, s84, s74
    s_add_u32 m0, s37, 0
    s_waitcnt vmcnt(28)
    buffer_load_dwordx4 v12, s[8:11], s34 offen offset:0 nt lds
    s_waitcnt vmcnt(28)
    buffer_load_dwordx4 v13, s[8:11], s34 offen offset:1024 nt lds
    s_waitcnt vmcnt(28)
    buffer_load_dwordx4 v14, s[8:11], s34 offen offset:2048 nt lds
    s_waitcnt vmcnt(28)
    buffer_load_dwordx4 v15, s[8:11], s34 offen offset:3072 nt lds
    s_add_u32 m0, s37, 4096
    s_waitcnt vmcnt(28)
    buffer_load_dwordx4 v12, s[8:11], s35 offen offset:0 nt lds
    v_subrev_u32 v27, 3, v23
    ds_write_b32 v22, v27
    s_waitcnt vmcnt(28)
    buffer_load_dwordx4 v13, s[8:11], s35 offen offset:1024 nt lds
    s_waitcnt vmcnt(28)
    buffer_load_dwordx4 v14, s[8:11], s35 offen offset:2048 nt lds
    s_waitcnt vmcnt(28)
    buffer_load_dwordx4 v15, s[8:11], s35 offen offset:3072 nt lds
    v_add_u32 v23, 1, v23
    s_add_u32 s75, s75, 1
    s_add_u32 s38, s38, 1
    s_add_u32 s37, s37, 32768
    s_add_u32 s83, s39, 2
    s_lshl_b32 s84, s83, 13
    s_and_b32 s84, s84, 16384
    s_add_u32 s84, s84, 8192
    s_cmp_eq_u32 s38, 3
    s_cselect_b32 s38, 0, s38
    s_cselect_b32 s39, s83, s39
    s_cselect_b32 s37, s84, s37
    s_cmp_lt_u32 s36, s77
    s_cbranch_scc1 L_lp2_116
L_tl_116:
    v_readlane_b32 s34, v20, s75
    v_readlane_b32 s35, v21, s75
L_chv_116:
    s_waitcnt lgkmcnt(0)
    v_readlane_b32 s84, v25, s38
    ds_read_b32 v25, v24
    s_cmp_lt_u32 s39, 4
    s_cselect_b32 s84, s39, s84
    s_cmp_lt_u32 s84, s39
    s_cbranch_scc1 L_chv_116
    s_add_u32 m0, s37, 0
    s_waitcnt vmcnt(28)
    buffer_load_dwordx4 v12, s[8:11], s34 offen offset:0 nt lds
    s_waitcnt vmcnt(28)
    buffer_load_dwordx4 v13, s[8:11], s34 offen offset:1024 nt lds
    s_waitcnt vmcnt(28)
    buffer_load_dwordx4 v14, s[8:11], s34 offen offset:2048 nt lds
    s_waitcnt vmcnt(28)
    buffer_load_dwordx4 v15, s[8:11], s34 offen offset:3072 nt lds
    s_add_u32 m0, s37, 4096
    s_waitcnt vmcnt(28)
    buffer_load_dwordx4 v12, s[8:11], s35 offen offset:0 nt lds
    v_subrev_u32 v27, 3, v23
    ds_write_b32 v22, v27
    s_waitcnt vmcnt(28)
    buffer_load_dwordx4 v13, s[8:11], s35 offen offset:1024 nt lds
    s_waitcnt vmcnt(28)
    buffer_load_dwordx4 v14, s[8:11], s35 offen offset:2048 nt lds
    s_waitcnt vmcnt(28)
    buffer_load_dwordx4 v15, s[8:11], s35 offen offset:3072 nt lds
    v_add_u32 v23, 1, v23
    s_add_u32 s75, s75, 1
    s_add_u32 s38, s38, 1
    s_add_u32 s37, s37, 32768
    s_add_u32 s83, s39, 2
    s_lshl_b32 s84, s83, 13
    s_and_b32 s84, s84, 16384
    s_add_u32 s84, s84, 8192
    s_cmp_eq_u32 s38, 3
    s_cselect_b32 s38, 0, s38
    s_cselect_b32 s39, s83, s39
    s_cselect_b32 s37, s84, s37
    s_cmp_lt_u32 s75, s77
    s_cbranch_scc1 L_tl_116
    s_waitcnt vmcnt(24)
    v_subrev_u32 v27, 3, v23
    ds_write_b32 v22, v27
    s_waitcnt vmcnt(16)
    v_subrev_u32 v27, 2, v23
    ds_write_b32 v22, v27
    s_waitcnt vmcnt(8)
    v_subrev_u32 v27, 1, v23
    ds_write_b32 v22, v27
    s_waitcnt vmcnt(0)
    ds_write_b32 v22, v23
    s_branch L_ldone
L_var_118:
    s_cmp_ge_u32 s36, s68
    s_cbranch_scc1 L_lp_118
L_pk_118:
    v_readlane_b32 s80, v20, s36
    v_readlane_b32 s81, v21, s36
    s_nop 2
    s_add_u32 m0, s74, 0
    s_waitcnt vmcnt(29)
    buffer_load_dwordx4 v8, s[4:7], s80 offen offset:0 nt lds
    s_waitcnt vmcnt(29)
    buffer_load_dwordx4 v9, s[4:7], s80 offen offset:1024 nt lds
    s_waitcnt vmcnt(29)
    buffer_load_dwordx4 v10, s[4:7], s80 offen offset:2048 nt lds
    s_waitcnt vmcnt(29)
    buffer_load_dwordx4 v11, s[4:7], s80 offen offset:3072 nt lds
    s_add_u32 m0, s74, 4096
    s_waitcnt vmcnt(29)
    buffer_load_dwordx4 v8, s[4:7], s81 offen offset:0 nt lds
    s_waitcnt vmcnt(29)
    buffer_load_dwordx4 v9, s[4:7], s81 offen offset:1024 nt lds
    v_subrev_u32 v27, 3, v23
    ds_write_b32 v22, v27
    s_waitcnt vmcnt(29)
    buffer_load_dwordx4 v10, s[4:7], s81 offen offset:2048 nt lds
    s_waitcnt vmcnt(29)
    buffer_load_dwordx4 v11, s[4:7], s81 offen offset:3072 nt lds
    v_add_u32 v23, 1, v23
    s_add_u32 s36, s36, 1
    s_add_u32 s87, s87, 1
    s_add_u32 s74, s74, 32768
    s_add_u32 s83, s70, 2
    s_lshl_b32 s84, s83, 13
    s_and_b32 s84, s84, 16384
    s_cmp_eq_u32 s87, 3
    s_cselect_b32 s87, 0, s87
    s_cselect_b32 s70, s83, s70
    s_cselect_b32 s74, s84, s74
    s_cmp_lt_u32 s36, s68
    s_cbranch_scc1 L_pk_118
L_lp_118:
    s_cmp_ge_u32 s36, s77
    s_cbranch_scc1 L_tl_118
L_lp2_118:
    v_readlane_b32 s34, v20, s75
    v_readlane_b32 s35, v21, s75
    v_readlane_b32 s80, v20, s36
    v_readlane_b32 s81, v21, s36
L_chk_118:
    s_waitcnt lgkmcnt(0)
    v_readlane_b32 s83, v25, s87
    v_readlane_b32 s84, v25, s38
    ds_read_b32 v25, v24
    s_cmp_lt_u32 s39, 4
    s_cselect_b32 s84, s39, s84
    s_cmp_lt_u32 s84, s39
    s_cbranch_scc1 L_chk_118
    s_add_u32 s83, s83, 3
    s_cmp_lt_u32 s83, s70
    s_cbranch_scc1 L_chk_118
    s_add_u32 m0, s74, 0
    s_waitcnt vmcnt(29)
    buffer_load_dwordx4 v8, s[4:7], s80 offen offset:0 nt lds
    s_waitcnt vmcnt(29)
    buffer_load_dwordx4 v9, s[4:7], s80 offen offset:1024 nt lds
    s_waitcnt vmcnt(29)
    buffer_load_dwordx4 v10, s[4:7], s80 offen offset:2048 nt lds
    s_waitcnt vmcnt(29)
    buffer_load_dwordx4 v11, s[4:7], s80 offen offset:3072 nt lds
    s_add_u32 m0, s74, 4096
    s_waitcnt vmcnt(29)
    buffer_load_dwordx4 v8, s[4:7], s81 offen offset:0 nt lds
    s_waitcnt vmcnt(29)
    buffer_load_dwordx4 v9, s[4:7], s81 offen offset:1024 nt lds
    v_subrev_u32 v27, 3, v23
    ds_write_b32 v22, v27
    s_waitcnt vmcnt(29)
    buffer_load_dwordx4 v10, s[4:7], s81 offen offset:2048 nt lds
    s_waitcnt vmcnt(29)
    buffer_load_dwordx4 v11, s[4:7], s81 offen offset:3072 nt lds
    v_add_u32 v23, 1, v23
    s_add_u32 s36, s36, 1
    s_add_u32 s87, s87, 1
    s_add_u32 s74, s74, 32768
    s_add_u32 s83, s70, 2
    s_lshl_b32 s84, s83, 13
    s_and_b32 s84, s84, 16384
    s_cmp_eq_u32 s87, 3
    s_cselect_b32 s87, 0, s87
    s_cselect_b32 s70, s83, s70
    s_cselect_b32 s74, s84, s74
    s_add_u32 m0, s37, 0
    s_waitcnt vmcnt(28)
    buffer_load_dwordx4 v12, s[8:11], s34 offen offset:0 nt lds
    s_waitcnt vmcnt(28)
    buffer_load_dwordx4 v13, s[8:11], s34 offen offset:1024 nt lds
    s_waitcnt vmcnt(28)
    buffer_load_dwordx4 v14, s[8:11], s34 offen offset:2048 nt lds
    s_waitcnt vmcnt(28)
    buffer_load_dwordx4 v15, s[8:11], s34 offen offset:3072 nt lds
    s_add_u32 m0, s37, 4096
    s_waitcnt vmcnt(28)
    buffer_load_dwordx4 v12, s[8:11], s35 offen offset:0 nt lds
    v_subrev_u32 v27, 3, v23
    ds_write_b32 v22, v27
    s_waitcnt vmcnt(28)
    buffer_load_dwordx4 v13, s[8:11], s35 offen offset:1024 nt lds
    s_waitcnt vmcnt(28)
    buffer_load_dwordx4 v14, s[8:11], s35 offen offset:2048 nt lds
    s_waitcnt vmcnt(28)
    buffer_load_dwordx4 v15, s[8:11], s35 offen offset:3072 nt lds
    v_add_u32 v23, 1, v23
    s_add_u32 s75, s75, 1
    s_add_u32 s38, s38, 1
    s_add_u32 s37, s37, 32768
    s_add_u32 s83, s39, 2
    s_lshl_b32 s84, s83, 13
    s_and_b32 s84, s84, 16384
    s_add_u32 s84, s84, 8192
    s_cmp_eq_u32 s38, 3
    s_cselect_b32 s38, 0, s38
    s_cselect_b32 s39, s83, s39
    s_cselect_b32 s37, s84, s37
    s_cmp_lt_u32 s36, s77
    s_cbranch_scc1 L_lp2_118
L_tl_118:
    v_readlane_b32 s34, v20, s75
    v_readlane_b32 s35, v21, s75
L_chv_118:
    s_waitcnt lgkmcnt(0)
    v_readlane_b32 s84, v25, s38
    ds_read_b32 v25, v24
    s_cmp_lt_u32 s39, 4
    s_cselect_b32 s84, s39, s84
    s_cmp_lt_u32 s84, s39
    s_cbranch_scc1 L_chv_118
    s_add_u32 m0, s37, 0
    s_waitcnt vmcnt(29)
    buffer_load_dwordx4 v12, s[8:11], s34 offen offset:0 nt lds
    s_waitcnt vmcnt(29)
    buffer_load_dwordx4 v13, s[8:11], s34 offen offset:1024 nt lds
    s_waitcnt vmcnt(29)
    buffer_load_dwordx4 v14, s[8:11], s34 offen offset:2048 nt lds
    s_waitcnt vmcnt(29)
    buffer_load_dwordx4 v15, s[8:11], s34 offen offset:3072 nt lds
    s_add_u32 m0, s37, 4096
    s_waitcnt vmcnt(29)
    buffer_load_dwordx4 v12, s[8:11], s35 offen offset:0 nt lds
    s_waitcnt vmcnt(29)
    buffer_load_dwordx4 v13, s[8:11], s35 offen offset:1024 nt lds
    v_subrev_u32 v27, 3, v23
    ds_write_b32 v22, v27
    s_waitcnt vmcnt(29)
    buffer_load_dwordx4 v14, s[8:11], s35 offen offset:2048 nt lds
    s_waitcnt vmcnt(29)
    buffer_load_dwordx4 v15, s[8:11], s35 offen offset:3072 nt lds
    v_add_u32 v23, 1, v23
    s_add_u32 s75, s75, 1
    s_add_u32 s38, s38, 1
    s_add_u32 s37, s37, 32768
    s_add_u32 s83, s39, 2
    s_lshl_b32 s84, s83, 13
    s_and_b32 s84, s84, 16384
    s_add_u32 s84, s84, 8192
    s_cmp_eq_u32 s38, 3
    s_cselect_b32 s38, 0, s38
    s_cselect_b32 s39, s83, s39
    s_cselect_b32 s37, s84, s37
    s_cmp_lt_u32 s75, s77
    s_cbranch_scc1 L_tl_118
    s_waitcnt vmcnt(24)
    v_subrev_u32 v27, 3, v23
    ds_write_b32 v22, v27
    s_waitcnt vmcnt(16)
    v_subrev_u32 v27, 2, v23
    ds_write_b32 v22, v27
    s_waitcnt vmcnt(8)
    v_subrev_u32 v27, 1, v23
    ds_write_b32 v22, v27
    s_waitcnt vmcnt(0)
    ds_write_b32 v22, v23
    s_branch L_ldone
L_var_120:
    s_cmp_ge_u32 s36, s68
    s_cbranch_scc1 L_lp_120
L_pk_120:
    v_readlane_b32 s80, v20, s36
    v_readlane_b32 s81, v21, s36
    s_nop 2
    s_add_u32 m0, s74, 0
    s_waitcnt vmcnt(29)
    buffer_load_dwordx4 v8, s[4:7], s80 offen offset:0 nt lds
    s_waitcnt vmcnt(29)
    buffer_load_dwordx4 v9, s[4:7], s80 offen offset:1024 nt lds
    s_waitcnt vmcnt(29)
    buffer_load_dwordx4 v10, s[4:7], s80 offen offset:2048 nt lds
    s_waitcnt vmcnt(29)
    buffer_load_dwordx4 v11, s[4:7], s80 offen offset:3072 nt lds
    s_add_u32 m0, s74, 4096
    s_waitcnt vmcnt(29)
    buffer_load_dwordx4 v8, s[4:7], s81 offen offset:0 nt lds
    s_waitcnt vmcnt(29)
    buffer_load_dwordx4 v9, s[4:7], s81 offen offset:1024 nt lds
    v_subrev_u32 v27, 3, v23
    ds_write_b32 v22, v27
    s_waitcnt vmcnt(29)
    buffer_load_dwordx4 v10, s[4:7], s81 offen offset:2048 nt lds
    s_waitcnt vmcnt(29)
    buffer_load_dwordx4 v11, s[4:7], s81 offen offset:3072 nt lds
    v_add_u32 v23, 1, v23
    s_add_u32 s36, s36, 1
    s_add_u32 s87, s87, 1
    s_add_u32 s74, s74, 32768
    s_add_u32 s83, s70, 2
    s_lshl_b32 s84, s83, 13
    s_and_b32 s84, s84, 16384
    s_cmp_eq_u32 s87, 3
    s_cselect_b32 s87, 0, s87
    s_cselect_b32 s70, s83, s70
    s_cselect_b32 s74, s84, s74
    s_cmp_lt_u32 s36, s68
    s_cbranch_scc1 L_pk_120
L_lp_120:
    s_cmp_ge_u32 s36, s77
    s_cbranch_scc1 L_tl_120
L_lp2_120:
    v_readlane_b32 s34, v20, s75
    v_readlane_b32 s35, v21, s75
    v_readlane_b32 s80, v20, s36
    v_readlane_b32 s81, v21, s36
L_chk_120:
    s_waitcnt lgkmcnt(0)
    v_readlane_b32 s83, v25, s87
    v_readlane_b32 s84, v25, s38
    ds_read_b32 v25, v24
    s_cmp_lt_u32 s39, 4
    s_cselect_b32 s84, s39, s84
    s_cmp_lt_u32 s84, s39
    s_cbranch_scc1 L_chk_120
    s_add_u32 s83, s83, 3
    s_cmp_lt_u32 s83, s70
    s_cbranch_scc1 L_chk_120
    s_add_u32 m0, s74, 0
    s_waitcnt vmcnt(29)
    buffer_load_dwordx4 v8, s[4:7], s80 offen offset:0 nt lds
    s_waitcnt vmcnt(29)
    buffer_load_dwordx4 v9, s[4:7], s80 offen offset:1024 nt lds
    s_waitcnt vmcnt(29)
    buffer_load_dwordx4 v10, s[4:7], s80 offen offset:2048 nt lds
    s_waitcnt vmcnt(29)
    buffer_load_dwordx4 v11, s[4:7], s80 offen offset:3072 nt lds
    s_add_u32 m0, s74, 4096
    s_waitcnt vmcnt(29)
    buffer_load_dwordx4 v8, s[4:7], s81 offen offset:0 nt lds
    s_waitcnt vmcnt(29)
    buffer_load_dwordx4 v9, s[4:7], s81 offen offset:1024 nt lds
    v_subrev_u32 v27, 3, v23
    ds_write_b32 v22, v27
    s_waitcnt vmcnt(29)
    buffer_load_dwordx4 v10, s[4:7], s81 offen offset:2048 nt lds
    s_waitcnt vmcnt(29)
    buffer_load_dwordx4 v11, s[4:7], s81 offen offset:3072 nt lds
    v_add_u32 v23, 1, v23
    s_add_u32 s36, s36, 1
    s_add_u32 s87, s87, 1
    s_add_u32 s74, s74, 32768
    s_add_u32 s83, s70, 2
    s_lshl_b32 s84, s83, 13
    s_and_b32 s84, s84, 16384
    s_cmp_eq_u32 s87, 3
    s_cselect_b32 s87, 0, s87
    s_cselect_b32 s70, s83, s70
    s_cselect_b32 s74, s84, s74
    s_add_u32 m0, s37, 0
    s_waitcnt vmcnt(29)
    buffer_load_dwordx4 v12, s[8:11], s34 offen offset:0 nt lds
    s_waitcnt vmcnt(29)
    buffer_load_dwordx4 v13, s[8:11], s34 offen offset:1024 nt lds
    s_waitcnt vmcnt(29)
    buffer_load_dwordx4 v14, s[8:11], s34 offen offset:2048 nt lds
    s_waitcnt vmcnt(29)
    buffer_load_dwordx4 v15, s[8:11], s34 offen offset:3072 nt lds
    s_add_u32 m0, s37, 4096
    s_waitcnt vmcnt(29)
    buffer_load_dwordx4 v12, s[8:11], s35 offen offset:0 nt lds
    s_waitcnt vmcnt(29)
    buffer_load_dwordx4 v13, s[8:11], s35 offen offset:1024 nt lds
    v_subrev_u32 v27, 3, v23
    ds_write_b32 v22, v27
    s_waitcnt vmcnt(29)
    buffer_load_dwordx4 v14, s[8:11], s35 offen offset:2048 nt lds
    s_waitcnt vmcnt(29)
    buffer_load_dwordx4 v15, s[8:11], s35 offen offset:3072 nt lds
    v_add_u32 v23, 1, v23
    s_add_u32 s75, s75, 1
    s_add_u32 s38, s38, 1
    s_add_u32 s37, s37, 32768
    s_add_u32 s83, s39, 2
    s_lshl_b32 s84, s83, 13
    s_and_b32 s84, s84, 16384
    s_add_u32 s84, s84, 8192
    s_cmp_eq_u32 s38, 3
    s_cselect_b32 s38, 0, s38
    s_cselect_b32 s39, s83, s39
    s_cselect_b32 s37, s84, s37
    s_cmp_lt_u32 s36, s77
    s_cbranch_scc1 L_lp2_120
L_tl_120:
    v_readlane_b32 s34, v20, s75
    v_readlane_b32 s35, v21, s75
L_chv_120:
    s_waitcnt lgkmcnt(0)
    v_readlane_b32 s84, v25, s38
    ds_read_b32 v25, v24
    s_cmp_lt_u32 s39, 4
    s_cselect_b32 s84, s39, s84
    s_cmp_lt_u32 s84, s39
    s_cbranch_scc1 L_chv_120
    s_add_u32 m0, s37, 0
    s_waitcnt vmcnt(29)
    buffer_load_dwordx4 v12, s[8:11], s34 offen offset:0 nt lds
    s_waitcnt vmcnt(29)
    buffer_load_dwordx4 v13, s[8:11], s34 offen offset:1024 nt lds
    s_waitcnt vmcnt(29)
    buffer_load_dwordx4 v14, s[8:11], s34 offen offset:2048 nt lds
    s_waitcnt vmcnt(29)
    buffer_load_dwordx4 v15, s[8:11], s34 offen offset:3072 nt lds
    s_add_u32 m0, s37, 4096
    s_waitcnt vmcnt(29)
    buffer_load_dwordx4 v12, s[8:11], s35 offen offset:0 nt lds
    s_waitcnt vmcnt(29)
    buffer_load_dwordx4 v13, s[8:11], s35 offen offset:1024 nt lds
    v_subrev_u32 v27, 3, v23
    ds_write_b32 v22, v27
    s_waitcnt vmcnt(29)
    buffer_load_dwordx4 v14, s[8:11], s35 offen offset:2048 nt lds
    s_waitcnt vmcnt(29)
    buffer_load_dwordx4 v15, s[8:11], s35 offen offset:3072 nt lds
    v_add_u32 v23, 1, v23
    s_add_u32 s75, s75, 1
    s_add_u32 s38, s38, 1
    s_add_u32 s37, s37, 32768
    s_add_u32 s83, s39, 2
    s_lshl_b32 s84, s83, 13
    s_and_b32 s84, s84, 16384
    s_add_u32 s84, s84, 8192
    s_cmp_eq_u32 s38, 3
    s_cselect_b32 s38, 0, s38
    s_cselect_b32 s39, s83, s39
    s_cselect_b32 s37, s84, s37
    s_cmp_lt_u32 s75, s77
    s_cbranch_scc1 L_tl_120
    s_waitcnt vmcnt(24)
    v_subrev_u32 v27, 3, v23
    ds_write_b32 v22, v27
    s_waitcnt vmcnt(16)
    v_subrev_u32 v27, 2, v23
    ds_write_b32 v22, v27
    s_waitcnt vmcnt(8)
    v_subrev_u32 v27, 1, v23
    ds_write_b32 v22, v27
    s_waitcnt vmcnt(0)
    ds_write_b32 v22, v23
    s_branch L_ldone
L_var_122:
    s_cmp_ge_u32 s36, s68
    s_cbranch_scc1 L_lp_122
L_pk_122:
    v_readlane_b32 s80, v20, s36
    v_readlane_b32 s81, v21, s36
    s_nop 2
    s_add_u32 m0, s74, 0
    s_waitcnt vmcnt(30)
    buffer_load_dwordx4 v8, s[4:7], s80 offen offset:0 nt lds
    s_waitcnt vmcnt(30)
    buffer_load_dwordx4 v9, s[4:7], s80 offen offset:1024 nt lds
    s_waitcnt vmcnt(30)
    buffer_load_dwordx4 v10, s[4:7], s80 offen offset:2048 nt lds
    s_waitcnt vmcnt(30)
    buffer_load_dwordx4 v11, s[4:7], s80 offen offset:3072 nt lds
    s_add_u32 m0, s74, 4096
    s_waitcnt vmcnt(30)
    buffer_load_dwordx4 v8, s[4:7], s81 offen offset:0 nt lds
    s_waitcnt vmcnt(30)
    buffer_load_dwordx4 v9, s[4:7], s81 offen offset:1024 nt lds
    s_waitcnt vmcnt(30)
    buffer_load_dwordx4 v10, s[4:7], s81 offen offset:2048 nt lds
    v_subrev_u32 v27, 3, v23
    ds_write_b32 v22, v27
    s_waitcnt vmcnt(30)
    buffer_load_dwordx4 v11, s[4:7], s81 offen offset:3072 nt lds
    v_add_u32 v23, 1, v23
    s_add_u32 s36, s36, 1
    s_add_u32 s87, s87, 1
    s_add_u32 s74, s74, 32768
    s_add_u32 s83, s70, 2
    s_lshl_b32 s84, s83, 13
    s_and_b32 s84, s84, 16384
    s_cmp_eq_u32 s87, 3
    s_cselect_b32 s87, 0, s87
    s_cselect_b32 s70, s83, s70
    s_cselect_b32 s74, s84, s74
    s_cmp_lt_u32 s36, s68
    s_cbranch_scc1 L_pk_122
L_lp_122:
    s_cmp_ge_u32 s36, s77
    s_cbranch_scc1 L_tl_122
L_lp2_122:
    v_readlane_b32 s34, v20, s75
    v_readlane_b32 s35, v21, s75
    v_readlane_b32 s80, v20, s36
    v_readlane_b32 s81, v21, s36
L_chk_122:
    s_waitcnt lgkmcnt(0)
    v_readlane_b32 s83, v25, s87
    v_readlane_b32 s84, v25, s38
    ds_read_b32 v25, v24
    s_cmp_lt_u32 s39, 4
    s_cselect_b32 s84, s39, s84
    s_cmp_lt_u32 s84, s39
    s_cbranch_scc1 L_chk_122
    s_add_u32 s83, s83, 3
    s_cmp_lt_u32 s83, s70
    s_cbranch_scc1 L_chk_122
    s_add_u32 m0, s74, 0
    s_waitcnt vmcnt(30)
    buffer_load_dwordx4 v8, s[4:7], s80 offen offset:0 nt lds
    s_waitcnt vmcnt(30)
    buffer_load_dwordx4 v9, s[4:7], s80 offen offset:1024 nt lds
    s_waitcnt vmcnt(30)
    buffer_load_dwordx4 v10, s[4:7], s80 offen offset:2048 nt lds
    s_waitcnt vmcnt(30)
    buffer_load_dwordx4 v11, s[4:7], s80 offen offset:3072 nt lds
    s_add_u32 m0, s74, 4096
    s_waitcnt vmcnt(30)
    buffer_load_dwordx4 v8, s[4:7], s81 offen offset:0 nt lds
    s_waitcnt vmcnt(30)
    buffer_load_dwordx4 v9, s[4:7], s81 offen offset:1024 nt lds
    s_waitcnt vmcnt(30)
    buffer_load_dwordx4 v10, s[4:7], s81 offen offset:2048 nt lds
    v_subrev_u32 v27, 3, v23
    ds_write_b32 v22, v27
    s_waitcnt vmcnt(30)
    buffer_load_dwordx4 v11, s[4:7], s81 offen offset:3072 nt lds
    v_add_u32 v23, 1, v23
    s_add_u32 s36, s36, 1
    s_add_u32 s87, s87, 1
    s_add_u32 s74, s74, 32768
    s_add_u32 s83, s70, 2
    s_lshl_b32 s84, s83, 13
    s_and_b32 s84, s84, 16384
    s_cmp_eq_u32 s87, 3
    s_cselect_b32 s87, 0, s87
    s_cselect_b32 s70, s83, s70
    s_cselect_b32 s74, s84, s74
    s_add_u32 m0, s37, 0
    s_waitcnt vmcnt(29)
    buffer_load_dwordx4 v12, s[8:11], s34 offen offset:0 nt lds
    s_waitcnt vmcnt(29)
    buffer_load_dwordx4 v13, s[8:11], s34 offen offset:1024 nt lds
    s_waitcnt vmcnt(29)
    buffer_load_dwordx4 v14, s[8:11], s34 offen offset:2048 nt lds
    s_waitcnt vmcnt(29)
    buffer_load_dwordx4 v15, s[8:11], s34 offen offset:3072 nt lds
    s_add_u32 m0, s37, 4096
    s_waitcnt vmcnt(29)
    buffer_load_dwordx4 v12, s[8:11], s35 offen offset:0 nt lds
    s_waitcnt vmcnt(29)
    buffer_load_dwordx4 v13, s[8:11], s35 offen offset:1024 nt lds
    v_subrev_u32 v27, 3, v23
    ds_write_b32 v22, v27
    s_waitcnt vmcnt(29)
    buffer_load_dwordx4 v14, s[8:11], s35 offen offset:2048 nt lds
    s_waitcnt vmcnt(29)
    buffer_load_dwordx4 v15, s[8:11], s35 offen offset:3072 nt lds
    v_add_u32 v23, 1, v23
    s_add_u32 s75, s75, 1
    s_add_u32 s38, s38, 1
    s_add_u32 s37, s37, 32768
    s_add_u32 s83, s39, 2
    s_lshl_b32 s84, s83, 13
    s_and_b32 s84, s84, 16384
    s_add_u32 s84, s84, 8192
    s_cmp_eq_u32 s38, 3
    s_cselect_b32 s38, 0, s38
    s_cselect_b32 s39, s83, s39
    s_cselect_b32 s37, s84, s37
    s_cmp_lt_u32 s36, s77
    s_cbranch_scc1 L_lp2_122
L_tl_122:
    v_readlane_b32 s34, v20, s75
    v_readlane_b32 s35, v21, s75
L_chv_122:
    s_waitcnt lgkmcnt(0)
    v_readlane_b32 s84, v25, s38
    ds_read_b32 v25, v24
    s_cmp_lt_u32 s39, 4
    s_cselect_b32 s84, s39, s84
    s_cmp_lt_u32 s84, s39
    s_cbranch_scc1 L_chv_122
    s_add_u32 m0, s37, 0
    s_waitcnt vmcnt(29)
    buffer_load_dwordx4 v12, s[8:11], s34 offen offset:0 nt lds
    s_waitcnt vmcnt(29)
    buffer_load_dwordx4 v13, s[8:11], s34 offen offset:1024 nt lds
    s_waitcnt vmcnt(29)
    buffer_load_dwordx4 v14, s[8:11], s34 offen offset:2048 nt lds
    s_waitcnt vmcnt(29)
    buffer_load_dwordx4 v15, s[8:11], s34 offen offset:3072 nt lds
    s_add_u32 m0, s37, 4096
    s_waitcnt vmcnt(29)
    buffer_load_dwordx4 v12, s[8:11], s35 offen offset:0 nt lds
    s_waitcnt vmcnt(29)
    buffer_load_dwordx4 v13, s[8:11], s35 offen offset:1024 nt lds
    v_subrev_u32 v27, 3, v23
    ds_write_b32 v22, v27
    s_waitcnt vmcnt(29)
    buffer_load_dwordx4 v14, s[8:11], s35 offen offset:2048 nt lds
    s_waitcnt vmcnt(29)
    buffer_load_dwordx4 v15, s[8:11], s35 offen offset:3072 nt lds
    v_add_u32 v23, 1, v23
    s_add_u32 s75, s75, 1
    s_add_u32 s38, s38, 1
    s_add_u32 s37, s37, 32768
    s_add_u32 s83, s39, 2
    s_lshl_b32 s84, s83, 13
    s_and_b32 s84, s84, 16384
    s_add_u32 s84, s84, 8192
    s_cmp_eq_u32 s38, 3
    s_cselect_b32 s38, 0, s38
    s_cselect_b32 s39, s83, s39
    s_cselect_b32 s37, s84, s37
    s_cmp_lt_u32 s75, s77
    s_cbranch_scc1 L_tl_122
    s_waitcnt vmcnt(24)
    v_subrev_u32 v27, 3, v23
    ds_write_b32 v22, v27
    s_waitcnt vmcnt(16)
    v_subrev_u32 v27, 2, v23
    ds_write_b32 v22, v27
    s_waitcnt vmcnt(8)
    v_subrev_u32 v27, 1, v23
    ds_write_b32 v22, v27
    s_waitcnt vmcnt(0)
    ds_write_b32 v22, v23
    s_branch L_ldone
L_var_124:
    s_cmp_ge_u32 s36, s68
    s_cbranch_scc1 L_lp_124
L_pk_124:
    v_readlane_b32 s80, v20, s36
    v_readlane_b32 s81, v21, s36
    s_nop 2
    s_add_u32 m0, s74, 0
    s_waitcnt vmcnt(30)
    buffer_load_dwordx4 v8, s[4:7], s80 offen offset:0 nt lds
    s_waitcnt vmcnt(30)
    buffer_load_dwordx4 v9, s[4:7], s80 offen offset:1024 nt lds
    s_waitcnt vmcnt(30)
    buffer_load_dwordx4 v10, s[4:7], s80 offen offset:2048 nt lds
    s_waitcnt vmcnt(30)
    buffer_load_dwordx4 v11, s[4:7], s80 offen offset:3072 nt lds
    s_add_u32 m0, s74, 4096
    s_waitcnt vmcnt(30)
    buffer_load_dwordx4 v8, s[4:7], s81 offen offset:0 nt lds
    s_waitcnt vmcnt(30)
    buffer_load_dwordx4 v9, s[4:7], s81 offen offset:1024 nt lds
    s_waitcnt vmcnt(30)
    buffer_load_dwordx4 v10, s[4:7], s81 offen offset:2048 nt lds
    v_subrev_u32 v27, 3, v23
    ds_write_b32 v22, v27
    s_waitcnt vmcnt(30)
    buffer_load_dwordx4 v11, s[4:7], s81 offen offset:3072 nt lds
    v_add_u32 v23, 1, v23
    s_add_u32 s36, s36, 1
    s_add_u32 s87, s87, 1
    s_add_u32 s74, s74, 32768
    s_add_u32 s83, s70, 2
    s_lshl_b32 s84, s83, 13
    s_and_b32 s84, s84, 16384
    s_cmp_eq_u32 s87, 3
    s_cselect_b32 s87, 0, s87
    s_cselect_b32 s70, s83, s70
    s_cselect_b32 s74, s84, s74
    s_cmp_lt_u32 s36, s68
    s_cbranch_scc1 L_pk_124
L_lp_124:
    s_cmp_ge_u32 s36, s77
    s_cbranch_scc1 L_tl_124
L_lp2_124:
    v_readlane_b32 s34, v20, s75
    v_readlane_b32 s35, v21, s75
    v_readlane_b32 s80, v20, s36
    v_readlane_b32 s81, v21, s36
L_chk_124:
    s_waitcnt lgkmcnt(0)
    v_readlane_b32 s83, v25, s87
    v_readlane_b32 s84, v25, s38
    ds_read_b32 v25, v24
    s_cmp_lt_u32 s39, 4
    s_cselect_b32 s84, s39, s84
    s_cmp_lt_u32 s84, s39
    s_cbranch_scc1 L_chk_124
    s_add_u32 s83, s83, 3
    s_cmp_lt_u32 s83, s70
    s_cbranch_scc1 L_chk_124
    s_add_u32 m0, s74, 0
    s_waitcnt vmcnt(30)
    buffer_load_dwordx4 v8, s[4:7], s80 offen offset:0 nt lds
    s_waitcnt vmcnt(30)
    buffer_load_dwordx4 v9, s[4:7], s80 offen offset:1024 nt lds
    s_waitcnt vmcnt(30)
    buffer_load_dwordx4 v10, s[4:7], s80 offen offset:2048 nt lds
    s_waitcnt vmcnt(30)
    buffer_load_dwordx4 v11, s[4:7], s80 offen offset:3072 nt lds
    s_add_u32 m0, s74, 4096
    s_waitcnt vmcnt(30)
    buffer_load_dwordx4 v8, s[4:7], s81 offen offset:0 nt lds
    s_waitcnt vmcnt(30)
    buffer_load_dwordx4 v9, s[4:7], s81 offen offset:1024 nt lds
    s_waitcnt vmcnt(30)
    buffer_load_dwordx4 v10, s[4:7], s81 offen offset:2048 nt lds
    v_subrev_u32 v27, 3, v23
    ds_write_b32 v22, v27
    s_waitcnt vmcnt(30)
    buffer_load_dwordx4 v11, s[4:7], s81 offen offset:3072 nt lds
    v_add_u32 v23, 1, v23
    s_add_u32 s36, s36, 1
    s_add_u32 s87, s87, 1
    s_add_u32 s74, s74, 32768
    s_add_u32 s83, s70, 2
    s_lshl_b32 s84, s83, 13
    s_and_b32 s84, s84, 16384
    s_cmp_eq_u32 s87, 3
    s_cselect_b32 s87, 0, s87
    s_cselect_b32 s70, s83, s70
    s_cselect_b32 s74, s84, s74
    s_add_u32 m0, s37, 0
    s_waitcnt vmcnt(30)
    buffer_load_dwordx4 v12, s[8:11], s34 offen offset:0 nt lds
    s_waitcnt vmcnt(30)
    buffer_load_dwordx4 v13, s[8:11], s34 offen offset:1024 nt lds
    s_waitcnt vmcnt(30)
    buffer_load_dwordx4 v14, s[8:11], s34 offen offset:2048 nt lds
    s_waitcnt vmcnt(30)
    buffer_load_dwordx4 v15, s[8:11], s34 offen offset:3072 nt lds
    s_add_u32 m0, s37, 4096
    s_waitcnt vmcnt(30)
    buffer_load_dwordx4 v12, s[8:11], s35 offen offset:0 nt lds
    s_waitcnt vmcnt(30)
    buffer_load_dwordx4 v13, s[8:11], s35 offen offset:1024 nt lds
    s_waitcnt vmcnt(30)
    buffer_load_dwordx4 v14, s[8:11], s35 offen offset:2048 nt lds
    v_subrev_u32 v27, 3, v23
    ds_write_b32 v22, v27
    s_waitcnt vmcnt(30)
    buffer_load_dwordx4 v15, s[8:11], s35 offen offset:3072 nt lds
    v_add_u32 v23, 1, v23
    s_add_u32 s75, s75, 1
    s_add_u32 s38, s38, 1
    s_add_u32 s37, s37, 32768
    s_add_u32 s83, s39, 2
    s_lshl_b32 s84, s83, 13
    s_and_b32 s84, s84, 16384
    s_add_u32 s84, s84, 8192
    s_cmp_eq_u32 s38, 3
    s_cselect_b32 s38, 0, s38
    s_cselect_b32 s39, s83, s39
    s_cselect_b32 s37, s84, s37
    s_cmp_lt_u32 s36, s77
    s_cbranch_scc1 L_lp2_124
L_tl_124:
    v_readlane_b32 s34, v20, s75
    v_readlane_b32 s35, v21, s75
L_chv_124:
    s_waitcnt lgkmcnt(0)
    v_readlane_b32 s84, v25, s38
    ds_read_b32 v25, v24
    s_cmp_lt_u32 s39, 4
    s_cselect_b32 s84, s39, s84
    s_cmp_lt_u32 s84, s39
    s_cbranch_scc1 L_chv_124
    s_add_u32 m0, s37, 0
    s_waitcnt vmcnt(30)
    buffer_load_dwordx4 v12, s[8:11], s34 offen offset:0 nt lds
    s_waitcnt vmcnt(30)
    buffer_load_dwordx4 v13, s[8:11], s34 offen offset:1024 nt lds
    s_waitcnt vmcnt(30)
    buffer_load_dwordx4 v14, s[8:11], s34 offen offset:2048 nt lds
    s_waitcnt vmcnt(30)
    buffer_load_dwordx4 v15, s[8:11], s34 offen offset:3072 nt lds
    s_add_u32 m0, s37, 4096
    s_waitcnt vmcnt(30)
    buffer_load_dwordx4 v12, s[8:11], s35 offen offset:0 nt lds
    s_waitcnt vmcnt(30)
    buffer_load_dwordx4 v13, s[8:11], s35 offen offset:1024 nt lds
    s_waitcnt vmcnt(30)
    buffer_load_dwordx4 v14, s[8:11], s35 offen offset:2048 nt lds
    v_subrev_u32 v27, 3, v23
    ds_write_b32 v22, v27
    s_waitcnt vmcnt(30)
    buffer_load_dwordx4 v15, s[8:11], s35 offen offset:3072 nt lds
    v_add_u32 v23, 1, v23
    s_add_u32 s75, s75, 1
    s_add_u32 s38, s38, 1
    s_add_u32 s37, s37, 32768
    s_add_u32 s83, s39, 2
    s_lshl_b32 s84, s83, 13
    s_and_b32 s84, s84, 16384
    s_add_u32 s84, s84, 8192
    s_cmp_eq_u32 s38, 3
    s_cselect_b32 s38, 0, s38
    s_cselect_b32 s39, s83, s39
    s_cselect_b32 s37, s84, s37
    s_cmp_lt_u32 s75, s77
    s_cbranch_scc1 L_tl_124
    s_waitcnt vmcnt(24)
    v_subrev_u32 v27, 3, v23
    ds_write_b32 v22, v27
    s_waitcnt vmcnt(16)
    v_subrev_u32 v27, 2, v23
    ds_write_b32 v22, v27
    s_waitcnt vmcnt(8)
    v_subrev_u32 v27, 1, v23
    ds_write_b32 v22, v27
    s_waitcnt vmcnt(0)
    ds_write_b32 v22, v23
    s_branch L_ldone
L_var_126:
    s_cmp_ge_u32 s36, s68
    s_cbranch_scc1 L_lp_126
L_pk_126:
    v_readlane_b32 s80, v20, s36
    v_readlane_b32 s81, v21, s36
    s_nop 2
    s_add_u32 m0, s74, 0
    s_waitcnt vmcnt(31)
    buffer_load_dwordx4 v8, s[4:7], s80 offen offset:0 nt lds
    s_waitcnt vmcnt(31)
    buffer_load_dwordx4 v9, s[4:7], s80 offen offset:1024 nt lds
    s_waitcnt vmcnt(31)
    buffer_load_dwordx4 v10, s[4:7], s80 offen offset:2048 nt lds
    s_waitcnt vmcnt(31)
    buffer_load_dwordx4 v11, s[4:7], s80 offen offset:3072 nt lds
    s_add_u32 m0, s74, 4096
    s_waitcnt vmcnt(31)
    buffer_load_dwordx4 v8, s[4:7], s81 offen offset:0 nt lds
    s_waitcnt vmcnt(31)
    buffer_load_dwordx4 v9, s[4:7], s81 offen offset:1024 nt lds
    s_waitcnt vmcnt(31)
    buffer_load_dwordx4 v10, s[4:7], s81 offen offset:2048 nt lds
    s_waitcnt vmcnt(31)
    buffer_load_dwordx4 v11, s[4:7], s81 offen offset:3072 nt lds
    v_subrev_u32 v27, 3, v23
    ds_write_b32 v22, v27
    v_add_u32 v23, 1, v23
    s_add_u32 s36, s36, 1
    s_add_u32 s87, s87, 1
    s_add_u32 s74, s74, 32768
    s_add_u32 s83, s70, 2
    s_lshl_b32 s84, s83, 13
    s_and_b32 s84, s84, 16384
    s_cmp_eq_u32 s87, 3
    s_cselect_b32 s87, 0, s87
    s_cselect_b32 s70, s83, s70
    s_cselect_b32 s74, s84, s74
    s_cmp_lt_u32 s36, s68
    s_cbranch_scc1 L_pk_126
L_lp_126:
    s_cmp_ge_u32 s36, s77
    s_cbranch_scc1 L_tl_126
L_lp2_126:
    v_readlane_b32 s34, v20, s75
    v_readlane_b32 s35, v21, s75
    v_readlane_b32 s80, v20, s36
    v_readlane_b32 s81, v21, s36
L_chk_126:
    s_waitcnt lgkmcnt(0)
    v_readlane_b32 s83, v25, s87
    v_readlane_b32 s84, v25, s38
    ds_read_b32 v25, v24
    s_cmp_lt_u32 s39, 4
    s_cselect_b32 s84, s39, s84
    s_cmp_lt_u32 s84, s39
    s_cbranch_scc1 L_chk_126
    s_add_u32 s83, s83, 3
    s_cmp_lt_u32 s83, s70
    s_cbranch_scc1 L_chk_126
    s_add_u32 m0, s74, 0
    s_waitcnt vmcnt(31)
    buffer_load_dwordx4 v8, s[4:7], s80 offen offset:0 nt lds
    s_waitcnt vmcnt(31)
    buffer_load_dwordx4 v9, s[4:7], s80 offen offset:1024 nt lds
    s_waitcnt vmcnt(31)
    buffer_load_dwordx4 v10, s[4:7], s80 offen offset:2048 nt lds
    s_waitcnt vmcnt(31)
    buffer_load_dwordx4 v11, s[4:7], s80 offen offset:3072 nt lds
    s_add_u32 m0, s74, 4096
    s_waitcnt vmcnt(31)
    buffer_load_dwordx4 v8, s[4:7], s81 offen offset:0 nt lds
    s_waitcnt vmcnt(31)
    buffer_load_dwordx4 v9, s[4:7], s81 offen offset:1024 nt lds
    s_waitcnt vmcnt(31)
    buffer_load_dwordx4 v10, s[4:7], s81 offen offset:2048 nt lds
    s_waitcnt vmcnt(31)
    buffer_load_dwordx4 v11, s[4:7], s81 offen offset:3072 nt lds
    v_subrev_u32 v27, 3, v23
    ds_write_b32 v22, v27
    v_add_u32 v23, 1, v23
    s_add_u32 s36, s36, 1
    s_add_u32 s87, s87, 1
    s_add_u32 s74, s74, 32768
    s_add_u32 s83, s70, 2
    s_lshl_b32 s84, s83, 13
    s_and_b32 s84, s84, 16384
    s_cmp_eq_u32 s87, 3
    s_cselect_b32 s87, 0, s87
    s_cselect_b32 s70, s83, s70
    s_cselect_b32 s74, s84, s74
    s_add_u32 m0, s37, 0
    s_waitcnt vmcnt(30)
    buffer_load_dwordx4 v12, s[8:11], s34 offen offset:0 nt lds
    s_waitcnt vmcnt(30)
    buffer_load_dwordx4 v13, s[8:11], s34 offen offset:1024 nt lds
    s_waitcnt vmcnt(30)
    buffer_load_dwordx4 v14, s[8:11], s34 offen offset:2048 nt lds
    s_waitcnt vmcnt(30)
    buffer_load_dwordx4 v15, s[8:11], s34 offen offset:3072 nt lds
    s_add_u32 m0, s37, 4096
    s_waitcnt vmcnt(30)
    buffer_load_dwordx4 v12, s[8:11], s35 offen offset:0 nt lds
    s_waitcnt vmcnt(30)
    buffer_load_dwordx4 v13, s[8:11], s35 offen offset:1024 nt lds
    s_waitcnt vmcnt(30)
    buffer_load_dwordx4 v14, s[8:11], s35 offen offset:2048 nt lds
    v_subrev_u32 v27, 3, v23
    ds_write_b32 v22, v27
    s_waitcnt vmcnt(30)
    buffer_load_dwordx4 v15, s[8:11], s35 offen offset:3072 nt lds
    v_add_u32 v23, 1, v23
    s_add_u32 s75, s75, 1
    s_add_u32 s38, s38, 1
    s_add_u32 s37, s37, 32768
    s_add_u32 s83, s39, 2
    s_lshl_b32 s84, s83, 13
    s_and_b32 s84, s84, 16384
    s_add_u32 s84, s84, 8192
    s_cmp_eq_u32 s38, 3
    s_cselect_b32 s38, 0, s38
    s_cselect_b32 s39, s83, s39
    s_cselect_b32 s37, s84, s37
    s_cmp_lt_u32 s36, s77
    s_cbranch_scc1 L_lp2_126
L_tl_126:
    v_readlane_b32 s34, v20, s75
    v_readlane_b32 s35, v21, s75
L_chv_126:
    s_waitcnt lgkmcnt(0)
    v_readlane_b32 s84, v25, s38
    ds_read_b32 v25, v24
    s_cmp_lt_u32 s39, 4
    s_cselect_b32 s84, s39, s84
    s_cmp_lt_u32 s84, s39
    s_cbranch_scc1 L_chv_126
    s_add_u32 m0, s37, 0
    s_waitcnt vmcnt(31)
    buffer_load_dwordx4 v12, s[8:11], s34 offen offset:0 nt lds
    s_waitcnt vmcnt(31)
    buffer_load_dwordx4 v13, s[8:11], s34 offen offset:1024 nt lds
    s_waitcnt vmcnt(31)
    buffer_load_dwordx4 v14, s[8:11], s34 offen offset:2048 nt lds
    s_waitcnt vmcnt(31)
    buffer_load_dwordx4 v15, s[8:11], s34 offen offset:3072 nt lds
    s_add_u32 m0, s37, 4096
    s_waitcnt vmcnt(31)
    buffer_load_dwordx4 v12, s[8:11], s35 offen offset:0 nt lds
    s_waitcnt vmcnt(31)
    buffer_load_dwordx4 v13, s[8:11], s35 offen offset:1024 nt lds
    s_waitcnt vmcnt(31)
    buffer_load_dwordx4 v14, s[8:11], s35 offen offset:2048 nt lds
    s_waitcnt vmcnt(31)
    buffer_load_dwordx4 v15, s[8:11], s35 offen offset:3072 nt lds
    v_subrev_u32 v27, 3, v23
    ds_write_b32 v22, v27
    v_add_u32 v23, 1, v23
    s_add_u32 s75, s75, 1
    s_add_u32 s38, s38, 1
    s_add_u32 s37, s37, 32768
    s_add_u32 s83, s39, 2
    s_lshl_b32 s84, s83, 13
    s_and_b32 s84, s84, 16384
    s_add_u32 s84, s84, 8192
    s_cmp_eq_u32 s38, 3
    s_cselect_b32 s38, 0, s38
    s_cselect_b32 s39, s83, s39
    s_cselect_b32 s37, s84, s37
    s_cmp_lt_u32 s75, s77
    s_cbranch_scc1 L_tl_126
    s_waitcnt vmcnt(24)
    v_subrev_u32 v27, 3, v23
    ds_write_b32 v22, v27
    s_waitcnt vmcnt(16)
    v_subrev_u32 v27, 2, v23
    ds_write_b32 v22, v27
    s_waitcnt vmcnt(8)
    v_subrev_u32 v27, 1, v23
    ds_write_b32 v22, v27
    s_waitcnt vmcnt(0)
    ds_write_b32 v22, v23
    s_branch L_ldone
L_var_128:
    s_cmp_ge_u32 s36, s68
    s_cbranch_scc1 L_lp_128
L_pk_128:
    v_readlane_b32 s80, v20, s36
    v_readlane_b32 s81, v21, s36
    s_nop 2
    s_add_u32 m0, s74, 0
    s_waitcnt vmcnt(31)
    buffer_load_dwordx4 v8, s[4:7], s80 offen offset:0 nt lds
    s_waitcnt vmcnt(31)
    buffer_load_dwordx4 v9, s[4:7], s80 offen offset:1024 nt lds
    s_waitcnt vmcnt(31)
    buffer_load_dwordx4 v10, s[4:7], s80 offen offset:2048 nt lds
    s_waitcnt vmcnt(31)
    buffer_load_dwordx4 v11, s[4:7], s80 offen offset:3072 nt lds
    s_add_u32 m0, s74, 4096
    s_waitcnt vmcnt(31)
    buffer_load_dwordx4 v8, s[4:7], s81 offen offset:0 nt lds
    s_waitcnt vmcnt(31)
    buffer_load_dwordx4 v9, s[4:7], s81 offen offset:1024 nt lds
    s_waitcnt vmcnt(31)
    buffer_load_dwordx4 v10, s[4:7], s81 offen offset:2048 nt lds
    s_waitcnt vmcnt(31)
    buffer_load_dwordx4 v11, s[4:7], s81 offen offset:3072 nt lds
    v_subrev_u32 v27, 3, v23
    ds_write_b32 v22, v27
    v_add_u32 v23, 1, v23
    s_add_u32 s36, s36, 1
    s_add_u32 s87, s87, 1
    s_add_u32 s74, s74, 32768
    s_add_u32 s83, s70, 2
    s_lshl_b32 s84, s83, 13
    s_and_b32 s84, s84, 16384
    s_cmp_eq_u32 s87, 3
    s_cselect_b32 s87, 0, s87
    s_cselect_b32 s70, s83, s70
    s_cselect_b32 s74, s84, s74
    s_cmp_lt_u32 s36, s68
    s_cbranch_scc1 L_pk_128
L_lp_128:
    s_cmp_ge_u32 s36, s77
    s_cbranch_scc1 L_tl_128
L_lp2_128:
    v_readlane_b32 s34, v20, s75
    v_readlane_b32 s35, v21, s75
    v_readlane_b32 s80, v20, s36
    v_readlane_b32 s81, v21, s36
L_chk_128:
    s_waitcnt lgkmcnt(0)
    v_readlane_b32 s83, v25, s87
    v_readlane_b32 s84, v25, s38
    ds_read_b32 v25, v24
    s_cmp_lt_u32 s39, 4
    s_cselect_b32 s84, s39, s84
    s_cmp_lt_u32 s84, s39
    s_cbranch_scc1 L_chk_128
    s_add_u32 s83, s83, 3
    s_cmp_lt_u32 s83, s70
    s_cbranch_scc1 L_chk_128
    s_add_u32 m0, s74, 0
    s_waitcnt vmcnt(31)
    buffer_load_dwordx4 v8, s[4:7], s80 offen offset:0 nt lds
    s_waitcnt vmcnt(31)
    buffer_load_dwordx4 v9, s[4:7], s80 offen offset:1024 nt lds
    s_waitcnt vmcnt(31)
    buffer_load_dwordx4 v10, s[4:7], s80 offen offset:2048 nt lds
    s_waitcnt vmcnt(31)
    buffer_load_dwordx4 v11, s[4:7], s80 offen offset:3072 nt lds
    s_add_u32 m0, s74, 4096
    s_waitcnt vmcnt(31)
    buffer_load_dwordx4 v8, s[4:7], s81 offen offset:0 nt lds
    s_waitcnt vmcnt(31)
    buffer_load_dwordx4 v9, s[4:7], s81 offen offset:1024 nt lds
    s_waitcnt vmcnt(31)
    buffer_load_dwordx4 v10, s[4:7], s81 offen offset:2048 nt lds
    s_waitcnt vmcnt(31)
    buffer_load_dwordx4 v11, s[4:7], s81 offen offset:3072 nt lds
    v_subrev_u32 v27, 3, v23
    ds_write_b32 v22, v27
    v_add_u32 v23, 1, v23
    s_add_u32 s36, s36, 1
    s_add_u32 s87, s87, 1
    s_add_u32 s74, s74, 32768
    s_add_u32 s83, s70, 2
    s_lshl_b32 s84, s83, 13
    s_and_b32 s84, s84, 16384
    s_cmp_eq_u32 s87, 3
    s_cselect_b32 s87, 0, s87
    s_cselect_b32 s70, s83, s70
    s_cselect_b32 s74, s84, s74
    s_add_u32 m0, s37, 0
    s_waitcnt vmcnt(31)
    buffer_load_dwordx4 v12, s[8:11], s34 offen offset:0 nt lds
    s_waitcnt vmcnt(31)
    buffer_load_dwordx4 v13, s[8:11], s34 offen offset:1024 nt lds
    s_waitcnt vmcnt(31)
    buffer_load_dwordx4 v14, s[8:11], s34 offen offset:2048 nt lds
    s_waitcnt vmcnt(31)
    buffer_load_dwordx4 v15, s[8:11], s34 offen offset:3072 nt lds
    s_add_u32 m0, s37, 4096
    s_waitcnt vmcnt(31)
    buffer_load_dwordx4 v12, s[8:11], s35 offen offset:0 nt lds
    s_waitcnt vmcnt(31)
    buffer_load_dwordx4 v13, s[8:11], s35 offen offset:1024 nt lds
    s_waitcnt vmcnt(31)
    buffer_load_dwordx4 v14, s[8:11], s35 offen offset:2048 nt lds
    s_waitcnt vmcnt(31)
    buffer_load_dwordx4 v15, s[8:11], s35 offen offset:3072 nt lds
    v_subrev_u32 v27, 3, v23
    ds_write_b32 v22, v27
    v_add_u32 v23, 1, v23
    s_add_u32 s75, s75, 1
    s_add_u32 s38, s38, 1
    s_add_u32 s37, s37, 32768
    s_add_u32 s83, s39, 2
    s_lshl_b32 s84, s83, 13
    s_and_b32 s84, s84, 16384
    s_add_u32 s84, s84, 8192
    s_cmp_eq_u32 s38, 3
    s_cselect_b32 s38, 0, s38
    s_cselect_b32 s39, s83, s39
    s_cselect_b32 s37, s84, s37
    s_cmp_lt_u32 s36, s77
    s_cbranch_scc1 L_lp2_128
L_tl_128:
    v_readlane_b32 s34, v20, s75
    v_readlane_b32 s35, v21, s75
L_chv_128:
    s_waitcnt lgkmcnt(0)
    v_readlane_b32 s84, v25, s38
    ds_read_b32 v25, v24
    s_cmp_lt_u32 s39, 4
    s_cselect_b32 s84, s39, s84
    s_cmp_lt_u32 s84, s39
    s_cbranch_scc1 L_chv_128
    s_add_u32 m0, s37, 0
    s_waitcnt vmcnt(31)
    buffer_load_dwordx4 v12, s[8:11], s34 offen offset:0 nt lds
    s_waitcnt vmcnt(31)
    buffer_load_dwordx4 v13, s[8:11], s34 offen offset:1024 nt lds
    s_waitcnt vmcnt(31)
    buffer_load_dwordx4 v14, s[8:11], s34 offen offset:2048 nt lds
    s_waitcnt vmcnt(31)
    buffer_load_dwordx4 v15, s[8:11], s34 offen offset:3072 nt lds
    s_add_u32 m0, s37, 4096
    s_waitcnt vmcnt(31)
    buffer_load_dwordx4 v12, s[8:11], s35 offen offset:0 nt lds
    s_waitcnt vmcnt(31)
    buffer_load_dwordx4 v13, s[8:11], s35 offen offset:1024 nt lds
    s_waitcnt vmcnt(31)
    buffer_load_dwordx4 v14, s[8:11], s35 offen offset:2048 nt lds
    s_waitcnt vmcnt(31)
    buffer_load_dwordx4 v15, s[8:11], s35 offen offset:3072 nt lds
    v_subrev_u32 v27, 3, v23
    ds_write_b32 v22, v27
    v_add_u32 v23, 1, v23
    s_add_u32 s75, s75, 1
    s_add_u32 s38, s38, 1
    s_add_u32 s37, s37, 32768
    s_add_u32 s83, s39, 2
    s_lshl_b32 s84, s83, 13
    s_and_b32 s84, s84, 16384
    s_add_u32 s84, s84, 8192
    s_cmp_eq_u32 s38, 3
    s_cselect_b32 s38, 0, s38
    s_cselect_b32 s39, s83, s39
    s_cselect_b32 s37, s84, s37
    s_cmp_lt_u32 s75, s77
    s_cbranch_scc1 L_tl_128
    s_waitcnt vmcnt(24)
    v_subrev_u32 v27, 3, v23
    ds_write_b32 v22, v27
    s_waitcnt vmcnt(16)
    v_subrev_u32 v27, 2, v23
    ds_write_b32 v22, v27
    s_waitcnt vmcnt(8)
    v_subrev_u32 v27, 1, v23
    ds_write_b32 v22, v27
    s_waitcnt vmcnt(0)
    ds_write_b32 v22, v23
    s_branch L_ldone
L_var_130:
    s_cmp_ge_u32 s36, s68
    s_cbranch_scc1 L_lp_130
L_pk_130:
    v_readlane_b32 s80, v20, s36
    v_readlane_b32 s81, v21, s36
    s_nop 2
    s_add_u32 m0, s74, 0
    s_waitcnt vmcnt(32)
    buffer_load_dwordx4 v8, s[4:7], s80 offen offset:0 nt lds
    v_subrev_u32 v27, 4, v23
    ds_write_b32 v22, v27
    s_waitcnt vmcnt(32)
    buffer_load_dwordx4 v9, s[4:7], s80 offen offset:1024 nt lds
    s_waitcnt vmcnt(32)
    buffer_load_dwordx4 v10, s[4:7], s80 offen offset:2048 nt lds
    s_waitcnt vmcnt(32)
    buffer_load_dwordx4 v11, s[4:7], s80 offen offset:3072 nt lds
    s_add_u32 m0, s74, 4096
    s_waitcnt vmcnt(32)
    buffer_load_dwordx4 v8, s[4:7], s81 offen offset:0 nt lds
    s_waitcnt vmcnt(32)
    buffer_load_dwordx4 v9, s[4:7], s81 offen offset:1024 nt lds
    s_waitcnt vmcnt(32)
    buffer_load_dwordx4 v10, s[4:7], s81 offen offset:2048 nt lds
    s_waitcnt vmcnt(32)
    buffer_load_dwordx4 v11, s[4:7], s81 offen offset:3072 nt lds
    v_add_u32 v23, 1, v23
    s_add_u32 s36, s36, 1
    s_add_u32 s87, s87, 1
    s_add_u32 s74, s74, 32768
    s_add_u32 s83, s70, 2
    s_lshl_b32 s84, s83, 13
    s_and_b32 s84, s84, 16384
    s_cmp_eq_u32 s87, 3
    s_cselect_b32 s87, 0, s87
    s_cselect_b32 s70, s83, s70
    s_cselect_b32 s74, s84, s74
    s_cmp_lt_u32 s36, s68
    s_cbranch_scc1 L_pk_130
L_lp_130:
    s_cmp_ge_u32 s36, s77
    s_cbranch_scc1 L_tl_130
L_lp2_130:
    v_readlane_b32 s34, v20, s75
    v_readlane_b32 s35, v21, s75
    v_readlane_b32 s80, v20, s36
    v_readlane_b32 s81, v21, s36
L_chk_130:
    s_waitcnt lgkmcnt(0)
    v_readlane_b32 s83, v25, s87
    v_readlane_b32 s84, v25, s38
    ds_read_b32 v25, v24
    s_cmp_lt_u32 s39, 4
    s_cselect_b32 s84, s39, s84
    s_cmp_lt_u32 s84, s39
    s_cbranch_scc1 L_chk_130
    s_add_u32 s83, s83, 3
    s_cmp_lt_u32 s83, s70
    s_cbranch_scc1 L_chk_130
    s_add_u32 m0, s74, 0
    s_waitcnt vmcnt(32)
    buffer_load_dwordx4 v8, s[4:7], s80 offen offset:0 nt lds
    v_subrev_u32 v27, 4, v23
    ds_write_b32 v22, v27
    s_waitcnt vmcnt(32)
    buffer_load_dwordx4 v9, s[4:7], s80 offen offset:1024 nt lds
    s_waitcnt vmcnt(32)
    buffer_load_dwordx4 v10, s[4:7], s80 offen offset:2048 nt lds
    s_waitcnt vmcnt(32)
    buffer_load_dwordx4 v11, s[4:7], s80 offen offset:3072 nt lds
    s_add_u32 m0, s74, 4096
    s_waitcnt vmcnt(32)
    buffer_load_dwordx4 v8, s[4:7], s81 offen offset:0 nt lds
    s_waitcnt vmcnt(32)
    buffer_load_dwordx4 v9, s[4:7], s81 offen offset:1024 nt lds
    s_waitcnt vmcnt(32)
    buffer_load_dwordx4 v10, s[4:7], s81 offen offset:2048 nt lds
    s_waitcnt vmcnt(32)
    buffer_load_dwordx4 v11, s[4:7], s81 offen offset:3072 nt lds
    v_add_u32 v23, 1, v23
    s_add_u32 s36, s36, 1
    s_add_u32 s87, s87, 1
    s_add_u32 s74, s74, 32768
    s_add_u32 s83, s70, 2
    s_lshl_b32 s84, s83, 13
    s_and_b32 s84, s84, 16384
    s_cmp_eq_u32 s87, 3
    s_cselect_b32 s87, 0, s87
    s_cselect_b32 s70, s83, s70
    s_cselect_b32 s74, s84, s74
    s_add_u32 m0, s37, 0
    s_waitcnt vmcnt(31)
    buffer_load_dwordx4 v12, s[8:11], s34 offen offset:0 nt lds
    s_waitcnt vmcnt(31)
    buffer_load_dwordx4 v13, s[8:11], s34 offen offset:1024 nt lds
    s_waitcnt vmcnt(31)
    buffer_load_dwordx4 v14, s[8:11], s34 offen offset:2048 nt lds
    s_waitcnt vmcnt(31)
    buffer_load_dwordx4 v15, s[8:11], s34 offen offset:3072 nt lds
    s_add_u32 m0, s37, 4096
    s_waitcnt vmcnt(31)
    buffer_load_dwordx4 v12, s[8:11], s35 offen offset:0 nt lds
    s_waitcnt vmcnt(31)
    buffer_load_dwordx4 v13, s[8:11], s35 offen offset:1024 nt lds
    s_waitcnt vmcnt(31)
    buffer_load_dwordx4 v14, s[8:11], s35 offen offset:2048 nt lds
    s_waitcnt vmcnt(31)
    buffer_load_dwordx4 v15, s[8:11], s35 offen offset:3072 nt lds
    v_subrev_u32 v27, 3, v23
    ds_write_b32 v22, v27
    v_add_u32 v23, 1, v23
    s_add_u32 s75, s75, 1
    s_add_u32 s38, s38, 1
    s_add_u32 s37, s37, 32768
    s_add_u32 s83, s39, 2
    s_lshl_b32 s84, s83, 13
    s_and_b32 s84, s84, 16384
    s_add_u32 s84, s84, 8192
    s_cmp_eq_u32 s38, 3
    s_cselect_b32 s38, 0, s38
    s_cselect_b32 s39, s83, s39
    s_cselect_b32 s37, s84, s37
    s_cmp_lt_u32 s36, s77
    s_cbranch_scc1 L_lp2_130
L_tl_130:
    v_readlane_b32 s34, v20, s75
    v_readlane_b32 s35, v21, s75
L_chv_130:
    s_waitcnt lgkmcnt(0)
    v_readlane_b32 s84, v25, s38
    ds_read_b32 v25, v24
    s_cmp_lt_u32 s39, 4
    s_cselect_b32 s84, s39, s84
    s_cmp_lt_u32 s84, s39
    s_cbranch_scc1 L_chv_130
    s_add_u32 m0, s37, 0
    s_waitcnt vmcnt(31)
    buffer_load_dwordx4 v12, s[8:11], s34 offen offset:0 nt lds
    s_waitcnt vmcnt(31)
    buffer_load_dwordx4 v13, s[8:11], s34 offen offset:1024 nt lds
    s_waitcnt vmcnt(31)
    buffer_load_dwordx4 v14, s[8:11], s34 offen offset:2048 nt lds
    s_waitcnt vmcnt(31)
    buffer_load_dwordx4 v15, s[8:11], s34 offen offset:3072 nt lds
    s_add_u32 m0, s37, 4096
    s_waitcnt vmcnt(31)
    buffer_load_dwordx4 v12, s[8:11], s35 offen offset:0 nt lds
    s_waitcnt vmcnt(31)
    buffer_load_dwordx4 v13, s[8:11], s35 offen offset:1024 nt lds
    s_waitcnt vmcnt(31)
    buffer_load_dwordx4 v14, s[8:11], s35 offen offset:2048 nt lds
    s_waitcnt vmcnt(31)
    buffer_load_dwordx4 v15, s[8:11], s35 offen offset:3072 nt lds
    v_subrev_u32 v27, 3, v23
    ds_write_b32 v22, v27
    v_add_u32 v23, 1, v23
    s_add_u32 s75, s75, 1
    s_add_u32 s38, s38, 1
    s_add_u32 s37, s37, 32768
    s_add_u32 s83, s39, 2
    s_lshl_b32 s84, s83, 13
    s_and_b32 s84, s84, 16384
    s_add_u32 s84, s84, 8192
    s_cmp_eq_u32 s38, 3
    s_cselect_b32 s38, 0, s38
    s_cselect_b32 s39, s83, s39
    s_cselect_b32 s37, s84, s37
    s_cmp_lt_u32 s75, s77
    s_cbranch_scc1 L_tl_130
    s_waitcnt vmcnt(24)
    v_subrev_u32 v27, 3, v23
    ds_write_b32 v22, v27
    s_waitcnt vmcnt(16)
    v_subrev_u32 v27, 2, v23
    ds_write_b32 v22, v27
    s_waitcnt vmcnt(8)
    v_subrev_u32 v27, 1, v23
    ds_write_b32 v22, v27
    s_waitcnt vmcnt(0)
    ds_write_b32 v22, v23
    s_branch L_ldone
L_var_132:
    s_cmp_ge_u32 s36, s68
    s_cbranch_scc1 L_lp_132
L_pk_132:
    v_readlane_b32 s80, v20, s36
    v_readlane_b32 s81, v21, s36
    s_nop 2
    s_add_u32 m0, s74, 0
    s_waitcnt vmcnt(32)
    buffer_load_dwordx4 v8, s[4:7], s80 offen offset:0 nt lds
    v_subrev_u32 v27, 4, v23
    ds_write_b32 v22, v27
    s_waitcnt vmcnt(32)
    buffer_load_dwordx4 v9, s[4:7], s80 offen offset:1024 nt lds
    s_waitcnt vmcnt(32)
    buffer_load_dwordx4 v10, s[4:7], s80 offen offset:2048 nt lds
    s_waitcnt vmcnt(32)
    buffer_load_dwordx4 v11, s[4:7], s80 offen offset:3072 nt lds
    s_add_u32 m0, s74, 4096
    s_waitcnt vmcnt(32)
    buffer_load_dwordx4 v8, s[4:7], s81 offen offset:0 nt lds
    s_waitcnt vmcnt(32)
    buffer_load_dwordx4 v9, s[4:7], s81 offen offset:1024 nt lds
    s_waitcnt vmcnt(32)
    buffer_load_dwordx4 v10, s[4:7], s81 offen offset:2048 nt lds
    s_waitcnt vmcnt(32)
    buffer_load_dwordx4 v11, s[4:7], s81 offen offset:3072 nt lds
    v_add_u32 v23, 1, v23
    s_add_u32 s36, s36, 1
    s_add_u32 s87, s87, 1
    s_add_u32 s74, s74, 32768
    s_add_u32 s83, s70, 2
    s_lshl_b32 s84, s83, 13
    s_and_b32 s84, s84, 16384
    s_cmp_eq_u32 s87, 3
    s_cselect_b32 s87, 0, s87
    s_cselect_b32 s70, s83, s70
    s_cselect_b32 s74, s84, s74
    s_cmp_lt_u32 s36, s68
    s_cbranch_scc1 L_pk_132
L_lp_132:
    s_cmp_ge_u32 s36, s77
    s_cbranch_scc1 L_tl_132
L_lp2_132:
    v_readlane_b32 s34, v20, s75
    v_readlane_b32 s35, v21, s75
    v_readlane_b32 s80, v20, s36
    v_readlane_b32 s81, v21, s36
L_chk_132:
    s_waitcnt lgkmcnt(0)
    v_readlane_b32 s83, v25, s87
    v_readlane_b32 s84, v25, s38
    ds_read_b32 v25, v24
    s_cmp_lt_u32 s39, 4
    s_cselect_b32 s84, s39, s84
    s_cmp_lt_u32 s84, s39
    s_cbranch_scc1 L_chk_132
    s_add_u32 s83, s83, 3
    s_cmp_lt_u32 s83, s70
    s_cbranch_scc1 L_chk_132
    s_add_u32 m0, s74, 0
    s_waitcnt vmcnt(32)
    buffer_load_dwordx4 v8, s[4:7], s80 offen offset:0 nt lds
    v_subrev_u32 v27, 4, v23
    ds_write_b32 v22, v27
    s_waitcnt vmcnt(32)
    buffer_load_dwordx4 v9, s[4:7], s80 offen offset:1024 nt lds
    s_waitcnt vmcnt(32)
    buffer_load_dwordx4 v10, s[4:7], s80 offen offset:2048 nt lds
    s_waitcnt vmcnt(32)
    buffer_load_dwordx4 v11, s[4:7], s80 offen offset:3072 nt lds
    s_add_u32 m0, s74, 4096
    s_waitcnt vmcnt(32)
    buffer_load_dwordx4 v8, s[4:7], s81 offen offset:0 nt lds
    s_waitcnt vmcnt(32)
    buffer_load_dwordx4 v9, s[4:7], s81 offen offset:1024 nt lds
    s_waitcnt vmcnt(32)
    buffer_load_dwordx4 v10, s[4:7], s81 offen offset:2048 nt lds
    s_waitcnt vmcnt(32)
    buffer_load_dwordx4 v11, s[4:7], s81 offen offset:3072 nt lds
    v_add_u32 v23, 1, v23
    s_add_u32 s36, s36, 1
    s_add_u32 s87, s87, 1
    s_add_u32 s74, s74, 32768
    s_add_u32 s83, s70, 2
    s_lshl_b32 s84, s83, 13
    s_and_b32 s84, s84, 16384
    s_cmp_eq_u32 s87, 3
    s_cselect_b32 s87, 0, s87
    s_cselect_b32 s70, s83, s70
    s_cselect_b32 s74, s84, s74
    s_add_u32 m0, s37, 0
    s_waitcnt vmcnt(32)
    buffer_load_dwordx4 v12, s[8:11], s34 offen offset:0 nt lds
    v_subrev_u32 v27, 4, v23
    ds_write_b32 v22, v27
    s_waitcnt vmcnt(32)
    buffer_load_dwordx4 v13, s[8:11], s34 offen offset:1024 nt lds
    s_waitcnt vmcnt(32)
    buffer_load_dwordx4 v14, s[8:11], s34 offen offset:2048 nt lds
    s_waitcnt vmcnt(32)
    buffer_load_dwordx4 v15, s[8:11], s34 offen offset:3072 nt lds
    s_add_u32 m0, s37, 4096
    s_waitcnt vmcnt(32)
    buffer_load_dwordx4 v12, s[8:11], s35 offen offset:0 nt lds
    s_waitcnt vmcnt(32)
    buffer_load_dwordx4 v13, s[8:11], s35 offen offset:1024 nt lds
    s_waitcnt vmcnt(32)
    buffer_load_dwordx4 v14, s[8:11], s35 offen offset:2048 nt lds
    s_waitcnt vmcnt(32)
    buffer_load_dwordx4 v15, s[8:11], s35 offen offset:3072 nt lds
    v_add_u32 v23, 1, v23
    s_add_u32 s75, s75, 1
    s_add_u32 s38, s38, 1
    s_add_u32 s37, s37, 32768
    s_add_u32 s83, s39, 2
    s_lshl_b32 s84, s83, 13
    s_and_b32 s84, s84, 16384
    s_add_u32 s84, s84, 8192
    s_cmp_eq_u32 s38, 3
    s_cselect_b32 s38, 0, s38
    s_cselect_b32 s39, s83, s39
    s_cselect_b32 s37, s84, s37
    s_cmp_lt_u32 s36, s77
    s_cbranch_scc1 L_lp2_132
L_tl_132:
    v_readlane_b32 s34, v20, s75
    v_readlane_b32 s35, v21, s75
L_chv_132:
    s_waitcnt lgkmcnt(0)
    v_readlane_b32 s84, v25, s38
    ds_read_b32 v25, v24
    s_cmp_lt_u32 s39, 4
    s_cselect_b32 s84, s39, s84
    s_cmp_lt_u32 s84, s39
    s_cbranch_scc1 L_chv_132
    s_add_u32 m0, s37, 0
    s_waitcnt vmcnt(31)
    buffer_load_dwordx4 v12, s[8:11], s34 offen offset:0 nt lds
    s_waitcnt vmcnt(31)
    buffer_load_dwordx4 v13, s[8:11], s34 offen offset:1024 nt lds
    s_waitcnt vmcnt(31)
    buffer_load_dwordx4 v14, s[8:11], s34 offen offset:2048 nt lds
    s_waitcnt vmcnt(31)
    buffer_load_dwordx4 v15, s[8:11], s34 offen offset:3072 nt lds
    s_add_u32 m0, s37, 4096
    s_waitcnt vmcnt(31)
    buffer_load_dwordx4 v12, s[8:11], s35 offen offset:0 nt lds
    s_waitcnt vmcnt(31)
    buffer_load_dwordx4 v13, s[8:11], s35 offen offset:1024 nt lds
    s_waitcnt vmcnt(31)
    buffer_load_dwordx4 v14, s[8:11], s35 offen offset:2048 nt lds
    s_waitcnt vmcnt(31)
    buffer_load_dwordx4 v15, s[8:11], s35 offen offset:3072 nt lds
    v_subrev_u32 v27, 3, v23
    ds_write_b32 v22, v27
    v_add_u32 v23, 1, v23
    s_add_u32 s75, s75, 1
    s_add_u32 s38, s38, 1
    s_add_u32 s37, s37, 32768
    s_add_u32 s83, s39, 2
    s_lshl_b32 s84, s83, 13
    s_and_b32 s84, s84, 16384
    s_add_u32 s84, s84, 8192
    s_cmp_eq_u32 s38, 3
    s_cselect_b32 s38, 0, s38
    s_cselect_b32 s39, s83, s39
    s_cselect_b32 s37, s84, s37
    s_cmp_lt_u32 s75, s77
    s_cbranch_scc1 L_tl_132
    s_waitcnt vmcnt(24)
    v_subrev_u32 v27, 3, v23
    ds_write_b32 v22, v27
    s_waitcnt vmcnt(16)
    v_subrev_u32 v27, 2, v23
    ds_write_b32 v22, v27
    s_waitcnt vmcnt(8)
    v_subrev_u32 v27, 1, v23
    ds_write_b32 v22, v27
    s_waitcnt vmcnt(0)
    ds_write_b32 v22, v23
    s_branch L_ldone
L_var_134:
    s_cmp_ge_u32 s36, s68
    s_cbranch_scc1 L_lp_134
L_pk_134:
    v_readlane_b32 s80, v20, s36
    v_readlane_b32 s81, v21, s36
    s_nop 2
    s_add_u32 m0, s74, 0
    s_waitcnt vmcnt(33)
    buffer_load_dwordx4 v8, s[4:7], s80 offen offset:0 nt lds
    s_waitcnt vmcnt(33)
    buffer_load_dwordx4 v9, s[4:7], s80 offen offset:1024 nt lds
    v_subrev_u32 v27, 4, v23
    ds_write_b32 v22, v27
    s_waitcnt vmcnt(33)
    buffer_load_dwordx4 v10, s[4:7], s80 offen offset:2048 nt lds
    s_waitcnt vmcnt(33)
    buffer_load_dwordx4 v11, s[4:7], s80 offen offset:3072 nt lds
    s_add_u32 m0, s74, 4096
    s_waitcnt vmcnt(33)
    buffer_load_dwordx4 v8, s[4:7], s81 offen offset:0 nt lds
    s_waitcnt vmcnt(33)
    buffer_load_dwordx4 v9, s[4:7], s81 offen offset:1024 nt lds
    s_waitcnt vmcnt(33)
    buffer_load_dwordx4 v10, s[4:7], s81 offen offset:2048 nt lds
    s_waitcnt vmcnt(33)
    buffer_load_dwordx4 v11, s[4:7], s81 offen offset:3072 nt lds
    v_add_u32 v23, 1, v23
    s_add_u32 s36, s36, 1
    s_add_u32 s87, s87, 1
    s_add_u32 s74, s74, 32768
    s_add_u32 s83, s70, 2
    s_lshl_b32 s84, s83, 13
    s_and_b32 s84, s84, 16384
    s_cmp_eq_u32 s87, 3
    s_cselect_b32 s87, 0, s87
    s_cselect_b32 s70, s83, s70
    s_cselect_b32 s74, s84, s74
    s_cmp_lt_u32 s36, s68
    s_cbranch_scc1 L_pk_134
L_lp_134:
    s_cmp_ge_u32 s36, s77
    s_cbranch_scc1 L_tl_134
L_lp2_134:
    v_readlane_b32 s34, v20, s75
    v_readlane_b32 s35, v21, s75
    v_readlane_b32 s80, v20, s36
    v_readlane_b32 s81, v21, s36
L_chk_134:
    s_waitcnt lgkmcnt(0)
    v_readlane_b32 s83, v25, s87
    v_readlane_b32 s84, v25, s38
    ds_read_b32 v25, v24
    s_cmp_lt_u32 s39, 4
    s_cselect_b32 s84, s39, s84
    s_cmp_lt_u32 s84, s39
    s_cbranch_scc1 L_chk_134
    s_add_u32 s83, s83, 3
    s_cmp_lt_u32 s83, s70
    s_cbranch_scc1 L_chk_134
    s_add_u32 m0, s74, 0
    s_waitcnt vmcnt(33)
    buffer_load_dwordx4 v8, s[4:7], s80 offen offset:0 nt lds
    s_waitcnt vmcnt(33)
    buffer_load_dwordx4 v9, s[4:7], s80 offen offset:1024 nt lds
    v_subrev_u32 v27, 4, v23
    ds_write_b32 v22, v27
    s_waitcnt vmcnt(33)
    buffer_load_dwordx4 v10, s[4:7], s80 offen offset:2048 nt lds
    s_waitcnt vmcnt(33)
    buffer_load_dwordx4 v11, s[4:7], s80 offen offset:3072 nt lds
    s_add_u32 m0, s74, 4096
    s_waitcnt vmcnt(33)
    buffer_load_dwordx4 v8, s[4:7], s81 offen offset:0 nt lds
    s_waitcnt vmcnt(33)
    buffer_load_dwordx4 v9, s[4:7], s81 offen offset:1024 nt lds
    s_waitcnt vmcnt(33)
    buffer_load_dwordx4 v10, s[4:7], s81 offen offset:2048 nt lds
    s_waitcnt vmcnt(33)
    buffer_load_dwordx4 v11, s[4:7], s81 offen offset:3072 nt lds
    v_add_u32 v23, 1, v23
    s_add_u32 s36, s36, 1
    s_add_u32 s87, s87, 1
    s_add_u32 s74, s74, 32768
    s_add_u32 s83, s70, 2
    s_lshl_b32 s84, s83, 13
    s_and_b32 s84, s84, 16384
    s_cmp_eq_u32 s87, 3
    s_cselect_b32 s87, 0, s87
    s_cselect_b32 s70, s83, s70
    s_cselect_b32 s74, s84, s74
    s_add_u32 m0, s37, 0
    s_waitcnt vmcnt(32)
    buffer_load_dwordx4 v12, s[8:11], s34 offen offset:0 nt lds
    v_subrev_u32 v27, 4, v23
    ds_write_b32 v22, v27
    s_waitcnt vmcnt(32)
    buffer_load_dwordx4 v13, s[8:11], s34 offen offset:1024 nt lds
    s_waitcnt vmcnt(32)
    buffer_load_dwordx4 v14, s[8:11], s34 offen offset:2048 nt lds
    s_waitcnt vmcnt(32)
    buffer_load_dwordx4 v15, s[8:11], s34 offen offset:3072 nt lds
    s_add_u32 m0, s37, 4096
    s_waitcnt vmcnt(32)
    buffer_load_dwordx4 v12, s[8:11], s35 offen offset:0 nt lds
    s_waitcnt vmcnt(32)
    buffer_load_dwordx4 v13, s[8:11], s35 offen offset:1024 nt lds
    s_waitcnt vmcnt(32)
    buffer_load_dwordx4 v14, s[8:11], s35 offen offset:2048 nt lds
    s_waitcnt vmcnt(32)
    buffer_load_dwordx4 v15, s[8:11], s35 offen offset:3072 nt lds
    v_add_u32 v23, 1, v23
    s_add_u32 s75, s75, 1
    s_add_u32 s38, s38, 1
    s_add_u32 s37, s37, 32768
    s_add_u32 s83, s39, 2
    s_lshl_b32 s84, s83, 13
    s_and_b32 s84, s84, 16384
    s_add_u32 s84, s84, 8192
    s_cmp_eq_u32 s38, 3
    s_cselect_b32 s38, 0, s38
    s_cselect_b32 s39, s83, s39
    s_cselect_b32 s37, s84, s37
    s_cmp_lt_u32 s36, s77
    s_cbranch_scc1 L_lp2_134
L_tl_134:
    v_readlane_b32 s34, v20, s75
    v_readlane_b32 s35, v21, s75
L_chv_134:
    s_waitcnt lgkmcnt(0)
    v_readlane_b32 s84, v25, s38
    ds_read_b32 v25, v24
    s_cmp_lt_u32 s39, 4
    s_cselect_b32 s84, s39, s84
    s_cmp_lt_u32 s84, s39
    s_cbranch_scc1 L_chv_134
    s_add_u32 m0, s37, 0
    s_waitcnt vmcnt(31)
    buffer_load_dwordx4 v12, s[8:11], s34 offen offset:0 nt lds
    s_waitcnt vmcnt(31)
    buffer_load_dwordx4 v13, s[8:11], s34 offen offset:1024 nt lds
    s_waitcnt vmcnt(31)
    buffer_load_dwordx4 v14, s[8:11], s34 offen offset:2048 nt lds
    s_waitcnt vmcnt(31)
    buffer_load_dwordx4 v15, s[8:11], s34 offen offset:3072 nt lds
    s_add_u32 m0, s37, 4096
    s_waitcnt vmcnt(31)
    buffer_load_dwordx4 v12, s[8:11], s35 offen offset:0 nt lds
    s_waitcnt vmcnt(31)
    buffer_load_dwordx4 v13, s[8:11], s35 offen offset:1024 nt lds
    s_waitcnt vmcnt(31)
    buffer_load_dwordx4 v14, s[8:11], s35 offen offset:2048 nt lds
    s_waitcnt vmcnt(31)
    buffer_load_dwordx4 v15, s[8:11], s35 offen offset:3072 nt lds
    v_subrev_u32 v27, 3, v23
    ds_write_b32 v22, v27
    v_add_u32 v23, 1, v23
    s_add_u32 s75, s75, 1
    s_add_u32 s38, s38, 1
    s_add_u32 s37, s37, 32768
    s_add_u32 s83, s39, 2
    s_lshl_b32 s84, s83, 13
    s_and_b32 s84, s84, 16384
    s_add_u32 s84, s84, 8192
    s_cmp_eq_u32 s38, 3
    s_cselect_b32 s38, 0, s38
    s_cselect_b32 s39, s83, s39
    s_cselect_b32 s37, s84, s37
    s_cmp_lt_u32 s75, s77
    s_cbranch_scc1 L_tl_134
    s_waitcnt vmcnt(24)
    v_subrev_u32 v27, 3, v23
    ds_write_b32 v22, v27
    s_waitcnt vmcnt(16)
    v_subrev_u32 v27, 2, v23
    ds_write_b32 v22, v27
    s_waitcnt vmcnt(8)
    v_subrev_u32 v27, 1, v23
    ds_write_b32 v22, v27
    s_waitcnt vmcnt(0)
    ds_write_b32 v22, v23
    s_branch L_ldone
L_var_136:
    s_cmp_ge_u32 s36, s68
    s_cbranch_scc1 L_lp_136
L_pk_136:
    v_readlane_b32 s80, v20, s36
    v_readlane_b32 s81, v21, s36
    s_nop 2
    s_add_u32 m0, s74, 0
    s_waitcnt vmcnt(33)
    buffer_load_dwordx4 v8, s[4:7], s80 offen offset:0 nt lds
    s_waitcnt vmcnt(33)
    buffer_load_dwordx4 v9, s[4:7], s80 offen offset:1024 nt lds
    v_subrev_u32 v27, 4, v23
    ds_write_b32 v22, v27
    s_waitcnt vmcnt(33)
    buffer_load_dwordx4 v10, s[4:7], s80 offen offset:2048 nt lds
    s_waitcnt vmcnt(33)
    buffer_load_dwordx4 v11, s[4:7], s80 offen offset:3072 nt lds
    s_add_u32 m0, s74, 4096
    s_waitcnt vmcnt(33)
    buffer_load_dwordx4 v8, s[4:7], s81 offen offset:0 nt lds
    s_waitcnt vmcnt(33)
    buffer_load_dwordx4 v9, s[4:7], s81 offen offset:1024 nt lds
    s_waitcnt vmcnt(33)
    buffer_load_dwordx4 v10, s[4:7], s81 offen offset:2048 nt lds
    s_waitcnt vmcnt(33)
    buffer_load_dwordx4 v11, s[4:7], s81 offen offset:3072 nt lds
    v_add_u32 v23, 1, v23
    s_add_u32 s36, s36, 1
    s_add_u32 s87, s87, 1
    s_add_u32 s74, s74, 32768
    s_add_u32 s83, s70, 2
    s_lshl_b32 s84, s83, 13
    s_and_b32 s84, s84, 16384
    s_cmp_eq_u32 s87, 3
    s_cselect_b32 s87, 0, s87
    s_cselect_b32 s70, s83, s70
    s_cselect_b32 s74, s84, s74
    s_cmp_lt_u32 s36, s68
    s_cbranch_scc1 L_pk_136
L_lp_136:
    s_cmp_ge_u32 s36, s77
    s_cbranch_scc1 L_tl_136
L_lp2_136:
    v_readlane_b32 s34, v20, s75
    v_readlane_b32 s35, v21, s75
    v_readlane_b32 s80, v20, s36
    v_readlane_b32 s81, v21, s36
L_chk_136:
    s_waitcnt lgkmcnt(0)
    v_readlane_b32 s83, v25, s87
    v_readlane_b32 s84, v25, s38
    ds_read_b32 v25, v24
    s_cmp_lt_u32 s39, 4
    s_cselect_b32 s84, s39, s84
    s_cmp_lt_u32 s84, s39
    s_cbranch_scc1 L_chk_136
    s_add_u32 s83, s83, 3
    s_cmp_lt_u32 s83, s70
    s_cbranch_scc1 L_chk_136
    s_add_u32 m0, s74, 0
    s_waitcnt vmcnt(33)
    buffer_load_dwordx4 v8, s[4:7], s80 offen offset:0 nt lds
    s_waitcnt vmcnt(33)
    buffer_load_dwordx4 v9, s[4:7], s80 offen offset:1024 nt lds
    v_subrev_u32 v27, 4, v23
    ds_write_b32 v22, v27
    s_waitcnt vmcnt(33)
    buffer_load_dwordx4 v10, s[4:7], s80 offen offset:2048 nt lds
    s_waitcnt vmcnt(33)
    buffer_load_dwordx4 v11, s[4:7], s80 offen offset:3072 nt lds
    s_add_u32 m0, s74, 4096
    s_waitcnt vmcnt(33)
    buffer_load_dwordx4 v8, s[4:7], s81 offen offset:0 nt lds
    s_waitcnt vmcnt(33)
    buffer_load_dwordx4 v9, s[4:7], s81 offen offset:1024 nt lds
    s_waitcnt vmcnt(33)
    buffer_load_dwordx4 v10, s[4:7], s81 offen offset:2048 nt lds
    s_waitcnt vmcnt(33)
    buffer_load_dwordx4 v11, s[4:7], s81 offen offset:3072 nt lds
    v_add_u32 v23, 1, v23
    s_add_u32 s36, s36, 1
    s_add_u32 s87, s87, 1
    s_add_u32 s74, s74, 32768
    s_add_u32 s83, s70, 2
    s_lshl_b32 s84, s83, 13
    s_and_b32 s84, s84, 16384
    s_cmp_eq_u32 s87, 3
    s_cselect_b32 s87, 0, s87
    s_cselect_b32 s70, s83, s70
    s_cselect_b32 s74, s84, s74
    s_add_u32 m0, s37, 0
    s_waitcnt vmcnt(33)
    buffer_load_dwordx4 v12, s[8:11], s34 offen offset:0 nt lds
    s_waitcnt vmcnt(33)
    buffer_load_dwordx4 v13, s[8:11], s34 offen offset:1024 nt lds
    v_subrev_u32 v27, 4, v23
    ds_write_b32 v22, v27
    s_waitcnt vmcnt(33)
    buffer_load_dwordx4 v14, s[8:11], s34 offen offset:2048 nt lds
    s_waitcnt vmcnt(33)
    buffer_load_dwordx4 v15, s[8:11], s34 offen offset:3072 nt lds
    s_add_u32 m0, s37, 4096
    s_waitcnt vmcnt(33)
    buffer_load_dwordx4 v12, s[8:11], s35 offen offset:0 nt lds
    s_waitcnt vmcnt(33)
    buffer_load_dwordx4 v13, s[8:11], s35 offen offset:1024 nt lds
    s_waitcnt vmcnt(33)
    buffer_load_dwordx4 v14, s[8:11], s35 offen offset:2048 nt lds
    s_waitcnt vmcnt(33)
    buffer_load_dwordx4 v15, s[8:11], s35 offen offset:3072 nt lds
    v_add_u32 v23, 1, v23
    s_add_u32 s75, s75, 1
    s_add_u32 s38, s38, 1
    s_add_u32 s37, s37, 32768
    s_add_u32 s83, s39, 2
    s_lshl_b32 s84, s83, 13
    s_and_b32 s84, s84, 16384
    s_add_u32 s84, s84, 8192
    s_cmp_eq_u32 s38, 3
    s_cselect_b32 s38, 0, s38
    s_cselect_b32 s39, s83, s39
    s_cselect_b32 s37, s84, s37
    s_cmp_lt_u32 s36, s77
    s_cbranch_scc1 L_lp2_136
L_tl_136:
    v_readlane_b32 s34, v20, s75
    v_readlane_b32 s35, v21, s75
L_chv_136:
    s_waitcnt lgkmcnt(0)
    v_readlane_b32 s84, v25, s38
    ds_read_b32 v25, v24
    s_cmp_lt_u32 s39, 4
    s_cselect_b32 s84, s39, s84
    s_cmp_lt_u32 s84, s39
    s_cbranch_scc1 L_chv_136
    s_add_u32 m0, s37, 0
    s_waitcnt vmcnt(31)
    buffer_load_dwordx4 v12, s[8:11], s34 offen offset:0 nt lds
    s_waitcnt vmcnt(31)
    buffer_load_dwordx4 v13, s[8:11], s34 offen offset:1024 nt lds
    s_waitcnt vmcnt(31)
    buffer_load_dwordx4 v14, s[8:11], s34 offen offset:2048 nt lds
    s_waitcnt vmcnt(31)
    buffer_load_dwordx4 v15, s[8:11], s34 offen offset:3072 nt lds
    s_add_u32 m0, s37, 4096
    s_waitcnt vmcnt(31)
    buffer_load_dwordx4 v12, s[8:11], s35 offen offset:0 nt lds
    s_waitcnt vmcnt(31)
    buffer_load_dwordx4 v13, s[8:11], s35 offen offset:1024 nt lds
    s_waitcnt vmcnt(31)
    buffer_load_dwordx4 v14, s[8:11], s35 offen offset:2048 nt lds
    s_waitcnt vmcnt(31)
    buffer_load_dwordx4 v15, s[8:11], s35 offen offset:3072 nt lds
    v_subrev_u32 v27, 3, v23
    ds_write_b32 v22, v27
    v_add_u32 v23, 1, v23
    s_add_u32 s75, s75, 1
    s_add_u32 s38, s38, 1
    s_add_u32 s37, s37, 32768
    s_add_u32 s83, s39, 2
    s_lshl_b32 s84, s83, 13
    s_and_b32 s84, s84, 16384
    s_add_u32 s84, s84, 8192
    s_cmp_eq_u32 s38, 3
    s_cselect_b32 s38, 0, s38
    s_cselect_b32 s39, s83, s39
    s_cselect_b32 s37, s84, s37
    s_cmp_lt_u32 s75, s77
    s_cbranch_scc1 L_tl_136
    s_waitcnt vmcnt(24)
    v_subrev_u32 v27, 3, v23
    ds_write_b32 v22, v27
    s_waitcnt vmcnt(16)
    v_subrev_u32 v27, 2, v23
    ds_write_b32 v22, v27
    s_waitcnt vmcnt(8)
    v_subrev_u32 v27, 1, v23
    ds_write_b32 v22, v27
    s_waitcnt vmcnt(0)
    ds_write_b32 v22, v23
    s_branch L_ldone
L_var_160:
    s_cmp_ge_u32 s36, s68
    s_cbranch_scc1 L_lp_160
L_pk_160:
    v_readlane_b32 s80, v20, s36
    v_readlane_b32 s81, v21, s36
    s_nop 2
    s_add_u32 m0, s74, 0
    s_waitcnt vmcnt(39)
    buffer_load_dwordx4 v8, s[4:7], s80 offen offset:0 nt lds
    s_waitcnt vmcnt(39)
    buffer_load_dwordx4 v9, s[4:7], s80 offen offset:1024 nt lds
    s_waitcnt vmcnt(39)
    buffer_load_dwordx4 v10, s[4:7], s80 offen offset:2048 nt lds
    s_waitcnt vmcnt(39)
    buffer_load_dwordx4 v11, s[4:7], s80 offen offset:3072 nt lds
    s_add_u32 m0, s74, 4096
    s_waitcnt vmcnt(39)
    buffer_load_dwordx4 v8, s[4:7], s81 offen offset:0 nt lds
    s_waitcnt vmcnt(39)
    buffer_load_dwordx4 v9, s[4:7], s81 offen offset:1024 nt lds
    s_waitcnt vmcnt(39)
    buffer_load_dwordx4 v10, s[4:7], s81 offen offset:2048 nt lds
    s_waitcnt vmcnt(39)
    buffer_load_dwordx4 v11, s[4:7], s81 offen offset:3072 nt lds
    v_subrev_u32 v27, 4, v23
    ds_write_b32 v22, v27
    v_add_u32 v23, 1, v23
    s_add_u32 s36, s36, 1
    s_add_u32 s87, s87, 1
    s_add_u32 s74, s74, 32768
    s_add_u32 s83, s70, 2
    s_lshl_b32 s84, s83, 13
    s_and_b32 s84, s84, 16384
    s_cmp_eq_u32 s87, 3
    s_cselect_b32 s87, 0, s87
    s_cselect_b32 s70, s83, s70
    s_cselect_b32 s74, s84, s74
    s_cmp_lt_u32 s36, s68
    s_cbranch_scc1 L_pk_160
L_lp_160:
    s_cmp_ge_u32 s36, s77
    s_cbranch_scc1 L_tl_160
L_lp2_160:
    v_readlane_b32 s34, v20, s75
    v_readlane_b32 s35, v21, s75
    v_readlane_b32 s80, v20, s36
    v_readlane_b32 s81, v21, s36
L_chk_160:
    s_waitcnt lgkmcnt(0)
    v_readlane_b32 s83, v25, s87
    v_readlane_b32 s84, v25, s38
    ds_read_b32 v25, v24
    s_cmp_lt_u32 s39, 4
    s_cselect_b32 s84, s39, s84
    s_cmp_lt_u32 s84, s39
    s_cbranch_scc1 L_chk_160
    s_add_u32 s83, s83, 3
    s_cmp_lt_u32 s83, s70
    s_cbranch_scc1 L_chk_160
    s_add_u32 m0, s74, 0
    s_waitcnt vmcnt(39)
    buffer_load_dwordx4 v8, s[4:7], s80 offen offset:0 nt lds
    s_waitcnt vmcnt(39)
    buffer_load_dwordx4 v9, s[4:7], s80 offen offset:1024 nt lds
    s_waitcnt vmcnt(39)
    buffer_load_dwordx4 v10, s[4:7], s80 offen offset:2048 nt lds
    s_waitcnt vmcnt(39)
    buffer_load_dwordx4 v11, s[4:7], s80 offen offset:3072 nt lds
    s_add_u32 m0, s74, 4096
    s_waitcnt vmcnt(39)
    buffer_load_dwordx4 v8, s[4:7], s81 offen offset:0 nt lds
    s_waitcnt vmcnt(39)
    buffer_load_dwordx4 v9, s[4:7], s81 offen offset:1024 nt lds
    s_waitcnt vmcnt(39)
    buffer_load_dwordx4 v10, s[4:7], s81 offen offset:2048 nt lds
    s_waitcnt vmcnt(39)
    buffer_load_dwordx4 v11, s[4:7], s81 offen offset:3072 nt lds
    v_subrev_u32 v27, 4, v23
    ds_write_b32 v22, v27
    v_add_u32 v23, 1, v23
    s_add_u32 s36, s36, 1
    s_add_u32 s87, s87, 1
    s_add_u32 s74, s74, 32768
    s_add_u32 s83, s70, 2
    s_lshl_b32 s84, s83, 13
    s_and_b32 s84, s84, 16384
    s_cmp_eq_u32 s87, 3
    s_cselect_b32 s87, 0, s87
    s_cselect_b32 s70, s83, s70
    s_cselect_b32 s74, s84, s74
    s_add_u32 m0, s37, 0
    s_waitcnt vmcnt(39)
    buffer_load_dwordx4 v12, s[8:11], s34 offen offset:0 nt lds
    s_waitcnt vmcnt(39)
    buffer_load_dwordx4 v13, s[8:11], s34 offen offset:1024 nt lds
    s_waitcnt vmcnt(39)
    buffer_load_dwordx4 v14, s[8:11], s34 offen offset:2048 nt lds
    s_waitcnt vmcnt(39)
    buffer_load_dwordx4 v15, s[8:11], s34 offen offset:3072 nt lds
    s_add_u32 m0, s37, 4096
    s_waitcnt vmcnt(39)
    buffer_load_dwordx4 v12, s[8:11], s35 offen offset:0 nt lds
    s_waitcnt vmcnt(39)
    buffer_load_dwordx4 v13, s[8:11], s35 offen offset:1024 nt lds
    s_waitcnt vmcnt(39)
    buffer_load_dwordx4 v14, s[8:11], s35 offen offset:2048 nt lds
    s_waitcnt vmcnt(39)
    buffer_load_dwordx4 v15, s[8:11], s35 offen offset:3072 nt lds
    v_subrev_u32 v27, 4, v23
    ds_write_b32 v22, v27
    v_add_u32 v23, 1, v23
    s_add_u32 s75, s75, 1
    s_add_u32 s38, s38, 1
    s_add_u32 s37, s37, 32768
    s_add_u32 s83, s39, 2
    s_lshl_b32 s84, s83, 13
    s_and_b32 s84, s84, 16384
    s_add_u32 s84, s84, 8192
    s_cmp_eq_u32 s38, 3
    s_cselect_b32 s38, 0, s38
    s_cselect_b32 s39, s83, s39
    s_cselect_b32 s37, s84, s37
    s_cmp_lt_u32 s36, s77
    s_cbranch_scc1 L_lp2_160
L_tl_160:
    v_readlane_b32 s34, v20, s75
    v_readlane_b32 s35, v21, s75
L_chv_160:
    s_waitcnt lgkmcnt(0)
    v_readlane_b32 s84, v25, s38
    ds_read_b32 v25, v24
    s_cmp_lt_u32 s39, 4
    s_cselect_b32 s84, s39, s84
    s_cmp_lt_u32 s84, s39
    s_cbranch_scc1 L_chv_160
    s_add_u32 m0, s37, 0
    s_waitcnt vmcnt(31)
    buffer_load_dwordx4 v12, s[8:11], s34 offen offset:0 nt lds
    s_waitcnt vmcnt(31)
    buffer_load_dwordx4 v13, s[8:11], s34 offen offset:1024 nt lds
    s_waitcnt vmcnt(31)
    buffer_load_dwordx4 v14, s[8:11], s34 offen offset:2048 nt lds
    s_waitcnt vmcnt(31)
    buffer_load_dwordx4 v15, s[8:11], s34 offen offset:3072 nt lds
    s_add_u32 m0, s37, 4096
    s_waitcnt vmcnt(31)
    buffer_load_dwordx4 v12, s[8:11], s35 offen offset:0 nt lds
    s_waitcnt vmcnt(31)
    buffer_load_dwordx4 v13, s[8:11], s35 offen offset:1024 nt lds
    s_waitcnt vmcnt(31)
    buffer_load_dwordx4 v14, s[8:11], s35 offen offset:2048 nt lds
    s_waitcnt vmcnt(31)
    buffer_load_dwordx4 v15, s[8:11], s35 offen offset:3072 nt lds
    v_subrev_u32 v27, 3, v23
    ds_write_b32 v22, v27
    v_add_u32 v23, 1, v23
    s_add_u32 s75, s75, 1
    s_add_u32 s38, s38, 1
    s_add_u32 s37, s37, 32768
    s_add_u32 s83, s39, 2
    s_lshl_b32 s84, s83, 13
    s_and_b32 s84, s84, 16384
    s_add_u32 s84, s84, 8192
    s_cmp_eq_u32 s38, 3
    s_cselect_b32 s38, 0, s38
    s_cselect_b32 s39, s83, s39
    s_cselect_b32 s37, s84, s37
    s_cmp_lt_u32 s75, s77
    s_cbranch_scc1 L_tl_160
    s_waitcnt vmcnt(24)
    v_subrev_u32 v27, 3, v23
    ds_write_b32 v22, v27
    s_waitcnt vmcnt(16)
    v_subrev_u32 v27, 2, v23
    ds_write_b32 v22, v27
    s_waitcnt vmcnt(8)
    v_subrev_u32 v27, 1, v23
    ds_write_b32 v22, v27
    s_waitcnt vmcnt(0)
    ds_write_b32 v22, v23
    s_branch L_ldone
L_ldone:
    s_branch L_red_d
L_ljob:
    s_lshl_b32 s74, s58, 15
    s_mov_b32 s36, s53
    s_mov_b32 s87, s58
    s_mov_b32 s70, 0
    s_min_u32 s68, s67, 4
    s_add_u32 s83, s68, 2
    v_mov_b32 v23, s83
    s_add_u32 s68, s68, s53
L_burst1:
    v_readlane_b32 s80, v20, s36
    v_readlane_b32 s81, v21, s36
    s_nop 2
    s_add_u32 m0, s74, 0
    s_nop 0
    buffer_load_dwordx4 v8, s[4:7], s80 offen offset:0 nt lds
    buffer_load_dwordx4 v9, s[4:7], s80 offen offset:1024 nt lds
    buffer_load_dwordx4 v10, s[4:7], s80 offen offset:2048 nt lds
    buffer_load_dwordx4 v11, s[4:7], s80 offen offset:3072 nt lds
    s_add_u32 m0, s74, 4096
    s_nop 0
    buffer_load_dwordx4 v8, s[4:7], s81 offen offset:0 nt lds
    buffer_load_dwordx4 v9, s[4:7], s81 offen offset:1024 nt lds
    buffer_load_dwordx4 v10, s[4:7], s81 offen offset:2048 nt lds
    buffer_load_dwordx4 v11, s[4:7], s81 offen offset:3072 nt lds
    s_add_u32 s36, s36, 1
    s_add_u32 s87, s87, 1
    s_add_u32 s74, s74, 32768
    s_add_u32 s83, s70, 2
    s_lshl_b32 s84, s83, 13
    s_and_b32 s84, s84, 16384
    s_cmp_eq_u32 s87, 3
    s_cselect_b32 s87, 0, s87
    s_cselect_b32 s70, s83, s70
    s_cselect_b32 s74, s84, s74
    s_cmp_lt_u32 s36, s68
    s_cbranch_scc1 L_burst1
    s_mov_b32 s75, s53
    s_mov_b32 s38, s58
    s_mov_b32 s39, 0
    s_lshl_b32 s37, s58, 15
    s_add_u32 s37, s37, 8192
    s_branch L_lgo
L_consumer:
    s_and_b32 s81, s3, 30
    s_lshl_b32 s81, s81, 2
    v_lshlrev_b32 v22, 2, v1
    v_add_u32 v22, 114688, v22
    s_sub_u32 s87, s66, 1
    s_lshl_b32 s74, s87, 15
    v_lshrrev_b32 v3, 5, v1
    v_and_b32 v4, 31, v1
    s_add_u32 s86, s87, 0
    s_lshl_b32 s83, s86, 8
    s_add_u32 s83, s83, 1024
    v_add_u32 v26, s83, v22
    v_lshrrev_b32 v48, 2, v47
    v_lshl_add_u32 v49, v3, 2, v48
    v_lshlrev_b32 v49, 8, v49
    v_and_b32 v50, 1, v46
    v_lshl_add_u32 v49, v50, 5, v49
    v_and_b32 v50, 3, v1
    v_lshl_add_u32 v49, v50, 3, v49
    v_add_u32 v49, s74, v49
    v_add_u32 v49, 8192, v49
    v_xor_b32 v50, 0, v48
    v_lshl_add_u32 v16, v50, 6, v49
    v_xor_b32 v50, 1, v48
    v_lshl_add_u32 v17, v50, 6, v49
    v_xor_b32 v50, 2, v48
    v_lshl_add_u32 v18, v50, 6, v49
    v_xor_b32 v50, 3, v48
    v_lshl_add_u32 v19, v50, 6, v49
    s_waitcnt lgkmcnt(0)
    s_load_dwordx2 s[40:41], s[24:25], s81
    s_mov_b32 s12, s26
    s_mov_b32 s13, s27
    s_mov_b32 s14, 4194304
    s_mov_b32 s15, 0x20000
    s_mov_b32 s4, s18
    s_mov_b32 s5, s19
    s_mov_b32 s6, 134348800
    s_mov_b32 s7, 0x20000
    s_mov_b32 s8, s20
    s_mov_b32 s9, s21
    s_mov_b32 s10, 134348800
    s_mov_b32 s11, 0x20000
    s_cmp_eq_u32 s86, 0
    s_cselect_b32 s82, 3, 5
    s_mov_b32 s76, s82
    v_lshrrev_b32 v48, 2, v47
    v_and_b32 v49, 3, v47
    v_lshl_add_u32 v48, v48, 3, v49
    v_lshlrev_b32 v48, 10, v48
    v_xor_b32 v49, v46, v47
    s_add_u32 s79, s82, 0
    s_and_b32 s83, s79, 3
    s_lshl_b32 s83, s83, 2
    v_xor_b32 v50, s83, v49
    v_lshl_add_u32 v50, v50, 4, v48
    s_bfe_u32 s84, s79, 0x10002
    s_lshl_b32 s84, s84, 8
    v_add_u32 v52, s84, v50
    s_add_u32 s79, s82, 1
    s_and_b32 s83, s79, 3
    s_lshl_b32 s83, s83, 2
    v_xor_b32 v50, s83, v49
    v_lshl_add_u32 v50, v50, 4, v48
    s_bfe_u32 s84, s79, 0x10002
    s_lshl_b32 s84, s84, 8
    v_add_u32 v53, s84, v50
    s_add_u32 s79, s82, 2
    s_and_b32 s83, s79, 3
    s_lshl_b32 s83, s83, 2
    v_xor_b32 v50, s83, v49
    v_lshl_add_u32 v50, v50, 4, v48
    s_bfe_u32 s84, s79, 0x10002
    s_lshl_b32 s84, s84, 8
    v_add_u32 v54, s84, v50
    v_lshlrev_b32 v58, 3, v1
    v_add_u32 v58, 116736, v58
    s_lshl_b32 s83, s82, 6
    s_add_u32 s83, s83, 118784
    v_lshl_add_u32 v57, v46, 4, s83
    v_min_u32 v59, 3, v1
    v_lshlrev_b32 v59, 8, v59
    v_add_u32 v59, 115712, v59
    s_lshl_b32 s83, s82, 10
    s_add_u32 s78, s85, s83
    s_add_u32 s79, s78, 8192
    v_lshlrev_b32 v60, 4, v1
    v_and_b32 v48, 15, v4
    v_xor_b32 v48, v48, v3
    v_lshlrev_b32 v49, 8, v4
    v_xor_b32 v50, 0, v48
    v_lshl_add_u32 v50, v50, 4, v49
    v_add_u32 v8, s74, v50
    v_xor_b32 v50, 2, v48
    v_lshl_add_u32 v50, v50, 4, v49
    v_add_u32 v9, s74, v50
    v_xor_b32 v50, 4, v48
    v_lshl_add_u32 v50, v50, 4, v49
    v_add_u32 v10, s74, v50
    v_xor_b32 v50, 6, v48
    v_lshl_add_u32 v50, v50, 4, v49
    v_add_u32 v11, s74, v50
    v_xor_b32 v50, 8, v48
    v_lshl_add_u32 v50, v50, 4, v49
    v_add_u32 v12, s74, v50
    v_xor_b32 v50, 10, v48
    v_lshl_add_u32 v50, v50, 4, v49
    v_add_u32 v13, s74, v50
    v_xor_b32 v50, 12, v48
    v_lshl_add_u32 v50, v50, 4, v49
    v_add_u32 v14, s74, v50
    v_xor_b32 v50, 14, v48
    v_lshl_add_u32 v50, v50, 4, v49
    v_add_u32 v15, s74, v50
    s_lshl_b32 s83, s66, 8
    v_add_u32 v24, s83, v22
    v_mov_b32 v27, 0xd028965f
    s_mov_b32 s73, 0x3e0293ee
    s_mov_b32 s38, s73
    s_mov_b32 s39, s73
    s_waitcnt lgkmcnt(0)
    s_max_i32 s40, s40, 0
    s_min_i32 s40, s40, 2048
    s_max_i32 s41, s41, 0
    s_min_i32 s41, s41, 2048
    s_bitcmp1_b32 s3, 0
    s_cselect_b32 s54, s41, s40
    s_cselect_b32 s83, s40, s41
    s_cmp_eq_u32 s54, 0
    s_cselect_b32 s60, 2048, s54
    s_bfe_u32 s82, s85, 0x2000e
    s_cmp_eq_u32 s82, 1
    s_cselect_b32 s63, s54, s83
    s_cselect_b32 s83, s83, s54
    s_cselect_b32 s52, 2, 1
    s_cselect_b32 s84, 1700, -1
    s_bitcmp1_b32 s82, 0
    s_cselect_b32 s52, s52, 0
    s_cmp_lt_u32 s63, 1800
    s_cselect_b32 s52, 0, s52
    s_sub_u32 s83, s83, 1
    s_cmp_ge_u32 s83, 1700
    s_cselect_b32 s52, 0, s52
    s_cmp_ge_u32 s60, s84
    s_cselect_b32 s60, 4096, s60
    s_mov_b32 s61, 98304
    s_xor_b32 s84, s3, 1
    s_cmp_eq_u32 s52, 2
    s_cselect_b32 s84, s3, s84
    s_lshl1_add_u32 s57, s84, s2
    s_and_b32 s57, s57, 7
    s_lshr_b32 s56, s57, 2
    s_lshl1_add_u32 s56, s84, s56
    s_bfe_u32 s55, s85, 0x3000e
    s_sub_u32 s55, s57, s55
    s_lshl_b32 s55, s55, 8
    s_lshl3_add_u32 s57, s84, s57
    s_lshl_b32 s57, s57, 14
    s_add_u32 s84, s63, -1665
    s_lshr_b32 s84, s84, 5
    s_and_b32 s84, s84, 63
    s_mul_i32 s46, s84, 171
    s_lshr_b32 s46, s46, 9
    s_mul_i32 s46, s46, 3
    s_sub_u32 s46, s84, s46
    s_add_u32 s46, s46, 53
    s_lshl_b32 s84, s46, 5
    s_sub_u32 s84, s63, s84
    s_add_u32 s84, s84, s60
    s_mul_i32 s84, s84, 312
    s_lshr_b32 s84, s84, 8
    s_cmp_eq_u32 s52, 1
    s_cselect_b32 s60, s84, s60
    s_cselect_b32 s64, s63, s54
    s_cselect_b32 s53, s46, 0
    s_cselect_b32 s61, 119808, s61
    s_mov_b32 s62, 0
    s_lshl_b32 s83, s56, 2
    v_mov_b32 v62, s83
    s_lshl_b32 s83, s52, 2
    s_add_u32 s83, s83, s86
    s_cmp_eq_u32 s83, 10
    s_addc_u32 s62, 0, 0
    s_barrier
L_cjob:
    s_cmp_eq_u32 s64, 0
    s_cselect_b32 s65, 2048, s64
    s_add_u32 s77, s65, 31
    s_lshr_b32 s77, s77, 5
    s_cmp_eq_u32 s52, 2
    s_cselect_b32 s77, s46, s77
    s_sub_u32 s67, s77, s53
    s_sub_u32 s83, s67, 1
    s_mul_i32 s84, s83, 171
    s_lshr_b32 s84, s84, 9
    s_mul_i32 s84, s84, 3
    s_sub_u32 s83, s83, s84
    s_sub_u32 s58, 5, s83
    s_cmp_ge_u32 s58, 3
    s_cselect_b32 s84, 3, 0
    s_sub_u32 s58, s58, s84
    v_mov_b32 v29, 0xff61b1e6
    v_mov_b32 v30, 0
    v_mov_b32 v31, 0
    s_sub_u32 s83, s61, s74
    v_add_u32 v96, s83, v8
    v_add_u32 v97, s83, v9
    v_add_u32 v98, s83, v10
    v_add_u32 v99, s83, v11
    v_add_u32 v100, s83, v12
    v_add_u32 v101, s83, v13
    v_add_u32 v102, s83, v14
    v_add_u32 v103, s83, v15
    v_pk_mul_f32 v[128:129], v[30:31], v[30:31]
    v_pk_mul_f32 v[130:131], v[30:31], v[30:31]
    v_pk_mul_f32 v[132:133], v[30:31], v[30:31]
    v_pk_mul_f32 v[134:135], v[30:31], v[30:31]
    v_pk_mul_f32 v[136:137], v[30:31], v[30:31]
    v_pk_mul_f32 v[138:139], v[30:31], v[30:31]
    v_pk_mul_f32 v[140:141], v[30:31], v[30:31]
    v_pk_mul_f32 v[142:143], v[30:31], v[30:31]
    v_pk_mul_f32 v[144:145], v[30:31], v[30:31]
    v_pk_mul_f32 v[146:147], v[30:31], v[30:31]
    v_pk_mul_f32 v[148:149], v[30:31], v[30:31]
    v_pk_mul_f32 v[150:151], v[30:31], v[30:31]
    v_pk_mul_f32 v[152:153], v[30:31], v[30:31]
    v_pk_mul_f32 v[154:155], v[30:31], v[30:31]
    v_pk_mul_f32 v[156:157], v[30:31], v[30:31]
    v_pk_mul_f32 v[158:159], v[30:31], v[30:31]
    v_pk_mul_f32 v[160:161], v[30:31], v[30:31]
    v_pk_mul_f32 v[162:163], v[30:31], v[30:31]
    v_pk_mul_f32 v[164:165], v[30:31], v[30:31]
    v_pk_mul_f32 v[166:167], v[30:31], v[30:31]
    v_pk_mul_f32 v[168:169], v[30:31], v[30:31]
    v_pk_mul_f32 v[170:171], v[30:31], v[30:31]
    v_pk_mul_f32 v[172:173], v[30:31], v[30:31]
    v_pk_mul_f32 v[174:175], v[30:31], v[30:31]
    v_pk_mul_f32 v[176:177], v[30:31], v[30:31]
    v_pk_mul_f32 v[178:179], v[30:31], v[30:31]
    v_pk_mul_f32 v[180:181], v[30:31], v[30:31]
    v_pk_mul_f32 v[182:183], v[30:31], v[30:31]
    v_pk_mul_f32 v[184:185], v[30:31], v[30:31]
    v_pk_mul_f32 v[186:187], v[30:31], v[30:31]
    v_pk_mul_f32 v[188:189], v[30:31], v[30:31]
    v_pk_mul_f32 v[190:191], v[30:31], v[30:31]
    v_pk_mul_f32 v[192:193], v[30:31], v[30:31]
    v_pk_mul_f32 v[194:195], v[30:31], v[30:31]
    v_pk_mul_f32 v[196:197], v[30:31], v[30:31]
    v_pk_mul_f32 v[198:199], v[30:31], v[30:31]
    v_pk_mul_f32 v[200:201], v[30:31], v[30:31]
    v_pk_mul_f32 v[202:203], v[30:31], v[30:31]
    v_pk_mul_f32 v[204:205], v[30:31], v[30:31]
    v_pk_mul_f32 v[206:207], v[30:31], v[30:31]
    v_pk_mul_f32 v[208:209], v[30:31], v[30:31]
    v_pk_mul_f32 v[210:211], v[30:31], v[30:31]
    v_pk_mul_f32 v[212:213], v[30:31], v[30:31]
    v_pk_mul_f32 v[214:215], v[30:31], v[30:31]
    v_pk_mul_f32 v[216:217], v[30:31], v[30:31]
    v_pk_mul_f32 v[218:219], v[30:31], v[30:31]
    v_pk_mul_f32 v[220:221], v[30:31], v[30:31]
    v_pk_mul_f32 v[222:223], v[30:31], v[30:31]
    v_pk_mul_f32 v[224:225], v[30:31], v[30:31]
    v_pk_mul_f32 v[226:227], v[30:31], v[30:31]
    v_pk_mul_f32 v[228:229], v[30:31], v[30:31]
    v_pk_mul_f32 v[230:231], v[30:31], v[30:31]
    v_pk_mul_f32 v[232:233], v[30:31], v[30:31]
    v_pk_mul_f32 v[234:235], v[30:31], v[30:31]
    v_pk_mul_f32 v[236:237], v[30:31], v[30:31]
    v_pk_mul_f32 v[238:239], v[30:31], v[30:31]
    v_pk_mul_f32 v[240:241], v[30:31], v[30:31]
    v_pk_mul_f32 v[242:243], v[30:31], v[30:31]
    v_pk_mul_f32 v[244:245], v[30:31], v[30:31]
    v_pk_mul_f32 v[246:247], v[30:31], v[30:31]
    v_pk_mul_f32 v[248:249], v[30:31], v[30:31]
    v_pk_mul_f32 v[250:251], v[30:31], v[30:31]
    v_pk_mul_f32 v[252:253], v[30:31], v[30:31]
    v_pk_mul_f32 v[254:255], v[30:31], v[30:31]
    s_add_u32 s59, s67, 3
    s_sub_u32 s69, s67, 1
    s_sub_u32 s83, s77, 1
    s_lshl_b32 s83, s83, 5
    s_sub_i32 s70, s64, s83
    s_cmp_eq_u32 s64, 0
    s_cselect_b32 s69, 0, s69
    v_lshrrev_b32 v48, 5, v1
    v_lshlrev_b32 v48, 2, v48
    v_sub_u32 v28, s70, v48
    s_sub_u32 s75, s87, s58
    s_cmp_lt_u32 s87, s58
    s_cselect_b32 s83, 3, 0
    s_addc_u32 s47, 0, 0
    s_add_u32 s75, s75, s83
    v_mov_b32 v23, s47
    ds_write_b32 v24, v23
    s_lshl_b32 s83, s47, 1
    s_add_u32 s83, s83, 1
    v_mov_b32 v23, s83
    s_cmp_ge_u32 s75, s67
    s_cbranch_scc1 L_notiles
    s_mov_b32 s71, 0
    s_mov_b32 s72, 2
    s_cmp_ge_i32 s71, s72
    s_cbranch_scc0 L_poll_q
L_ok_q:
    ds_read_b128 a[0:3], v96 offset:0
    ds_read_b128 a[4:7], v97 offset:0
    ds_read_b128 a[8:11], v98 offset:0
    ds_read_b128 a[12:15], v99 offset:0
    ds_read_b128 a[16:19], v100 offset:0
    ds_read_b128 a[20:23], v101 offset:0
    ds_read_b128 a[24:27], v102 offset:0
    ds_read_b128 a[28:31], v103 offset:0
    s_waitcnt lgkmcnt(4)
    ds_read_b128 a[32:35], v96 offset:8192
    ds_read_b128 a[36:39], v97 offset:8192
    ds_read_b128 a[40:43], v98 offset:8192
    ds_read_b128 a[44:47], v99 offset:8192
    ds_read_b128 a[48:51], v100 offset:8192
    ds_read_b128 a[52:55], v101 offset:8192
    ds_read_b128 a[56:59], v102 offset:8192
    ds_read_b128 a[60:63], v103 offset:8192
    s_lshl_b32 s72, s75, 1
    s_add_i32 s72, s72, -2
    s_add_u32 s83, s75, 3
    s_max_i32 s72, s72, s83
    s_waitcnt lgkmcnt(0)
    s_cmp_ge_i32 s71, s72
    s_cbranch_scc0 L_poll_k0
L_ok_k0:
    s_cmp_eq_u32 s47, 1
    s_cbranch_scc1 L_start_b
    ds_read_b128 a[64:67], v8 offset:0
    ds_read_b128 a[68:71], v9 offset:0
    ds_read_b128 a[72:75], v10 offset:0
    ds_read_b128 a[76:79], v11 offset:0
    ds_read_b128 a[80:83], v12 offset:0
    ds_read_b128 a[84:87], v13 offset:0
    ds_read_b128 a[88:91], v14 offset:0
    ds_read_b128 a[92:95], v15 offset:0
    s_waitcnt lgkmcnt(7)
    v_mfma_f32_32x32x16_bf16 v[96:111], a[64:67], a[0:3], 0
    v_mfma_f32_32x32x16_bf16 v[112:127], a[64:67], a[32:35], 0
    s_waitcnt lgkmcnt(6)
    v_mfma_f32_32x32x16_bf16 v[96:111], a[68:71], a[4:7], v[96:111]
    v_mfma_f32_32x32x16_bf16 v[112:127], a[68:71], a[36:39], v[112:127]
    s_waitcnt lgkmcnt(5)
    v_mfma_f32_32x32x16_bf16 v[96:111], a[72:75], a[8:11], v[96:111]
    v_mfma_f32_32x32x16_bf16 v[112:127], a[72:75], a[40:43], v[112:127]
    s_waitcnt lgkmcnt(4)
    v_mfma_f32_32x32x16_bf16 v[96:111], a[76:79], a[12:15], v[96:111]
    v_mfma_f32_32x32x16_bf16 v[112:127], a[76:79], a[44:47], v[112:127]
    s_waitcnt lgkmcnt(0)
    ds_write_b32 v24, v23
    v_mfma_f32_32x32x16_bf16 v[96:111], a[80:83], a[16:19], v[96:111]
    v_mfma_f32_32x32x16_bf16 v[112:127], a[80:83], a[48:51], v[112:127]
    v_mfma_f32_32x32x16_bf16 v[96:111], a[84:87], a[20:23], v[96:111]
    v_mfma_f32_32x32x16_bf16 v[112:127], a[84:87], a[52:55], v[112:127]
    v_mfma_f32_32x32x16_bf16 v[96:111], a[88:91], a[24:27], v[96:111]
    v_mfma_f32_32x32x16_bf16 v[112:127], a[88:91], a[56:59], v[112:127]
    v_mfma_f32_32x32x16_bf16 v[96:111], a[92:95], a[28:31], v[96:111]
    v_mfma_f32_32x32x16_bf16 v[112:127], a[92:95], a[60:63], v[112:127]
    s_nop 7
    s_nop 1
    s_cmp_lt_u32 s75, s69
    s_cbranch_scc0 L_mask_fa
L_nomask_fa:
    v_max3_f32 v32, v96, v97, v98
    v_max3_f32 v33, v112, v113, v114
    v_max3_f32 v32, v32, v99, v100
    v_max3_f32 v33, v33, v115, v116
    v_max3_f32 v32, v32, v101, v102
    v_max3_f32 v33, v33, v117, v118
    v_max3_f32 v32, v32, v103, v104
    v_max3_f32 v33, v33, v119, v120
    v_max3_f32 v32, v32, v105, v106
    v_max3_f32 v33, v33, v121, v122
    v_max3_f32 v32, v32, v107, v108
    v_max3_f32 v33, v33, v123, v124
    v_max3_f32 v32, v32, v109, v110
    v_max3_f32 v33, v33, v125, v126
    v_max_f32 v32, v32, v111
    v_max_f32 v33, v33, v127
    v_add_u32 v23, 1, v23
    s_nop 0
    v_permlane32_swap_b32 v32, v33
    v_max_f32 v32, v32, v33
    v_mul_f32 v32, s73, v32
    v_max_f32 v34, v29, v32
    v_sub_f32 v33, v29, v34
    v_mov_b32 v36, v34
    v_exp_f32 v38, v33
    v_mov_b32 v29, v34
    v_permlane32_swap_b32 v34, v36
    v_mov_b32 v40, v38
    v_pk_fma_f32 v[96:97], v[96:97], s[38:39], v[34:35] op_sel_hi:[1,1,0] neg_lo:[0,0,1] neg_hi:[0,0,1]
    v_pk_fma_f32 v[112:113], v[112:113], s[38:39], v[36:37] op_sel_hi:[1,1,0] neg_lo:[0,0,1] neg_hi:[0,0,1]
    v_permlane32_swap_b32 v38, v40
    v_pk_fma_f32 v[98:99], v[98:99], s[38:39], v[34:35] op_sel_hi:[1,1,0] neg_lo:[0,0,1] neg_hi:[0,0,1]
    v_pk_fma_f32 v[114:115], v[114:115], s[38:39], v[36:37] op_sel_hi:[1,1,0] neg_lo:[0,0,1] neg_hi:[0,0,1]
    v_pk_fma_f32 v[100:101], v[100:101], s[38:39], v[34:35] op_sel_hi:[1,1,0] neg_lo:[0,0,1] neg_hi:[0,0,1]
    v_pk_fma_f32 v[116:117], v[116:117], s[38:39], v[36:37] op_sel_hi:[1,1,0] neg_lo:[0,0,1] neg_hi:[0,0,1]
    v_pk_fma_f32 v[102:103], v[102:103], s[38:39], v[34:35] op_sel_hi:[1,1,0] neg_lo:[0,0,1] neg_hi:[0,0,1]
    v_pk_fma_f32 v[118:119], v[118:119], s[38:39], v[36:37] op_sel_hi:[1,1,0] neg_lo:[0,0,1] neg_hi:[0,0,1]
    v_pk_fma_f32 v[104:105], v[104:105], s[38:39], v[34:35] op_sel_hi:[1,1,0] neg_lo:[0,0,1] neg_hi:[0,0,1]
    v_pk_fma_f32 v[120:121], v[120:121], s[38:39], v[36:37] op_sel_hi:[1,1,0] neg_lo:[0,0,1] neg_hi:[0,0,1]
    v_pk_fma_f32 v[106:107], v[106:107], s[38:39], v[34:35] op_sel_hi:[1,1,0] neg_lo:[0,0,1] neg_hi:[0,0,1]
    v_pk_fma_f32 v[122:123], v[122:123], s[38:39], v[36:37] op_sel_hi:[1,1,0] neg_lo:[0,0,1] neg_hi:[0,0,1]
    v_pk_fma_f32 v[108:109], v[108:109], s[38:39], v[34:35] op_sel_hi:[1,1,0] neg_lo:[0,0,1] neg_hi:[0,0,1]
    v_pk_fma_f32 v[124:125], v[124:125], s[38:39], v[36:37] op_sel_hi:[1,1,0] neg_lo:[0,0,1] neg_hi:[0,0,1]
    v_pk_fma_f32 v[110:111], v[110:111], s[38:39], v[34:35] op_sel_hi:[1,1,0] neg_lo:[0,0,1] neg_hi:[0,0,1]
    v_pk_fma_f32 v[126:127], v[126:127], s[38:39], v[36:37] op_sel_hi:[1,1,0] neg_lo:[0,0,1] neg_hi:[0,0,1]
    v_exp_f32 v96, v96
    v_exp_f32 v112, v112
    v_exp_f32 v97, v97
    v_exp_f32 v113, v113
    v_exp_f32 v98, v98
    v_exp_f32 v114, v114
    v_exp_f32 v99, v99
    v_exp_f32 v115, v115
    v_exp_f32 v100, v100
    v_exp_f32 v116, v116
    v_exp_f32 v101, v101
    v_exp_f32 v117, v117
    v_exp_f32 v102, v102
    v_exp_f32 v118, v118
    v_exp_f32 v103, v103
    v_exp_f32 v119, v119
    v_exp_f32 v104, v104
    v_exp_f32 v120, v120
    v_exp_f32 v105, v105
    v_exp_f32 v121, v121
    v_exp_f32 v106, v106
    v_exp_f32 v122, v122
    v_exp_f32 v107, v107
    v_exp_f32 v123, v123
    v_exp_f32 v108, v108
    v_exp_f32 v124, v124
    v_exp_f32 v109, v109
    v_exp_f32 v125, v125
    v_exp_f32 v110, v110
    v_exp_f32 v126, v126
    v_exp_f32 v111, v111
    v_exp_f32 v127, v127
    ds_read_b32 v25, v22
    v_cvt_pk_bf16_f32 v64, v96, v97
    v_cvt_pk_bf16_f32 v72, v112, v113
    v_cvt_pk_bf16_f32 v65, v98, v99
    v_cvt_pk_bf16_f32 v73, v114, v115
    v_cvt_pk_bf16_f32 v66, v100, v101
    v_cvt_pk_bf16_f32 v74, v116, v117
    v_cvt_pk_bf16_f32 v67, v102, v103
    v_cvt_pk_bf16_f32 v75, v118, v119
    v_cvt_pk_bf16_f32 v68, v104, v105
    v_cvt_pk_bf16_f32 v76, v120, v121
    v_cvt_pk_bf16_f32 v69, v106, v107
    v_cvt_pk_bf16_f32 v77, v122, v123
    v_cvt_pk_bf16_f32 v70, v108, v109
    v_cvt_pk_bf16_f32 v78, v124, v125
    v_cvt_pk_bf16_f32 v71, v110, v111
    v_cvt_pk_bf16_f32 v79, v126, v127
    v_pk_add_f32 v[48:49], v[96:97], v[98:99]
    v_pk_add_f32 v[50:51], v[112:113], v[114:115]
    v_pk_add_f32 v[48:49], v[48:49], v[100:101]
    v_pk_add_f32 v[50:51], v[50:51], v[116:117]
    v_pk_add_f32 v[48:49], v[48:49], v[102:103]
    v_pk_add_f32 v[50:51], v[50:51], v[118:119]
    v_pk_add_f32 v[48:49], v[48:49], v[104:105]
    v_pk_add_f32 v[50:51], v[50:51], v[120:121]
    v_pk_add_f32 v[48:49], v[48:49], v[106:107]
    v_pk_add_f32 v[50:51], v[50:51], v[122:123]
    v_pk_add_f32 v[48:49], v[48:49], v[108:109]
    v_pk_add_f32 v[50:51], v[50:51], v[124:125]
    v_pk_add_f32 v[48:49], v[48:49], v[110:111]
    v_pk_add_f32 v[50:51], v[50:51], v[126:127]
    v_fma_f32 v30, v30, v38, v48
    v_fma_f32 v31, v31, v40, v50
    v_add_f32 v30, v30, v49
    v_add_f32 v31, v31, v51
    v_add_u32 v23, 1, v23
    s_lshl_b32 s72, s75, 1
    s_add_i32 s72, s72, 4
    s_add_u32 s83, s75, 6
    s_max_i32 s72, s72, s83
L_loop:
    s_add_u32 s83, s75, 3
    s_cmp_ge_u32 s83, s67
    s_cbranch_scc1 L_last_a
    s_waitcnt lgkmcnt(0)
    v_readfirstlane_b32 s71, v25
    s_cmp_ge_i32 s71, s72
    s_cbranch_scc0 L_poll_ka
L_ok_ka:
    ds_read_b128 a[64:67], v8 offset:16384
    ds_read_b128 a[68:71], v9 offset:16384
    ds_read_b128 a[72:75], v10 offset:16384
    ds_read_b128 a[76:79], v11 offset:16384
    ds_read_b128 a[80:83], v12 offset:16384
    ds_read_b128 a[84:87], v13 offset:16384
    ds_read_b128 a[88:91], v14 offset:16384
    ds_read_b128 a[92:95], v15 offset:16384
    v_pk_mul_f32 v[128:129], v[128:129], v[38:39] op_sel_hi:[1,0]
    v_pk_mul_f32 v[130:131], v[130:131], v[38:39] op_sel_hi:[1,0]
    v_pk_mul_f32 v[132:133], v[132:133], v[38:39] op_sel_hi:[1,0]
    v_pk_mul_f32 v[134:135], v[134:135], v[38:39] op_sel_hi:[1,0]
    v_pk_mul_f32 v[136:137], v[136:137], v[38:39] op_sel_hi:[1,0]
    v_pk_mul_f32 v[138:139], v[138:139], v[38:39] op_sel_hi:[1,0]
    v_pk_mul_f32 v[140:141], v[140:141], v[38:39] op_sel_hi:[1,0]
    v_pk_mul_f32 v[142:143], v[142:143], v[38:39] op_sel_hi:[1,0]
    v_pk_mul_f32 v[144:145], v[144:145], v[40:41] op_sel_hi:[1,0]
    v_pk_mul_f32 v[146:147], v[146:147], v[40:41] op_sel_hi:[1,0]
    v_pk_mul_f32 v[148:149], v[148:149], v[40:41] op_sel_hi:[1,0]
    v_pk_mul_f32 v[150:151], v[150:151], v[40:41] op_sel_hi:[1,0]
    v_pk_mul_f32 v[152:153], v[152:153], v[40:41] op_sel_hi:[1,0]
    v_pk_mul_f32 v[154:155], v[154:155], v[40:41] op_sel_hi:[1,0]
    v_pk_mul_f32 v[156:157], v[156:157], v[40:41] op_sel_hi:[1,0]
    v_pk_mul_f32 v[158:159], v[158:159], v[40:41] op_sel_hi:[1,0]
    s_waitcnt lgkmcnt(7)
    v_mfma_f32_32x32x16_bf16 v[96:111], a[64:67], a[0:3], 0
    v_mul_f32 v160, v160, v38
    v_mul_f32 v161, v161, v38
    v_mul_f32 v162, v162, v38
    v_mul_f32 v163, v163, v38
    v_mul_f32 v164, v164, v38
    v_mul_f32 v165, v165, v38
    v_mfma_f32_32x32x16_bf16 v[112:127], a[64:67], a[32:35], 0
    v_mul_f32 v166, v166, v38
    v_mul_f32 v167, v167, v38
    v_mul_f32 v168, v168, v38
    v_mul_f32 v169, v169, v38
    v_mul_f32 v170, v170, v38
    v_mul_f32 v171, v171, v38
    s_waitcnt lgkmcnt(6)
    v_mfma_f32_32x32x16_bf16 v[96:111], a[68:71], a[4:7], v[96:111]
    v_mul_f32 v172, v172, v38
    v_mul_f32 v173, v173, v38
    v_mul_f32 v174, v174, v38
    v_mul_f32 v175, v175, v38
    v_mul_f32 v176, v176, v40
    v_mfma_f32_32x32x16_bf16 v[112:127], a[68:71], a[36:39], v[112:127]
    v_mul_f32 v177, v177, v40
    v_mul_f32 v178, v178, v40
    v_mul_f32 v179, v179, v40
    v_mul_f32 v180, v180, v40
    v_mul_f32 v181, v181, v40
    v_mul_f32 v182, v182, v40
    s_waitcnt lgkmcnt(5)
    v_mfma_f32_32x32x16_bf16 v[96:111], a[72:75], a[8:11], v[96:111]
    v_mul_f32 v183, v183, v40
    v_mul_f32 v184, v184, v40
    v_mul_f32 v185, v185, v40
    v_mul_f32 v186, v186, v40
    v_mul_f32 v187, v187, v40
    v_mul_f32 v188, v188, v40
    v_mfma_f32_32x32x16_bf16 v[112:127], a[72:75], a[40:43], v[112:127]
    v_mul_f32 v189, v189, v40
    v_mul_f32 v190, v190, v40
    v_mul_f32 v191, v191, v40
    v_mul_f32 v192, v192, v38
    v_mul_f32 v193, v193, v38
    s_waitcnt lgkmcnt(4)
    v_mfma_f32_32x32x16_bf16 v[96:111], a[76:79], a[12:15], v[96:111]
    v_mul_f32 v194, v194, v38
    v_mul_f32 v195, v195, v38
    v_mul_f32 v196, v196, v38
    v_mul_f32 v197, v197, v38
    v_mul_f32 v198, v198, v38
    v_mul_f32 v199, v199, v38
    v_mfma_f32_32x32x16_bf16 v[112:127], a[76:79], a[44:47], v[112:127]
    v_mul_f32 v200, v200, v38
    v_mul_f32 v201, v201, v38
    v_mul_f32 v202, v202, v38
    v_mul_f32 v203, v203, v38
    v_mul_f32 v204, v204, v38
    s_waitcnt lgkmcnt(0)
    ds_write_b32 v24, v23
    v_mfma_f32_32x32x16_bf16 v[96:111], a[80:83], a[16:19], v[96:111]
    v_mul_f32 v205, v205, v38
    v_mul_f32 v206, v206, v38
    v_mul_f32 v207, v207, v38
    v_mul_f32 v208, v208, v40
    v_mul_f32 v209, v209, v40
    v_mul_f32 v210, v210, v40
    v_mfma_f32_32x32x16_bf16 v[112:127], a[80:83], a[48:51], v[112:127]
    v_mul_f32 v211, v211, v40
    v_mul_f32 v212, v212, v40
    v_mul_f32 v213, v213, v40
    v_mul_f32 v214, v214, v40
    v_mul_f32 v215, v215, v40
    v_mul_f32 v216, v216, v40
    v_mfma_f32_32x32x16_bf16 v[96:111], a[84:87], a[20:23], v[96:111]
    v_mul_f32 v217, v217, v40
    v_mul_f32 v218, v218, v40
    v_mul_f32 v219, v219, v40
    v_mul_f32 v220, v220, v40
    v_mul_f32 v221, v221, v40
    v_mfma_f32_32x32x16_bf16 v[112:127], a[84:87], a[52:55], v[112:127]
    v_mul_f32 v222, v222, v40
    v_mul_f32 v223, v223, v40
    v_mul_f32 v224, v224, v38
    v_mul_f32 v225, v225, v38
    v_mul_f32 v226, v226, v38
    v_mul_f32 v227, v227, v38
    v_mfma_f32_32x32x16_bf16 v[96:111], a[88:91], a[24:27], v[96:111]
    v_mul_f32 v228, v228, v38
    v_mul_f32 v229, v229, v38
    v_mul_f32 v230, v230, v38
    v_mul_f32 v231, v231, v38
    v_mul_f32 v232, v232, v38
    v_mul_f32 v233, v233, v38
    v_mfma_f32_32x32x16_bf16 v[112:127], a[88:91], a[56:59], v[112:127]
    v_mul_f32 v234, v234, v38
    v_mul_f32 v235, v235, v38
    v_mul_f32 v236, v236, v38
    v_mul_f32 v237, v237, v38
    v_mul_f32 v238, v238, v38
    v_mfma_f32_32x32x16_bf16 v[96:111], a[92:95], a[28:31], v[96:111]
    v_mul_f32 v239, v239, v38
    v_mul_f32 v240, v240, v40
    v_mul_f32 v241, v241, v40
    v_mul_f32 v242, v242, v40
    v_mul_f32 v243, v243, v40
    v_mul_f32 v244, v244, v40
    v_mfma_f32_32x32x16_bf16 v[112:127], a[92:95], a[60:63], v[112:127]
    v_mul_f32 v245, v245, v40
    v_mul_f32 v246, v246, v40
    v_mul_f32 v247, v247, v40
    v_mul_f32 v248, v248, v40
    v_mul_f32 v249, v249, v40
    v_mul_f32 v250, v250, v40
    v_mul_f32 v251, v251, v40
    v_mul_f32 v252, v252, v40
    v_mul_f32 v253, v253, v40
    v_mul_f32 v254, v254, v40
    v_mul_f32 v255, v255, v40
    s_lshl_b32 s72, s75, 1
    s_add_u32 s72, s72, 9
    s_add_u32 s83, s75, s59
    s_min_i32 s72, s72, s83
    s_add_u32 s84, s75, 3
    s_cmp_lt_u32 s84, s69
    s_cbranch_scc0 L_mask_a
L_nomask_a:
    v_max3_f32 v32, v96, v97, v98
    v_max3_f32 v33, v112, v113, v114
    v_max3_f32 v32, v32, v99, v100
    v_max3_f32 v33, v33, v115, v116
    v_max3_f32 v32, v32, v101, v102
    v_max3_f32 v33, v33, v117, v118
    v_max3_f32 v32, v32, v103, v104
    v_max3_f32 v33, v33, v119, v120
    v_max3_f32 v32, v32, v105, v106
    v_max3_f32 v33, v33, v121, v122
    v_max3_f32 v32, v32, v107, v108
    v_max3_f32 v33, v33, v123, v124
    v_max3_f32 v32, v32, v109, v110
    v_max3_f32 v33, v33, v125, v126
    v_max_f32 v32, v32, v111
    v_max_f32 v33, v33, v127
    v_add_u32 v23, 1, v23
    s_nop 0
    v_permlane32_swap_b32 v32, v33
    v_max_f32 v32, v32, v33
    v_mul_f32 v32, s73, v32
    v_max_f32 v34, v29, v32
    v_sub_f32 v33, v29, v34
    v_mov_b32 v36, v34
    v_exp_f32 v42, v33
    v_mov_b32 v29, v34
    v_permlane32_swap_b32 v34, v36
    v_mov_b32 v44, v42
    v_pk_fma_f32 v[96:97], v[96:97], s[38:39], v[34:35] op_sel_hi:[1,1,0] neg_lo:[0,0,1] neg_hi:[0,0,1]
    v_pk_fma_f32 v[112:113], v[112:113], s[38:39], v[36:37] op_sel_hi:[1,1,0] neg_lo:[0,0,1] neg_hi:[0,0,1]
    v_permlane32_swap_b32 v42, v44
    v_pk_fma_f32 v[98:99], v[98:99], s[38:39], v[34:35] op_sel_hi:[1,1,0] neg_lo:[0,0,1] neg_hi:[0,0,1]
    v_pk_fma_f32 v[114:115], v[114:115], s[38:39], v[36:37] op_sel_hi:[1,1,0] neg_lo:[0,0,1] neg_hi:[0,0,1]
    v_pk_fma_f32 v[100:101], v[100:101], s[38:39], v[34:35] op_sel_hi:[1,1,0] neg_lo:[0,0,1] neg_hi:[0,0,1]
    v_pk_fma_f32 v[116:117], v[116:117], s[38:39], v[36:37] op_sel_hi:[1,1,0] neg_lo:[0,0,1] neg_hi:[0,0,1]
    v_pk_fma_f32 v[102:103], v[102:103], s[38:39], v[34:35] op_sel_hi:[1,1,0] neg_lo:[0,0,1] neg_hi:[0,0,1]
    v_pk_fma_f32 v[118:119], v[118:119], s[38:39], v[36:37] op_sel_hi:[1,1,0] neg_lo:[0,0,1] neg_hi:[0,0,1]
    v_pk_fma_f32 v[104:105], v[104:105], s[38:39], v[34:35] op_sel_hi:[1,1,0] neg_lo:[0,0,1] neg_hi:[0,0,1]
    v_pk_fma_f32 v[120:121], v[120:121], s[38:39], v[36:37] op_sel_hi:[1,1,0] neg_lo:[0,0,1] neg_hi:[0,0,1]
    v_pk_fma_f32 v[106:107], v[106:107], s[38:39], v[34:35] op_sel_hi:[1,1,0] neg_lo:[0,0,1] neg_hi:[0,0,1]
    v_pk_fma_f32 v[122:123], v[122:123], s[38:39], v[36:37] op_sel_hi:[1,1,0] neg_lo:[0,0,1] neg_hi:[0,0,1]
    v_pk_fma_f32 v[108:109], v[108:109], s[38:39], v[34:35] op_sel_hi:[1,1,0] neg_lo:[0,0,1] neg_hi:[0,0,1]
    v_pk_fma_f32 v[124:125], v[124:125], s[38:39], v[36:37] op_sel_hi:[1,1,0] neg_lo:[0,0,1] neg_hi:[0,0,1]
    v_pk_fma_f32 v[110:111], v[110:111], s[38:39], v[34:35] op_sel_hi:[1,1,0] neg_lo:[0,0,1] neg_hi:[0,0,1]
    v_pk_fma_f32 v[126:127], v[126:127], s[38:39], v[36:37] op_sel_hi:[1,1,0] neg_lo:[0,0,1] neg_hi:[0,0,1]
    v_exp_f32 v96, v96
    v_exp_f32 v112, v112
    v_exp_f32 v97, v97
    v_exp_f32 v113, v113
    v_exp_f32 v98, v98
    v_exp_f32 v114, v114
    v_exp_f32 v99, v99
    v_exp_f32 v115, v115
    v_exp_f32 v100, v100
    v_exp_f32 v116, v116
    v_exp_f32 v101, v101
    v_exp_f32 v117, v117
    v_exp_f32 v102, v102
    v_exp_f32 v118, v118
    v_exp_f32 v103, v103
    v_exp_f32 v119, v119
    v_exp_f32 v104, v104
    v_exp_f32 v120, v120
    v_exp_f32 v105, v105
    v_exp_f32 v121, v121
    v_exp_f32 v106, v106
    v_exp_f32 v122, v122
    v_exp_f32 v107, v107
    v_exp_f32 v123, v123
    v_exp_f32 v108, v108
    v_exp_f32 v124, v124
    v_exp_f32 v109, v109
    v_exp_f32 v125, v125
    v_exp_f32 v110, v110
    v_exp_f32 v126, v126
    v_exp_f32 v111, v111
    v_exp_f32 v127, v127
    ds_read_b32 v25, v22
    v_cvt_pk_bf16_f32 v80, v96, v97
    v_cvt_pk_bf16_f32 v88, v112, v113
    v_cvt_pk_bf16_f32 v81, v98, v99
    v_cvt_pk_bf16_f32 v89, v114, v115
    v_cvt_pk_bf16_f32 v82, v100, v101
    v_cvt_pk_bf16_f32 v90, v116, v117
    v_cvt_pk_bf16_f32 v83, v102, v103
    v_cvt_pk_bf16_f32 v91, v118, v119
    v_cvt_pk_bf16_f32 v84, v104, v105
    v_cvt_pk_bf16_f32 v92, v120, v121
    v_cvt_pk_bf16_f32 v85, v106, v107
    v_cvt_pk_bf16_f32 v93, v122, v123
    v_cvt_pk_bf16_f32 v86, v108, v109
    v_cvt_pk_bf16_f32 v94, v124, v125
    v_cvt_pk_bf16_f32 v87, v110, v111
    v_cvt_pk_bf16_f32 v95, v126, v127
    s_waitcnt lgkmcnt(0)
    v_readfirstlane_b32 s71, v25
    s_cmp_ge_i32 s71, s72
    s_cbranch_scc0 L_poll_va
L_ok_va:
    ds_read_b64_tr_b16 a[96:97], v16 offset:0
    ds_read_b64_tr_b16 a[98:99], v16 offset:2048
    ds_read_b64_tr_b16 a[100:101], v16 offset:4096
    ds_read_b64_tr_b16 a[102:103], v16 offset:6144
    ds_read_b64_tr_b16 a[104:105], v17 offset:0
    ds_read_b64_tr_b16 a[106:107], v17 offset:2048
    ds_read_b64_tr_b16 a[108:109], v17 offset:4096
    ds_read_b64_tr_b16 a[110:111], v17 offset:6144
    ds_read_b64_tr_b16 a[112:113], v18 offset:0
    ds_read_b64_tr_b16 a[114:115], v18 offset:2048
    ds_read_b64_tr_b16 a[116:117], v18 offset:4096
    ds_read_b64_tr_b16 a[118:119], v18 offset:6144
    v_pk_add_f32 v[48:49], v[96:97], v[98:99]
    v_pk_add_f32 v[50:51], v[112:113], v[114:115]
    v_pk_add_f32 v[48:49], v[48:49], v[100:101]
    v_pk_add_f32 v[50:51], v[50:51], v[116:117]
    v_pk_add_f32 v[48:49], v[48:49], v[102:103]
    v_pk_add_f32 v[50:51], v[50:51], v[118:119]
    v_pk_add_f32 v[48:49], v[48:49], v[104:105]
    v_pk_add_f32 v[50:51], v[50:51], v[120:121]
    v_pk_add_f32 v[48:49], v[48:49], v[106:107]
    v_pk_add_f32 v[50:51], v[50:51], v[122:123]
    s_waitcnt lgkmcnt(10)
    ds_read_b64_tr_b16 a[120:121], v19 offset:0
    ds_read_b64_tr_b16 a[122:123], v19 offset:2048
    ds_read_b64_tr_b16 a[124:125], v19 offset:4096
    ds_read_b64_tr_b16 a[126:127], v19 offset:6144
    v_pk_add_f32 v[48:49], v[48:49], v[108:109]
    v_pk_add_f32 v[50:51], v[50:51], v[124:125]
    v_pk_add_f32 v[48:49], v[48:49], v[110:111]
    v_pk_add_f32 v[50:51], v[50:51], v[126:127]
    v_fma_f32 v30, v30, v42, v48
    v_fma_f32 v31, v31, v44, v50
    v_add_f32 v30, v30, v49
    v_add_f32 v31, v31, v51
    s_waitcnt lgkmcnt(12)
    v_mfma_f32_32x32x16_bf16 v[128:143], a[96:99], v[64:67], v[128:143]
    v_mfma_f32_32x32x16_bf16 v[144:159], a[96:99], v[72:75], v[144:159]
    v_mfma_f32_32x32x16_bf16 v[128:143], a[100:103], v[68:71], v[128:143]
    v_mfma_f32_32x32x16_bf16 v[144:159], a[100:103], v[76:79], v[144:159]
    s_waitcnt lgkmcnt(8)
    v_mfma_f32_32x32x16_bf16 v[160:175], a[104:107], v[64:67], v[160:175]
    v_mfma_f32_32x32x16_bf16 v[176:191], a[104:107], v[72:75], v[176:191]
    v_mfma_f32_32x32x16_bf16 v[160:175], a[108:111], v[68:71], v[160:175]
    v_mfma_f32_32x32x16_bf16 v[176:191], a[108:111], v[76:79], v[176:191]
    s_waitcnt lgkmcnt(0)
    ds_write_b32 v24, v23
    s_add_u32 s75, s75, 3
    v_mfma_f32_32x32x16_bf16 v[192:207], a[112:115], v[64:67], v[192:207]
    v_mfma_f32_32x32x16_bf16 v[208:223], a[112:115], v[72:75], v[208:223]
    v_mfma_f32_32x32x16_bf16 v[192:207], a[116:119], v[68:71], v[192:207]
    v_mfma_f32_32x32x16_bf16 v[208:223], a[116:119], v[76:79], v[208:223]
    v_add_u32 v23, 1, v23
    s_lshl_b32 s72, s75, 1
    s_add_i32 s72, s72, 4
    s_add_u32 s83, s75, 6
    s_max_i32 s72, s72, s83
    v_mfma_f32_32x32x16_bf16 v[224:239], a[120:123], v[64:67], v[224:239]
    s_cmp_lg_u32 s62, 0
    s_cbranch_scc1 L_imp_a
L_impr_a:
    v_mfma_f32_32x32x16_bf16 v[240:255], a[120:123], v[72:75], v[240:255]
    ds_read_b32 v25, v22
    v_mfma_f32_32x32x16_bf16 v[224:239], a[124:127], v[68:71], v[224:239]
    v_mfma_f32_32x32x16_bf16 v[240:255], a[124:127], v[76:79], v[240:255]
L_loop_b:
    s_add_u32 s83, s75, 3
    s_cmp_ge_u32 s83, s67
    s_cbranch_scc1 L_last_b
    s_waitcnt lgkmcnt(0)
    v_readfirstlane_b32 s71, v25
    s_cmp_ge_i32 s71, s72
    s_cbranch_scc0 L_poll_kb
L_ok_kb:
    ds_read_b128 a[64:67], v8 offset:0
    ds_read_b128 a[68:71], v9 offset:0
    ds_read_b128 a[72:75], v10 offset:0
    ds_read_b128 a[76:79], v11 offset:0
    ds_read_b128 a[80:83], v12 offset:0
    ds_read_b128 a[84:87], v13 offset:0
    ds_read_b128 a[88:91], v14 offset:0
    ds_read_b128 a[92:95], v15 offset:0
    v_pk_mul_f32 v[128:129], v[128:129], v[42:43] op_sel_hi:[1,0]
    v_pk_mul_f32 v[130:131], v[130:131], v[42:43] op_sel_hi:[1,0]
    v_pk_mul_f32 v[132:133], v[132:133], v[42:43] op_sel_hi:[1,0]
    v_pk_mul_f32 v[134:135], v[134:135], v[42:43] op_sel_hi:[1,0]
    v_pk_mul_f32 v[136:137], v[136:137], v[42:43] op_sel_hi:[1,0]
    v_pk_mul_f32 v[138:139], v[138:139], v[42:43] op_sel_hi:[1,0]
    v_pk_mul_f32 v[140:141], v[140:141], v[42:43] op_sel_hi:[1,0]
    v_pk_mul_f32 v[142:143], v[142:143], v[42:43] op_sel_hi:[1,0]
    v_pk_mul_f32 v[144:145], v[144:145], v[44:45] op_sel_hi:[1,0]
    v_pk_mul_f32 v[146:147], v[146:147], v[44:45] op_sel_hi:[1,0]
    v_pk_mul_f32 v[148:149], v[148:149], v[44:45] op_sel_hi:[1,0]
    v_pk_mul_f32 v[150:151], v[150:151], v[44:45] op_sel_hi:[1,0]
    v_pk_mul_f32 v[152:153], v[152:153], v[44:45] op_sel_hi:[1,0]
    v_pk_mul_f32 v[154:155], v[154:155], v[44:45] op_sel_hi:[1,0]
    v_pk_mul_f32 v[156:157], v[156:157], v[44:45] op_sel_hi:[1,0]
    v_pk_mul_f32 v[158:159], v[158:159], v[44:45] op_sel_hi:[1,0]
    s_waitcnt lgkmcnt(7)
    v_mfma_f32_32x32x16_bf16 v[96:111], a[64:67], a[0:3], 0
    v_mul_f32 v160, v160, v42
    v_mul_f32 v161, v161, v42
    v_mul_f32 v162, v162, v42
    v_mul_f32 v163, v163, v42
    v_mul_f32 v164, v164, v42
    v_mul_f32 v165, v165, v42
    v_mfma_f32_32x32x16_bf16 v[112:127], a[64:67], a[32:35], 0
    v_mul_f32 v166, v166, v42
    v_mul_f32 v167, v167, v42
    v_mul_f32 v168, v168, v42
    v_mul_f32 v169, v169, v42
    v_mul_f32 v170, v170, v42
    v_mul_f32 v171, v171, v42
    s_waitcnt lgkmcnt(6)
    v_mfma_f32_32x32x16_bf16 v[96:111], a[68:71], a[4:7], v[96:111]
    v_mul_f32 v172, v172, v42
    v_mul_f32 v173, v173, v42
    v_mul_f32 v174, v174, v42
    v_mul_f32 v175, v175, v42
    v_mul_f32 v176, v176, v44
    v_mfma_f32_32x32x16_bf16 v[112:127], a[68:71], a[36:39], v[112:127]
    v_mul_f32 v177, v177, v44
    v_mul_f32 v178, v178, v44
    v_mul_f32 v179, v179, v44
    v_mul_f32 v180, v180, v44
    v_mul_f32 v181, v181, v44
    v_mul_f32 v182, v182, v44
    s_waitcnt lgkmcnt(5)
    v_mfma_f32_32x32x16_bf16 v[96:111], a[72:75], a[8:11], v[96:111]
    v_mul_f32 v183, v183, v44
    v_mul_f32 v184, v184, v44
    v_mul_f32 v185, v185, v44
    v_mul_f32 v186, v186, v44
    v_mul_f32 v187, v187, v44
    v_mul_f32 v188, v188, v44
    v_mfma_f32_32x32x16_bf16 v[112:127], a[72:75], a[40:43], v[112:127]
    v_mul_f32 v189, v189, v44
    v_mul_f32 v190, v190, v44
    v_mul_f32 v191, v191, v44
    v_mul_f32 v192, v192, v42
    v_mul_f32 v193, v193, v42
    s_waitcnt lgkmcnt(4)
    v_mfma_f32_32x32x16_bf16 v[96:111], a[76:79], a[12:15], v[96:111]
    v_mul_f32 v194, v194, v42
    v_mul_f32 v195, v195, v42
    v_mul_f32 v196, v196, v42
    v_mul_f32 v197, v197, v42
    v_mul_f32 v198, v198, v42
    v_mul_f32 v199, v199, v42
    v_mfma_f32_32x32x16_bf16 v[112:127], a[76:79], a[44:47], v[112:127]
    v_mul_f32 v200, v200, v42
    v_mul_f32 v201, v201, v42
    v_mul_f32 v202, v202, v42
    v_mul_f32 v203, v203, v42
    v_mul_f32 v204, v204, v42
    s_waitcnt lgkmcnt(0)
    ds_write_b32 v24, v23
    v_mfma_f32_32x32x16_bf16 v[96:111], a[80:83], a[16:19], v[96:111]
    v_mul_f32 v205, v205, v42
    v_mul_f32 v206, v206, v42
    v_mul_f32 v207, v207, v42
    v_mul_f32 v208, v208, v44
    v_mul_f32 v209, v209, v44
    v_mul_f32 v210, v210, v44
    v_mfma_f32_32x32x16_bf16 v[112:127], a[80:83], a[48:51], v[112:127]
    v_mul_f32 v211, v211, v44
    v_mul_f32 v212, v212, v44
    v_mul_f32 v213, v213, v44
    v_mul_f32 v214, v214, v44
    v_mul_f32 v215, v215, v44
    v_mul_f32 v216, v216, v44
    v_mfma_f32_32x32x16_bf16 v[96:111], a[84:87], a[20:23], v[96:111]
    v_mul_f32 v217, v217, v44
    v_mul_f32 v218, v218, v44
    v_mul_f32 v219, v219, v44
    v_mul_f32 v220, v220, v44
    v_mul_f32 v221, v221, v44
    v_mfma_f32_32x32x16_bf16 v[112:127], a[84:87], a[52:55], v[112:127]
    v_mul_f32 v222, v222, v44
    v_mul_f32 v223, v223, v44
    v_mul_f32 v224, v224, v42
    v_mul_f32 v225, v225, v42
    v_mul_f32 v226, v226, v42
    v_mul_f32 v227, v227, v42
    v_mfma_f32_32x32x16_bf16 v[96:111], a[88:91], a[24:27], v[96:111]
    v_mul_f32 v228, v228, v42
    v_mul_f32 v229, v229, v42
    v_mul_f32 v230, v230, v42
    v_mul_f32 v231, v231, v42
    v_mul_f32 v232, v232, v42
    v_mul_f32 v233, v233, v42
    v_mfma_f32_32x32x16_bf16 v[112:127], a[88:91], a[56:59], v[112:127]
    v_mul_f32 v234, v234, v42
    v_mul_f32 v235, v235, v42
    v_mul_f32 v236, v236, v42
    v_mul_f32 v237, v237, v42
    v_mul_f32 v238, v238, v42
    v_mfma_f32_32x32x16_bf16 v[96:111], a[92:95], a[28:31], v[96:111]
    v_mul_f32 v239, v239, v42
    v_mul_f32 v240, v240, v44
    v_mul_f32 v241, v241, v44
    v_mul_f32 v242, v242, v44
    v_mul_f32 v243, v243, v44
    v_mul_f32 v244, v244, v44
    v_mfma_f32_32x32x16_bf16 v[112:127], a[92:95], a[60:63], v[112:127]
    v_mul_f32 v245, v245, v44
    v_mul_f32 v246, v246, v44
    v_mul_f32 v247, v247, v44
    v_mul_f32 v248, v248, v44
    v_mul_f32 v249, v249, v44
    v_mul_f32 v250, v250, v44
    v_mul_f32 v251, v251, v44
    v_mul_f32 v252, v252, v44
    v_mul_f32 v253, v253, v44
    v_mul_f32 v254, v254, v44
    v_mul_f32 v255, v255, v44
    s_lshl_b32 s72, s75, 1
    s_add_u32 s72, s72, 9
    s_add_u32 s83, s75, s59
    s_min_i32 s72, s72, s83
    s_add_u32 s84, s75, 3
    s_cmp_lt_u32 s84, s69
    s_cbranch_scc0 L_mask_b
L_nomask_b:
    v_max3_f32 v32, v96, v97, v98
    v_max3_f32 v33, v112, v113, v114
    v_max3_f32 v32, v32, v99, v100
    v_max3_f32 v33, v33, v115, v116
    v_max3_f32 v32, v32, v101, v102
    v_max3_f32 v33, v33, v117, v118
    v_max3_f32 v32, v32, v103, v104
    v_max3_f32 v33, v33, v119, v120
    v_max3_f32 v32, v32, v105, v106
    v_max3_f32 v33, v33, v121, v122
    v_max3_f32 v32, v32, v107, v108
    v_max3_f32 v33, v33, v123, v124
    v_max3_f32 v32, v32, v109, v110
    v_max3_f32 v33, v33, v125, v126
    v_max_f32 v32, v32, v111
    v_max_f32 v33, v33, v127
    v_add_u32 v23, 1, v23
    s_nop 0
    v_permlane32_swap_b32 v32, v33
    v_max_f32 v32, v32, v33
    v_mul_f32 v32, s73, v32
    v_max_f32 v34, v29, v32
    v_sub_f32 v33, v29, v34
    v_mov_b32 v36, v34
    v_exp_f32 v38, v33
    v_mov_b32 v29, v34
    v_permlane32_swap_b32 v34, v36
    v_mov_b32 v40, v38
    v_pk_fma_f32 v[96:97], v[96:97], s[38:39], v[34:35] op_sel_hi:[1,1,0] neg_lo:[0,0,1] neg_hi:[0,0,1]
    v_pk_fma_f32 v[112:113], v[112:113], s[38:39], v[36:37] op_sel_hi:[1,1,0] neg_lo:[0,0,1] neg_hi:[0,0,1]
    v_permlane32_swap_b32 v38, v40
    v_pk_fma_f32 v[98:99], v[98:99], s[38:39], v[34:35] op_sel_hi:[1,1,0] neg_lo:[0,0,1] neg_hi:[0,0,1]
    v_pk_fma_f32 v[114:115], v[114:115], s[38:39], v[36:37] op_sel_hi:[1,1,0] neg_lo:[0,0,1] neg_hi:[0,0,1]
    v_pk_fma_f32 v[100:101], v[100:101], s[38:39], v[34:35] op_sel_hi:[1,1,0] neg_lo:[0,0,1] neg_hi:[0,0,1]
    v_pk_fma_f32 v[116:117], v[116:117], s[38:39], v[36:37] op_sel_hi:[1,1,0] neg_lo:[0,0,1] neg_hi:[0,0,1]
    v_pk_fma_f32 v[102:103], v[102:103], s[38:39], v[34:35] op_sel_hi:[1,1,0] neg_lo:[0,0,1] neg_hi:[0,0,1]
    v_pk_fma_f32 v[118:119], v[118:119], s[38:39], v[36:37] op_sel_hi:[1,1,0] neg_lo:[0,0,1] neg_hi:[0,0,1]
    v_pk_fma_f32 v[104:105], v[104:105], s[38:39], v[34:35] op_sel_hi:[1,1,0] neg_lo:[0,0,1] neg_hi:[0,0,1]
    v_pk_fma_f32 v[120:121], v[120:121], s[38:39], v[36:37] op_sel_hi:[1,1,0] neg_lo:[0,0,1] neg_hi:[0,0,1]
    v_pk_fma_f32 v[106:107], v[106:107], s[38:39], v[34:35] op_sel_hi:[1,1,0] neg_lo:[0,0,1] neg_hi:[0,0,1]
    v_pk_fma_f32 v[122:123], v[122:123], s[38:39], v[36:37] op_sel_hi:[1,1,0] neg_lo:[0,0,1] neg_hi:[0,0,1]
    v_pk_fma_f32 v[108:109], v[108:109], s[38:39], v[34:35] op_sel_hi:[1,1,0] neg_lo:[0,0,1] neg_hi:[0,0,1]
    v_pk_fma_f32 v[124:125], v[124:125], s[38:39], v[36:37] op_sel_hi:[1,1,0] neg_lo:[0,0,1] neg_hi:[0,0,1]
    v_pk_fma_f32 v[110:111], v[110:111], s[38:39], v[34:35] op_sel_hi:[1,1,0] neg_lo:[0,0,1] neg_hi:[0,0,1]
    v_pk_fma_f32 v[126:127], v[126:127], s[38:39], v[36:37] op_sel_hi:[1,1,0] neg_lo:[0,0,1] neg_hi:[0,0,1]
    v_exp_f32 v96, v96
    v_exp_f32 v112, v112
    v_exp_f32 v97, v97
    v_exp_f32 v113, v113
    v_exp_f32 v98, v98
    v_exp_f32 v114, v114
    v_exp_f32 v99, v99
    v_exp_f32 v115, v115
    v_exp_f32 v100, v100
    v_exp_f32 v116, v116
    v_exp_f32 v101, v101
    v_exp_f32 v117, v117
    v_exp_f32 v102, v102
    v_exp_f32 v118, v118
    v_exp_f32 v103, v103
    v_exp_f32 v119, v119
    v_exp_f32 v104, v104
    v_exp_f32 v120, v120
    v_exp_f32 v105, v105
    v_exp_f32 v121, v121
    v_exp_f32 v106, v106
    v_exp_f32 v122, v122
    v_exp_f32 v107, v107
    v_exp_f32 v123, v123
    v_exp_f32 v108, v108
    v_exp_f32 v124, v124
    v_exp_f32 v109, v109
    v_exp_f32 v125, v125
    v_exp_f32 v110, v110
    v_exp_f32 v126, v126
    v_exp_f32 v111, v111
    v_exp_f32 v127, v127
    ds_read_b32 v25, v22
    v_cvt_pk_bf16_f32 v64, v96, v97
    v_cvt_pk_bf16_f32 v72, v112, v113
    v_cvt_pk_bf16_f32 v65, v98, v99
    v_cvt_pk_bf16_f32 v73, v114, v115
    v_cvt_pk_bf16_f32 v66, v100, v101
    v_cvt_pk_bf16_f32 v74, v116, v117
    v_cvt_pk_bf16_f32 v67, v102, v103
    v_cvt_pk_bf16_f32 v75, v118, v119
    v_cvt_pk_bf16_f32 v68, v104, v105
    v_cvt_pk_bf16_f32 v76, v120, v121
    v_cvt_pk_bf16_f32 v69, v106, v107
    v_cvt_pk_bf16_f32 v77, v122, v123
    v_cvt_pk_bf16_f32 v70, v108, v109
    v_cvt_pk_bf16_f32 v78, v124, v125
    v_cvt_pk_bf16_f32 v71, v110, v111
    v_cvt_pk_bf16_f32 v79, v126, v127
    s_waitcnt lgkmcnt(0)
    v_readfirstlane_b32 s71, v25
    s_cmp_ge_i32 s71, s72
    s_cbranch_scc0 L_poll_vb
L_ok_vb:
    ds_read_b64_tr_b16 a[96:97], v16 offset:16384
    ds_read_b64_tr_b16 a[98:99], v16 offset:18432
    ds_read_b64_tr_b16 a[100:101], v16 offset:20480
    ds_read_b64_tr_b16 a[102:103], v16 offset:22528
    ds_read_b64_tr_b16 a[104:105], v17 offset:16384
    ds_read_b64_tr_b16 a[106:107], v17 offset:18432
    ds_read_b64_tr_b16 a[108:109], v17 offset:20480
    ds_read_b64_tr_b16 a[110:111], v17 offset:22528
    ds_read_b64_tr_b16 a[112:113], v18 offset:16384
    ds_read_b64_tr_b16 a[114:115], v18 offset:18432
    ds_read_b64_tr_b16 a[116:117], v18 offset:20480
    ds_read_b64_tr_b16 a[118:119], v18 offset:22528
    v_pk_add_f32 v[48:49], v[96:97], v[98:99]
    v_pk_add_f32 v[50:51], v[112:113], v[114:115]
    v_pk_add_f32 v[48:49], v[48:49], v[100:101]
    v_pk_add_f32 v[50:51], v[50:51], v[116:117]
    v_pk_add_f32 v[48:49], v[48:49], v[102:103]
    v_pk_add_f32 v[50:51], v[50:51], v[118:119]
    v_pk_add_f32 v[48:49], v[48:49], v[104:105]
    v_pk_add_f32 v[50:51], v[50:51], v[120:121]
    v_pk_add_f32 v[48:49], v[48:49], v[106:107]
    v_pk_add_f32 v[50:51], v[50:51], v[122:123]
    s_waitcnt lgkmcnt(10)
    ds_read_b64_tr_b16 a[120:121], v19 offset:16384
    ds_read_b64_tr_b16 a[122:123], v19 offset:18432
    ds_read_b64_tr_b16 a[124:125], v19 offset:20480
    ds_read_b64_tr_b16 a[126:127], v19 offset:22528
    v_pk_add_f32 v[48:49], v[48:49], v[108:109]
    v_pk_add_f32 v[50:51], v[50:51], v[124:125]
    v_pk_add_f32 v[48:49], v[48:49], v[110:111]
    v_pk_add_f32 v[50:51], v[50:51], v[126:127]
    v_fma_f32 v30, v30, v38, v48
    v_fma_f32 v31, v31, v40, v50
    v_add_f32 v30, v30, v49
    v_add_f32 v31, v31, v51
    s_waitcnt lgkmcnt(12)
    v_mfma_f32_32x32x16_bf16 v[128:143], a[96:99], v[80:83], v[128:143]
    v_mfma_f32_32x32x16_bf16 v[144:159], a[96:99], v[88:91], v[144:159]
    v_mfma_f32_32x32x16_bf16 v[128:143], a[100:103], v[84:87], v[128:143]
    v_mfma_f32_32x32x16_bf16 v[144:159], a[100:103], v[92:95], v[144:159]
    s_waitcnt lgkmcnt(8)
    v_mfma_f32_32x32x16_bf16 v[160:175], a[104:107], v[80:83], v[160:175]
    v_mfma_f32_32x32x16_bf16 v[176:191], a[104:107], v[88:91], v[176:191]
    v_mfma_f32_32x32x16_bf16 v[160:175], a[108:111], v[84:87], v[160:175]
    v_mfma_f32_32x32x16_bf16 v[176:191], a[108:111], v[92:95], v[176:191]
    s_waitcnt lgkmcnt(0)
    ds_write_b32 v24, v23
    s_add_u32 s75, s75, 3
    v_mfma_f32_32x32x16_bf16 v[192:207], a[112:115], v[80:83], v[192:207]
    v_mfma_f32_32x32x16_bf16 v[208:223], a[112:115], v[88:91], v[208:223]
    v_mfma_f32_32x32x16_bf16 v[192:207], a[116:119], v[84:87], v[192:207]
    v_mfma_f32_32x32x16_bf16 v[208:223], a[116:119], v[92:95], v[208:223]
    v_add_u32 v23, 1, v23
    s_lshl_b32 s72, s75, 1
    s_add_i32 s72, s72, 4
    s_add_u32 s83, s75, 6
    s_max_i32 s72, s72, s83
    v_mfma_f32_32x32x16_bf16 v[224:239], a[120:123], v[80:83], v[224:239]
    s_cmp_lg_u32 s62, 0
    s_cbranch_scc1 L_imp_b
L_impr_b:
    v_mfma_f32_32x32x16_bf16 v[240:255], a[120:123], v[88:91], v[240:255]
    ds_read_b32 v25, v22
    v_mfma_f32_32x32x16_bf16 v[224:239], a[124:127], v[84:87], v[224:239]
    v_mfma_f32_32x32x16_bf16 v[240:255], a[124:127], v[92:95], v[240:255]
    s_branch L_loop
L_start_b:
    ds_read_b128 a[64:67], v8 offset:16384
    ds_read_b128 a[68:71], v9 offset:16384
    ds_read_b128 a[72:75], v10 offset:16384
    ds_read_b128 a[76:79], v11 offset:16384
    ds_read_b128 a[80:83], v12 offset:16384
    ds_read_b128 a[84:87], v13 offset:16384
    ds_read_b128 a[88:91], v14 offset:16384
    ds_read_b128 a[92:95], v15 offset:16384
    s_waitcnt lgkmcnt(7)
    v_mfma_f32_32x32x16_bf16 v[96:111], a[64:67], a[0:3], 0
    v_mfma_f32_32x32x16_bf16 v[112:127], a[64:67], a[32:35], 0
    s_waitcnt lgkmcnt(6)
    v_mfma_f32_32x32x16_bf16 v[96:111], a[68:71], a[4:7], v[96:111]
    v_mfma_f32_32x32x16_bf16 v[112:127], a[68:71], a[36:39], v[112:127]
    s_waitcnt lgkmcnt(5)
    v_mfma_f32_32x32x16_bf16 v[96:111], a[72:75], a[8:11], v[96:111]
    v_mfma_f32_32x32x16_bf16 v[112:127], a[72:75], a[40:43], v[112:127]
    s_waitcnt lgkmcnt(4)
    v_mfma_f32_32x32x16_bf16 v[96:111], a[76:79], a[12:15], v[96:111]
    v_mfma_f32_32x32x16_bf16 v[112:127], a[76:79], a[44:47], v[112:127]
    s_waitcnt lgkmcnt(0)
    ds_write_b32 v24, v23
    v_mfma_f32_32x32x16_bf16 v[96:111], a[80:83], a[16:19], v[96:111]
    v_mfma_f32_32x32x16_bf16 v[112:127], a[80:83], a[48:51], v[112:127]
    v_mfma_f32_32x32x16_bf16 v[96:111], a[84:87], a[20:23], v[96:111]
    v_mfma_f32_32x32x16_bf16 v[112:127], a[84:87], a[52:55], v[112:127]
    v_mfma_f32_32x32x16_bf16 v[96:111], a[88:91], a[24:27], v[96:111]
    v_mfma_f32_32x32x16_bf16 v[112:127], a[88:91], a[56:59], v[112:127]
    v_mfma_f32_32x32x16_bf16 v[96:111], a[92:95], a[28:31], v[96:111]
    v_mfma_f32_32x32x16_bf16 v[112:127], a[92:95], a[60:63], v[112:127]
    s_nop 7
    s_nop 1
    s_cmp_lt_u32 s75, s69
    s_cbranch_scc0 L_mask_fb
L_nomask_fb:
    v_max3_f32 v32, v96, v97, v98
    v_max3_f32 v33, v112, v113, v114
    v_max3_f32 v32, v32, v99, v100
    v_max3_f32 v33, v33, v115, v116
    v_max3_f32 v32, v32, v101, v102
    v_max3_f32 v33, v33, v117, v118
    v_max3_f32 v32, v32, v103, v104
    v_max3_f32 v33, v33, v119, v120
    v_max3_f32 v32, v32, v105, v106
    v_max3_f32 v33, v33, v121, v122
    v_max3_f32 v32, v32, v107, v108
    v_max3_f32 v33, v33, v123, v124
    v_max3_f32 v32, v32, v109, v110
    v_max3_f32 v33, v33, v125, v126
    v_max_f32 v32, v32, v111
    v_max_f32 v33, v33, v127
    v_add_u32 v23, 1, v23
    s_nop 0
    v_permlane32_swap_b32 v32, v33
    v_max_f32 v32, v32, v33
    v_mul_f32 v32, s73, v32
    v_max_f32 v34, v29, v32
    v_sub_f32 v33, v29, v34
    v_mov_b32 v36, v34
    v_exp_f32 v42, v33
    v_mov_b32 v29, v34
    v_permlane32_swap_b32 v34, v36
    v_mov_b32 v44, v42
    v_pk_fma_f32 v[96:97], v[96:97], s[38:39], v[34:35] op_sel_hi:[1,1,0] neg_lo:[0,0,1] neg_hi:[0,0,1]
    v_pk_fma_f32 v[112:113], v[112:113], s[38:39], v[36:37] op_sel_hi:[1,1,0] neg_lo:[0,0,1] neg_hi:[0,0,1]
    v_permlane32_swap_b32 v42, v44
    v_pk_fma_f32 v[98:99], v[98:99], s[38:39], v[34:35] op_sel_hi:[1,1,0] neg_lo:[0,0,1] neg_hi:[0,0,1]
    v_pk_fma_f32 v[114:115], v[114:115], s[38:39], v[36:37] op_sel_hi:[1,1,0] neg_lo:[0,0,1] neg_hi:[0,0,1]
    v_pk_fma_f32 v[100:101], v[100:101], s[38:39], v[34:35] op_sel_hi:[1,1,0] neg_lo:[0,0,1] neg_hi:[0,0,1]
    v_pk_fma_f32 v[116:117], v[116:117], s[38:39], v[36:37] op_sel_hi:[1,1,0] neg_lo:[0,0,1] neg_hi:[0,0,1]
    v_pk_fma_f32 v[102:103], v[102:103], s[38:39], v[34:35] op_sel_hi:[1,1,0] neg_lo:[0,0,1] neg_hi:[0,0,1]
    v_pk_fma_f32 v[118:119], v[118:119], s[38:39], v[36:37] op_sel_hi:[1,1,0] neg_lo:[0,0,1] neg_hi:[0,0,1]
    v_pk_fma_f32 v[104:105], v[104:105], s[38:39], v[34:35] op_sel_hi:[1,1,0] neg_lo:[0,0,1] neg_hi:[0,0,1]
    v_pk_fma_f32 v[120:121], v[120:121], s[38:39], v[36:37] op_sel_hi:[1,1,0] neg_lo:[0,0,1] neg_hi:[0,0,1]
    v_pk_fma_f32 v[106:107], v[106:107], s[38:39], v[34:35] op_sel_hi:[1,1,0] neg_lo:[0,0,1] neg_hi:[0,0,1]
    v_pk_fma_f32 v[122:123], v[122:123], s[38:39], v[36:37] op_sel_hi:[1,1,0] neg_lo:[0,0,1] neg_hi:[0,0,1]
    v_pk_fma_f32 v[108:109], v[108:109], s[38:39], v[34:35] op_sel_hi:[1,1,0] neg_lo:[0,0,1] neg_hi:[0,0,1]
    v_pk_fma_f32 v[124:125], v[124:125], s[38:39], v[36:37] op_sel_hi:[1,1,0] neg_lo:[0,0,1] neg_hi:[0,0,1]
    v_pk_fma_f32 v[110:111], v[110:111], s[38:39], v[34:35] op_sel_hi:[1,1,0] neg_lo:[0,0,1] neg_hi:[0,0,1]
    v_pk_fma_f32 v[126:127], v[126:127], s[38:39], v[36:37] op_sel_hi:[1,1,0] neg_lo:[0,0,1] neg_hi:[0,0,1]
    v_exp_f32 v96, v96
    v_exp_f32 v112, v112
    v_exp_f32 v97, v97
    v_exp_f32 v113, v113
    v_exp_f32 v98, v98
    v_exp_f32 v114, v114
    v_exp_f32 v99, v99
    v_exp_f32 v115, v115
    v_exp_f32 v100, v100
    v_exp_f32 v116, v116
    v_exp_f32 v101, v101
    v_exp_f32 v117, v117
    v_exp_f32 v102, v102
    v_exp_f32 v118, v118
    v_exp_f32 v103, v103
    v_exp_f32 v119, v119
    v_exp_f32 v104, v104
    v_exp_f32 v120, v120
    v_exp_f32 v105, v105
    v_exp_f32 v121, v121
    v_exp_f32 v106, v106
    v_exp_f32 v122, v122
    v_exp_f32 v107, v107
    v_exp_f32 v123, v123
    v_exp_f32 v108, v108
    v_exp_f32 v124, v124
    v_exp_f32 v109, v109
    v_exp_f32 v125, v125
    v_exp_f32 v110, v110
    v_exp_f32 v126, v126
    v_exp_f32 v111, v111
    v_exp_f32 v127, v127
    ds_read_b32 v25, v22
    v_cvt_pk_bf16_f32 v80, v96, v97
    v_cvt_pk_bf16_f32 v88, v112, v113
    v_cvt_pk_bf16_f32 v81, v98, v99
    v_cvt_pk_bf16_f32 v89, v114, v115
    v_cvt_pk_bf16_f32 v82, v100, v101
    v_cvt_pk_bf16_f32 v90, v116, v117
    v_cvt_pk_bf16_f32 v83, v102, v103
    v_cvt_pk_bf16_f32 v91, v118, v119
    v_cvt_pk_bf16_f32 v84, v104, v105
    v_cvt_pk_bf16_f32 v92, v120, v121
    v_cvt_pk_bf16_f32 v85, v106, v107
    v_cvt_pk_bf16_f32 v93, v122, v123
    v_cvt_pk_bf16_f32 v86, v108, v109
    v_cvt_pk_bf16_f32 v94, v124, v125
    v_cvt_pk_bf16_f32 v87, v110, v111
    v_cvt_pk_bf16_f32 v95, v126, v127
    v_pk_add_f32 v[48:49], v[96:97], v[98:99]
    v_pk_add_f32 v[50:51], v[112:113], v[114:115]
    v_pk_add_f32 v[48:49], v[48:49], v[100:101]
    v_pk_add_f32 v[50:51], v[50:51], v[116:117]
    v_pk_add_f32 v[48:49], v[48:49], v[102:103]
    v_pk_add_f32 v[50:51], v[50:51], v[118:119]
    v_pk_add_f32 v[48:49], v[48:49], v[104:105]
    v_pk_add_f32 v[50:51], v[50:51], v[120:121]
    v_pk_add_f32 v[48:49], v[48:49], v[106:107]
    v_pk_add_f32 v[50:51], v[50:51], v[122:123]
    v_pk_add_f32 v[48:49], v[48:49], v[108:109]
    v_pk_add_f32 v[50:51], v[50:51], v[124:125]
    v_pk_add_f32 v[48:49], v[48:49], v[110:111]
    v_pk_add_f32 v[50:51], v[50:51], v[126:127]
    v_fma_f32 v30, v30, v42, v48
    v_fma_f32 v31, v31, v44, v50
    v_add_f32 v30, v30, v49
    v_add_f32 v31, v31, v51
    v_add_u32 v23, 1, v23
    s_lshl_b32 s72, s75, 1
    s_add_i32 s72, s72, 4
    s_add_u32 s83, s75, 6
    s_max_i32 s72, s72, s83
    s_branch L_loop_b
L_last_a:
    s_cmp_lg_u32 s62, 0
    s_cbranch_scc1 L_impb_a
L_impbr_a:
    v_permlane32_swap_b32 v30, v31
    v_lshlrev_b32 v48, 3, v1
    s_lshl_b32 s83, s86, 9
    s_add_u32 s83, s83, 116736
    v_add_u32 v49, s83, v48
    v_mov_b32 v50, v29
    v_add_f32 v51, v30, v31
    ds_write_b64 v49, v[50:51]
    v_mov_b32 v23, 1
    s_lshl_b32 s72, s75, 1
    s_add_u32 s72, s72, 9
    s_add_u32 s83, s75, s59
    s_min_i32 s72, s72, s83
    s_waitcnt lgkmcnt(0)
    ds_write_b32 v26, v23
    v_xor_b32 v48, 0, v1
    v_lshl_add_u32 v96, v48, 4, s74
    v_xor_b32 v48, 1, v1
    v_lshl_add_u32 v97, v48, 4, s74
    v_xor_b32 v48, 2, v1
    v_lshl_add_u32 v98, v48, 4, s74
    v_xor_b32 v48, 3, v1
    v_lshl_add_u32 v99, v48, 4, s74
    v_xor_b32 v48, 4, v1
    v_lshl_add_u32 v100, v48, 4, s74
    v_xor_b32 v48, 5, v1
    v_lshl_add_u32 v101, v48, 4, s74
    v_xor_b32 v48, 6, v1
    v_lshl_add_u32 v102, v48, 4, s74
    v_xor_b32 v48, 7, v1
    v_lshl_add_u32 v103, v48, 4, s74
    v_xor_b32 v48, 8, v1
    v_lshl_add_u32 v104, v48, 4, s74
    v_xor_b32 v48, 9, v1
    v_lshl_add_u32 v105, v48, 4, s74
    v_xor_b32 v48, 10, v1
    v_lshl_add_u32 v106, v48, 4, s74
    v_xor_b32 v48, 11, v1
    v_lshl_add_u32 v107, v48, 4, s74
    v_xor_b32 v48, 12, v1
    v_lshl_add_u32 v108, v48, 4, s74
    v_xor_b32 v48, 13, v1
    v_lshl_add_u32 v109, v48, 4, s74
    v_xor_b32 v48, 14, v1
    v_lshl_add_u32 v110, v48, 4, s74
    v_xor_b32 v48, 15, v1
    v_lshl_add_u32 v111, v48, 4, s74
    v_pk_mul_f32 v[128:129], v[128:129], v[38:39] op_sel_hi:[1,0]
    v_pk_mul_f32 v[130:131], v[130:131], v[38:39] op_sel_hi:[1,0]
    v_pk_mul_f32 v[132:133], v[132:133], v[38:39] op_sel_hi:[1,0]
    v_pk_mul_f32 v[134:135], v[134:135], v[38:39] op_sel_hi:[1,0]
    v_pk_mul_f32 v[136:137], v[136:137], v[38:39] op_sel_hi:[1,0]
    v_pk_mul_f32 v[138:139], v[138:139], v[38:39] op_sel_hi:[1,0]
    v_pk_mul_f32 v[140:141], v[140:141], v[38:39] op_sel_hi:[1,0]
    v_pk_mul_f32 v[142:143], v[142:143], v[38:39] op_sel_hi:[1,0]
    v_pk_mul_f32 v[144:145], v[144:145], v[40:41] op_sel_hi:[1,0]
    v_pk_mul_f32 v[146:147], v[146:147], v[40:41] op_sel_hi:[1,0]
    v_pk_mul_f32 v[148:149], v[148:149], v[40:41] op_sel_hi:[1,0]
    v_pk_mul_f32 v[150:151], v[150:151], v[40:41] op_sel_hi:[1,0]
    v_pk_mul_f32 v[152:153], v[152:153], v[40:41] op_sel_hi:[1,0]
    v_pk_mul_f32 v[154:155], v[154:155], v[40:41] op_sel_hi:[1,0]
    v_pk_mul_f32 v[156:157], v[156:157], v[40:41] op_sel_hi:[1,0]
    v_pk_mul_f32 v[158:159], v[158:159], v[40:41] op_sel_hi:[1,0]
    v_pk_mul_f32 v[160:161], v[160:161], v[38:39] op_sel_hi:[1,0]
    v_pk_mul_f32 v[162:163], v[162:163], v[38:39] op_sel_hi:[1,0]
    v_pk_mul_f32 v[164:165], v[164:165], v[38:39] op_sel_hi:[1,0]
    v_pk_mul_f32 v[166:167], v[166:167], v[38:39] op_sel_hi:[1,0]
    v_pk_mul_f32 v[168:169], v[168:169], v[38:39] op_sel_hi:[1,0]
    v_pk_mul_f32 v[170:171], v[170:171], v[38:39] op_sel_hi:[1,0]
    v_pk_mul_f32 v[172:173], v[172:173], v[38:39] op_sel_hi:[1,0]
    v_pk_mul_f32 v[174:175], v[174:175], v[38:39] op_sel_hi:[1,0]
    v_pk_mul_f32 v[176:177], v[176:177], v[40:41] op_sel_hi:[1,0]
    v_pk_mul_f32 v[178:179], v[178:179], v[40:41] op_sel_hi:[1,0]
    v_pk_mul_f32 v[180:181], v[180:181], v[40:41] op_sel_hi:[1,0]
    v_pk_mul_f32 v[182:183], v[182:183], v[40:41] op_sel_hi:[1,0]
    v_pk_mul_f32 v[184:185], v[184:185], v[40:41] op_sel_hi:[1,0]
    v_pk_mul_f32 v[186:187], v[186:187], v[40:41] op_sel_hi:[1,0]
    v_pk_mul_f32 v[188:189], v[188:189], v[40:41] op_sel_hi:[1,0]
    v_pk_mul_f32 v[190:191], v[190:191], v[40:41] op_sel_hi:[1,0]
    v_pk_mul_f32 v[192:193], v[192:193], v[38:39] op_sel_hi:[1,0]
    v_pk_mul_f32 v[194:195], v[194:195], v[38:39] op_sel_hi:[1,0]
    v_pk_mul_f32 v[196:197], v[196:197], v[38:39] op_sel_hi:[1,0]
    v_pk_mul_f32 v[198:199], v[198:199], v[38:39] op_sel_hi:[1,0]
    v_pk_mul_f32 v[200:201], v[200:201], v[38:39] op_sel_hi:[1,0]
    v_pk_mul_f32 v[202:203], v[202:203], v[38:39] op_sel_hi:[1,0]
    v_pk_mul_f32 v[204:205], v[204:205], v[38:39] op_sel_hi:[1,0]
    v_pk_mul_f32 v[206:207], v[206:207], v[38:39] op_sel_hi:[1,0]
    v_pk_mul_f32 v[208:209], v[208:209], v[40:41] op_sel_hi:[1,0]
    v_pk_mul_f32 v[210:211], v[210:211], v[40:41] op_sel_hi:[1,0]
    v_pk_mul_f32 v[212:213], v[212:213], v[40:41] op_sel_hi:[1,0]
    v_pk_mul_f32 v[214:215], v[214:215], v[40:41] op_sel_hi:[1,0]
    v_pk_mul_f32 v[216:217], v[216:217], v[40:41] op_sel_hi:[1,0]
    v_pk_mul_f32 v[218:219], v[218:219], v[40:41] op_sel_hi:[1,0]
    v_pk_mul_f32 v[220:221], v[220:221], v[40:41] op_sel_hi:[1,0]
    v_pk_mul_f32 v[222:223], v[222:223], v[40:41] op_sel_hi:[1,0]
    v_pk_mul_f32 v[224:225], v[224:225], v[38:39] op_sel_hi:[1,0]
    v_pk_mul_f32 v[226:227], v[226:227], v[38:39] op_sel_hi:[1,0]
    v_pk_mul_f32 v[228:229], v[228:229], v[38:39] op_sel_hi:[1,0]
    v_pk_mul_f32 v[230:231], v[230:231], v[38:39] op_sel_hi:[1,0]
    v_pk_mul_f32 v[232:233], v[232:233], v[38:39] op_sel_hi:[1,0]
    v_pk_mul_f32 v[234:235], v[234:235], v[38:39] op_sel_hi:[1,0]
    v_pk_mul_f32 v[236:237], v[236:237], v[38:39] op_sel_hi:[1,0]
    v_pk_mul_f32 v[238:239], v[238:239], v[38:39] op_sel_hi:[1,0]
    v_pk_mul_f32 v[240:241], v[240:241], v[40:41] op_sel_hi:[1,0]
    v_pk_mul_f32 v[242:243], v[242:243], v[40:41] op_sel_hi:[1,0]
    v_pk_mul_f32 v[244:245], v[244:245], v[40:41] op_sel_hi:[1,0]
    v_pk_mul_f32 v[246:247], v[246:247], v[40:41] op_sel_hi:[1,0]
    v_pk_mul_f32 v[248:249], v[248:249], v[40:41] op_sel_hi:[1,0]
    v_pk_mul_f32 v[250:251], v[250:251], v[40:41] op_sel_hi:[1,0]
    v_pk_mul_f32 v[252:253], v[252:253], v[40:41] op_sel_hi:[1,0]
    v_pk_mul_f32 v[254:255], v[254:255], v[40:41] op_sel_hi:[1,0]
L_tp_a:
    ds_read_b32 v25, v22
    s_waitcnt lgkmcnt(0)
    v_readfirstlane_b32 s71, v25
    s_cmp_ge_i32 s71, s72
    s_cbranch_scc0 L_tp_a
    ds_read_b64_tr_b16 a[96:97], v16 offset:0
    ds_read_b64_tr_b16 a[98:99], v16 offset:2048
    ds_read_b64_tr_b16 a[100:101], v16 offset:4096
    ds_read_b64_tr_b16 a[102:103], v16 offset:6144
    ds_read_b64_tr_b16 a[104:105], v17 offset:0
    ds_read_b64_tr_b16 a[106:107], v17 offset:2048
    ds_read_b64_tr_b16 a[108:109], v17 offset:4096
    ds_read_b64_tr_b16 a[110:111], v17 offset:6144
    ds_read_b64_tr_b16 a[112:113], v18 offset:0
    ds_read_b64_tr_b16 a[114:115], v18 offset:2048
    ds_read_b64_tr_b16 a[116:117], v18 offset:4096
    ds_read_b64_tr_b16 a[118:119], v18 offset:6144
    v_mov_b32 v23, 2
    s_waitcnt lgkmcnt(10)
    v_mfma_f32_32x32x16_bf16 v[128:143], a[96:99], v[64:67], v[128:143]
    ds_read_b64_tr_b16 a[120:121], v19 offset:0
    ds_read_b64_tr_b16 a[122:123], v19 offset:2048
    ds_read_b64_tr_b16 a[124:125], v19 offset:4096
    ds_read_b64_tr_b16 a[126:127], v19 offset:6144
    s_waitcnt lgkmcnt(12)
    v_mfma_f32_32x32x16_bf16 v[128:143], a[100:103], v[68:71], v[128:143]
    s_waitcnt lgkmcnt(8)
    v_mfma_f32_32x32x16_bf16 v[160:175], a[104:107], v[64:67], v[160:175]
    s_nop 3
    v_mfma_f32_32x32x16_bf16 v[160:175], a[108:111], v[68:71], v[160:175]
    s_nop 3
    s_waitcnt lgkmcnt(0)
    v_mfma_f32_32x32x16_bf16 v[192:207], a[112:115], v[64:67], v[192:207]
    ds_write_b128 v96, v[128:131] offset:0
    v_mfma_f32_32x32x16_bf16 v[192:207], a[116:119], v[68:71], v[192:207]
    ds_write_b128 v97, v[132:135] offset:1024
    v_mfma_f32_32x32x16_bf16 v[224:239], a[120:123], v[64:67], v[224:239]
    ds_write_b128 v98, v[136:139] offset:2048
    v_mfma_f32_32x32x16_bf16 v[224:239], a[124:127], v[68:71], v[224:239]
    ds_write_b128 v99, v[140:143] offset:3072
    v_mfma_f32_32x32x16_bf16 v[144:159], a[96:99], v[72:75], v[144:159]
    ds_write_b128 v100, v[160:163] offset:8192
    ds_write_b128 v101, v[164:167] offset:9216
    v_mfma_f32_32x32x16_bf16 v[144:159], a[100:103], v[76:79], v[144:159]
    ds_write_b128 v102, v[168:171] offset:10240
    ds_write_b128 v103, v[172:175] offset:11264
    v_mfma_f32_32x32x16_bf16 v[176:191], a[104:107], v[72:75], v[176:191]
    ds_write_b128 v104, v[192:195] offset:16384
    ds_write_b128 v105, v[196:199] offset:17408
    v_mfma_f32_32x32x16_bf16 v[176:191], a[108:111], v[76:79], v[176:191]
    ds_write_b128 v106, v[200:203] offset:18432
    ds_write_b128 v107, v[204:207] offset:19456
    v_mfma_f32_32x32x16_bf16 v[208:223], a[112:115], v[72:75], v[208:223]
    ds_write_b128 v108, v[224:227] offset:24576
    ds_write_b128 v109, v[228:231] offset:25600
    v_mfma_f32_32x32x16_bf16 v[208:223], a[116:119], v[76:79], v[208:223]
    ds_write_b128 v110, v[232:235] offset:26624
    ds_write_b128 v111, v[236:239] offset:27648
    ds_write_b32 v26, v23
    v_mfma_f32_32x32x16_bf16 v[240:255], a[120:123], v[72:75], v[240:255]
    ds_write_b128 v96, v[144:147] offset:4096
    ds_write_b128 v97, v[148:151] offset:5120
    v_mfma_f32_32x32x16_bf16 v[240:255], a[124:127], v[76:79], v[240:255]
    ds_write_b128 v98, v[152:155] offset:6144
    ds_write_b128 v99, v[156:159] offset:7168
    v_mov_b32 v23, 3
    ds_write_b128 v100, v[176:179] offset:12288
    ds_write_b128 v101, v[180:183] offset:13312
    ds_write_b128 v102, v[184:187] offset:14336
    ds_write_b128 v103, v[188:191] offset:15360
    ds_write_b128 v104, v[208:211] offset:20480
    ds_write_b128 v105, v[212:215] offset:21504
    ds_write_b128 v106, v[216:219] offset:22528
    ds_write_b128 v107, v[220:223] offset:23552
    s_nop 3
    ds_write_b128 v108, v[240:243] offset:28672
    ds_write_b128 v109, v[244:247] offset:29696
    ds_write_b128 v110, v[248:251] offset:30720
    ds_write_b128 v111, v[252:255] offset:31744
    s_branch L_fin2
L_last_b:
    s_cmp_lg_u32 s62, 0
    s_cbranch_scc1 L_impb_b
L_impbr_b:
    v_permlane32_swap_b32 v30, v31
    v_lshlrev_b32 v48, 3, v1
    s_lshl_b32 s83, s86, 9
    s_add_u32 s83, s83, 116736
    v_add_u32 v49, s83, v48
    v_mov_b32 v50, v29
    v_add_f32 v51, v30, v31
    ds_write_b64 v49, v[50:51]
    v_mov_b32 v23, 1
    s_lshl_b32 s72, s75, 1
    s_add_u32 s72, s72, 9
    s_add_u32 s83, s75, s59
    s_min_i32 s72, s72, s83
    s_waitcnt lgkmcnt(0)
    ds_write_b32 v26, v23
    v_xor_b32 v48, 0, v1
    v_lshl_add_u32 v96, v48, 4, s74
    v_xor_b32 v48, 1, v1
    v_lshl_add_u32 v97, v48, 4, s74
    v_xor_b32 v48, 2, v1
    v_lshl_add_u32 v98, v48, 4, s74
    v_xor_b32 v48, 3, v1
    v_lshl_add_u32 v99, v48, 4, s74
    v_xor_b32 v48, 4, v1
    v_lshl_add_u32 v100, v48, 4, s74
    v_xor_b32 v48, 5, v1
    v_lshl_add_u32 v101, v48, 4, s74
    v_xor_b32 v48, 6, v1
    v_lshl_add_u32 v102, v48, 4, s74
    v_xor_b32 v48, 7, v1
    v_lshl_add_u32 v103, v48, 4, s74
    v_xor_b32 v48, 8, v1
    v_lshl_add_u32 v104, v48, 4, s74
    v_xor_b32 v48, 9, v1
    v_lshl_add_u32 v105, v48, 4, s74
    v_xor_b32 v48, 10, v1
    v_lshl_add_u32 v106, v48, 4, s74
    v_xor_b32 v48, 11, v1
    v_lshl_add_u32 v107, v48, 4, s74
    v_xor_b32 v48, 12, v1
    v_lshl_add_u32 v108, v48, 4, s74
    v_xor_b32 v48, 13, v1
    v_lshl_add_u32 v109, v48, 4, s74
    v_xor_b32 v48, 14, v1
    v_lshl_add_u32 v110, v48, 4, s74
    v_xor_b32 v48, 15, v1
    v_lshl_add_u32 v111, v48, 4, s74
    v_pk_mul_f32 v[128:129], v[128:129], v[42:43] op_sel_hi:[1,0]
    v_pk_mul_f32 v[130:131], v[130:131], v[42:43] op_sel_hi:[1,0]
    v_pk_mul_f32 v[132:133], v[132:133], v[42:43] op_sel_hi:[1,0]
    v_pk_mul_f32 v[134:135], v[134:135], v[42:43] op_sel_hi:[1,0]
    v_pk_mul_f32 v[136:137], v[136:137], v[42:43] op_sel_hi:[1,0]
    v_pk_mul_f32 v[138:139], v[138:139], v[42:43] op_sel_hi:[1,0]
    v_pk_mul_f32 v[140:141], v[140:141], v[42:43] op_sel_hi:[1,0]
    v_pk_mul_f32 v[142:143], v[142:143], v[42:43] op_sel_hi:[1,0]
    v_pk_mul_f32 v[144:145], v[144:145], v[44:45] op_sel_hi:[1,0]
    v_pk_mul_f32 v[146:147], v[146:147], v[44:45] op_sel_hi:[1,0]
    v_pk_mul_f32 v[148:149], v[148:149], v[44:45] op_sel_hi:[1,0]
    v_pk_mul_f32 v[150:151], v[150:151], v[44:45] op_sel_hi:[1,0]
    v_pk_mul_f32 v[152:153], v[152:153], v[44:45] op_sel_hi:[1,0]
    v_pk_mul_f32 v[154:155], v[154:155], v[44:45] op_sel_hi:[1,0]
    v_pk_mul_f32 v[156:157], v[156:157], v[44:45] op_sel_hi:[1,0]
    v_pk_mul_f32 v[158:159], v[158:159], v[44:45] op_sel_hi:[1,0]
    v_pk_mul_f32 v[160:161], v[160:161], v[42:43] op_sel_hi:[1,0]
    v_pk_mul_f32 v[162:163], v[162:163], v[42:43] op_sel_hi:[1,0]
    v_pk_mul_f32 v[164:165], v[164:165], v[42:43] op_sel_hi:[1,0]
    v_pk_mul_f32 v[166:167], v[166:167], v[42:43] op_sel_hi:[1,0]
    v_pk_mul_f32 v[168:169], v[168:169], v[42:43] op_sel_hi:[1,0]
    v_pk_mul_f32 v[170:171], v[170:171], v[42:43] op_sel_hi:[1,0]
    v_pk_mul_f32 v[172:173], v[172:173], v[42:43] op_sel_hi:[1,0]
    v_pk_mul_f32 v[174:175], v[174:175], v[42:43] op_sel_hi:[1,0]
    v_pk_mul_f32 v[176:177], v[176:177], v[44:45] op_sel_hi:[1,0]
    v_pk_mul_f32 v[178:179], v[178:179], v[44:45] op_sel_hi:[1,0]
    v_pk_mul_f32 v[180:181], v[180:181], v[44:45] op_sel_hi:[1,0]
    v_pk_mul_f32 v[182:183], v[182:183], v[44:45] op_sel_hi:[1,0]
    v_pk_mul_f32 v[184:185], v[184:185], v[44:45] op_sel_hi:[1,0]
    v_pk_mul_f32 v[186:187], v[186:187], v[44:45] op_sel_hi:[1,0]
    v_pk_mul_f32 v[188:189], v[188:189], v[44:45] op_sel_hi:[1,0]
    v_pk_mul_f32 v[190:191], v[190:191], v[44:45] op_sel_hi:[1,0]
    v_pk_mul_f32 v[192:193], v[192:193], v[42:43] op_sel_hi:[1,0]
    v_pk_mul_f32 v[194:195], v[194:195], v[42:43] op_sel_hi:[1,0]
    v_pk_mul_f32 v[196:197], v[196:197], v[42:43] op_sel_hi:[1,0]
    v_pk_mul_f32 v[198:199], v[198:199], v[42:43] op_sel_hi:[1,0]
    v_pk_mul_f32 v[200:201], v[200:201], v[42:43] op_sel_hi:[1,0]
    v_pk_mul_f32 v[202:203], v[202:203], v[42:43] op_sel_hi:[1,0]
    v_pk_mul_f32 v[204:205], v[204:205], v[42:43] op_sel_hi:[1,0]
    v_pk_mul_f32 v[206:207], v[206:207], v[42:43] op_sel_hi:[1,0]
    v_pk_mul_f32 v[208:209], v[208:209], v[44:45] op_sel_hi:[1,0]
    v_pk_mul_f32 v[210:211], v[210:211], v[44:45] op_sel_hi:[1,0]
    v_pk_mul_f32 v[212:213], v[212:213], v[44:45] op_sel_hi:[1,0]
    v_pk_mul_f32 v[214:215], v[214:215], v[44:45] op_sel_hi:[1,0]
    v_pk_mul_f32 v[216:217], v[216:217], v[44:45] op_sel_hi:[1,0]
    v_pk_mul_f32 v[218:219], v[218:219], v[44:45] op_sel_hi:[1,0]
    v_pk_mul_f32 v[220:221], v[220:221], v[44:45] op_sel_hi:[1,0]
    v_pk_mul_f32 v[222:223], v[222:223], v[44:45] op_sel_hi:[1,0]
    v_pk_mul_f32 v[224:225], v[224:225], v[42:43] op_sel_hi:[1,0]
    v_pk_mul_f32 v[226:227], v[226:227], v[42:43] op_sel_hi:[1,0]
    v_pk_mul_f32 v[228:229], v[228:229], v[42:43] op_sel_hi:[1,0]
    v_pk_mul_f32 v[230:231], v[230:231], v[42:43] op_sel_hi:[1,0]
    v_pk_mul_f32 v[232:233], v[232:233], v[42:43] op_sel_hi:[1,0]
    v_pk_mul_f32 v[234:235], v[234:235], v[42:43] op_sel_hi:[1,0]
    v_pk_mul_f32 v[236:237], v[236:237], v[42:43] op_sel_hi:[1,0]
    v_pk_mul_f32 v[238:239], v[238:239], v[42:43] op_sel_hi:[1,0]
    v_pk_mul_f32 v[240:241], v[240:241], v[44:45] op_sel_hi:[1,0]
    v_pk_mul_f32 v[242:243], v[242:243], v[44:45] op_sel_hi:[1,0]
    v_pk_mul_f32 v[244:245], v[244:245], v[44:45] op_sel_hi:[1,0]
    v_pk_mul_f32 v[246:247], v[246:247], v[44:45] op_sel_hi:[1,0]
    v_pk_mul_f32 v[248:249], v[248:249], v[44:45] op_sel_hi:[1,0]
    v_pk_mul_f32 v[250:251], v[250:251], v[44:45] op_sel_hi:[1,0]
    v_pk_mul_f32 v[252:253], v[252:253], v[44:45] op_sel_hi:[1,0]
    v_pk_mul_f32 v[254:255], v[254:255], v[44:45] op_sel_hi:[1,0]
L_tp_b:
    ds_read_b32 v25, v22
    s_waitcnt lgkmcnt(0)
    v_readfirstlane_b32 s71, v25
    s_cmp_ge_i32 s71, s72
    s_cbranch_scc0 L_tp_b
    ds_read_b64_tr_b16 a[96:97], v16 offset:16384
    ds_read_b64_tr_b16 a[98:99], v16 offset:18432
    ds_read_b64_tr_b16 a[100:101], v16 offset:20480
    ds_read_b64_tr_b16 a[102:103], v16 offset:22528
    ds_read_b64_tr_b16 a[104:105], v17 offset:16384
    ds_read_b64_tr_b16 a[106:107], v17 offset:18432
    ds_read_b64_tr_b16 a[108:109], v17 offset:20480
    ds_read_b64_tr_b16 a[110:111], v17 offset:22528
    ds_read_b64_tr_b16 a[112:113], v18 offset:16384
    ds_read_b64_tr_b16 a[114:115], v18 offset:18432
    ds_read_b64_tr_b16 a[116:117], v18 offset:20480
    ds_read_b64_tr_b16 a[118:119], v18 offset:22528
    v_mov_b32 v23, 2
    s_waitcnt lgkmcnt(10)
    v_mfma_f32_32x32x16_bf16 v[128:143], a[96:99], v[80:83], v[128:143]
    ds_read_b64_tr_b16 a[120:121], v19 offset:16384
    ds_read_b64_tr_b16 a[122:123], v19 offset:18432
    ds_read_b64_tr_b16 a[124:125], v19 offset:20480
    ds_read_b64_tr_b16 a[126:127], v19 offset:22528
    s_waitcnt lgkmcnt(12)
    v_mfma_f32_32x32x16_bf16 v[128:143], a[100:103], v[84:87], v[128:143]
    s_waitcnt lgkmcnt(8)
    v_mfma_f32_32x32x16_bf16 v[160:175], a[104:107], v[80:83], v[160:175]
    s_nop 3
    v_mfma_f32_32x32x16_bf16 v[160:175], a[108:111], v[84:87], v[160:175]
    s_nop 3
    s_waitcnt lgkmcnt(0)
    v_mfma_f32_32x32x16_bf16 v[192:207], a[112:115], v[80:83], v[192:207]
    ds_write_b128 v96, v[128:131] offset:0
    v_mfma_f32_32x32x16_bf16 v[192:207], a[116:119], v[84:87], v[192:207]
    ds_write_b128 v97, v[132:135] offset:1024
    v_mfma_f32_32x32x16_bf16 v[224:239], a[120:123], v[80:83], v[224:239]
    ds_write_b128 v98, v[136:139] offset:2048
    v_mfma_f32_32x32x16_bf16 v[224:239], a[124:127], v[84:87], v[224:239]
    ds_write_b128 v99, v[140:143] offset:3072
    v_mfma_f32_32x32x16_bf16 v[144:159], a[96:99], v[88:91], v[144:159]
    ds_write_b128 v100, v[160:163] offset:8192
    ds_write_b128 v101, v[164:167] offset:9216
    v_mfma_f32_32x32x16_bf16 v[144:159], a[100:103], v[92:95], v[144:159]
    ds_write_b128 v102, v[168:171] offset:10240
    ds_write_b128 v103, v[172:175] offset:11264
    v_mfma_f32_32x32x16_bf16 v[176:191], a[104:107], v[88:91], v[176:191]
    ds_write_b128 v104, v[192:195] offset:16384
    ds_write_b128 v105, v[196:199] offset:17408
    v_mfma_f32_32x32x16_bf16 v[176:191], a[108:111], v[92:95], v[176:191]
    ds_write_b128 v106, v[200:203] offset:18432
    ds_write_b128 v107, v[204:207] offset:19456
    v_mfma_f32_32x32x16_bf16 v[208:223], a[112:115], v[88:91], v[208:223]
    ds_write_b128 v108, v[224:227] offset:24576
    ds_write_b128 v109, v[228:231] offset:25600
    v_mfma_f32_32x32x16_bf16 v[208:223], a[116:119], v[92:95], v[208:223]
    ds_write_b128 v110, v[232:235] offset:26624
    ds_write_b128 v111, v[236:239] offset:27648
    ds_write_b32 v26, v23
    v_mfma_f32_32x32x16_bf16 v[240:255], a[120:123], v[88:91], v[240:255]
    ds_write_b128 v96, v[144:147] offset:4096
    ds_write_b128 v97, v[148:151] offset:5120
    v_mfma_f32_32x32x16_bf16 v[240:255], a[124:127], v[92:95], v[240:255]
    ds_write_b128 v98, v[152:155] offset:6144
    ds_write_b128 v99, v[156:159] offset:7168
    v_mov_b32 v23, 3
    ds_write_b128 v100, v[176:179] offset:12288
    ds_write_b128 v101, v[180:183] offset:13312
    ds_write_b128 v102, v[184:187] offset:14336
    ds_write_b128 v103, v[188:191] offset:15360
    ds_write_b128 v104, v[208:211] offset:20480
    ds_write_b128 v105, v[212:215] offset:21504
    ds_write_b128 v106, v[216:219] offset:22528
    ds_write_b128 v107, v[220:223] offset:23552
    s_nop 3
    ds_write_b128 v108, v[240:243] offset:28672
    ds_write_b128 v109, v[244:247] offset:29696
    ds_write_b128 v110, v[248:251] offset:30720
    ds_write_b128 v111, v[252:255] offset:31744
    s_branch L_fin2
L_lhelp:
    s_waitcnt vmcnt(24)
    s_lshr_b32 s83, s57, 17
    s_lshl_b32 s83, s83, 9
    v_add_u32 v48, s83, v6
    global_load_dwordx2 v[50:51], v48, s[22:23]
    s_mov_b32 m0, 119808
    s_add_u32 s83, s57, 0
    buffer_load_dwordx4 v16, s[12:15], s83 offen offset:0 nt lds
    buffer_load_dwordx4 v17, s[12:15], s83 offen offset:1024 nt lds
    buffer_load_dwordx4 v18, s[12:15], s83 offen offset:2048 nt lds
    buffer_load_dwordx4 v19, s[12:15], s83 offen offset:3072 nt lds
    s_mov_b32 m0, 123904
    s_add_u32 s83, s57, 4096
    buffer_load_dwordx4 v16, s[12:15], s83 offen offset:0 nt lds
    buffer_load_dwordx4 v17, s[12:15], s83 offen offset:1024 nt lds
    buffer_load_dwordx4 v18, s[12:15], s83 offen offset:2048 nt lds
    buffer_load_dwordx4 v19, s[12:15], s83 offen offset:3072 nt lds
    s_mov_b32 m0, 128000
    s_add_u32 s83, s57, 8192
    buffer_load_dwordx4 v16, s[12:15], s83 offen offset:0 nt lds
    buffer_load_dwordx4 v17, s[12:15], s83 offen offset:1024 nt lds
    buffer_load_dwordx4 v18, s[12:15], s83 offen offset:2048 nt lds
    buffer_load_dwordx4 v19, s[12:15], s83 offen offset:3072 nt lds
    s_mov_b32 m0, 132096
    s_add_u32 s83, s57, 12288
    buffer_load_dwordx4 v16, s[12:15], s83 offen offset:0 nt lds
    buffer_load_dwordx4 v17, s[12:15], s83 offen offset:1024 nt lds
    buffer_load_dwordx4 v18, s[12:15], s83 offen offset:2048 nt lds
    buffer_load_dwordx4 v19, s[12:15], s83 offen offset:3072 nt lds
    s_mov_b32 s12, s26
    s_mov_b32 s13, s27
    s_add_u32 s68, s63, 15
    s_lshr_b32 s68, s68, 4
    v_cmp_gt_u32 vcc, s68, v5
    v_cmp_gt_u32 s[32:33], s68, v7
    v_mov_b32 v62, v20
    v_mov_b32 v63, v21
    v_add_u32 v8, s55, v8
    v_add_u32 v9, s55, v9
    v_add_u32 v10, s55, v10
    v_add_u32 v11, s55, v11
    v_add_u32 v12, s55, v12
    v_add_u32 v13, s55, v13
    v_add_u32 v14, s55, v14
    v_add_u32 v15, s55, v15
    s_cmp_eq_u32 s64, 0
    s_cselect_b32 s65, 2048, s64
    s_add_u32 s77, s65, 31
    s_lshr_b32 s77, s77, 5
    s_cmp_eq_u32 s52, 2
    s_cselect_b32 s77, s46, s77
    s_sub_u32 s67, s77, s53
    s_sub_u32 s83, s67, 1
    s_mul_i32 s84, s83, 171
    s_lshr_b32 s84, s84, 9
    s_mul_i32 s84, s84, 3
    s_sub_u32 s83, s83, s84
    s_sub_u32 s58, 5, s83
    s_cmp_ge_u32 s58, 3
    s_cselect_b32 s84, 3, 0
    s_sub_u32 s58, s58, s84
    s_waitcnt vmcnt(16)
    v_lshlrev_b32 v50, 15, v50
    v_lshlrev_b32 v51, 15, v51
    v_cndmask_b32 v20, v61, v50, vcc
    v_cndmask_b32 v21, v61, v51, s[32:33]
    s_branch L_ljob
L_poll_q:
    ds_read_b32 v25, v22
    s_waitcnt lgkmcnt(0)
    v_readfirstlane_b32 s71, v25
    s_cmp_ge_i32 s71, s72
    s_cbranch_scc1 L_ok_q
    s_branch L_poll_q
L_poll_k0:
    ds_read_b32 v25, v22
    s_waitcnt lgkmcnt(0)
    v_readfirstlane_b32 s71, v25
    s_cmp_ge_i32 s71, s72
    s_cbranch_scc1 L_ok_k0
    s_branch L_poll_k0
L_mask_fa:
    v_cmp_gt_i32 vcc, v28, 0
    v_cmp_gt_i32 s[32:33], v28, 1
    v_cmp_gt_i32 s[34:35], v28, 2
    v_cmp_gt_i32 s[36:37], v28, 3
    s_nop 1
    v_cndmask_b32 v96, v27, v96, vcc
    v_cndmask_b32 v112, v27, v112, vcc
    v_cndmask_b32 v97, v27, v97, s[32:33]
    v_cndmask_b32 v113, v27, v113, s[32:33]
    v_cndmask_b32 v98, v27, v98, s[34:35]
    v_cndmask_b32 v114, v27, v114, s[34:35]
    v_cndmask_b32 v99, v27, v99, s[36:37]
    v_cndmask_b32 v115, v27, v115, s[36:37]
    v_cmp_gt_i32 vcc, v28, 8
    v_cmp_gt_i32 s[32:33], v28, 9
    v_cmp_gt_i32 s[34:35], v28, 10
    v_cmp_gt_i32 s[36:37], v28, 11
    s_nop 1
    v_cndmask_b32 v100, v27, v100, vcc
    v_cndmask_b32 v116, v27, v116, vcc
    v_cndmask_b32 v101, v27, v101, s[32:33]
    v_cndmask_b32 v117, v27, v117, s[32:33]
    v_cndmask_b32 v102, v27, v102, s[34:35]
    v_cndmask_b32 v118, v27, v118, s[34:35]
    v_cndmask_b32 v103, v27, v103, s[36:37]
    v_cndmask_b32 v119, v27, v119, s[36:37]
    v_cmp_gt_i32 vcc, v28, 16
    v_cmp_gt_i32 s[32:33], v28, 17
    v_cmp_gt_i32 s[34:35], v28, 18
    v_cmp_gt_i32 s[36:37], v28, 19
    s_nop 1
    v_cndmask_b32 v104, v27, v104, vcc
    v_cndmask_b32 v120, v27, v120, vcc
    v_cndmask_b32 v105, v27, v105, s[32:33]
    v_cndmask_b32 v121, v27, v121, s[32:33]
    v_cndmask_b32 v106, v27, v106, s[34:35]
    v_cndmask_b32 v122, v27, v122, s[34:35]
    v_cndmask_b32 v107, v27, v107, s[36:37]
    v_cndmask_b32 v123, v27, v123, s[36:37]
    v_cmp_gt_i32 vcc, v28, 24
    v_cmp_gt_i32 s[32:33], v28, 25
    v_cmp_gt_i32 s[34:35], v28, 26
    v_cmp_gt_i32 s[36:37], v28, 27
    s_nop 1
    v_cndmask_b32 v108, v27, v108, vcc
    v_cndmask_b32 v124, v27, v124, vcc
    v_cndmask_b32 v109, v27, v109, s[32:33]
    v_cndmask_b32 v125, v27, v125, s[32:33]
    v_cndmask_b32 v110, v27, v110, s[34:35]
    v_cndmask_b32 v126, v27, v126, s[34:35]
    v_cndmask_b32 v111, v27, v111, s[36:37]
    v_cndmask_b32 v127, v27, v127, s[36:37]
    s_branch L_nomask_fa
L_poll_ka:
    ds_read_b32 v25, v22
    s_waitcnt lgkmcnt(0)
    v_readfirstlane_b32 s71, v25
    s_cmp_ge_i32 s71, s72
    s_cbranch_scc1 L_ok_ka
    s_branch L_poll_ka
L_mask_a:
    v_cmp_gt_i32 vcc, v28, 0
    v_cmp_gt_i32 s[32:33], v28, 1
    v_cmp_gt_i32 s[34:35], v28, 2
    v_cmp_gt_i32 s[36:37], v28, 3
    s_nop 1
    v_cndmask_b32 v96, v27, v96, vcc
    v_cndmask_b32 v112, v27, v112, vcc
    v_cndmask_b32 v97, v27, v97, s[32:33]
    v_cndmask_b32 v113, v27, v113, s[32:33]
    v_cndmask_b32 v98, v27, v98, s[34:35]
    v_cndmask_b32 v114, v27, v114, s[34:35]
    v_cndmask_b32 v99, v27, v99, s[36:37]
    v_cndmask_b32 v115, v27, v115, s[36:37]
    v_cmp_gt_i32 vcc, v28, 8
    v_cmp_gt_i32 s[32:33], v28, 9
    v_cmp_gt_i32 s[34:35], v28, 10
    v_cmp_gt_i32 s[36:37], v28, 11
    s_nop 1
    v_cndmask_b32 v100, v27, v100, vcc
    v_cndmask_b32 v116, v27, v116, vcc
    v_cndmask_b32 v101, v27, v101, s[32:33]
    v_cndmask_b32 v117, v27, v117, s[32:33]
    v_cndmask_b32 v102, v27, v102, s[34:35]
    v_cndmask_b32 v118, v27, v118, s[34:35]
    v_cndmask_b32 v103, v27, v103, s[36:37]
    v_cndmask_b32 v119, v27, v119, s[36:37]
    v_cmp_gt_i32 vcc, v28, 16
    v_cmp_gt_i32 s[32:33], v28, 17
    v_cmp_gt_i32 s[34:35], v28, 18
    v_cmp_gt_i32 s[36:37], v28, 19
    s_nop 1
    v_cndmask_b32 v104, v27, v104, vcc
    v_cndmask_b32 v120, v27, v120, vcc
    v_cndmask_b32 v105, v27, v105, s[32:33]
    v_cndmask_b32 v121, v27, v121, s[32:33]
    v_cndmask_b32 v106, v27, v106, s[34:35]
    v_cndmask_b32 v122, v27, v122, s[34:35]
    v_cndmask_b32 v107, v27, v107, s[36:37]
    v_cndmask_b32 v123, v27, v123, s[36:37]
    v_cmp_gt_i32 vcc, v28, 24
    v_cmp_gt_i32 s[32:33], v28, 25
    v_cmp_gt_i32 s[34:35], v28, 26
    v_cmp_gt_i32 s[36:37], v28, 27
    s_nop 1
    v_cndmask_b32 v108, v27, v108, vcc
    v_cndmask_b32 v124, v27, v124, vcc
    v_cndmask_b32 v109, v27, v109, s[32:33]
    v_cndmask_b32 v125, v27, v125, s[32:33]
    v_cndmask_b32 v110, v27, v110, s[34:35]
    v_cndmask_b32 v126, v27, v126, s[34:35]
    v_cndmask_b32 v111, v27, v111, s[36:37]
    v_cndmask_b32 v127, v27, v127, s[36:37]
    s_branch L_nomask_a
L_poll_va:
    ds_read_b32 v25, v22
    s_waitcnt lgkmcnt(0)
    v_readfirstlane_b32 s71, v25
    s_cmp_ge_i32 s71, s72
    s_cbranch_scc1 L_ok_va
    s_branch L_poll_va
L_imp_a:
    s_cmp_eq_u32 s62, 2
    s_cbranch_scc1 L_imp2_a
    s_add_u32 s84, s75, 18
    s_cmp_lt_u32 s84, s67
    s_cbranch_scc1 L_impr_a
    global_load_dword v63, v62, s[28:29] sc1
    s_add_u32 s62, s62, 1
    s_branch L_impr_a
L_imp2_a:
    s_waitcnt vmcnt(0)
    v_readfirstlane_b32 s84, v63
    s_cmp_eq_u32 s84, 0
    s_addc_u32 s62, 0, 0
    s_branch L_impr_a
L_poll_kb:
    ds_read_b32 v25, v22
    s_waitcnt lgkmcnt(0)
    v_readfirstlane_b32 s71, v25
    s_cmp_ge_i32 s71, s72
    s_cbranch_scc1 L_ok_kb
    s_branch L_poll_kb
L_mask_b:
    v_cmp_gt_i32 vcc, v28, 0
    v_cmp_gt_i32 s[32:33], v28, 1
    v_cmp_gt_i32 s[34:35], v28, 2
    v_cmp_gt_i32 s[36:37], v28, 3
    s_nop 1
    v_cndmask_b32 v96, v27, v96, vcc
    v_cndmask_b32 v112, v27, v112, vcc
    v_cndmask_b32 v97, v27, v97, s[32:33]
    v_cndmask_b32 v113, v27, v113, s[32:33]
    v_cndmask_b32 v98, v27, v98, s[34:35]
    v_cndmask_b32 v114, v27, v114, s[34:35]
    v_cndmask_b32 v99, v27, v99, s[36:37]
    v_cndmask_b32 v115, v27, v115, s[36:37]
    v_cmp_gt_i32 vcc, v28, 8
    v_cmp_gt_i32 s[32:33], v28, 9
    v_cmp_gt_i32 s[34:35], v28, 10
    v_cmp_gt_i32 s[36:37], v28, 11
    s_nop 1
    v_cndmask_b32 v100, v27, v100, vcc
    v_cndmask_b32 v116, v27, v116, vcc
    v_cndmask_b32 v101, v27, v101, s[32:33]
    v_cndmask_b32 v117, v27, v117, s[32:33]
    v_cndmask_b32 v102, v27, v102, s[34:35]
    v_cndmask_b32 v118, v27, v118, s[34:35]
    v_cndmask_b32 v103, v27, v103, s[36:37]
    v_cndmask_b32 v119, v27, v119, s[36:37]
    v_cmp_gt_i32 vcc, v28, 16
    v_cmp_gt_i32 s[32:33], v28, 17
    v_cmp_gt_i32 s[34:35], v28, 18
    v_cmp_gt_i32 s[36:37], v28, 19
    s_nop 1
    v_cndmask_b32 v104, v27, v104, vcc
    v_cndmask_b32 v120, v27, v120, vcc
    v_cndmask_b32 v105, v27, v105, s[32:33]
    v_cndmask_b32 v121, v27, v121, s[32:33]
    v_cndmask_b32 v106, v27, v106, s[34:35]
    v_cndmask_b32 v122, v27, v122, s[34:35]
    v_cndmask_b32 v107, v27, v107, s[36:37]
    v_cndmask_b32 v123, v27, v123, s[36:37]
    v_cmp_gt_i32 vcc, v28, 24
    v_cmp_gt_i32 s[32:33], v28, 25
    v_cmp_gt_i32 s[34:35], v28, 26
    v_cmp_gt_i32 s[36:37], v28, 27
    s_nop 1
    v_cndmask_b32 v108, v27, v108, vcc
    v_cndmask_b32 v124, v27, v124, vcc
    v_cndmask_b32 v109, v27, v109, s[32:33]
    v_cndmask_b32 v125, v27, v125, s[32:33]
    v_cndmask_b32 v110, v27, v110, s[34:35]
    v_cndmask_b32 v126, v27, v126, s[34:35]
    v_cndmask_b32 v111, v27, v111, s[36:37]
    v_cndmask_b32 v127, v27, v127, s[36:37]
    s_branch L_nomask_b
L_poll_vb:
    ds_read_b32 v25, v22
    s_waitcnt lgkmcnt(0)
    v_readfirstlane_b32 s71, v25
    s_cmp_ge_i32 s71, s72
    s_cbranch_scc1 L_ok_vb
    s_branch L_poll_vb
L_imp_b:
    s_cmp_eq_u32 s62, 2
    s_cbranch_scc1 L_imp2_b
    s_add_u32 s84, s75, 18
    s_cmp_lt_u32 s84, s67
    s_cbranch_scc1 L_impr_b
    global_load_dword v63, v62, s[28:29] sc1
    s_add_u32 s62, s62, 1
    s_branch L_impr_b
L_imp2_b:
    s_waitcnt vmcnt(0)
    v_readfirstlane_b32 s84, v63
    s_cmp_eq_u32 s84, 0
    s_addc_u32 s62, 0, 0
    s_branch L_impr_b
L_mask_fb:
    v_cmp_gt_i32 vcc, v28, 0
    v_cmp_gt_i32 s[32:33], v28, 1
    v_cmp_gt_i32 s[34:35], v28, 2
    v_cmp_gt_i32 s[36:37], v28, 3
    s_nop 1
    v_cndmask_b32 v96, v27, v96, vcc
    v_cndmask_b32 v112, v27, v112, vcc
    v_cndmask_b32 v97, v27, v97, s[32:33]
    v_cndmask_b32 v113, v27, v113, s[32:33]
    v_cndmask_b32 v98, v27, v98, s[34:35]
    v_cndmask_b32 v114, v27, v114, s[34:35]
    v_cndmask_b32 v99, v27, v99, s[36:37]
    v_cndmask_b32 v115, v27, v115, s[36:37]
    v_cmp_gt_i32 vcc, v28, 8
    v_cmp_gt_i32 s[32:33], v28, 9
    v_cmp_gt_i32 s[34:35], v28, 10
    v_cmp_gt_i32 s[36:37], v28, 11
    s_nop 1
    v_cndmask_b32 v100, v27, v100, vcc
    v_cndmask_b32 v116, v27, v116, vcc
    v_cndmask_b32 v101, v27, v101, s[32:33]
    v_cndmask_b32 v117, v27, v117, s[32:33]
    v_cndmask_b32 v102, v27, v102, s[34:35]
    v_cndmask_b32 v118, v27, v118, s[34:35]
    v_cndmask_b32 v103, v27, v103, s[36:37]
    v_cndmask_b32 v119, v27, v119, s[36:37]
    v_cmp_gt_i32 vcc, v28, 16
    v_cmp_gt_i32 s[32:33], v28, 17
    v_cmp_gt_i32 s[34:35], v28, 18
    v_cmp_gt_i32 s[36:37], v28, 19
    s_nop 1
    v_cndmask_b32 v104, v27, v104, vcc
    v_cndmask_b32 v120, v27, v120, vcc
    v_cndmask_b32 v105, v27, v105, s[32:33]
    v_cndmask_b32 v121, v27, v121, s[32:33]
    v_cndmask_b32 v106, v27, v106, s[34:35]
    v_cndmask_b32 v122, v27, v122, s[34:35]
    v_cndmask_b32 v107, v27, v107, s[36:37]
    v_cndmask_b32 v123, v27, v123, s[36:37]
    v_cmp_gt_i32 vcc, v28, 24
    v_cmp_gt_i32 s[32:33], v28, 25
    v_cmp_gt_i32 s[34:35], v28, 26
    v_cmp_gt_i32 s[36:37], v28, 27
    s_nop 1
    v_cndmask_b32 v108, v27, v108, vcc
    v_cndmask_b32 v124, v27, v124, vcc
    v_cndmask_b32 v109, v27, v109, s[32:33]
    v_cndmask_b32 v125, v27, v125, s[32:33]
    v_cndmask_b32 v110, v27, v110, s[34:35]
    v_cndmask_b32 v126, v27, v126, s[34:35]
    v_cndmask_b32 v111, v27, v111, s[36:37]
    v_cndmask_b32 v127, v27, v127, s[36:37]
    s_branch L_nomask_fb
L_impb_a:
    global_load_dword v63, v62, s[28:29] sc1
    s_waitcnt vmcnt(0)
    v_readfirstlane_b32 s84, v63
    s_cmp_eq_u32 s84, 0
    s_cbranch_scc1 L_impb_a
    s_branch L_impbr_a
L_impb_b:
    global_load_dword v63, v62, s[28:29] sc1
    s_waitcnt vmcnt(0)
    v_readfirstlane_b32 s84, v63
    s_cmp_eq_u32 s84, 0
    s_cbranch_scc1 L_impb_b
    s_branch L_impbr_b
L_notiles:
    v_permlane32_swap_b32 v30, v31
    v_lshlrev_b32 v48, 3, v1
    s_lshl_b32 s83, s86, 9
    s_add_u32 s83, s83, 116736
    v_add_u32 v49, s83, v48
    v_mov_b32 v50, v29
    v_add_f32 v51, v30, v31
    ds_write_b64 v49, v[50:51]
    v_xor_b32 v48, 0, v1
    v_lshl_add_u32 v96, v48, 4, s74
    v_xor_b32 v48, 1, v1
    v_lshl_add_u32 v97, v48, 4, s74
    v_xor_b32 v48, 2, v1
    v_lshl_add_u32 v98, v48, 4, s74
    v_xor_b32 v48, 3, v1
    v_lshl_add_u32 v99, v48, 4, s74
    v_xor_b32 v48, 4, v1
    v_lshl_add_u32 v100, v48, 4, s74
    v_xor_b32 v48, 5, v1
    v_lshl_add_u32 v101, v48, 4, s74
    v_xor_b32 v48, 6, v1
    v_lshl_add_u32 v102, v48, 4, s74
    v_xor_b32 v48, 7, v1
    v_lshl_add_u32 v103, v48, 4, s74
    v_xor_b32 v48, 8, v1
    v_lshl_add_u32 v104, v48, 4, s74
    v_xor_b32 v48, 9, v1
    v_lshl_add_u32 v105, v48, 4, s74
    v_xor_b32 v48, 10, v1
    v_lshl_add_u32 v106, v48, 4, s74
    v_xor_b32 v48, 11, v1
    v_lshl_add_u32 v107, v48, 4, s74
    v_xor_b32 v48, 12, v1
    v_lshl_add_u32 v108, v48, 4, s74
    v_xor_b32 v48, 13, v1
    v_lshl_add_u32 v109, v48, 4, s74
    v_xor_b32 v48, 14, v1
    v_lshl_add_u32 v110, v48, 4, s74
    v_xor_b32 v48, 15, v1
    v_lshl_add_u32 v111, v48, 4, s74
    v_mov_b32 v23, 3
    ds_write_b128 v96, v[128:131] offset:0
    ds_write_b128 v97, v[132:135] offset:1024
    ds_write_b128 v98, v[136:139] offset:2048
    ds_write_b128 v99, v[140:143] offset:3072
    ds_write_b128 v96, v[144:147] offset:4096
    ds_write_b128 v97, v[148:151] offset:5120
    ds_write_b128 v98, v[152:155] offset:6144
    ds_write_b128 v99, v[156:159] offset:7168
    ds_write_b128 v100, v[160:163] offset:8192
    ds_write_b128 v101, v[164:167] offset:9216
    ds_write_b128 v102, v[168:171] offset:10240
    ds_write_b128 v103, v[172:175] offset:11264
    ds_write_b128 v100, v[176:179] offset:12288
    ds_write_b128 v101, v[180:183] offset:13312
    ds_write_b128 v102, v[184:187] offset:14336
    ds_write_b128 v103, v[188:191] offset:15360
    ds_write_b128 v104, v[192:195] offset:16384
    ds_write_b128 v105, v[196:199] offset:17408
    ds_write_b128 v106, v[200:203] offset:18432
    ds_write_b128 v107, v[204:207] offset:19456
    ds_write_b128 v104, v[208:211] offset:20480
    ds_write_b128 v105, v[212:215] offset:21504
    ds_write_b128 v106, v[216:219] offset:22528
    ds_write_b128 v107, v[220:223] offset:23552
    ds_write_b128 v108, v[224:227] offset:24576
    ds_write_b128 v109, v[228:231] offset:25600
    ds_write_b128 v110, v[232:235] offset:26624
    ds_write_b128 v111, v[236:239] offset:27648
    ds_write_b128 v108, v[240:243] offset:28672
    ds_write_b128 v109, v[244:247] offset:29696
    ds_write_b128 v110, v[248:251] offset:30720
    ds_write_b128 v111, v[252:255] offset:31744
L_fin2:
    ds_write_b32 v26, v23
    s_cmp_eq_u32 s86, 0
    s_cbranch_scc1 L_red_a
    s_cmp_eq_u32 s86, 2
    s_cbranch_scc1 L_red_c
    s_cmp_eq_u32 s52, 1
    s_cbranch_scc1 L_reduce_b1
    s_cmp_eq_u32 s52, 2
    s_cbranch_scc1 L_reduce_b2
L_reduce_b0:
    ds_read_b32 v43, v59
    s_waitcnt lgkmcnt(0)
    v_readlane_b32 s40, v43, 0
    v_readlane_b32 s41, v43, 1
    v_readlane_b32 s42, v43, 2
    v_readlane_b32 s43, v43, 3
    s_min_u32 s82, s40, s41
    s_min_u32 s82, s82, s42
    s_cmp_ge_u32 s82, 1
    s_cbranch_scc0 L_reduce_b0
    s_cmp_ge_u32 s43, 1
    s_cbranch_scc0 L_rpg_b0
L_rpg_b0r:
    ds_read_b128 v[64:67], v57 offset:0
    ds_read_b128 v[68:71], v57 offset:64
    ds_read_b128 v[72:75], v57 offset:128
    ds_read_b128 v[76:79], v57 offset:512
    ds_read_b128 v[80:83], v57 offset:576
    ds_read_b128 v[84:87], v57 offset:640
    s_cmp_ge_u32 s40, 3
    s_cbranch_scc0 L_rpa_b0
L_rpa_b0r:
    s_waitcnt lgkmcnt(3)
    ds_read_b128 v[192:195], v52 offset:0
    ds_read_b128 v[196:199], v52 offset:512
    ds_read_b128 v[200:203], v53 offset:0
    ds_read_b128 v[204:207], v53 offset:512
    ds_read_b128 v[208:211], v54 offset:0
    ds_read_b128 v[212:215], v54 offset:512
    ds_read_b128 v[216:219], v52 offset:4096
    ds_read_b128 v[220:223], v52 offset:4608
    ds_read_b128 v[224:227], v53 offset:4096
    ds_read_b128 v[228:231], v53 offset:4608
    ds_read_b128 v[232:235], v54 offset:4096
    ds_read_b128 v[236:239], v54 offset:4608
    s_waitcnt lgkmcnt(10)
    v_pk_mul_f32 v[128:129], v[192:193], v[64:65] op_sel:[0,0] op_sel_hi:[1,0]
    v_pk_mul_f32 v[130:131], v[194:195], v[64:65] op_sel:[0,0] op_sel_hi:[1,0]
    v_pk_mul_f32 v[132:133], v[196:197], v[64:65] op_sel:[0,0] op_sel_hi:[1,0]
    v_pk_mul_f32 v[134:135], v[198:199], v[64:65] op_sel:[0,0] op_sel_hi:[1,0]
    s_waitcnt lgkmcnt(8)
    v_pk_mul_f32 v[136:137], v[200:201], v[68:69] op_sel:[0,0] op_sel_hi:[1,0]
    v_pk_mul_f32 v[138:139], v[202:203], v[68:69] op_sel:[0,0] op_sel_hi:[1,0]
    v_pk_mul_f32 v[140:141], v[204:205], v[68:69] op_sel:[0,0] op_sel_hi:[1,0]
    v_pk_mul_f32 v[142:143], v[206:207], v[68:69] op_sel:[0,0] op_sel_hi:[1,0]
    s_waitcnt lgkmcnt(6)
    v_pk_mul_f32 v[144:145], v[208:209], v[72:73] op_sel:[0,0] op_sel_hi:[1,0]
    v_pk_mul_f32 v[146:147], v[210:211], v[72:73] op_sel:[0,0] op_sel_hi:[1,0]
    v_pk_mul_f32 v[148:149], v[212:213], v[72:73] op_sel:[0,0] op_sel_hi:[1,0]
    v_pk_mul_f32 v[150:151], v[214:215], v[72:73] op_sel:[0,0] op_sel_hi:[1,0]
    s_waitcnt lgkmcnt(4)
    v_pk_mul_f32 v[152:153], v[216:217], v[76:77] op_sel:[0,0] op_sel_hi:[1,0]
    v_pk_mul_f32 v[154:155], v[218:219], v[76:77] op_sel:[0,0] op_sel_hi:[1,0]
    v_pk_mul_f32 v[156:157], v[220:221], v[76:77] op_sel:[0,0] op_sel_hi:[1,0]
    v_pk_mul_f32 v[158:159], v[222:223], v[76:77] op_sel:[0,0] op_sel_hi:[1,0]
    s_waitcnt lgkmcnt(2)
    v_pk_mul_f32 v[160:161], v[224:225], v[80:81] op_sel:[0,0] op_sel_hi:[1,0]
    v_pk_mul_f32 v[162:163], v[226:227], v[80:81] op_sel:[0,0] op_sel_hi:[1,0]
    v_pk_mul_f32 v[164:165], v[228:229], v[80:81] op_sel:[0,0] op_sel_hi:[1,0]
    v_pk_mul_f32 v[166:167], v[230:231], v[80:81] op_sel:[0,0] op_sel_hi:[1,0]
    s_waitcnt lgkmcnt(0)
    v_pk_mul_f32 v[168:169], v[232:233], v[84:85] op_sel:[0,0] op_sel_hi:[1,0]
    v_pk_mul_f32 v[170:171], v[234:235], v[84:85] op_sel:[0,0] op_sel_hi:[1,0]
    v_pk_mul_f32 v[172:173], v[236:237], v[84:85] op_sel:[0,0] op_sel_hi:[1,0]
    v_pk_mul_f32 v[174:175], v[238:239], v[84:85] op_sel:[0,0] op_sel_hi:[1,0]
    v_add_u32 v52, 0x8000, v52
    v_add_u32 v53, 0x8000, v53
    v_add_u32 v54, 0x8000, v54
    s_cmp_ge_u32 s41, 3
    s_cbranch_scc0 L_rpb_b0
L_rpb_b0r:
    s_waitcnt lgkmcnt(3)
    ds_read_b128 v[192:195], v52 offset:0
    ds_read_b128 v[196:199], v52 offset:512
    ds_read_b128 v[200:203], v53 offset:0
    ds_read_b128 v[204:207], v53 offset:512
    ds_read_b128 v[208:211], v54 offset:0
    ds_read_b128 v[212:215], v54 offset:512
    ds_read_b128 v[216:219], v52 offset:4096
    ds_read_b128 v[220:223], v52 offset:4608
    ds_read_b128 v[224:227], v53 offset:4096
    ds_read_b128 v[228:231], v53 offset:4608
    ds_read_b128 v[232:235], v54 offset:4096
    ds_read_b128 v[236:239], v54 offset:4608
    s_waitcnt lgkmcnt(10)
    v_pk_fma_f32 v[128:129], v[192:193], v[64:65], v[128:129] op_sel:[0,1,0] op_sel_hi:[1,1,1]
    v_pk_fma_f32 v[130:131], v[194:195], v[64:65], v[130:131] op_sel:[0,1,0] op_sel_hi:[1,1,1]
    v_pk_fma_f32 v[132:133], v[196:197], v[64:65], v[132:133] op_sel:[0,1,0] op_sel_hi:[1,1,1]
    v_pk_fma_f32 v[134:135], v[198:199], v[64:65], v[134:135] op_sel:[0,1,0] op_sel_hi:[1,1,1]
    s_waitcnt lgkmcnt(8)
    v_pk_fma_f32 v[136:137], v[200:201], v[68:69], v[136:137] op_sel:[0,1,0] op_sel_hi:[1,1,1]
    v_pk_fma_f32 v[138:139], v[202:203], v[68:69], v[138:139] op_sel:[0,1,0] op_sel_hi:[1,1,1]
    v_pk_fma_f32 v[140:141], v[204:205], v[68:69], v[140:141] op_sel:[0,1,0] op_sel_hi:[1,1,1]
    v_pk_fma_f32 v[142:143], v[206:207], v[68:69], v[142:143] op_sel:[0,1,0] op_sel_hi:[1,1,1]
    s_waitcnt lgkmcnt(6)
    v_pk_fma_f32 v[144:145], v[208:209], v[72:73], v[144:145] op_sel:[0,1,0] op_sel_hi:[1,1,1]
    v_pk_fma_f32 v[146:147], v[210:211], v[72:73], v[146:147] op_sel:[0,1,0] op_sel_hi:[1,1,1]
    v_pk_fma_f32 v[148:149], v[212:213], v[72:73], v[148:149] op_sel:[0,1,0] op_sel_hi:[1,1,1]
    v_pk_fma_f32 v[150:151], v[214:215], v[72:73], v[150:151] op_sel:[0,1,0] op_sel_hi:[1,1,1]
    s_waitcnt lgkmcnt(4)
    v_pk_fma_f32 v[152:153], v[216:217], v[76:77], v[152:153] op_sel:[0,1,0] op_sel_hi:[1,1,1]
    v_pk_fma_f32 v[154:155], v[218:219], v[76:77], v[154:155] op_sel:[0,1,0] op_sel_hi:[1,1,1]
    v_pk_fma_f32 v[156:157], v[220:221], v[76:77], v[156:157] op_sel:[0,1,0] op_sel_hi:[1,1,1]
    v_pk_fma_f32 v[158:159], v[222:223], v[76:77], v[158:159] op_sel:[0,1,0] op_sel_hi:[1,1,1]
    s_waitcnt lgkmcnt(2)
    v_pk_fma_f32 v[160:161], v[224:225], v[80:81], v[160:161] op_sel:[0,1,0] op_sel_hi:[1,1,1]
    v_pk_fma_f32 v[162:163], v[226:227], v[80:81], v[162:163] op_sel:[0,1,0] op_sel_hi:[1,1,1]
    v_pk_fma_f32 v[164:165], v[228:229], v[80:81], v[164:165] op_sel:[0,1,0] op_sel_hi:[1,1,1]
    v_pk_fma_f32 v[166:167], v[230:231], v[80:81], v[166:167] op_sel:[0,1,0] op_sel_hi:[1,1,1]
    s_waitcnt lgkmcnt(0)
    v_pk_fma_f32 v[168:169], v[232:233], v[84:85], v[168:169] op_sel:[0,1,0] op_sel_hi:[1,1,1]
    v_pk_fma_f32 v[170:171], v[234:235], v[84:85], v[170:171] op_sel:[0,1,0] op_sel_hi:[1,1,1]
    v_pk_fma_f32 v[172:173], v[236:237], v[84:85], v[172:173] op_sel:[0,1,0] op_sel_hi:[1,1,1]
    v_pk_fma_f32 v[174:175], v[238:239], v[84:85], v[174:175] op_sel:[0,1,0] op_sel_hi:[1,1,1]
    v_add_u32 v52, 0x8000, v52
    v_add_u32 v53, 0x8000, v53
    v_add_u32 v54, 0x8000, v54
    s_cmp_ge_u32 s42, 2
    s_cbranch_scc0 L_rpc0_b0
L_rpc0_b0r:
    s_waitcnt lgkmcnt(3)
    ds_read_b128 v[192:195], v52 offset:0
    ds_read_b128 v[196:199], v52 offset:512
    ds_read_b128 v[200:203], v53 offset:0
    ds_read_b128 v[204:207], v53 offset:512
    ds_read_b128 v[208:211], v54 offset:0
    ds_read_b128 v[212:215], v54 offset:512
    s_waitcnt lgkmcnt(4)
    v_pk_fma_f32 v[128:129], v[192:193], v[66:67], v[128:129] op_sel:[0,0,0] op_sel_hi:[1,0,1]
    v_pk_fma_f32 v[130:131], v[194:195], v[66:67], v[130:131] op_sel:[0,0,0] op_sel_hi:[1,0,1]
    v_pk_fma_f32 v[132:133], v[196:197], v[66:67], v[132:133] op_sel:[0,0,0] op_sel_hi:[1,0,1]
    v_pk_fma_f32 v[134:135], v[198:199], v[66:67], v[134:135] op_sel:[0,0,0] op_sel_hi:[1,0,1]
    v_cvt_pk_bf16_f32 v96, v128, v129
    v_cvt_pk_bf16_f32 v97, v130, v131
    v_cvt_pk_bf16_f32 v98, v132, v133
    v_cvt_pk_bf16_f32 v99, v134, v135
    buffer_store_dwordx4 v[96:99], v60, s[12:15], s78 offen offset:0 nt
    s_waitcnt lgkmcnt(2)
    v_pk_fma_f32 v[136:137], v[200:201], v[70:71], v[136:137] op_sel:[0,0,0] op_sel_hi:[1,0,1]
    v_pk_fma_f32 v[138:139], v[202:203], v[70:71], v[138:139] op_sel:[0,0,0] op_sel_hi:[1,0,1]
    v_pk_fma_f32 v[140:141], v[204:205], v[70:71], v[140:141] op_sel:[0,0,0] op_sel_hi:[1,0,1]
    v_pk_fma_f32 v[142:143], v[206:207], v[70:71], v[142:143] op_sel:[0,0,0] op_sel_hi:[1,0,1]
    v_cvt_pk_bf16_f32 v100, v136, v137
    v_cvt_pk_bf16_f32 v101, v138, v139
    v_cvt_pk_bf16_f32 v102, v140, v141
    v_cvt_pk_bf16_f32 v103, v142, v143
    buffer_store_dwordx4 v[100:103], v60, s[12:15], s78 offen offset:1024 nt
    s_waitcnt lgkmcnt(0)
    v_pk_fma_f32 v[144:145], v[208:209], v[74:75], v[144:145] op_sel:[0,0,0] op_sel_hi:[1,0,1]
    v_pk_fma_f32 v[146:147], v[210:211], v[74:75], v[146:147] op_sel:[0,0,0] op_sel_hi:[1,0,1]
    v_pk_fma_f32 v[148:149], v[212:213], v[74:75], v[148:149] op_sel:[0,0,0] op_sel_hi:[1,0,1]
    v_pk_fma_f32 v[150:151], v[214:215], v[74:75], v[150:151] op_sel:[0,0,0] op_sel_hi:[1,0,1]
    v_cvt_pk_bf16_f32 v104, v144, v145
    v_cvt_pk_bf16_f32 v105, v146, v147
    v_cvt_pk_bf16_f32 v106, v148, v149
    v_cvt_pk_bf16_f32 v107, v150, v151
    buffer_store_dwordx4 v[104:107], v60, s[12:15], s78 offen offset:2048 nt
L_rpc1_b0:
    ds_read_b32 v43, v59
    s_waitcnt lgkmcnt(0)
    v_readlane_b32 s42, v43, 2
    s_cmp_ge_u32 s42, 3
    s_cbranch_scc0 L_rpc1_b0
    s_waitcnt lgkmcnt(3)
    ds_read_b128 v[216:219], v52 offset:4096
    ds_read_b128 v[220:223], v52 offset:4608
    ds_read_b128 v[224:227], v53 offset:4096
    ds_read_b128 v[228:231], v53 offset:4608
    ds_read_b128 v[232:235], v54 offset:4096
    ds_read_b128 v[236:239], v54 offset:4608
    s_waitcnt lgkmcnt(4)
    v_pk_fma_f32 v[152:153], v[216:217], v[78:79], v[152:153] op_sel:[0,0,0] op_sel_hi:[1,0,1]
    v_pk_fma_f32 v[154:155], v[218:219], v[78:79], v[154:155] op_sel:[0,0,0] op_sel_hi:[1,0,1]
    v_pk_fma_f32 v[156:157], v[220:221], v[78:79], v[156:157] op_sel:[0,0,0] op_sel_hi:[1,0,1]
    v_pk_fma_f32 v[158:159], v[222:223], v[78:79], v[158:159] op_sel:[0,0,0] op_sel_hi:[1,0,1]
    v_cvt_pk_bf16_f32 v108, v152, v153
    v_cvt_pk_bf16_f32 v109, v154, v155
    v_cvt_pk_bf16_f32 v110, v156, v157
    v_cvt_pk_bf16_f32 v111, v158, v159
    buffer_store_dwordx4 v[108:111], v60, s[12:15], s79 offen offset:0 nt
    s_waitcnt lgkmcnt(2)
    v_pk_fma_f32 v[160:161], v[224:225], v[82:83], v[160:161] op_sel:[0,0,0] op_sel_hi:[1,0,1]
    v_pk_fma_f32 v[162:163], v[226:227], v[82:83], v[162:163] op_sel:[0,0,0] op_sel_hi:[1,0,1]
    v_pk_fma_f32 v[164:165], v[228:229], v[82:83], v[164:165] op_sel:[0,0,0] op_sel_hi:[1,0,1]
    v_pk_fma_f32 v[166:167], v[230:231], v[82:83], v[166:167] op_sel:[0,0,0] op_sel_hi:[1,0,1]
    v_cvt_pk_bf16_f32 v112, v160, v161
    v_cvt_pk_bf16_f32 v113, v162, v163
    v_cvt_pk_bf16_f32 v114, v164, v165
    v_cvt_pk_bf16_f32 v115, v166, v167
    buffer_store_dwordx4 v[112:115], v60, s[12:15], s79 offen offset:1024 nt
    s_waitcnt lgkmcnt(0)
    v_pk_fma_f32 v[168:169], v[232:233], v[86:87], v[168:169] op_sel:[0,0,0] op_sel_hi:[1,0,1]
    v_pk_fma_f32 v[170:171], v[234:235], v[86:87], v[170:171] op_sel:[0,0,0] op_sel_hi:[1,0,1]
    v_pk_fma_f32 v[172:173], v[236:237], v[86:87], v[172:173] op_sel:[0,0,0] op_sel_hi:[1,0,1]
    v_pk_fma_f32 v[174:175], v[238:239], v[86:87], v[174:175] op_sel:[0,0,0] op_sel_hi:[1,0,1]
    v_cvt_pk_bf16_f32 v116, v168, v169
    v_cvt_pk_bf16_f32 v117, v170, v171
    v_cvt_pk_bf16_f32 v118, v172, v173
    v_cvt_pk_bf16_f32 v119, v174, v175
    buffer_store_dwordx4 v[116:119], v60, s[12:15], s79 offen offset:2048 nt
    s_branch L_out
L_rpg_b0:
    ds_read_b32 v43, v59
    s_waitcnt lgkmcnt(0)
    v_readlane_b32 s40, v43, 0
    v_readlane_b32 s41, v43, 1
    v_readlane_b32 s42, v43, 2
    v_readlane_b32 s43, v43, 3
    s_cmp_ge_u32 s43, 1
    s_cbranch_scc1 L_rpg_b0r
    s_branch L_rpg_b0
L_rpa_b0:
    ds_read_b32 v43, v59
    s_waitcnt lgkmcnt(0)
    v_readlane_b32 s40, v43, 0
    v_readlane_b32 s41, v43, 1
    v_readlane_b32 s42, v43, 2
    v_readlane_b32 s43, v43, 3
    s_cmp_ge_u32 s40, 3
    s_cbranch_scc1 L_rpa_b0r
    s_branch L_rpa_b0
L_rpb_b0:
    ds_read_b32 v43, v59
    s_waitcnt lgkmcnt(0)
    v_readlane_b32 s40, v43, 0
    v_readlane_b32 s41, v43, 1
    v_readlane_b32 s42, v43, 2
    v_readlane_b32 s43, v43, 3
    s_cmp_ge_u32 s41, 3
    s_cbranch_scc1 L_rpb_b0r
    s_branch L_rpb_b0
L_rpc0_b0:
    ds_read_b32 v43, v59
    s_waitcnt lgkmcnt(0)
    v_readlane_b32 s40, v43, 0
    v_readlane_b32 s41, v43, 1
    v_readlane_b32 s42, v43, 2
    v_readlane_b32 s43, v43, 3
    s_cmp_ge_u32 s42, 2
    s_cbranch_scc1 L_rpc0_b0r
    s_branch L_rpc0_b0
L_red_a:
    s_cmp_eq_u32 s52, 1
    s_cbranch_scc1 L_reduce_a1
    s_cmp_eq_u32 s52, 2
    s_cbranch_scc1 L_reduce_a2
L_reduce_a0:
    ds_read_b32 v43, v59
    s_waitcnt lgkmcnt(0)
    v_readlane_b32 s40, v43, 0
    v_readlane_b32 s41, v43, 1
    v_readlane_b32 s42, v43, 2
    v_readlane_b32 s43, v43, 3
    s_min_u32 s82, s40, s41
    s_min_u32 s82, s82, s42
    s_cmp_ge_u32 s82, 1
    s_cbranch_scc0 L_reduce_a0
    s_cmp_ge_u32 s43, 1
    s_cbranch_scc0 L_rpg_a0
L_rpg_a0r:
    ds_read_b128 v[64:67], v57 offset:0
    ds_read_b128 v[68:71], v57 offset:64
    ds_read_b128 v[72:75], v57 offset:512
    ds_read_b128 v[76:79], v57 offset:576
    s_cmp_ge_u32 s40, 3
    s_cbranch_scc0 L_rpa_a0
L_rpa_a0r:
    s_waitcnt lgkmcnt(3)
    ds_read_b128 v[192:195], v52 offset:0
    ds_read_b128 v[196:199], v52 offset:512
    ds_read_b128 v[200:203], v53 offset:0
    ds_read_b128 v[204:207], v53 offset:512
    ds_read_b128 v[208:211], v52 offset:4096
    ds_read_b128 v[212:215], v52 offset:4608
    ds_read_b128 v[216:219], v53 offset:4096
    ds_read_b128 v[220:223], v53 offset:4608
    s_waitcnt lgkmcnt(6)
    v_pk_mul_f32 v[128:129], v[192:193], v[64:65] op_sel:[0,0] op_sel_hi:[1,0]
    v_pk_mul_f32 v[130:131], v[194:195], v[64:65] op_sel:[0,0] op_sel_hi:[1,0]
    v_pk_mul_f32 v[132:133], v[196:197], v[64:65] op_sel:[0,0] op_sel_hi:[1,0]
    v_pk_mul_f32 v[134:135], v[198:199], v[64:65] op_sel:[0,0] op_sel_hi:[1,0]
    s_waitcnt lgkmcnt(4)
    v_pk_mul_f32 v[136:137], v[200:201], v[68:69] op_sel:[0,0] op_sel_hi:[1,0]
    v_pk_mul_f32 v[138:139], v[202:203], v[68:69] op_sel:[0,0] op_sel_hi:[1,0]
    v_pk_mul_f32 v[140:141], v[204:205], v[68:69] op_sel:[0,0] op_sel_hi:[1,0]
    v_pk_mul_f32 v[142:143], v[206:207], v[68:69] op_sel:[0,0] op_sel_hi:[1,0]
    s_waitcnt lgkmcnt(2)
    v_pk_mul_f32 v[144:145], v[208:209], v[72:73] op_sel:[0,0] op_sel_hi:[1,0]
    v_pk_mul_f32 v[146:147], v[210:211], v[72:73] op_sel:[0,0] op_sel_hi:[1,0]
    v_pk_mul_f32 v[148:149], v[212:213], v[72:73] op_sel:[0,0] op_sel_hi:[1,0]
    v_pk_mul_f32 v[150:151], v[214:215], v[72:73] op_sel:[0,0] op_sel_hi:[1,0]
    s_waitcnt lgkmcnt(0)
    v_pk_mul_f32 v[152:153], v[216:217], v[76:77] op_sel:[0,0] op_sel_hi:[1,0]
    v_pk_mul_f32 v[154:155], v[218:219], v[76:77] op_sel:[0,0] op_sel_hi:[1,0]
    v_pk_mul_f32 v[156:157], v[220:221], v[76:77] op_sel:[0,0] op_sel_hi:[1,0]
    v_pk_mul_f32 v[158:159], v[222:223], v[76:77] op_sel:[0,0] op_sel_hi:[1,0]
    v_add_u32 v52, 0x8000, v52
    v_add_u32 v53, 0x8000, v53
    s_cmp_ge_u32 s41, 3
    s_cbranch_scc0 L_rpb_a0
L_rpb_a0r:
    s_waitcnt lgkmcnt(3)
    ds_read_b128 v[192:195], v52 offset:0
    ds_read_b128 v[196:199], v52 offset:512
    ds_read_b128 v[200:203], v53 offset:0
    ds_read_b128 v[204:207], v53 offset:512
    ds_read_b128 v[208:211], v52 offset:4096
    ds_read_b128 v[212:215], v52 offset:4608
    ds_read_b128 v[216:219], v53 offset:4096
    ds_read_b128 v[220:223], v53 offset:4608
    s_waitcnt lgkmcnt(6)
    v_pk_fma_f32 v[128:129], v[192:193], v[64:65], v[128:129] op_sel:[0,1,0] op_sel_hi:[1,1,1]
    v_pk_fma_f32 v[130:131], v[194:195], v[64:65], v[130:131] op_sel:[0,1,0] op_sel_hi:[1,1,1]
    v_pk_fma_f32 v[132:133], v[196:197], v[64:65], v[132:133] op_sel:[0,1,0] op_sel_hi:[1,1,1]
    v_pk_fma_f32 v[134:135], v[198:199], v[64:65], v[134:135] op_sel:[0,1,0] op_sel_hi:[1,1,1]
    s_waitcnt lgkmcnt(4)
    v_pk_fma_f32 v[136:137], v[200:201], v[68:69], v[136:137] op_sel:[0,1,0] op_sel_hi:[1,1,1]
    v_pk_fma_f32 v[138:139], v[202:203], v[68:69], v[138:139] op_sel:[0,1,0] op_sel_hi:[1,1,1]
    v_pk_fma_f32 v[140:141], v[204:205], v[68:69], v[140:141] op_sel:[0,1,0] op_sel_hi:[1,1,1]
    v_pk_fma_f32 v[142:143], v[206:207], v[68:69], v[142:143] op_sel:[0,1,0] op_sel_hi:[1,1,1]
    s_waitcnt lgkmcnt(2)
    v_pk_fma_f32 v[144:145], v[208:209], v[72:73], v[144:145] op_sel:[0,1,0] op_sel_hi:[1,1,1]
    v_pk_fma_f32 v[146:147], v[210:211], v[72:73], v[146:147] op_sel:[0,1,0] op_sel_hi:[1,1,1]
    v_pk_fma_f32 v[148:149], v[212:213], v[72:73], v[148:149] op_sel:[0,1,0] op_sel_hi:[1,1,1]
    v_pk_fma_f32 v[150:151], v[214:215], v[72:73], v[150:151] op_sel:[0,1,0] op_sel_hi:[1,1,1]
    s_waitcnt lgkmcnt(0)
    v_pk_fma_f32 v[152:153], v[216:217], v[76:77], v[152:153] op_sel:[0,1,0] op_sel_hi:[1,1,1]
    v_pk_fma_f32 v[154:155], v[218:219], v[76:77], v[154:155] op_sel:[0,1,0] op_sel_hi:[1,1,1]
    v_pk_fma_f32 v[156:157], v[220:221], v[76:77], v[156:157] op_sel:[0,1,0] op_sel_hi:[1,1,1]
    v_pk_fma_f32 v[158:159], v[222:223], v[76:77], v[158:159] op_sel:[0,1,0] op_sel_hi:[1,1,1]
    v_add_u32 v52, 0x8000, v52
    v_add_u32 v53, 0x8000, v53
    s_cmp_ge_u32 s42, 2
    s_cbranch_scc0 L_rpc0_a0
L_rpc0_a0r:
    s_waitcnt lgkmcnt(3)
    ds_read_b128 v[192:195], v52 offset:0
    ds_read_b128 v[196:199], v52 offset:512
    ds_read_b128 v[200:203], v53 offset:0
    ds_read_b128 v[204:207], v53 offset:512
    s_waitcnt lgkmcnt(2)
    v_pk_fma_f32 v[128:129], v[192:193], v[66:67], v[128:129] op_sel:[0,0,0] op_sel_hi:[1,0,1]
    v_pk_fma_f32 v[130:131], v[194:195], v[66:67], v[130:131] op_sel:[0,0,0] op_sel_hi:[1,0,1]
    v_pk_fma_f32 v[132:133], v[196:197], v[66:67], v[132:133] op_sel:[0,0,0] op_sel_hi:[1,0,1]
    v_pk_fma_f32 v[134:135], v[198:199], v[66:67], v[134:135] op_sel:[0,0,0] op_sel_hi:[1,0,1]
    v_cvt_pk_bf16_f32 v96, v128, v129
    v_cvt_pk_bf16_f32 v97, v130, v131
    v_cvt_pk_bf16_f32 v98, v132, v133
    v_cvt_pk_bf16_f32 v99, v134, v135
    buffer_store_dwordx4 v[96:99], v60, s[12:15], s78 offen offset:0 nt
    s_waitcnt lgkmcnt(0)
    v_pk_fma_f32 v[136:137], v[200:201], v[70:71], v[136:137] op_sel:[0,0,0] op_sel_hi:[1,0,1]
    v_pk_fma_f32 v[138:139], v[202:203], v[70:71], v[138:139] op_sel:[0,0,0] op_sel_hi:[1,0,1]
    v_pk_fma_f32 v[140:141], v[204:205], v[70:71], v[140:141] op_sel:[0,0,0] op_sel_hi:[1,0,1]
    v_pk_fma_f32 v[142:143], v[206:207], v[70:71], v[142:143] op_sel:[0,0,0] op_sel_hi:[1,0,1]
    v_cvt_pk_bf16_f32 v100, v136, v137
    v_cvt_pk_bf16_f32 v101, v138, v139
    v_cvt_pk_bf16_f32 v102, v140, v141
    v_cvt_pk_bf16_f32 v103, v142, v143
    buffer_store_dwordx4 v[100:103], v60, s[12:15], s78 offen offset:1024 nt
L_rpc1_a0:
    ds_read_b32 v43, v59
    s_waitcnt lgkmcnt(0)
    v_readlane_b32 s42, v43, 2
    s_cmp_ge_u32 s42, 3
    s_cbranch_scc0 L_rpc1_a0
    s_waitcnt lgkmcnt(3)
    ds_read_b128 v[208:211], v52 offset:4096
    ds_read_b128 v[212:215], v52 offset:4608
    ds_read_b128 v[216:219], v53 offset:4096
    ds_read_b128 v[220:223], v53 offset:4608
    s_waitcnt lgkmcnt(2)
    v_pk_fma_f32 v[144:145], v[208:209], v[74:75], v[144:145] op_sel:[0,0,0] op_sel_hi:[1,0,1]
    v_pk_fma_f32 v[146:147], v[210:211], v[74:75], v[146:147] op_sel:[0,0,0] op_sel_hi:[1,0,1]
    v_pk_fma_f32 v[148:149], v[212:213], v[74:75], v[148:149] op_sel:[0,0,0] op_sel_hi:[1,0,1]
    v_pk_fma_f32 v[150:151], v[214:215], v[74:75], v[150:151] op_sel:[0,0,0] op_sel_hi:[1,0,1]
    v_cvt_pk_bf16_f32 v104, v144, v145
    v_cvt_pk_bf16_f32 v105, v146, v147
    v_cvt_pk_bf16_f32 v106, v148, v149
    v_cvt_pk_bf16_f32 v107, v150, v151
    buffer_store_dwordx4 v[104:107], v60, s[12:15], s79 offen offset:0 nt
    s_waitcnt lgkmcnt(0)
    v_pk_fma_f32 v[152:153], v[216:217], v[78:79], v[152:153] op_sel:[0,0,0] op_sel_hi:[1,0,1]
    v_pk_fma_f32 v[154:155], v[218:219], v[78:79], v[154:155] op_sel:[0,0,0] op_sel_hi:[1,0,1]
    v_pk_fma_f32 v[156:157], v[220:221], v[78:79], v[156:157] op_sel:[0,0,0] op_sel_hi:[1,0,1]
    v_pk_fma_f32 v[158:159], v[222:223], v[78:79], v[158:159] op_sel:[0,0,0] op_sel_hi:[1,0,1]
    v_cvt_pk_bf16_f32 v108, v152, v153
    v_cvt_pk_bf16_f32 v109, v154, v155
    v_cvt_pk_bf16_f32 v110, v156, v157
    v_cvt_pk_bf16_f32 v111, v158, v159
    buffer_store_dwordx4 v[108:111], v60, s[12:15], s79 offen offset:1024 nt
    s_branch L_out
L_rpg_a0:
    ds_read_b32 v43, v59
    s_waitcnt lgkmcnt(0)
    v_readlane_b32 s40, v43, 0
    v_readlane_b32 s41, v43, 1
    v_readlane_b32 s42, v43, 2
    v_readlane_b32 s43, v43, 3
    s_cmp_ge_u32 s43, 1
    s_cbranch_scc1 L_rpg_a0r
    s_branch L_rpg_a0
L_rpa_a0:
    ds_read_b32 v43, v59
    s_waitcnt lgkmcnt(0)
    v_readlane_b32 s40, v43, 0
    v_readlane_b32 s41, v43, 1
    v_readlane_b32 s42, v43, 2
    v_readlane_b32 s43, v43, 3
    s_cmp_ge_u32 s40, 3
    s_cbranch_scc1 L_rpa_a0r
    s_branch L_rpa_a0
L_rpb_a0:
    ds_read_b32 v43, v59
    s_waitcnt lgkmcnt(0)
    v_readlane_b32 s40, v43, 0
    v_readlane_b32 s41, v43, 1
    v_readlane_b32 s42, v43, 2
    v_readlane_b32 s43, v43, 3
    s_cmp_ge_u32 s41, 3
    s_cbranch_scc1 L_rpb_a0r
    s_branch L_rpb_a0
L_rpc0_a0:
    ds_read_b32 v43, v59
    s_waitcnt lgkmcnt(0)
    v_readlane_b32 s40, v43, 0
    v_readlane_b32 s41, v43, 1
    v_readlane_b32 s42, v43, 2
    v_readlane_b32 s43, v43, 3
    s_cmp_ge_u32 s42, 2
    s_cbranch_scc1 L_rpc0_a0r
    s_branch L_rpc0_a0
L_red_d:
    s_cmp_eq_u32 s52, 1
    s_cbranch_scc1 L_reduce_d1
    s_cmp_eq_u32 s52, 2
    s_cbranch_scc1 L_reduce_d2
L_reduce_d0:
    ds_read_b32 v43, v59
    s_waitcnt lgkmcnt(0)
    v_readlane_b32 s40, v43, 0
    v_readlane_b32 s41, v43, 1
    v_readlane_b32 s42, v43, 2
    v_readlane_b32 s43, v43, 3
    s_min_u32 s82, s40, s41
    s_min_u32 s82, s82, s42
    s_cmp_ge_u32 s82, 1
    s_cbranch_scc0 L_reduce_d0
    ds_read_b64 v[32:33], v58 offset:0
    ds_read_b64 v[34:35], v58 offset:512
    ds_read_b64 v[36:37], v58 offset:1024
    v_add_u32 v43, 118784, v60
    v_mov_b32 v44, 1
    s_waitcnt lgkmcnt(0)
    v_max3_f32 v40, v32, v34, v36
    v_sub_f32 v32, v32, v40
    v_sub_f32 v34, v34, v40
    v_sub_f32 v36, v36, v40
    v_exp_f32 v32, v32
    v_exp_f32 v34, v34
    v_exp_f32 v36, v36
    v_mul_f32 v41, v32, v33
    v_fma_f32 v41, v34, v35, v41
    v_fma_f32 v41, v36, v37, v41
    v_rcp_f32 v33, v41
    s_nop 0
    v_mul_f32 v48, v32, v33
    v_mul_f32 v49, v34, v33
    v_mul_f32 v50, v36, v33
    ds_write_b128 v43, v[48:51]
    ds_write_b32 v22, v44 offset:1792
    ds_read_b128 v[64:67], v57 offset:0
    ds_read_b128 v[68:71], v57 offset:64
    ds_read_b128 v[72:75], v57 offset:128
    ds_read_b128 v[76:79], v57 offset:512
    ds_read_b128 v[80:83], v57 offset:576
    ds_read_b128 v[84:87], v57 offset:640
    s_cmp_ge_u32 s40, 3
    s_cbranch_scc0 L_rpa_d0
L_rpa_d0r:
    s_waitcnt lgkmcnt(3)
    ds_read_b128 v[192:195], v52 offset:0
    ds_read_b128 v[196:199], v52 offset:512
    ds_read_b128 v[200:203], v53 offset:0
    ds_read_b128 v[204:207], v53 offset:512
    ds_read_b128 v[208:211], v54 offset:0
    ds_read_b128 v[212:215], v54 offset:512
    ds_read_b128 v[216:219], v52 offset:4096
    ds_read_b128 v[220:223], v52 offset:4608
    ds_read_b128 v[224:227], v53 offset:4096
    ds_read_b128 v[228:231], v53 offset:4608
    ds_read_b128 v[232:235], v54 offset:4096
    ds_read_b128 v[236:239], v54 offset:4608
    s_waitcnt lgkmcnt(10)
    v_pk_mul_f32 v[128:129], v[192:193], v[64:65] op_sel:[0,0] op_sel_hi:[1,0]
    v_pk_mul_f32 v[130:131], v[194:195], v[64:65] op_sel:[0,0] op_sel_hi:[1,0]
    v_pk_mul_f32 v[132:133], v[196:197], v[64:65] op_sel:[0,0] op_sel_hi:[1,0]
    v_pk_mul_f32 v[134:135], v[198:199], v[64:65] op_sel:[0,0] op_sel_hi:[1,0]
    s_waitcnt lgkmcnt(8)
    v_pk_mul_f32 v[136:137], v[200:201], v[68:69] op_sel:[0,0] op_sel_hi:[1,0]
    v_pk_mul_f32 v[138:139], v[202:203], v[68:69] op_sel:[0,0] op_sel_hi:[1,0]
    v_pk_mul_f32 v[140:141], v[204:205], v[68:69] op_sel:[0,0] op_sel_hi:[1,0]
    v_pk_mul_f32 v[142:143], v[206:207], v[68:69] op_sel:[0,0] op_sel_hi:[1,0]
    s_waitcnt lgkmcnt(6)
    v_pk_mul_f32 v[144:145], v[208:209], v[72:73] op_sel:[0,0] op_sel_hi:[1,0]
    v_pk_mul_f32 v[146:147], v[210:211], v[72:73] op_sel:[0,0] op_sel_hi:[1,0]
    v_pk_mul_f32 v[148:149], v[212:213], v[72:73] op_sel:[0,0] op_sel_hi:[1,0]
    v_pk_mul_f32 v[150:151], v[214:215], v[72:73] op_sel:[0,0] op_sel_hi:[1,0]
    s_waitcnt lgkmcnt(4)
    v_pk_mul_f32 v[152:153], v[216:217], v[76:77] op_sel:[0,0] op_sel_hi:[1,0]
    v_pk_mul_f32 v[154:155], v[218:219], v[76:77] op_sel:[0,0] op_sel_hi:[1,0]
    v_pk_mul_f32 v[156:157], v[220:221], v[76:77] op_sel:[0,0] op_sel_hi:[1,0]
    v_pk_mul_f32 v[158:159], v[222:223], v[76:77] op_sel:[0,0] op_sel_hi:[1,0]
    s_waitcnt lgkmcnt(2)
    v_pk_mul_f32 v[160:161], v[224:225], v[80:81] op_sel:[0,0] op_sel_hi:[1,0]
    v_pk_mul_f32 v[162:163], v[226:227], v[80:81] op_sel:[0,0] op_sel_hi:[1,0]
    v_pk_mul_f32 v[164:165], v[228:229], v[80:81] op_sel:[0,0] op_sel_hi:[1,0]
    v_pk_mul_f32 v[166:167], v[230:231], v[80:81] op_sel:[0,0] op_sel_hi:[1,0]
    s_waitcnt lgkmcnt(0)
    v_pk_mul_f32 v[168:169], v[232:233], v[84:85] op_sel:[0,0] op_sel_hi:[1,0]
    v_pk_mul_f32 v[170:171], v[234:235], v[84:85] op_sel:[0,0] op_sel_hi:[1,0]
    v_pk_mul_f32 v[172:173], v[236:237], v[84:85] op_sel:[0,0] op_sel_hi:[1,0]
    v_pk_mul_f32 v[174:175], v[238:239], v[84:85] op_sel:[0,0] op_sel_hi:[1,0]
    v_add_u32 v52, 0x8000, v52
    v_add_u32 v53, 0x8000, v53
    v_add_u32 v54, 0x8000, v54
    s_cmp_ge_u32 s41, 3
    s_cbranch_scc0 L_rpb_d0
L_rpb_d0r:
    s_waitcnt lgkmcnt(3)
    ds_read_b128 v[192:195], v52 offset:0
    ds_read_b128 v[196:199], v52 offset:512
    ds_read_b128 v[200:203], v53 offset:0
    ds_read_b128 v[204:207], v53 offset:512
    ds_read_b128 v[208:211], v54 offset:0
    ds_read_b128 v[212:215], v54 offset:512
    ds_read_b128 v[216:219], v52 offset:4096
    ds_read_b128 v[220:223], v52 offset:4608
    ds_read_b128 v[224:227], v53 offset:4096
    ds_read_b128 v[228:231], v53 offset:4608
    ds_read_b128 v[232:235], v54 offset:4096
    ds_read_b128 v[236:239], v54 offset:4608
    s_waitcnt lgkmcnt(10)
    v_pk_fma_f32 v[128:129], v[192:193], v[64:65], v[128:129] op_sel:[0,1,0] op_sel_hi:[1,1,1]
    v_pk_fma_f32 v[130:131], v[194:195], v[64:65], v[130:131] op_sel:[0,1,0] op_sel_hi:[1,1,1]
    v_pk_fma_f32 v[132:133], v[196:197], v[64:65], v[132:133] op_sel:[0,1,0] op_sel_hi:[1,1,1]
    v_pk_fma_f32 v[134:135], v[198:199], v[64:65], v[134:135] op_sel:[0,1,0] op_sel_hi:[1,1,1]
    s_waitcnt lgkmcnt(8)
    v_pk_fma_f32 v[136:137], v[200:201], v[68:69], v[136:137] op_sel:[0,1,0] op_sel_hi:[1,1,1]
    v_pk_fma_f32 v[138:139], v[202:203], v[68:69], v[138:139] op_sel:[0,1,0] op_sel_hi:[1,1,1]
    v_pk_fma_f32 v[140:141], v[204:205], v[68:69], v[140:141] op_sel:[0,1,0] op_sel_hi:[1,1,1]
    v_pk_fma_f32 v[142:143], v[206:207], v[68:69], v[142:143] op_sel:[0,1,0] op_sel_hi:[1,1,1]
    s_waitcnt lgkmcnt(6)
    v_pk_fma_f32 v[144:145], v[208:209], v[72:73], v[144:145] op_sel:[0,1,0] op_sel_hi:[1,1,1]
    v_pk_fma_f32 v[146:147], v[210:211], v[72:73], v[146:147] op_sel:[0,1,0] op_sel_hi:[1,1,1]
    v_pk_fma_f32 v[148:149], v[212:213], v[72:73], v[148:149] op_sel:[0,1,0] op_sel_hi:[1,1,1]
    v_pk_fma_f32 v[150:151], v[214:215], v[72:73], v[150:151] op_sel:[0,1,0] op_sel_hi:[1,1,1]
    s_waitcnt lgkmcnt(4)
    v_pk_fma_f32 v[152:153], v[216:217], v[76:77], v[152:153] op_sel:[0,1,0] op_sel_hi:[1,1,1]
    v_pk_fma_f32 v[154:155], v[218:219], v[76:77], v[154:155] op_sel:[0,1,0] op_sel_hi:[1,1,1]
    v_pk_fma_f32 v[156:157], v[220:221], v[76:77], v[156:157] op_sel:[0,1,0] op_sel_hi:[1,1,1]
    v_pk_fma_f32 v[158:159], v[222:223], v[76:77], v[158:159] op_sel:[0,1,0] op_sel_hi:[1,1,1]
    s_waitcnt lgkmcnt(2)
    v_pk_fma_f32 v[160:161], v[224:225], v[80:81], v[160:161] op_sel:[0,1,0] op_sel_hi:[1,1,1]
    v_pk_fma_f32 v[162:163], v[226:227], v[80:81], v[162:163] op_sel:[0,1,0] op_sel_hi:[1,1,1]
    v_pk_fma_f32 v[164:165], v[228:229], v[80:81], v[164:165] op_sel:[0,1,0] op_sel_hi:[1,1,1]
    v_pk_fma_f32 v[166:167], v[230:231], v[80:81], v[166:167] op_sel:[0,1,0] op_sel_hi:[1,1,1]
    s_waitcnt lgkmcnt(0)
    v_pk_fma_f32 v[168:169], v[232:233], v[84:85], v[168:169] op_sel:[0,1,0] op_sel_hi:[1,1,1]
    v_pk_fma_f32 v[170:171], v[234:235], v[84:85], v[170:171] op_sel:[0,1,0] op_sel_hi:[1,1,1]
    v_pk_fma_f32 v[172:173], v[236:237], v[84:85], v[172:173] op_sel:[0,1,0] op_sel_hi:[1,1,1]
    v_pk_fma_f32 v[174:175], v[238:239], v[84:85], v[174:175] op_sel:[0,1,0] op_sel_hi:[1,1,1]
    v_add_u32 v52, 0x8000, v52
    v_add_u32 v53, 0x8000, v53
    v_add_u32 v54, 0x8000, v54
    s_cmp_ge_u32 s42, 2
    s_cbranch_scc0 L_rpc0_d0
L_rpc0_d0r:
    s_waitcnt lgkmcnt(3)
    ds_read_b128 v[192:195], v52 offset:0
    ds_read_b128 v[196:199], v52 offset:512
    ds_read_b128 v[200:203], v53 offset:0
    ds_read_b128 v[204:207], v53 offset:512
    ds_read_b128 v[208:211], v54 offset:0
    ds_read_b128 v[212:215], v54 offset:512
    s_waitcnt lgkmcnt(4)
    v_pk_fma_f32 v[128:129], v[192:193], v[66:67], v[128:129] op_sel:[0,0,0] op_sel_hi:[1,0,1]
    v_pk_fma_f32 v[130:131], v[194:195], v[66:67], v[130:131] op_sel:[0,0,0] op_sel_hi:[1,0,1]
    v_pk_fma_f32 v[132:133], v[196:197], v[66:67], v[132:133] op_sel:[0,0,0] op_sel_hi:[1,0,1]
    v_pk_fma_f32 v[134:135], v[198:199], v[66:67], v[134:135] op_sel:[0,0,0] op_sel_hi:[1,0,1]
    v_cvt_pk_bf16_f32 v96, v128, v129
    v_cvt_pk_bf16_f32 v97, v130, v131
    v_cvt_pk_bf16_f32 v98, v132, v133
    v_cvt_pk_bf16_f32 v99, v134, v135
    buffer_store_dwordx4 v[96:99], v60, s[12:15], s78 offen offset:0 nt
    s_waitcnt lgkmcnt(2)
    v_pk_fma_f32 v[136:137], v[200:201], v[70:71], v[136:137] op_sel:[0,0,0] op_sel_hi:[1,0,1]
    v_pk_fma_f32 v[138:139], v[202:203], v[70:71], v[138:139] op_sel:[0,0,0] op_sel_hi:[1,0,1]
    v_pk_fma_f32 v[140:141], v[204:205], v[70:71], v[140:141] op_sel:[0,0,0] op_sel_hi:[1,0,1]
    v_pk_fma_f32 v[142:143], v[206:207], v[70:71], v[142:143] op_sel:[0,0,0] op_sel_hi:[1,0,1]
    v_cvt_pk_bf16_f32 v100, v136, v137
    v_cvt_pk_bf16_f32 v101, v138, v139
    v_cvt_pk_bf16_f32 v102, v140, v141
    v_cvt_pk_bf16_f32 v103, v142, v143
    buffer_store_dwordx4 v[100:103], v60, s[12:15], s78 offen offset:1024 nt
    s_waitcnt lgkmcnt(0)
    v_pk_fma_f32 v[144:145], v[208:209], v[74:75], v[144:145] op_sel:[0,0,0] op_sel_hi:[1,0,1]
    v_pk_fma_f32 v[146:147], v[210:211], v[74:75], v[146:147] op_sel:[0,0,0] op_sel_hi:[1,0,1]
    v_pk_fma_f32 v[148:149], v[212:213], v[74:75], v[148:149] op_sel:[0,0,0] op_sel_hi:[1,0,1]
    v_pk_fma_f32 v[150:151], v[214:215], v[74:75], v[150:151] op_sel:[0,0,0] op_sel_hi:[1,0,1]
    v_cvt_pk_bf16_f32 v104, v144, v145
    v_cvt_pk_bf16_f32 v105, v146, v147
    v_cvt_pk_bf16_f32 v106, v148, v149
    v_cvt_pk_bf16_f32 v107, v150, v151
    buffer_store_dwordx4 v[104:107], v60, s[12:15], s78 offen offset:2048 nt
L_rpc1_d0:
    ds_read_b32 v43, v59
    s_waitcnt lgkmcnt(0)
    v_readlane_b32 s42, v43, 2
    s_cmp_ge_u32 s42, 3
    s_cbranch_scc0 L_rpc1_d0
    s_waitcnt lgkmcnt(3)
    ds_read_b128 v[216:219], v52 offset:4096
    ds_read_b128 v[220:223], v52 offset:4608
    ds_read_b128 v[224:227], v53 offset:4096
    ds_read_b128 v[228:231], v53 offset:4608
    ds_read_b128 v[232:235], v54 offset:4096
    ds_read_b128 v[236:239], v54 offset:4608
    s_waitcnt lgkmcnt(4)
    v_pk_fma_f32 v[152:153], v[216:217], v[78:79], v[152:153] op_sel:[0,0,0] op_sel_hi:[1,0,1]
    v_pk_fma_f32 v[154:155], v[218:219], v[78:79], v[154:155] op_sel:[0,0,0] op_sel_hi:[1,0,1]
    v_pk_fma_f32 v[156:157], v[220:221], v[78:79], v[156:157] op_sel:[0,0,0] op_sel_hi:[1,0,1]
    v_pk_fma_f32 v[158:159], v[222:223], v[78:79], v[158:159] op_sel:[0,0,0] op_sel_hi:[1,0,1]
    v_cvt_pk_bf16_f32 v108, v152, v153
    v_cvt_pk_bf16_f32 v109, v154, v155
    v_cvt_pk_bf16_f32 v110, v156, v157
    v_cvt_pk_bf16_f32 v111, v158, v159
    buffer_store_dwordx4 v[108:111], v60, s[12:15], s79 offen offset:0 nt
    s_waitcnt lgkmcnt(2)
    v_pk_fma_f32 v[160:161], v[224:225], v[82:83], v[160:161] op_sel:[0,0,0] op_sel_hi:[1,0,1]
    v_pk_fma_f32 v[162:163], v[226:227], v[82:83], v[162:163] op_sel:[0,0,0] op_sel_hi:[1,0,1]
    v_pk_fma_f32 v[164:165], v[228:229], v[82:83], v[164:165] op_sel:[0,0,0] op_sel_hi:[1,0,1]
    v_pk_fma_f32 v[166:167], v[230:231], v[82:83], v[166:167] op_sel:[0,0,0] op_sel_hi:[1,0,1]
    v_cvt_pk_bf16_f32 v112, v160, v161
    v_cvt_pk_bf16_f32 v113, v162, v163
    v_cvt_pk_bf16_f32 v114, v164, v165
    v_cvt_pk_bf16_f32 v115, v166, v167
    buffer_store_dwordx4 v[112:115], v60, s[12:15], s79 offen offset:1024 nt
    s_waitcnt lgkmcnt(0)
    v_pk_fma_f32 v[168:169], v[232:233], v[86:87], v[168:169] op_sel:[0,0,0] op_sel_hi:[1,0,1]
    v_pk_fma_f32 v[170:171], v[234:235], v[86:87], v[170:171] op_sel:[0,0,0] op_sel_hi:[1,0,1]
    v_pk_fma_f32 v[172:173], v[236:237], v[86:87], v[172:173] op_sel:[0,0,0] op_sel_hi:[1,0,1]
    v_pk_fma_f32 v[174:175], v[238:239], v[86:87], v[174:175] op_sel:[0,0,0] op_sel_hi:[1,0,1]
    v_cvt_pk_bf16_f32 v116, v168, v169
    v_cvt_pk_bf16_f32 v117, v170, v171
    v_cvt_pk_bf16_f32 v118, v172, v173
    v_cvt_pk_bf16_f32 v119, v174, v175
    buffer_store_dwordx4 v[116:119], v60, s[12:15], s79 offen offset:2048 nt
    s_branch L_out
L_rpa_d0:
    ds_read_b32 v43, v59
    s_waitcnt lgkmcnt(0)
    v_readlane_b32 s40, v43, 0
    v_readlane_b32 s41, v43, 1
    v_readlane_b32 s42, v43, 2
    v_readlane_b32 s43, v43, 3
    s_cmp_ge_u32 s40, 3
    s_cbranch_scc1 L_rpa_d0r
    s_branch L_rpa_d0
L_rpb_d0:
    ds_read_b32 v43, v59
    s_waitcnt lgkmcnt(0)
    v_readlane_b32 s40, v43, 0
    v_readlane_b32 s41, v43, 1
    v_readlane_b32 s42, v43, 2
    v_readlane_b32 s43, v43, 3
    s_cmp_ge_u32 s41, 3
    s_cbranch_scc1 L_rpb_d0r
    s_branch L_rpb_d0
L_rpc0_d0:
    ds_read_b32 v43, v59
    s_waitcnt lgkmcnt(0)
    v_readlane_b32 s40, v43, 0
    v_readlane_b32 s41, v43, 1
    v_readlane_b32 s42, v43, 2
    v_readlane_b32 s43, v43, 3
    s_cmp_ge_u32 s42, 2
    s_cbranch_scc1 L_rpc0_d0r
    s_branch L_rpc0_d0
L_reduce_b1:
    ds_read_b32 v43, v59
    s_waitcnt lgkmcnt(0)
    v_readlane_b32 s40, v43, 0
    v_readlane_b32 s41, v43, 1
    v_readlane_b32 s42, v43, 2
    v_readlane_b32 s43, v43, 3
    s_min_u32 s82, s40, s41
    s_min_u32 s82, s82, s42
    s_cmp_ge_u32 s82, 1
    s_cbranch_scc0 L_reduce_b1
    s_mov_b32 s48, s30
    s_mov_b32 s49, s31
    s_mov_b32 s50, 5242880
    s_mov_b32 s51, 0x20000
    s_lshl_b32 s80, s56, 16
    s_add_u32 s80, s80, 0x100000
    s_add_u32 s81, s80, 32768
    s_lshl_b32 s83, s76, 12
    s_add_u32 s80, s80, s83
    s_cmp_ge_u32 s43, 1
    s_cbranch_scc0 L_rpg_b1
L_rpg_b1r:
    ds_read_b128 v[64:67], v57 offset:0
    ds_read_b128 v[68:71], v57 offset:64
    ds_read_b128 v[72:75], v57 offset:128
    ds_read_b128 v[76:79], v57 offset:512
    ds_read_b128 v[80:83], v57 offset:576
    ds_read_b128 v[84:87], v57 offset:640
    s_cmp_ge_u32 s40, 3
    s_cbranch_scc0 L_rpa_b1
L_rpa_b1r:
    s_waitcnt lgkmcnt(3)
    ds_read_b128 v[192:195], v52 offset:0
    ds_read_b128 v[196:199], v52 offset:512
    ds_read_b128 v[200:203], v53 offset:0
    ds_read_b128 v[204:207], v53 offset:512
    ds_read_b128 v[208:211], v54 offset:0
    ds_read_b128 v[212:215], v54 offset:512
    ds_read_b128 v[216:219], v52 offset:4096
    ds_read_b128 v[220:223], v52 offset:4608
    ds_read_b128 v[224:227], v53 offset:4096
    ds_read_b128 v[228:231], v53 offset:4608
    ds_read_b128 v[232:235], v54 offset:4096
    ds_read_b128 v[236:239], v54 offset:4608
    s_waitcnt lgkmcnt(10)
    v_pk_mul_f32 v[128:129], v[192:193], v[64:65] op_sel:[0,0] op_sel_hi:[1,0]
    v_pk_mul_f32 v[130:131], v[194:195], v[64:65] op_sel:[0,0] op_sel_hi:[1,0]
    v_pk_mul_f32 v[132:133], v[196:197], v[64:65] op_sel:[0,0] op_sel_hi:[1,0]
    v_pk_mul_f32 v[134:135], v[198:199], v[64:65] op_sel:[0,0] op_sel_hi:[1,0]
    s_waitcnt lgkmcnt(8)
    v_pk_mul_f32 v[136:137], v[200:201], v[68:69] op_sel:[0,0] op_sel_hi:[1,0]
    v_pk_mul_f32 v[138:139], v[202:203], v[68:69] op_sel:[0,0] op_sel_hi:[1,0]
    v_pk_mul_f32 v[140:141], v[204:205], v[68:69] op_sel:[0,0] op_sel_hi:[1,0]
    v_pk_mul_f32 v[142:143], v[206:207], v[68:69] op_sel:[0,0] op_sel_hi:[1,0]
    s_waitcnt lgkmcnt(6)
    v_pk_mul_f32 v[144:145], v[208:209], v[72:73] op_sel:[0,0] op_sel_hi:[1,0]
    v_pk_mul_f32 v[146:147], v[210:211], v[72:73] op_sel:[0,0] op_sel_hi:[1,0]
    v_pk_mul_f32 v[148:149], v[212:213], v[72:73] op_sel:[0,0] op_sel_hi:[1,0]
    v_pk_mul_f32 v[150:151], v[214:215], v[72:73] op_sel:[0,0] op_sel_hi:[1,0]
    s_waitcnt lgkmcnt(4)
    v_pk_mul_f32 v[152:153], v[216:217], v[76:77] op_sel:[0,0] op_sel_hi:[1,0]
    v_pk_mul_f32 v[154:155], v[218:219], v[76:77] op_sel:[0,0] op_sel_hi:[1,0]
    v_pk_mul_f32 v[156:157], v[220:221], v[76:77] op_sel:[0,0] op_sel_hi:[1,0]
    v_pk_mul_f32 v[158:159], v[222:223], v[76:77] op_sel:[0,0] op_sel_hi:[1,0]
    s_waitcnt lgkmcnt(2)
    v_pk_mul_f32 v[160:161], v[224:225], v[80:81] op_sel:[0,0] op_sel_hi:[1,0]
    v_pk_mul_f32 v[162:163], v[226:227], v[80:81] op_sel:[0,0] op_sel_hi:[1,0]
    v_pk_mul_f32 v[164:165], v[228:229], v[80:81] op_sel:[0,0] op_sel_hi:[1,0]
    v_pk_mul_f32 v[166:167], v[230:231], v[80:81] op_sel:[0,0] op_sel_hi:[1,0]
    s_waitcnt lgkmcnt(0)
    v_pk_mul_f32 v[168:169], v[232:233], v[84:85] op_sel:[0,0] op_sel_hi:[1,0]
    v_pk_mul_f32 v[170:171], v[234:235], v[84:85] op_sel:[0,0] op_sel_hi:[1,0]
    v_pk_mul_f32 v[172:173], v[236:237], v[84:85] op_sel:[0,0] op_sel_hi:[1,0]
    v_pk_mul_f32 v[174:175], v[238:239], v[84:85] op_sel:[0,0] op_sel_hi:[1,0]
    v_add_u32 v52, 0x8000, v52
    v_add_u32 v53, 0x8000, v53
    v_add_u32 v54, 0x8000, v54
    s_cmp_ge_u32 s41, 3
    s_cbranch_scc0 L_rpb_b1
L_rpb_b1r:
    s_waitcnt lgkmcnt(3)
    ds_read_b128 v[192:195], v52 offset:0
    ds_read_b128 v[196:199], v52 offset:512
    ds_read_b128 v[200:203], v53 offset:0
    ds_read_b128 v[204:207], v53 offset:512
    ds_read_b128 v[208:211], v54 offset:0
    ds_read_b128 v[212:215], v54 offset:512
    ds_read_b128 v[216:219], v52 offset:4096
    ds_read_b128 v[220:223], v52 offset:4608
    ds_read_b128 v[224:227], v53 offset:4096
    ds_read_b128 v[228:231], v53 offset:4608
    ds_read_b128 v[232:235], v54 offset:4096
    ds_read_b128 v[236:239], v54 offset:4608
    s_waitcnt lgkmcnt(10)
    v_pk_fma_f32 v[128:129], v[192:193], v[64:65], v[128:129] op_sel:[0,1,0] op_sel_hi:[1,1,1]
    v_pk_fma_f32 v[130:131], v[194:195], v[64:65], v[130:131] op_sel:[0,1,0] op_sel_hi:[1,1,1]
    v_pk_fma_f32 v[132:133], v[196:197], v[64:65], v[132:133] op_sel:[0,1,0] op_sel_hi:[1,1,1]
    v_pk_fma_f32 v[134:135], v[198:199], v[64:65], v[134:135] op_sel:[0,1,0] op_sel_hi:[1,1,1]
    s_waitcnt lgkmcnt(8)
    v_pk_fma_f32 v[136:137], v[200:201], v[68:69], v[136:137] op_sel:[0,1,0] op_sel_hi:[1,1,1]
    v_pk_fma_f32 v[138:139], v[202:203], v[68:69], v[138:139] op_sel:[0,1,0] op_sel_hi:[1,1,1]
    v_pk_fma_f32 v[140:141], v[204:205], v[68:69], v[140:141] op_sel:[0,1,0] op_sel_hi:[1,1,1]
    v_pk_fma_f32 v[142:143], v[206:207], v[68:69], v[142:143] op_sel:[0,1,0] op_sel_hi:[1,1,1]
    s_waitcnt lgkmcnt(6)
    v_pk_fma_f32 v[144:145], v[208:209], v[72:73], v[144:145] op_sel:[0,1,0] op_sel_hi:[1,1,1]
    v_pk_fma_f32 v[146:147], v[210:211], v[72:73], v[146:147] op_sel:[0,1,0] op_sel_hi:[1,1,1]
    v_pk_fma_f32 v[148:149], v[212:213], v[72:73], v[148:149] op_sel:[0,1,0] op_sel_hi:[1,1,1]
    v_pk_fma_f32 v[150:151], v[214:215], v[72:73], v[150:151] op_sel:[0,1,0] op_sel_hi:[1,1,1]
    s_waitcnt lgkmcnt(4)
    v_pk_fma_f32 v[152:153], v[216:217], v[76:77], v[152:153] op_sel:[0,1,0] op_sel_hi:[1,1,1]
    v_pk_fma_f32 v[154:155], v[218:219], v[76:77], v[154:155] op_sel:[0,1,0] op_sel_hi:[1,1,1]
    v_pk_fma_f32 v[156:157], v[220:221], v[76:77], v[156:157] op_sel:[0,1,0] op_sel_hi:[1,1,1]
    v_pk_fma_f32 v[158:159], v[222:223], v[76:77], v[158:159] op_sel:[0,1,0] op_sel_hi:[1,1,1]
    s_waitcnt lgkmcnt(2)
    v_pk_fma_f32 v[160:161], v[224:225], v[80:81], v[160:161] op_sel:[0,1,0] op_sel_hi:[1,1,1]
    v_pk_fma_f32 v[162:163], v[226:227], v[80:81], v[162:163] op_sel:[0,1,0] op_sel_hi:[1,1,1]
    v_pk_fma_f32 v[164:165], v[228:229], v[80:81], v[164:165] op_sel:[0,1,0] op_sel_hi:[1,1,1]
    v_pk_fma_f32 v[166:167], v[230:231], v[80:81], v[166:167] op_sel:[0,1,0] op_sel_hi:[1,1,1]
    s_waitcnt lgkmcnt(0)
    v_pk_fma_f32 v[168:169], v[232:233], v[84:85], v[168:169] op_sel:[0,1,0] op_sel_hi:[1,1,1]
    v_pk_fma_f32 v[170:171], v[234:235], v[84:85], v[170:171] op_sel:[0,1,0] op_sel_hi:[1,1,1]
    v_pk_fma_f32 v[172:173], v[236:237], v[84:85], v[172:173] op_sel:[0,1,0] op_sel_hi:[1,1,1]
    v_pk_fma_f32 v[174:175], v[238:239], v[84:85], v[174:175] op_sel:[0,1,0] op_sel_hi:[1,1,1]
    v_add_u32 v52, 0x8000, v52
    v_add_u32 v53, 0x8000, v53
    v_add_u32 v54, 0x8000, v54
    s_cmp_ge_u32 s42, 2
    s_cbranch_scc0 L_rpc0_b1
L_rpc0_b1r:
    s_waitcnt lgkmcnt(3)
    ds_read_b128 v[192:195], v52 offset:0
    ds_read_b128 v[196:199], v52 offset:512
    ds_read_b128 v[200:203], v53 offset:0
    ds_read_b128 v[204:207], v53 offset:512
    ds_read_b128 v[208:211], v54 offset:0
    ds_read_b128 v[212:215], v54 offset:512
    s_waitcnt lgkmcnt(4)
    v_pk_fma_f32 v[128:129], v[192:193], v[66:67], v[128:129] op_sel:[0,0,0] op_sel_hi:[1,0,1]
    v_pk_fma_f32 v[130:131], v[194:195], v[66:67], v[130:131] op_sel:[0,0,0] op_sel_hi:[1,0,1]
    v_pk_fma_f32 v[132:133], v[196:197], v[66:67], v[132:133] op_sel:[0,0,0] op_sel_hi:[1,0,1]
    v_pk_fma_f32 v[134:135], v[198:199], v[66:67], v[134:135] op_sel:[0,0,0] op_sel_hi:[1,0,1]
    buffer_store_dwordx4 v[128:131], v60, s[48:51], s80 offen offset:0 sc1
    buffer_store_dwordx4 v[132:135], v60, s[48:51], s80 offen offset:1024 sc1
    s_waitcnt lgkmcnt(2)
    v_pk_fma_f32 v[136:137], v[200:201], v[70:71], v[136:137] op_sel:[0,0,0] op_sel_hi:[1,0,1]
    v_pk_fma_f32 v[138:139], v[202:203], v[70:71], v[138:139] op_sel:[0,0,0] op_sel_hi:[1,0,1]
    v_pk_fma_f32 v[140:141], v[204:205], v[70:71], v[140:141] op_sel:[0,0,0] op_sel_hi:[1,0,1]
    v_pk_fma_f32 v[142:143], v[206:207], v[70:71], v[142:143] op_sel:[0,0,0] op_sel_hi:[1,0,1]
    buffer_store_dwordx4 v[136:139], v60, s[48:51], s80 offen offset:2048 sc1
    buffer_store_dwordx4 v[140:143], v60, s[48:51], s80 offen offset:3072 sc1
    s_add_u32 s80, s80, 4096
    s_waitcnt lgkmcnt(0)
    v_pk_fma_f32 v[144:145], v[208:209], v[74:75], v[144:145] op_sel:[0,0,0] op_sel_hi:[1,0,1]
    v_pk_fma_f32 v[146:147], v[210:211], v[74:75], v[146:147] op_sel:[0,0,0] op_sel_hi:[1,0,1]
    v_pk_fma_f32 v[148:149], v[212:213], v[74:75], v[148:149] op_sel:[0,0,0] op_sel_hi:[1,0,1]
    v_pk_fma_f32 v[150:151], v[214:215], v[74:75], v[150:151] op_sel:[0,0,0] op_sel_hi:[1,0,1]
    buffer_store_dwordx4 v[144:147], v60, s[48:51], s80 offen offset:0 sc1
    buffer_store_dwordx4 v[148:151], v60, s[48:51], s80 offen offset:1024 sc1
L_rpc1_b1:
    ds_read_b32 v43, v59
    s_waitcnt lgkmcnt(0)
    v_readlane_b32 s42, v43, 2
    s_cmp_ge_u32 s42, 3
    s_cbranch_scc0 L_rpc1_b1
    s_waitcnt lgkmcnt(3)
    ds_read_b128 v[216:219], v52 offset:4096
    ds_read_b128 v[220:223], v52 offset:4608
    ds_read_b128 v[224:227], v53 offset:4096
    ds_read_b128 v[228:231], v53 offset:4608
    ds_read_b128 v[232:235], v54 offset:4096
    ds_read_b128 v[236:239], v54 offset:4608
    s_waitcnt lgkmcnt(4)
    v_pk_fma_f32 v[152:153], v[216:217], v[78:79], v[152:153] op_sel:[0,0,0] op_sel_hi:[1,0,1]
    v_pk_fma_f32 v[154:155], v[218:219], v[78:79], v[154:155] op_sel:[0,0,0] op_sel_hi:[1,0,1]
    v_pk_fma_f32 v[156:157], v[220:221], v[78:79], v[156:157] op_sel:[0,0,0] op_sel_hi:[1,0,1]
    v_pk_fma_f32 v[158:159], v[222:223], v[78:79], v[158:159] op_sel:[0,0,0] op_sel_hi:[1,0,1]
    buffer_store_dwordx4 v[152:155], v60, s[48:51], s80 offen offset:2048 sc1
    buffer_store_dwordx4 v[156:159], v60, s[48:51], s80 offen offset:3072 sc1
    s_add_u32 s80, s80, 4096
    s_waitcnt lgkmcnt(2)
    v_pk_fma_f32 v[160:161], v[224:225], v[82:83], v[160:161] op_sel:[0,0,0] op_sel_hi:[1,0,1]
    v_pk_fma_f32 v[162:163], v[226:227], v[82:83], v[162:163] op_sel:[0,0,0] op_sel_hi:[1,0,1]
    v_pk_fma_f32 v[164:165], v[228:229], v[82:83], v[164:165] op_sel:[0,0,0] op_sel_hi:[1,0,1]
    v_pk_fma_f32 v[166:167], v[230:231], v[82:83], v[166:167] op_sel:[0,0,0] op_sel_hi:[1,0,1]
    buffer_store_dwordx4 v[160:163], v60, s[48:51], s80 offen offset:0 sc1
    buffer_store_dwordx4 v[164:167], v60, s[48:51], s80 offen offset:1024 sc1
    s_waitcnt lgkmcnt(0)
    v_pk_fma_f32 v[168:169], v[232:233], v[86:87], v[168:169] op_sel:[0,0,0] op_sel_hi:[1,0,1]
    v_pk_fma_f32 v[170:171], v[234:235], v[86:87], v[170:171] op_sel:[0,0,0] op_sel_hi:[1,0,1]
    v_pk_fma_f32 v[172:173], v[236:237], v[86:87], v[172:173] op_sel:[0,0,0] op_sel_hi:[1,0,1]
    v_pk_fma_f32 v[174:175], v[238:239], v[86:87], v[174:175] op_sel:[0,0,0] op_sel_hi:[1,0,1]
    buffer_store_dwordx4 v[168:171], v60, s[48:51], s80 offen offset:2048 sc1
    buffer_store_dwordx4 v[172:175], v60, s[48:51], s80 offen offset:3072 sc1
    s_add_u32 s80, s80, 4096
    v_add_u32 v52, 0xffff0000, v52
    v_add_u32 v53, 0xffff0000, v53
    v_add_u32 v54, 0xffff0000, v54
    s_branch L_jobend
L_rpg_b1:
    ds_read_b32 v43, v59
    s_waitcnt lgkmcnt(0)
    v_readlane_b32 s40, v43, 0
    v_readlane_b32 s41, v43, 1
    v_readlane_b32 s42, v43, 2
    v_readlane_b32 s43, v43, 3
    s_cmp_ge_u32 s43, 1
    s_cbranch_scc1 L_rpg_b1r
    s_branch L_rpg_b1
L_rpa_b1:
    ds_read_b32 v43, v59
    s_waitcnt lgkmcnt(0)
    v_readlane_b32 s40, v43, 0
    v_readlane_b32 s41, v43, 1
    v_readlane_b32 s42, v43, 2
    v_readlane_b32 s43, v43, 3
    s_cmp_ge_u32 s40, 3
    s_cbranch_scc1 L_rpa_b1r
    s_branch L_rpa_b1
L_rpb_b1:
    ds_read_b32 v43, v59
    s_waitcnt lgkmcnt(0)
    v_readlane_b32 s40, v43, 0
    v_readlane_b32 s41, v43, 1
    v_readlane_b32 s42, v43, 2
    v_readlane_b32 s43, v43, 3
    s_cmp_ge_u32 s41, 3
    s_cbranch_scc1 L_rpb_b1r
    s_branch L_rpb_b1
L_rpc0_b1:
    ds_read_b32 v43, v59
    s_waitcnt lgkmcnt(0)
    v_readlane_b32 s40, v43, 0
    v_readlane_b32 s41, v43, 1
    v_readlane_b32 s42, v43, 2
    v_readlane_b32 s43, v43, 3
    s_cmp_ge_u32 s42, 2
    s_cbranch_scc1 L_rpc0_b1r
    s_branch L_rpc0_b1
L_reduce_a1:
    ds_read_b32 v43, v59
    s_waitcnt lgkmcnt(0)
    v_readlane_b32 s40, v43, 0
    v_readlane_b32 s41, v43, 1
    v_readlane_b32 s42, v43, 2
    v_readlane_b32 s43, v43, 3
    s_min_u32 s82, s40, s41
    s_min_u32 s82, s82, s42
    s_cmp_ge_u32 s82, 1
    s_cbranch_scc0 L_reduce_a1
    s_mov_b32 s48, s30
    s_mov_b32 s49, s31
    s_mov_b32 s50, 5242880
    s_mov_b32 s51, 0x20000
    s_lshl_b32 s80, s56, 16
    s_add_u32 s80, s80, 0x100000
    s_add_u32 s81, s80, 32768
    s_lshl_b32 s83, s76, 12
    s_add_u32 s80, s80, s83
    s_cmp_ge_u32 s43, 1
    s_cbranch_scc0 L_rpg_a1
L_rpg_a1r:
    ds_read_b128 v[64:67], v57 offset:0
    ds_read_b128 v[68:71], v57 offset:64
    ds_read_b128 v[72:75], v57 offset:512
    ds_read_b128 v[76:79], v57 offset:576
    s_cmp_ge_u32 s40, 3
    s_cbranch_scc0 L_rpa_a1
L_rpa_a1r:
    s_waitcnt lgkmcnt(3)
    ds_read_b128 v[192:195], v52 offset:0
    ds_read_b128 v[196:199], v52 offset:512
    ds_read_b128 v[200:203], v53 offset:0
    ds_read_b128 v[204:207], v53 offset:512
    ds_read_b128 v[208:211], v52 offset:4096
    ds_read_b128 v[212:215], v52 offset:4608
    ds_read_b128 v[216:219], v53 offset:4096
    ds_read_b128 v[220:223], v53 offset:4608
    s_waitcnt lgkmcnt(6)
    v_pk_mul_f32 v[128:129], v[192:193], v[64:65] op_sel:[0,0] op_sel_hi:[1,0]
    v_pk_mul_f32 v[130:131], v[194:195], v[64:65] op_sel:[0,0] op_sel_hi:[1,0]
    v_pk_mul_f32 v[132:133], v[196:197], v[64:65] op_sel:[0,0] op_sel_hi:[1,0]
    v_pk_mul_f32 v[134:135], v[198:199], v[64:65] op_sel:[0,0] op_sel_hi:[1,0]
    s_waitcnt lgkmcnt(4)
    v_pk_mul_f32 v[136:137], v[200:201], v[68:69] op_sel:[0,0] op_sel_hi:[1,0]
    v_pk_mul_f32 v[138:139], v[202:203], v[68:69] op_sel:[0,0] op_sel_hi:[1,0]
    v_pk_mul_f32 v[140:141], v[204:205], v[68:69] op_sel:[0,0] op_sel_hi:[1,0]
    v_pk_mul_f32 v[142:143], v[206:207], v[68:69] op_sel:[0,0] op_sel_hi:[1,0]
    s_waitcnt lgkmcnt(2)
    v_pk_mul_f32 v[144:145], v[208:209], v[72:73] op_sel:[0,0] op_sel_hi:[1,0]
    v_pk_mul_f32 v[146:147], v[210:211], v[72:73] op_sel:[0,0] op_sel_hi:[1,0]
    v_pk_mul_f32 v[148:149], v[212:213], v[72:73] op_sel:[0,0] op_sel_hi:[1,0]
    v_pk_mul_f32 v[150:151], v[214:215], v[72:73] op_sel:[0,0] op_sel_hi:[1,0]
    s_waitcnt lgkmcnt(0)
    v_pk_mul_f32 v[152:153], v[216:217], v[76:77] op_sel:[0,0] op_sel_hi:[1,0]
    v_pk_mul_f32 v[154:155], v[218:219], v[76:77] op_sel:[0,0] op_sel_hi:[1,0]
    v_pk_mul_f32 v[156:157], v[220:221], v[76:77] op_sel:[0,0] op_sel_hi:[1,0]
    v_pk_mul_f32 v[158:159], v[222:223], v[76:77] op_sel:[0,0] op_sel_hi:[1,0]
    v_add_u32 v52, 0x8000, v52
    v_add_u32 v53, 0x8000, v53
    s_cmp_ge_u32 s41, 3
    s_cbranch_scc0 L_rpb_a1
L_rpb_a1r:
    s_waitcnt lgkmcnt(3)
    ds_read_b128 v[192:195], v52 offset:0
    ds_read_b128 v[196:199], v52 offset:512
    ds_read_b128 v[200:203], v53 offset:0
    ds_read_b128 v[204:207], v53 offset:512
    ds_read_b128 v[208:211], v52 offset:4096
    ds_read_b128 v[212:215], v52 offset:4608
    ds_read_b128 v[216:219], v53 offset:4096
    ds_read_b128 v[220:223], v53 offset:4608
    s_waitcnt lgkmcnt(6)
    v_pk_fma_f32 v[128:129], v[192:193], v[64:65], v[128:129] op_sel:[0,1,0] op_sel_hi:[1,1,1]
    v_pk_fma_f32 v[130:131], v[194:195], v[64:65], v[130:131] op_sel:[0,1,0] op_sel_hi:[1,1,1]
    v_pk_fma_f32 v[132:133], v[196:197], v[64:65], v[132:133] op_sel:[0,1,0] op_sel_hi:[1,1,1]
    v_pk_fma_f32 v[134:135], v[198:199], v[64:65], v[134:135] op_sel:[0,1,0] op_sel_hi:[1,1,1]
    s_waitcnt lgkmcnt(4)
    v_pk_fma_f32 v[136:137], v[200:201], v[68:69], v[136:137] op_sel:[0,1,0] op_sel_hi:[1,1,1]
    v_pk_fma_f32 v[138:139], v[202:203], v[68:69], v[138:139] op_sel:[0,1,0] op_sel_hi:[1,1,1]
    v_pk_fma_f32 v[140:141], v[204:205], v[68:69], v[140:141] op_sel:[0,1,0] op_sel_hi:[1,1,1]
    v_pk_fma_f32 v[142:143], v[206:207], v[68:69], v[142:143] op_sel:[0,1,0] op_sel_hi:[1,1,1]
    s_waitcnt lgkmcnt(2)
    v_pk_fma_f32 v[144:145], v[208:209], v[72:73], v[144:145] op_sel:[0,1,0] op_sel_hi:[1,1,1]
    v_pk_fma_f32 v[146:147], v[210:211], v[72:73], v[146:147] op_sel:[0,1,0] op_sel_hi:[1,1,1]
    v_pk_fma_f32 v[148:149], v[212:213], v[72:73], v[148:149] op_sel:[0,1,0] op_sel_hi:[1,1,1]
    v_pk_fma_f32 v[150:151], v[214:215], v[72:73], v[150:151] op_sel:[0,1,0] op_sel_hi:[1,1,1]
    s_waitcnt lgkmcnt(0)
    v_pk_fma_f32 v[152:153], v[216:217], v[76:77], v[152:153] op_sel:[0,1,0] op_sel_hi:[1,1,1]
    v_pk_fma_f32 v[154:155], v[218:219], v[76:77], v[154:155] op_sel:[0,1,0] op_sel_hi:[1,1,1]
    v_pk_fma_f32 v[156:157], v[220:221], v[76:77], v[156:157] op_sel:[0,1,0] op_sel_hi:[1,1,1]
    v_pk_fma_f32 v[158:159], v[222:223], v[76:77], v[158:159] op_sel:[0,1,0] op_sel_hi:[1,1,1]
    v_add_u32 v52, 0x8000, v52
    v_add_u32 v53, 0x8000, v53
    s_cmp_ge_u32 s42, 2
    s_cbranch_scc0 L_rpc0_a1
L_rpc0_a1r:
    s_waitcnt lgkmcnt(3)
    ds_read_b128 v[192:195], v52 offset:0
    ds_read_b128 v[196:199], v52 offset:512
    ds_read_b128 v[200:203], v53 offset:0
    ds_read_b128 v[204:207], v53 offset:512
    s_waitcnt lgkmcnt(2)
    v_pk_fma_f32 v[128:129], v[192:193], v[66:67], v[128:129] op_sel:[0,0,0] op_sel_hi:[1,0,1]
    v_pk_fma_f32 v[130:131], v[194:195], v[66:67], v[130:131] op_sel:[0,0,0] op_sel_hi:[1,0,1]
    v_pk_fma_f32 v[132:133], v[196:197], v[66:67], v[132:133] op_sel:[0,0,0] op_sel_hi:[1,0,1]
    v_pk_fma_f32 v[134:135], v[198:199], v[66:67], v[134:135] op_sel:[0,0,0] op_sel_hi:[1,0,1]
    buffer_store_dwordx4 v[128:131], v60, s[48:51], s80 offen offset:0 sc1
    buffer_store_dwordx4 v[132:135], v60, s[48:51], s80 offen offset:1024 sc1
    s_waitcnt lgkmcnt(0)
    v_pk_fma_f32 v[136:137], v[200:201], v[70:71], v[136:137] op_sel:[0,0,0] op_sel_hi:[1,0,1]
    v_pk_fma_f32 v[138:139], v[202:203], v[70:71], v[138:139] op_sel:[0,0,0] op_sel_hi:[1,0,1]
    v_pk_fma_f32 v[140:141], v[204:205], v[70:71], v[140:141] op_sel:[0,0,0] op_sel_hi:[1,0,1]
    v_pk_fma_f32 v[142:143], v[206:207], v[70:71], v[142:143] op_sel:[0,0,0] op_sel_hi:[1,0,1]
    buffer_store_dwordx4 v[136:139], v60, s[48:51], s80 offen offset:2048 sc1
    buffer_store_dwordx4 v[140:143], v60, s[48:51], s80 offen offset:3072 sc1
    s_add_u32 s80, s80, 4096
L_rpc1_a1:
    ds_read_b32 v43, v59
    s_waitcnt lgkmcnt(0)
    v_readlane_b32 s42, v43, 2
    s_cmp_ge_u32 s42, 3
    s_cbranch_scc0 L_rpc1_a1
    s_waitcnt lgkmcnt(3)
    ds_read_b128 v[208:211], v52 offset:4096
    ds_read_b128 v[212:215], v52 offset:4608
    ds_read_b128 v[216:219], v53 offset:4096
    ds_read_b128 v[220:223], v53 offset:4608
    s_waitcnt lgkmcnt(2)
    v_pk_fma_f32 v[144:145], v[208:209], v[74:75], v[144:145] op_sel:[0,0,0] op_sel_hi:[1,0,1]
    v_pk_fma_f32 v[146:147], v[210:211], v[74:75], v[146:147] op_sel:[0,0,0] op_sel_hi:[1,0,1]
    v_pk_fma_f32 v[148:149], v[212:213], v[74:75], v[148:149] op_sel:[0,0,0] op_sel_hi:[1,0,1]
    v_pk_fma_f32 v[150:151], v[214:215], v[74:75], v[150:151] op_sel:[0,0,0] op_sel_hi:[1,0,1]
    buffer_store_dwordx4 v[144:147], v60, s[48:51], s80 offen offset:0 sc1
    buffer_store_dwordx4 v[148:151], v60, s[48:51], s80 offen offset:1024 sc1
    s_waitcnt lgkmcnt(0)
    v_pk_fma_f32 v[152:153], v[216:217], v[78:79], v[152:153] op_sel:[0,0,0] op_sel_hi:[1,0,1]
    v_pk_fma_f32 v[154:155], v[218:219], v[78:79], v[154:155] op_sel:[0,0,0] op_sel_hi:[1,0,1]
    v_pk_fma_f32 v[156:157], v[220:221], v[78:79], v[156:157] op_sel:[0,0,0] op_sel_hi:[1,0,1]
    v_pk_fma_f32 v[158:159], v[222:223], v[78:79], v[158:159] op_sel:[0,0,0] op_sel_hi:[1,0,1]
    buffer_store_dwordx4 v[152:155], v60, s[48:51], s80 offen offset:2048 sc1
    buffer_store_dwordx4 v[156:159], v60, s[48:51], s80 offen offset:3072 sc1
    s_add_u32 s80, s80, 4096
    v_add_u32 v52, 0xffff0000, v52
    v_add_u32 v53, 0xffff0000, v53
    s_branch L_jobend
L_rpg_a1:
    ds_read_b32 v43, v59
    s_waitcnt lgkmcnt(0)
    v_readlane_b32 s40, v43, 0
    v_readlane_b32 s41, v43, 1
    v_readlane_b32 s42, v43, 2
    v_readlane_b32 s43, v43, 3
    s_cmp_ge_u32 s43, 1
    s_cbranch_scc1 L_rpg_a1r
    s_branch L_rpg_a1
L_rpa_a1:
    ds_read_b32 v43, v59
    s_waitcnt lgkmcnt(0)
    v_readlane_b32 s40, v43, 0
    v_readlane_b32 s41, v43, 1
    v_readlane_b32 s42, v43, 2
    v_readlane_b32 s43, v43, 3
    s_cmp_ge_u32 s40, 3
    s_cbranch_scc1 L_rpa_a1r
    s_branch L_rpa_a1
L_rpb_a1:
    ds_read_b32 v43, v59
    s_waitcnt lgkmcnt(0)
    v_readlane_b32 s40, v43, 0
    v_readlane_b32 s41, v43, 1
    v_readlane_b32 s42, v43, 2
    v_readlane_b32 s43, v43, 3
    s_cmp_ge_u32 s41, 3
    s_cbranch_scc1 L_rpb_a1r
    s_branch L_rpb_a1
L_rpc0_a1:
    ds_read_b32 v43, v59
    s_waitcnt lgkmcnt(0)
    v_readlane_b32 s40, v43, 0
    v_readlane_b32 s41, v43, 1
    v_readlane_b32 s42, v43, 2
    v_readlane_b32 s43, v43, 3
    s_cmp_ge_u32 s42, 2
    s_cbranch_scc1 L_rpc0_a1r
    s_branch L_rpc0_a1
L_reduce_d1:
    ds_read_b32 v43, v59
    s_waitcnt lgkmcnt(0)
    v_readlane_b32 s40, v43, 0
    v_readlane_b32 s41, v43, 1
    v_readlane_b32 s42, v43, 2
    v_readlane_b32 s43, v43, 3
    s_min_u32 s82, s40, s41
    s_min_u32 s82, s82, s42
    s_cmp_ge_u32 s82, 1
    s_cbranch_scc0 L_reduce_d1
    ds_read_b64 v[32:33], v58 offset:0
    ds_read_b64 v[34:35], v58 offset:512
    ds_read_b64 v[36:37], v58 offset:1024
    s_mov_b32 s48, s30
    s_mov_b32 s49, s31
    s_mov_b32 s50, 5242880
    s_mov_b32 s51, 0x20000
    s_lshl_b32 s80, s56, 16
    s_add_u32 s80, s80, 0x100000
    s_add_u32 s81, s80, 32768
    s_lshl_b32 s83, s76, 12
    s_add_u32 s80, s80, s83
    v_lshlrev_b32 v42, 3, v1
    v_add_u32 v43, 118784, v60
    v_mov_b32 v44, 1
    s_waitcnt lgkmcnt(0)
    v_max3_f32 v40, v32, v34, v36
    v_sub_f32 v32, v32, v40
    v_sub_f32 v34, v34, v40
    v_sub_f32 v36, v36, v40
    v_exp_f32 v32, v32
    v_exp_f32 v34, v34
    v_exp_f32 v36, v36
    v_mul_f32 v41, v32, v33
    v_fma_f32 v41, v34, v35, v41
    v_fma_f32 v41, v36, v37, v41
    buffer_store_dwordx2 v[40:41], v42, s[48:51], s81 offen sc1
    v_rcp_f32 v33, v41
    s_nop 0
    v_mul_f32 v48, v32, v33
    v_mul_f32 v49, v34, v33
    v_mul_f32 v50, v36, v33
    ds_write_b128 v43, v[48:51]
    ds_write_b32 v22, v44 offset:1792
    ds_read_b128 v[64:67], v57 offset:0
    ds_read_b128 v[68:71], v57 offset:64
    ds_read_b128 v[72:75], v57 offset:128
    ds_read_b128 v[76:79], v57 offset:512
    ds_read_b128 v[80:83], v57 offset:576
    ds_read_b128 v[84:87], v57 offset:640
    s_cmp_ge_u32 s40, 3
    s_cbranch_scc0 L_rpa_d1
L_rpa_d1r:
    s_waitcnt lgkmcnt(3)
    ds_read_b128 v[192:195], v52 offset:0
    ds_read_b128 v[196:199], v52 offset:512
    ds_read_b128 v[200:203], v53 offset:0
    ds_read_b128 v[204:207], v53 offset:512
    ds_read_b128 v[208:211], v54 offset:0
    ds_read_b128 v[212:215], v54 offset:512
    ds_read_b128 v[216:219], v52 offset:4096
    ds_read_b128 v[220:223], v52 offset:4608
    ds_read_b128 v[224:227], v53 offset:4096
    ds_read_b128 v[228:231], v53 offset:4608
    ds_read_b128 v[232:235], v54 offset:4096
    ds_read_b128 v[236:239], v54 offset:4608
    s_waitcnt lgkmcnt(10)
    v_pk_mul_f32 v[128:129], v[192:193], v[64:65] op_sel:[0,0] op_sel_hi:[1,0]
    v_pk_mul_f32 v[130:131], v[194:195], v[64:65] op_sel:[0,0] op_sel_hi:[1,0]
    v_pk_mul_f32 v[132:133], v[196:197], v[64:65] op_sel:[0,0] op_sel_hi:[1,0]
    v_pk_mul_f32 v[134:135], v[198:199], v[64:65] op_sel:[0,0] op_sel_hi:[1,0]
    s_waitcnt lgkmcnt(8)
    v_pk_mul_f32 v[136:137], v[200:201], v[68:69] op_sel:[0,0] op_sel_hi:[1,0]
    v_pk_mul_f32 v[138:139], v[202:203], v[68:69] op_sel:[0,0] op_sel_hi:[1,0]
    v_pk_mul_f32 v[140:141], v[204:205], v[68:69] op_sel:[0,0] op_sel_hi:[1,0]
    v_pk_mul_f32 v[142:143], v[206:207], v[68:69] op_sel:[0,0] op_sel_hi:[1,0]
    s_waitcnt lgkmcnt(6)
    v_pk_mul_f32 v[144:145], v[208:209], v[72:73] op_sel:[0,0] op_sel_hi:[1,0]
    v_pk_mul_f32 v[146:147], v[210:211], v[72:73] op_sel:[0,0] op_sel_hi:[1,0]
    v_pk_mul_f32 v[148:149], v[212:213], v[72:73] op_sel:[0,0] op_sel_hi:[1,0]
    v_pk_mul_f32 v[150:151], v[214:215], v[72:73] op_sel:[0,0] op_sel_hi:[1,0]
    s_waitcnt lgkmcnt(4)
    v_pk_mul_f32 v[152:153], v[216:217], v[76:77] op_sel:[0,0] op_sel_hi:[1,0]
    v_pk_mul_f32 v[154:155], v[218:219], v[76:77] op_sel:[0,0] op_sel_hi:[1,0]
    v_pk_mul_f32 v[156:157], v[220:221], v[76:77] op_sel:[0,0] op_sel_hi:[1,0]
    v_pk_mul_f32 v[158:159], v[222:223], v[76:77] op_sel:[0,0] op_sel_hi:[1,0]
    s_waitcnt lgkmcnt(2)
    v_pk_mul_f32 v[160:161], v[224:225], v[80:81] op_sel:[0,0] op_sel_hi:[1,0]
    v_pk_mul_f32 v[162:163], v[226:227], v[80:81] op_sel:[0,0] op_sel_hi:[1,0]
    v_pk_mul_f32 v[164:165], v[228:229], v[80:81] op_sel:[0,0] op_sel_hi:[1,0]
    v_pk_mul_f32 v[166:167], v[230:231], v[80:81] op_sel:[0,0] op_sel_hi:[1,0]
    s_waitcnt lgkmcnt(0)
    v_pk_mul_f32 v[168:169], v[232:233], v[84:85] op_sel:[0,0] op_sel_hi:[1,0]
    v_pk_mul_f32 v[170:171], v[234:235], v[84:85] op_sel:[0,0] op_sel_hi:[1,0]
    v_pk_mul_f32 v[172:173], v[236:237], v[84:85] op_sel:[0,0] op_sel_hi:[1,0]
    v_pk_mul_f32 v[174:175], v[238:239], v[84:85] op_sel:[0,0] op_sel_hi:[1,0]
    v_add_u32 v52, 0x8000, v52
    v_add_u32 v53, 0x8000, v53
    v_add_u32 v54, 0x8000, v54
    s_cmp_ge_u32 s41, 3
    s_cbranch_scc0 L_rpb_d1
L_rpb_d1r:
    s_waitcnt lgkmcnt(3)
    ds_read_b128 v[192:195], v52 offset:0
    ds_read_b128 v[196:199], v52 offset:512
    ds_read_b128 v[200:203], v53 offset:0
    ds_read_b128 v[204:207], v53 offset:512
    ds_read_b128 v[208:211], v54 offset:0
    ds_read_b128 v[212:215], v54 offset:512
    ds_read_b128 v[216:219], v52 offset:4096
    ds_read_b128 v[220:223], v52 offset:4608
    ds_read_b128 v[224:227], v53 offset:4096
    ds_read_b128 v[228:231], v53 offset:4608
    ds_read_b128 v[232:235], v54 offset:4096
    ds_read_b128 v[236:239], v54 offset:4608
    s_waitcnt lgkmcnt(10)
    v_pk_fma_f32 v[128:129], v[192:193], v[64:65], v[128:129] op_sel:[0,1,0] op_sel_hi:[1,1,1]
    v_pk_fma_f32 v[130:131], v[194:195], v[64:65], v[130:131] op_sel:[0,1,0] op_sel_hi:[1,1,1]
    v_pk_fma_f32 v[132:133], v[196:197], v[64:65], v[132:133] op_sel:[0,1,0] op_sel_hi:[1,1,1]
    v_pk_fma_f32 v[134:135], v[198:199], v[64:65], v[134:135] op_sel:[0,1,0] op_sel_hi:[1,1,1]
    s_waitcnt lgkmcnt(8)
    v_pk_fma_f32 v[136:137], v[200:201], v[68:69], v[136:137] op_sel:[0,1,0] op_sel_hi:[1,1,1]
    v_pk_fma_f32 v[138:139], v[202:203], v[68:69], v[138:139] op_sel:[0,1,0] op_sel_hi:[1,1,1]
    v_pk_fma_f32 v[140:141], v[204:205], v[68:69], v[140:141] op_sel:[0,1,0] op_sel_hi:[1,1,1]
    v_pk_fma_f32 v[142:143], v[206:207], v[68:69], v[142:143] op_sel:[0,1,0] op_sel_hi:[1,1,1]
    s_waitcnt lgkmcnt(6)
    v_pk_fma_f32 v[144:145], v[208:209], v[72:73], v[144:145] op_sel:[0,1,0] op_sel_hi:[1,1,1]
    v_pk_fma_f32 v[146:147], v[210:211], v[72:73], v[146:147] op_sel:[0,1,0] op_sel_hi:[1,1,1]
    v_pk_fma_f32 v[148:149], v[212:213], v[72:73], v[148:149] op_sel:[0,1,0] op_sel_hi:[1,1,1]
    v_pk_fma_f32 v[150:151], v[214:215], v[72:73], v[150:151] op_sel:[0,1,0] op_sel_hi:[1,1,1]
    s_waitcnt lgkmcnt(4)
    v_pk_fma_f32 v[152:153], v[216:217], v[76:77], v[152:153] op_sel:[0,1,0] op_sel_hi:[1,1,1]
    v_pk_fma_f32 v[154:155], v[218:219], v[76:77], v[154:155] op_sel:[0,1,0] op_sel_hi:[1,1,1]
    v_pk_fma_f32 v[156:157], v[220:221], v[76:77], v[156:157] op_sel:[0,1,0] op_sel_hi:[1,1,1]
    v_pk_fma_f32 v[158:159], v[222:223], v[76:77], v[158:159] op_sel:[0,1,0] op_sel_hi:[1,1,1]
    s_waitcnt lgkmcnt(2)
    v_pk_fma_f32 v[160:161], v[224:225], v[80:81], v[160:161] op_sel:[0,1,0] op_sel_hi:[1,1,1]
    v_pk_fma_f32 v[162:163], v[226:227], v[80:81], v[162:163] op_sel:[0,1,0] op_sel_hi:[1,1,1]
    v_pk_fma_f32 v[164:165], v[228:229], v[80:81], v[164:165] op_sel:[0,1,0] op_sel_hi:[1,1,1]
    v_pk_fma_f32 v[166:167], v[230:231], v[80:81], v[166:167] op_sel:[0,1,0] op_sel_hi:[1,1,1]
    s_waitcnt lgkmcnt(0)
    v_pk_fma_f32 v[168:169], v[232:233], v[84:85], v[168:169] op_sel:[0,1,0] op_sel_hi:[1,1,1]
    v_pk_fma_f32 v[170:171], v[234:235], v[84:85], v[170:171] op_sel:[0,1,0] op_sel_hi:[1,1,1]
    v_pk_fma_f32 v[172:173], v[236:237], v[84:85], v[172:173] op_sel:[0,1,0] op_sel_hi:[1,1,1]
    v_pk_fma_f32 v[174:175], v[238:239], v[84:85], v[174:175] op_sel:[0,1,0] op_sel_hi:[1,1,1]
    v_add_u32 v52, 0x8000, v52
    v_add_u32 v53, 0x8000, v53
    v_add_u32 v54, 0x8000, v54
    s_cmp_ge_u32 s42, 2
    s_cbranch_scc0 L_rpc0_d1
L_rpc0_d1r:
    s_waitcnt lgkmcnt(3)
    ds_read_b128 v[192:195], v52 offset:0
    ds_read_b128 v[196:199], v52 offset:512
    ds_read_b128 v[200:203], v53 offset:0
    ds_read_b128 v[204:207], v53 offset:512
    ds_read_b128 v[208:211], v54 offset:0
    ds_read_b128 v[212:215], v54 offset:512
    s_waitcnt lgkmcnt(4)
    v_pk_fma_f32 v[128:129], v[192:193], v[66:67], v[128:129] op_sel:[0,0,0] op_sel_hi:[1,0,1]
    v_pk_fma_f32 v[130:131], v[194:195], v[66:67], v[130:131] op_sel:[0,0,0] op_sel_hi:[1,0,1]
    v_pk_fma_f32 v[132:133], v[196:197], v[66:67], v[132:133] op_sel:[0,0,0] op_sel_hi:[1,0,1]
    v_pk_fma_f32 v[134:135], v[198:199], v[66:67], v[134:135] op_sel:[0,0,0] op_sel_hi:[1,0,1]
    buffer_store_dwordx4 v[128:131], v60, s[48:51], s80 offen offset:0 sc1
    buffer_store_dwordx4 v[132:135], v60, s[48:51], s80 offen offset:1024 sc1
    s_waitcnt lgkmcnt(2)
    v_pk_fma_f32 v[136:137], v[200:201], v[70:71], v[136:137] op_sel:[0,0,0] op_sel_hi:[1,0,1]
    v_pk_fma_f32 v[138:139], v[202:203], v[70:71], v[138:139] op_sel:[0,0,0] op_sel_hi:[1,0,1]
    v_pk_fma_f32 v[140:141], v[204:205], v[70:71], v[140:141] op_sel:[0,0,0] op_sel_hi:[1,0,1]
    v_pk_fma_f32 v[142:143], v[206:207], v[70:71], v[142:143] op_sel:[0,0,0] op_sel_hi:[1,0,1]
    buffer_store_dwordx4 v[136:139], v60, s[48:51], s80 offen offset:2048 sc1
    buffer_store_dwordx4 v[140:143], v60, s[48:51], s80 offen offset:3072 sc1
    s_add_u32 s80, s80, 4096
    s_waitcnt lgkmcnt(0)
    v_pk_fma_f32 v[144:145], v[208:209], v[74:75], v[144:145] op_sel:[0,0,0] op_sel_hi:[1,0,1]
    v_pk_fma_f32 v[146:147], v[210:211], v[74:75], v[146:147] op_sel:[0,0,0] op_sel_hi:[1,0,1]
    v_pk_fma_f32 v[148:149], v[212:213], v[74:75], v[148:149] op_sel:[0,0,0] op_sel_hi:[1,0,1]
    v_pk_fma_f32 v[150:151], v[214:215], v[74:75], v[150:151] op_sel:[0,0,0] op_sel_hi:[1,0,1]
    buffer_store_dwordx4 v[144:147], v60, s[48:51], s80 offen offset:0 sc1
    buffer_store_dwordx4 v[148:151], v60, s[48:51], s80 offen offset:1024 sc1
L_rpc1_d1:
    ds_read_b32 v43, v59
    s_waitcnt lgkmcnt(0)
    v_readlane_b32 s42, v43, 2
    s_cmp_ge_u32 s42, 3
    s_cbranch_scc0 L_rpc1_d1
    s_waitcnt lgkmcnt(3)
    ds_read_b128 v[216:219], v52 offset:4096
    ds_read_b128 v[220:223], v52 offset:4608
    ds_read_b128 v[224:227], v53 offset:4096
    ds_read_b128 v[228:231], v53 offset:4608
    ds_read_b128 v[232:235], v54 offset:4096
    ds_read_b128 v[236:239], v54 offset:4608
    s_waitcnt lgkmcnt(4)
    v_pk_fma_f32 v[152:153], v[216:217], v[78:79], v[152:153] op_sel:[0,0,0] op_sel_hi:[1,0,1]
    v_pk_fma_f32 v[154:155], v[218:219], v[78:79], v[154:155] op_sel:[0,0,0] op_sel_hi:[1,0,1]
    v_pk_fma_f32 v[156:157], v[220:221], v[78:79], v[156:157] op_sel:[0,0,0] op_sel_hi:[1,0,1]
    v_pk_fma_f32 v[158:159], v[222:223], v[78:79], v[158:159] op_sel:[0,0,0] op_sel_hi:[1,0,1]
    buffer_store_dwordx4 v[152:155], v60, s[48:51], s80 offen offset:2048 sc1
    buffer_store_dwordx4 v[156:159], v60, s[48:51], s80 offen offset:3072 sc1
    s_add_u32 s80, s80, 4096
    s_waitcnt lgkmcnt(2)
    v_pk_fma_f32 v[160:161], v[224:225], v[82:83], v[160:161] op_sel:[0,0,0] op_sel_hi:[1,0,1]
    v_pk_fma_f32 v[162:163], v[226:227], v[82:83], v[162:163] op_sel:[0,0,0] op_sel_hi:[1,0,1]
    v_pk_fma_f32 v[164:165], v[228:229], v[82:83], v[164:165] op_sel:[0,0,0] op_sel_hi:[1,0,1]
    v_pk_fma_f32 v[166:167], v[230:231], v[82:83], v[166:167] op_sel:[0,0,0] op_sel_hi:[1,0,1]
    buffer_store_dwordx4 v[160:163], v60, s[48:51], s80 offen offset:0 sc1
    buffer_store_dwordx4 v[164:167], v60, s[48:51], s80 offen offset:1024 sc1
    s_waitcnt lgkmcnt(0)
    v_pk_fma_f32 v[168:169], v[232:233], v[86:87], v[168:169] op_sel:[0,0,0] op_sel_hi:[1,0,1]
    v_pk_fma_f32 v[170:171], v[234:235], v[86:87], v[170:171] op_sel:[0,0,0] op_sel_hi:[1,0,1]
    v_pk_fma_f32 v[172:173], v[236:237], v[86:87], v[172:173] op_sel:[0,0,0] op_sel_hi:[1,0,1]
    v_pk_fma_f32 v[174:175], v[238:239], v[86:87], v[174:175] op_sel:[0,0,0] op_sel_hi:[1,0,1]
    buffer_store_dwordx4 v[168:171], v60, s[48:51], s80 offen offset:2048 sc1
    buffer_store_dwordx4 v[172:175], v60, s[48:51], s80 offen offset:3072 sc1
    s_add_u32 s80, s80, 4096
    v_add_u32 v52, 0xffff0000, v52
    v_add_u32 v53, 0xffff0000, v53
    v_add_u32 v54, 0xffff0000, v54
    s_branch L_jobend
L_rpa_d1:
    ds_read_b32 v43, v59
    s_waitcnt lgkmcnt(0)
    v_readlane_b32 s40, v43, 0
    v_readlane_b32 s41, v43, 1
    v_readlane_b32 s42, v43, 2
    v_readlane_b32 s43, v43, 3
    s_cmp_ge_u32 s40, 3
    s_cbranch_scc1 L_rpa_d1r
    s_branch L_rpa_d1
L_rpb_d1:
    ds_read_b32 v43, v59
    s_waitcnt lgkmcnt(0)
    v_readlane_b32 s40, v43, 0
    v_readlane_b32 s41, v43, 1
    v_readlane_b32 s42, v43, 2
    v_readlane_b32 s43, v43, 3
    s_cmp_ge_u32 s41, 3
    s_cbranch_scc1 L_rpb_d1r
    s_branch L_rpb_d1
L_rpc0_d1:
    ds_read_b32 v43, v59
    s_waitcnt lgkmcnt(0)
    v_readlane_b32 s40, v43, 0
    v_readlane_b32 s41, v43, 1
    v_readlane_b32 s42, v43, 2
    v_readlane_b32 s43, v43, 3
    s_cmp_ge_u32 s42, 2
    s_cbranch_scc1 L_rpc0_d1r
    s_branch L_rpc0_d1
L_reduce_b2:
    ds_read_b32 v43, v59
    s_waitcnt lgkmcnt(0)
    v_readlane_b32 s40, v43, 0
    v_readlane_b32 s41, v43, 1
    v_readlane_b32 s42, v43, 2
    v_readlane_b32 s43, v43, 3
    s_min_u32 s82, s40, s41
    s_min_u32 s82, s82, s42
    s_cmp_ge_u32 s82, 1
    s_cbranch_scc0 L_reduce_b2
    s_mov_b32 s48, s30
    s_mov_b32 s49, s31
    s_mov_b32 s50, 5242880
    s_mov_b32 s51, 0x20000
    s_lshl_b32 s80, s56, 16
    s_add_u32 s80, s80, 0x100000
    s_add_u32 s81, s80, 32768
    s_lshl_b32 s83, s76, 12
    s_add_u32 s80, s80, s83
    buffer_load_dwordx4 v[128:131], v60, s[48:51], s80 offen offset:0 sc1
    buffer_load_dwordx4 v[132:135], v60, s[48:51], s80 offen offset:1024 sc1
    buffer_load_dwordx4 v[136:139], v60, s[48:51], s80 offen offset:2048 sc1
    buffer_load_dwordx4 v[140:143], v60, s[48:51], s80 offen offset:3072 sc1
    s_add_u32 s80, s80, 4096
    buffer_load_dwordx4 v[144:147], v60, s[48:51], s80 offen offset:0 sc1
    buffer_load_dwordx4 v[148:151], v60, s[48:51], s80 offen offset:1024 sc1
    buffer_load_dwordx4 v[152:155], v60, s[48:51], s80 offen offset:2048 sc1
    buffer_load_dwordx4 v[156:159], v60, s[48:51], s80 offen offset:3072 sc1
    s_add_u32 s80, s80, 4096
    buffer_load_dwordx4 v[160:163], v60, s[48:51], s80 offen offset:0 sc1
    buffer_load_dwordx4 v[164:167], v60, s[48:51], s80 offen offset:1024 sc1
    buffer_load_dwordx4 v[168:171], v60, s[48:51], s80 offen offset:2048 sc1
    buffer_load_dwordx4 v[172:175], v60, s[48:51], s80 offen offset:3072 sc1
    s_add_u32 s80, s80, 4096
    s_cmp_ge_u32 s43, 1
    s_cbranch_scc0 L_rpg_b2
L_rpg_b2r:
    ds_read_b128 v[64:67], v57 offset:0
    ds_read_b128 v[68:71], v57 offset:64
    ds_read_b128 v[72:75], v57 offset:128
    ds_read_b128 v[76:79], v57 offset:512
    ds_read_b128 v[80:83], v57 offset:576
    ds_read_b128 v[84:87], v57 offset:640
    s_waitcnt vmcnt(0) lgkmcnt(0)
    v_pk_mul_f32 v[128:129], v[128:129], v[66:67] op_sel:[0,1] op_sel_hi:[1,1]
    v_pk_mul_f32 v[130:131], v[130:131], v[66:67] op_sel:[0,1] op_sel_hi:[1,1]
    v_pk_mul_f32 v[132:133], v[132:133], v[66:67] op_sel:[0,1] op_sel_hi:[1,1]
    v_pk_mul_f32 v[134:135], v[134:135], v[66:67] op_sel:[0,1] op_sel_hi:[1,1]
    v_pk_mul_f32 v[136:137], v[136:137], v[70:71] op_sel:[0,1] op_sel_hi:[1,1]
    v_pk_mul_f32 v[138:139], v[138:139], v[70:71] op_sel:[0,1] op_sel_hi:[1,1]
    v_pk_mul_f32 v[140:141], v[140:141], v[70:71] op_sel:[0,1] op_sel_hi:[1,1]
    v_pk_mul_f32 v[142:143], v[142:143], v[70:71] op_sel:[0,1] op_sel_hi:[1,1]
    v_pk_mul_f32 v[144:145], v[144:145], v[74:75] op_sel:[0,1] op_sel_hi:[1,1]
    v_pk_mul_f32 v[146:147], v[146:147], v[74:75] op_sel:[0,1] op_sel_hi:[1,1]
    v_pk_mul_f32 v[148:149], v[148:149], v[74:75] op_sel:[0,1] op_sel_hi:[1,1]
    v_pk_mul_f32 v[150:151], v[150:151], v[74:75] op_sel:[0,1] op_sel_hi:[1,1]
    v_pk_mul_f32 v[152:153], v[152:153], v[78:79] op_sel:[0,1] op_sel_hi:[1,1]
    v_pk_mul_f32 v[154:155], v[154:155], v[78:79] op_sel:[0,1] op_sel_hi:[1,1]
    v_pk_mul_f32 v[156:157], v[156:157], v[78:79] op_sel:[0,1] op_sel_hi:[1,1]
    v_pk_mul_f32 v[158:159], v[158:159], v[78:79] op_sel:[0,1] op_sel_hi:[1,1]
    v_pk_mul_f32 v[160:161], v[160:161], v[82:83] op_sel:[0,1] op_sel_hi:[1,1]
    v_pk_mul_f32 v[162:163], v[162:163], v[82:83] op_sel:[0,1] op_sel_hi:[1,1]
    v_pk_mul_f32 v[164:165], v[164:165], v[82:83] op_sel:[0,1] op_sel_hi:[1,1]
    v_pk_mul_f32 v[166:167], v[166:167], v[82:83] op_sel:[0,1] op_sel_hi:[1,1]
    v_pk_mul_f32 v[168:169], v[168:169], v[86:87] op_sel:[0,1] op_sel_hi:[1,1]
    v_pk_mul_f32 v[170:171], v[170:171], v[86:87] op_sel:[0,1] op_sel_hi:[1,1]
    v_pk_mul_f32 v[172:173], v[172:173], v[86:87] op_sel:[0,1] op_sel_hi:[1,1]
    v_pk_mul_f32 v[174:175], v[174:175], v[86:87] op_sel:[0,1] op_sel_hi:[1,1]
    s_cmp_ge_u32 s40, 3
    s_cbranch_scc0 L_rpa_b2
L_rpa_b2r:
    s_waitcnt lgkmcnt(3)
    ds_read_b128 v[192:195], v52 offset:0
    ds_read_b128 v[196:199], v52 offset:512
    ds_read_b128 v[200:203], v53 offset:0
    ds_read_b128 v[204:207], v53 offset:512
    ds_read_b128 v[208:211], v54 offset:0
    ds_read_b128 v[212:215], v54 offset:512
    ds_read_b128 v[216:219], v52 offset:4096
    ds_read_b128 v[220:223], v52 offset:4608
    ds_read_b128 v[224:227], v53 offset:4096
    ds_read_b128 v[228:231], v53 offset:4608
    ds_read_b128 v[232:235], v54 offset:4096
    ds_read_b128 v[236:239], v54 offset:4608
    s_waitcnt lgkmcnt(10)
    v_pk_fma_f32 v[128:129], v[192:193], v[64:65], v[128:129] op_sel:[0,0,0] op_sel_hi:[1,0,1]
    v_pk_fma_f32 v[130:131], v[194:195], v[64:65], v[130:131] op_sel:[0,0,0] op_sel_hi:[1,0,1]
    v_pk_fma_f32 v[132:133], v[196:197], v[64:65], v[132:133] op_sel:[0,0,0] op_sel_hi:[1,0,1]
    v_pk_fma_f32 v[134:135], v[198:199], v[64:65], v[134:135] op_sel:[0,0,0] op_sel_hi:[1,0,1]
    s_waitcnt lgkmcnt(8)
    v_pk_fma_f32 v[136:137], v[200:201], v[68:69], v[136:137] op_sel:[0,0,0] op_sel_hi:[1,0,1]
    v_pk_fma_f32 v[138:139], v[202:203], v[68:69], v[138:139] op_sel:[0,0,0] op_sel_hi:[1,0,1]
    v_pk_fma_f32 v[140:141], v[204:205], v[68:69], v[140:141] op_sel:[0,0,0] op_sel_hi:[1,0,1]
    v_pk_fma_f32 v[142:143], v[206:207], v[68:69], v[142:143] op_sel:[0,0,0] op_sel_hi:[1,0,1]
    s_waitcnt lgkmcnt(6)
    v_pk_fma_f32 v[144:145], v[208:209], v[72:73], v[144:145] op_sel:[0,0,0] op_sel_hi:[1,0,1]
    v_pk_fma_f32 v[146:147], v[210:211], v[72:73], v[146:147] op_sel:[0,0,0] op_sel_hi:[1,0,1]
    v_pk_fma_f32 v[148:149], v[212:213], v[72:73], v[148:149] op_sel:[0,0,0] op_sel_hi:[1,0,1]
    v_pk_fma_f32 v[150:151], v[214:215], v[72:73], v[150:151] op_sel:[0,0,0] op_sel_hi:[1,0,1]
    s_waitcnt lgkmcnt(4)
    v_pk_fma_f32 v[152:153], v[216:217], v[76:77], v[152:153] op_sel:[0,0,0] op_sel_hi:[1,0,1]
    v_pk_fma_f32 v[154:155], v[218:219], v[76:77], v[154:155] op_sel:[0,0,0] op_sel_hi:[1,0,1]
    v_pk_fma_f32 v[156:157], v[220:221], v[76:77], v[156:157] op_sel:[0,0,0] op_sel_hi:[1,0,1]
    v_pk_fma_f32 v[158:159], v[222:223], v[76:77], v[158:159] op_sel:[0,0,0] op_sel_hi:[1,0,1]
    s_waitcnt lgkmcnt(2)
    v_pk_fma_f32 v[160:161], v[224:225], v[80:81], v[160:161] op_sel:[0,0,0] op_sel_hi:[1,0,1]
    v_pk_fma_f32 v[162:163], v[226:227], v[80:81], v[162:163] op_sel:[0,0,0] op_sel_hi:[1,0,1]
    v_pk_fma_f32 v[164:165], v[228:229], v[80:81], v[164:165] op_sel:[0,0,0] op_sel_hi:[1,0,1]
    v_pk_fma_f32 v[166:167], v[230:231], v[80:81], v[166:167] op_sel:[0,0,0] op_sel_hi:[1,0,1]
    s_waitcnt lgkmcnt(0)
    v_pk_fma_f32 v[168:169], v[232:233], v[84:85], v[168:169] op_sel:[0,0,0] op_sel_hi:[1,0,1]
    v_pk_fma_f32 v[170:171], v[234:235], v[84:85], v[170:171] op_sel:[0,0,0] op_sel_hi:[1,0,1]
    v_pk_fma_f32 v[172:173], v[236:237], v[84:85], v[172:173] op_sel:[0,0,0] op_sel_hi:[1,0,1]
    v_pk_fma_f32 v[174:175], v[238:239], v[84:85], v[174:175] op_sel:[0,0,0] op_sel_hi:[1,0,1]
    v_add_u32 v52, 0x8000, v52
    v_add_u32 v53, 0x8000, v53
    v_add_u32 v54, 0x8000, v54
    s_cmp_ge_u32 s41, 3
    s_cbranch_scc0 L_rpb_b2
L_rpb_b2r:
    s_waitcnt lgkmcnt(3)
    ds_read_b128 v[192:195], v52 offset:0
    ds_read_b128 v[196:199], v52 offset:512
    ds_read_b128 v[200:203], v53 offset:0
    ds_read_b128 v[204:207], v53 offset:512
    ds_read_b128 v[208:211], v54 offset:0
    ds_read_b128 v[212:215], v54 offset:512
    ds_read_b128 v[216:219], v52 offset:4096
    ds_read_b128 v[220:223], v52 offset:4608
    ds_read_b128 v[224:227], v53 offset:4096
    ds_read_b128 v[228:231], v53 offset:4608
    ds_read_b128 v[232:235], v54 offset:4096
    ds_read_b128 v[236:239], v54 offset:4608
    s_waitcnt lgkmcnt(10)
    v_pk_fma_f32 v[128:129], v[192:193], v[64:65], v[128:129] op_sel:[0,1,0] op_sel_hi:[1,1,1]
    v_pk_fma_f32 v[130:131], v[194:195], v[64:65], v[130:131] op_sel:[0,1,0] op_sel_hi:[1,1,1]
    v_pk_fma_f32 v[132:133], v[196:197], v[64:65], v[132:133] op_sel:[0,1,0] op_sel_hi:[1,1,1]
    v_pk_fma_f32 v[134:135], v[198:199], v[64:65], v[134:135] op_sel:[0,1,0] op_sel_hi:[1,1,1]
    s_waitcnt lgkmcnt(8)
    v_pk_fma_f32 v[136:137], v[200:201], v[68:69], v[136:137] op_sel:[0,1,0] op_sel_hi:[1,1,1]
    v_pk_fma_f32 v[138:139], v[202:203], v[68:69], v[138:139] op_sel:[0,1,0] op_sel_hi:[1,1,1]
    v_pk_fma_f32 v[140:141], v[204:205], v[68:69], v[140:141] op_sel:[0,1,0] op_sel_hi:[1,1,1]
    v_pk_fma_f32 v[142:143], v[206:207], v[68:69], v[142:143] op_sel:[0,1,0] op_sel_hi:[1,1,1]
    s_waitcnt lgkmcnt(6)
    v_pk_fma_f32 v[144:145], v[208:209], v[72:73], v[144:145] op_sel:[0,1,0] op_sel_hi:[1,1,1]
    v_pk_fma_f32 v[146:147], v[210:211], v[72:73], v[146:147] op_sel:[0,1,0] op_sel_hi:[1,1,1]
    v_pk_fma_f32 v[148:149], v[212:213], v[72:73], v[148:149] op_sel:[0,1,0] op_sel_hi:[1,1,1]
    v_pk_fma_f32 v[150:151], v[214:215], v[72:73], v[150:151] op_sel:[0,1,0] op_sel_hi:[1,1,1]
    s_waitcnt lgkmcnt(4)
    v_pk_fma_f32 v[152:153], v[216:217], v[76:77], v[152:153] op_sel:[0,1,0] op_sel_hi:[1,1,1]
    v_pk_fma_f32 v[154:155], v[218:219], v[76:77], v[154:155] op_sel:[0,1,0] op_sel_hi:[1,1,1]
    v_pk_fma_f32 v[156:157], v[220:221], v[76:77], v[156:157] op_sel:[0,1,0] op_sel_hi:[1,1,1]
    v_pk_fma_f32 v[158:159], v[222:223], v[76:77], v[158:159] op_sel:[0,1,0] op_sel_hi:[1,1,1]
    s_waitcnt lgkmcnt(2)
    v_pk_fma_f32 v[160:161], v[224:225], v[80:81], v[160:161] op_sel:[0,1,0] op_sel_hi:[1,1,1]
    v_pk_fma_f32 v[162:163], v[226:227], v[80:81], v[162:163] op_sel:[0,1,0] op_sel_hi:[1,1,1]
    v_pk_fma_f32 v[164:165], v[228:229], v[80:81], v[164:165] op_sel:[0,1,0] op_sel_hi:[1,1,1]
    v_pk_fma_f32 v[166:167], v[230:231], v[80:81], v[166:167] op_sel:[0,1,0] op_sel_hi:[1,1,1]
    s_waitcnt lgkmcnt(0)
    v_pk_fma_f32 v[168:169], v[232:233], v[84:85], v[168:169] op_sel:[0,1,0] op_sel_hi:[1,1,1]
    v_pk_fma_f32 v[170:171], v[234:235], v[84:85], v[170:171] op_sel:[0,1,0] op_sel_hi:[1,1,1]
    v_pk_fma_f32 v[172:173], v[236:237], v[84:85], v[172:173] op_sel:[0,1,0] op_sel_hi:[1,1,1]
    v_pk_fma_f32 v[174:175], v[238:239], v[84:85], v[174:175] op_sel:[0,1,0] op_sel_hi:[1,1,1]
    v_add_u32 v52, 0x8000, v52
    v_add_u32 v53, 0x8000, v53
    v_add_u32 v54, 0x8000, v54
    s_cmp_ge_u32 s42, 2
    s_cbranch_scc0 L_rpc0_b2
L_rpc0_b2r:
    s_waitcnt lgkmcnt(3)
    ds_read_b128 v[192:195], v52 offset:0
    ds_read_b128 v[196:199], v52 offset:512
    ds_read_b128 v[200:203], v53 offset:0
    ds_read_b128 v[204:207], v53 offset:512
    ds_read_b128 v[208:211], v54 offset:0
    ds_read_b128 v[212:215], v54 offset:512
    s_waitcnt lgkmcnt(4)
    v_pk_fma_f32 v[128:129], v[192:193], v[66:67], v[128:129] op_sel:[0,0,0] op_sel_hi:[1,0,1]
    v_pk_fma_f32 v[130:131], v[194:195], v[66:67], v[130:131] op_sel:[0,0,0] op_sel_hi:[1,0,1]
    v_pk_fma_f32 v[132:133], v[196:197], v[66:67], v[132:133] op_sel:[0,0,0] op_sel_hi:[1,0,1]
    v_pk_fma_f32 v[134:135], v[198:199], v[66:67], v[134:135] op_sel:[0,0,0] op_sel_hi:[1,0,1]
    v_cvt_pk_bf16_f32 v96, v128, v129
    v_cvt_pk_bf16_f32 v97, v130, v131
    v_cvt_pk_bf16_f32 v98, v132, v133
    v_cvt_pk_bf16_f32 v99, v134, v135
    buffer_store_dwordx4 v[96:99], v60, s[12:15], s78 offen offset:0 nt
    s_waitcnt lgkmcnt(2)
    v_pk_fma_f32 v[136:137], v[200:201], v[70:71], v[136:137] op_sel:[0,0,0] op_sel_hi:[1,0,1]
    v_pk_fma_f32 v[138:139], v[202:203], v[70:71], v[138:139] op_sel:[0,0,0] op_sel_hi:[1,0,1]
    v_pk_fma_f32 v[140:141], v[204:205], v[70:71], v[140:141] op_sel:[0,0,0] op_sel_hi:[1,0,1]
    v_pk_fma_f32 v[142:143], v[206:207], v[70:71], v[142:143] op_sel:[0,0,0] op_sel_hi:[1,0,1]
    v_cvt_pk_bf16_f32 v100, v136, v137
    v_cvt_pk_bf16_f32 v101, v138, v139
    v_cvt_pk_bf16_f32 v102, v140, v141
    v_cvt_pk_bf16_f32 v103, v142, v143
    buffer_store_dwordx4 v[100:103], v60, s[12:15], s78 offen offset:1024 nt
    s_waitcnt lgkmcnt(0)
    v_pk_fma_f32 v[144:145], v[208:209], v[74:75], v[144:145] op_sel:[0,0,0] op_sel_hi:[1,0,1]
    v_pk_fma_f32 v[146:147], v[210:211], v[74:75], v[146:147] op_sel:[0,0,0] op_sel_hi:[1,0,1]
    v_pk_fma_f32 v[148:149], v[212:213], v[74:75], v[148:149] op_sel:[0,0,0] op_sel_hi:[1,0,1]
    v_pk_fma_f32 v[150:151], v[214:215], v[74:75], v[150:151] op_sel:[0,0,0] op_sel_hi:[1,0,1]
    v_cvt_pk_bf16_f32 v104, v144, v145
    v_cvt_pk_bf16_f32 v105, v146, v147
    v_cvt_pk_bf16_f32 v106, v148, v149
    v_cvt_pk_bf16_f32 v107, v150, v151
    buffer_store_dwordx4 v[104:107], v60, s[12:15], s78 offen offset:2048 nt
L_rpc1_b2:
    ds_read_b32 v43, v59
    s_waitcnt lgkmcnt(0)
    v_readlane_b32 s42, v43, 2
    s_cmp_ge_u32 s42, 3
    s_cbranch_scc0 L_rpc1_b2
    s_waitcnt lgkmcnt(3)
    ds_read_b128 v[216:219], v52 offset:4096
    ds_read_b128 v[220:223], v52 offset:4608
    ds_read_b128 v[224:227], v53 offset:4096
    ds_read_b128 v[228:231], v53 offset:4608
    ds_read_b128 v[232:235], v54 offset:4096
    ds_read_b128 v[236:239], v54 offset:4608
    s_waitcnt lgkmcnt(4)
    v_pk_fma_f32 v[152:153], v[216:217], v[78:79], v[152:153] op_sel:[0,0,0] op_sel_hi:[1,0,1]
    v_pk_fma_f32 v[154:155], v[218:219], v[78:79], v[154:155] op_sel:[0,0,0] op_sel_hi:[1,0,1]
    v_pk_fma_f32 v[156:157], v[220:221], v[78:79], v[156:157] op_sel:[0,0,0] op_sel_hi:[1,0,1]
    v_pk_fma_f32 v[158:159], v[222:223], v[78:79], v[158:159] op_sel:[0,0,0] op_sel_hi:[1,0,1]
    v_cvt_pk_bf16_f32 v108, v152, v153
    v_cvt_pk_bf16_f32 v109, v154, v155
    v_cvt_pk_bf16_f32 v110, v156, v157
    v_cvt_pk_bf16_f32 v111, v158, v159
    buffer_store_dwordx4 v[108:111], v60, s[12:15], s79 offen offset:0 nt
    s_waitcnt lgkmcnt(2)
    v_pk_fma_f32 v[160:161], v[224:225], v[82:83], v[160:161] op_sel:[0,0,0] op_sel_hi:[1,0,1]
    v_pk_fma_f32 v[162:163], v[226:227], v[82:83], v[162:163] op_sel:[0,0,0] op_sel_hi:[1,0,1]
    v_pk_fma_f32 v[164:165], v[228:229], v[82:83], v[164:165] op_sel:[0,0,0] op_sel_hi:[1,0,1]
    v_pk_fma_f32 v[166:167], v[230:231], v[82:83], v[166:167] op_sel:[0,0,0] op_sel_hi:[1,0,1]
    v_cvt_pk_bf16_f32 v112, v160, v161
    v_cvt_pk_bf16_f32 v113, v162, v163
    v_cvt_pk_bf16_f32 v114, v164, v165
    v_cvt_pk_bf16_f32 v115, v166, v167
    buffer_store_dwordx4 v[112:115], v60, s[12:15], s79 offen offset:1024 nt
    s_waitcnt lgkmcnt(0)
    v_pk_fma_f32 v[168:169], v[232:233], v[86:87], v[168:169] op_sel:[0,0,0] op_sel_hi:[1,0,1]
    v_pk_fma_f32 v[170:171], v[234:235], v[86:87], v[170:171] op_sel:[0,0,0] op_sel_hi:[1,0,1]
    v_pk_fma_f32 v[172:173], v[236:237], v[86:87], v[172:173] op_sel:[0,0,0] op_sel_hi:[1,0,1]
    v_pk_fma_f32 v[174:175], v[238:239], v[86:87], v[174:175] op_sel:[0,0,0] op_sel_hi:[1,0,1]
    v_cvt_pk_bf16_f32 v116, v168, v169
    v_cvt_pk_bf16_f32 v117, v170, v171
    v_cvt_pk_bf16_f32 v118, v172, v173
    v_cvt_pk_bf16_f32 v119, v174, v175
    buffer_store_dwordx4 v[116:119], v60, s[12:15], s79 offen offset:2048 nt
    s_branch L_out
L_rpg_b2:
    ds_read_b32 v43, v59
    s_waitcnt lgkmcnt(0)
    v_readlane_b32 s40, v43, 0
    v_readlane_b32 s41, v43, 1
    v_readlane_b32 s42, v43, 2
    v_readlane_b32 s43, v43, 3
    s_cmp_ge_u32 s43, 1
    s_cbranch_scc1 L_rpg_b2r
    s_branch L_rpg_b2
L_rpa_b2:
    ds_read_b32 v43, v59
    s_waitcnt lgkmcnt(0)
    v_readlane_b32 s40, v43, 0
    v_readlane_b32 s41, v43, 1
    v_readlane_b32 s42, v43, 2
    v_readlane_b32 s43, v43, 3
    s_cmp_ge_u32 s40, 3
    s_cbranch_scc1 L_rpa_b2r
    s_branch L_rpa_b2
L_rpb_b2:
    ds_read_b32 v43, v59
    s_waitcnt lgkmcnt(0)
    v_readlane_b32 s40, v43, 0
    v_readlane_b32 s41, v43, 1
    v_readlane_b32 s42, v43, 2
    v_readlane_b32 s43, v43, 3
    s_cmp_ge_u32 s41, 3
    s_cbranch_scc1 L_rpb_b2r
    s_branch L_rpb_b2
L_rpc0_b2:
    ds_read_b32 v43, v59
    s_waitcnt lgkmcnt(0)
    v_readlane_b32 s40, v43, 0
    v_readlane_b32 s41, v43, 1
    v_readlane_b32 s42, v43, 2
    v_readlane_b32 s43, v43, 3
    s_cmp_ge_u32 s42, 2
    s_cbranch_scc1 L_rpc0_b2r
    s_branch L_rpc0_b2
L_reduce_a2:
    ds_read_b32 v43, v59
    s_waitcnt lgkmcnt(0)
    v_readlane_b32 s40, v43, 0
    v_readlane_b32 s41, v43, 1
    v_readlane_b32 s42, v43, 2
    v_readlane_b32 s43, v43, 3
    s_min_u32 s82, s40, s41
    s_min_u32 s82, s82, s42
    s_cmp_ge_u32 s82, 1
    s_cbranch_scc0 L_reduce_a2
    s_mov_b32 s48, s30
    s_mov_b32 s49, s31
    s_mov_b32 s50, 5242880
    s_mov_b32 s51, 0x20000
    s_lshl_b32 s80, s56, 16
    s_add_u32 s80, s80, 0x100000
    s_add_u32 s81, s80, 32768
    s_lshl_b32 s83, s76, 12
    s_add_u32 s80, s80, s83
    buffer_load_dwordx4 v[128:131], v60, s[48:51], s80 offen offset:0 sc1
    buffer_load_dwordx4 v[132:135], v60, s[48:51], s80 offen offset:1024 sc1
    buffer_load_dwordx4 v[136:139], v60, s[48:51], s80 offen offset:2048 sc1
    buffer_load_dwordx4 v[140:143], v60, s[48:51], s80 offen offset:3072 sc1
    s_add_u32 s80, s80, 4096
    buffer_load_dwordx4 v[144:147], v60, s[48:51], s80 offen offset:0 sc1
    buffer_load_dwordx4 v[148:151], v60, s[48:51], s80 offen offset:1024 sc1
    buffer_load_dwordx4 v[152:155], v60, s[48:51], s80 offen offset:2048 sc1
    buffer_load_dwordx4 v[156:159], v60, s[48:51], s80 offen offset:3072 sc1
    s_add_u32 s80, s80, 4096
    s_cmp_ge_u32 s43, 1
    s_cbranch_scc0 L_rpg_a2
L_rpg_a2r:
    ds_read_b128 v[64:67], v57 offset:0
    ds_read_b128 v[68:71], v57 offset:64
    ds_read_b128 v[72:75], v57 offset:512
    ds_read_b128 v[76:79], v57 offset:576
    s_waitcnt vmcnt(0) lgkmcnt(0)
    v_pk_mul_f32 v[128:129], v[128:129], v[66:67] op_sel:[0,1] op_sel_hi:[1,1]
    v_pk_mul_f32 v[130:131], v[130:131], v[66:67] op_sel:[0,1] op_sel_hi:[1,1]
    v_pk_mul_f32 v[132:133], v[132:133], v[66:67] op_sel:[0,1] op_sel_hi:[1,1]
    v_pk_mul_f32 v[134:135], v[134:135], v[66:67] op_sel:[0,1] op_sel_hi:[1,1]
    v_pk_mul_f32 v[136:137], v[136:137], v[70:71] op_sel:[0,1] op_sel_hi:[1,1]
    v_pk_mul_f32 v[138:139], v[138:139], v[70:71] op_sel:[0,1] op_sel_hi:[1,1]
    v_pk_mul_f32 v[140:141], v[140:141], v[70:71] op_sel:[0,1] op_sel_hi:[1,1]
    v_pk_mul_f32 v[142:143], v[142:143], v[70:71] op_sel:[0,1] op_sel_hi:[1,1]
    v_pk_mul_f32 v[144:145], v[144:145], v[74:75] op_sel:[0,1] op_sel_hi:[1,1]
    v_pk_mul_f32 v[146:147], v[146:147], v[74:75] op_sel:[0,1] op_sel_hi:[1,1]
    v_pk_mul_f32 v[148:149], v[148:149], v[74:75] op_sel:[0,1] op_sel_hi:[1,1]
    v_pk_mul_f32 v[150:151], v[150:151], v[74:75] op_sel:[0,1] op_sel_hi:[1,1]
    v_pk_mul_f32 v[152:153], v[152:153], v[78:79] op_sel:[0,1] op_sel_hi:[1,1]
    v_pk_mul_f32 v[154:155], v[154:155], v[78:79] op_sel:[0,1] op_sel_hi:[1,1]
    v_pk_mul_f32 v[156:157], v[156:157], v[78:79] op_sel:[0,1] op_sel_hi:[1,1]
    v_pk_mul_f32 v[158:159], v[158:159], v[78:79] op_sel:[0,1] op_sel_hi:[1,1]
    s_cmp_ge_u32 s40, 3
    s_cbranch_scc0 L_rpa_a2
L_rpa_a2r:
    s_waitcnt lgkmcnt(3)
    ds_read_b128 v[192:195], v52 offset:0
    ds_read_b128 v[196:199], v52 offset:512
    ds_read_b128 v[200:203], v53 offset:0
    ds_read_b128 v[204:207], v53 offset:512
    ds_read_b128 v[208:211], v52 offset:4096
    ds_read_b128 v[212:215], v52 offset:4608
    ds_read_b128 v[216:219], v53 offset:4096
    ds_read_b128 v[220:223], v53 offset:4608
    s_waitcnt lgkmcnt(6)
    v_pk_fma_f32 v[128:129], v[192:193], v[64:65], v[128:129] op_sel:[0,0,0] op_sel_hi:[1,0,1]
    v_pk_fma_f32 v[130:131], v[194:195], v[64:65], v[130:131] op_sel:[0,0,0] op_sel_hi:[1,0,1]
    v_pk_fma_f32 v[132:133], v[196:197], v[64:65], v[132:133] op_sel:[0,0,0] op_sel_hi:[1,0,1]
    v_pk_fma_f32 v[134:135], v[198:199], v[64:65], v[134:135] op_sel:[0,0,0] op_sel_hi:[1,0,1]
    s_waitcnt lgkmcnt(4)
    v_pk_fma_f32 v[136:137], v[200:201], v[68:69], v[136:137] op_sel:[0,0,0] op_sel_hi:[1,0,1]
    v_pk_fma_f32 v[138:139], v[202:203], v[68:69], v[138:139] op_sel:[0,0,0] op_sel_hi:[1,0,1]
    v_pk_fma_f32 v[140:141], v[204:205], v[68:69], v[140:141] op_sel:[0,0,0] op_sel_hi:[1,0,1]
    v_pk_fma_f32 v[142:143], v[206:207], v[68:69], v[142:143] op_sel:[0,0,0] op_sel_hi:[1,0,1]
    s_waitcnt lgkmcnt(2)
    v_pk_fma_f32 v[144:145], v[208:209], v[72:73], v[144:145] op_sel:[0,0,0] op_sel_hi:[1,0,1]
    v_pk_fma_f32 v[146:147], v[210:211], v[72:73], v[146:147] op_sel:[0,0,0] op_sel_hi:[1,0,1]
    v_pk_fma_f32 v[148:149], v[212:213], v[72:73], v[148:149] op_sel:[0,0,0] op_sel_hi:[1,0,1]
    v_pk_fma_f32 v[150:151], v[214:215], v[72:73], v[150:151] op_sel:[0,0,0] op_sel_hi:[1,0,1]
    s_waitcnt lgkmcnt(0)
    v_pk_fma_f32 v[152:153], v[216:217], v[76:77], v[152:153] op_sel:[0,0,0] op_sel_hi:[1,0,1]
    v_pk_fma_f32 v[154:155], v[218:219], v[76:77], v[154:155] op_sel:[0,0,0] op_sel_hi:[1,0,1]
    v_pk_fma_f32 v[156:157], v[220:221], v[76:77], v[156:157] op_sel:[0,0,0] op_sel_hi:[1,0,1]
    v_pk_fma_f32 v[158:159], v[222:223], v[76:77], v[158:159] op_sel:[0,0,0] op_sel_hi:[1,0,1]
    v_add_u32 v52, 0x8000, v52
    v_add_u32 v53, 0x8000, v53
    s_cmp_ge_u32 s41, 3
    s_cbranch_scc0 L_rpb_a2
L_rpb_a2r:
    s_waitcnt lgkmcnt(3)
    ds_read_b128 v[192:195], v52 offset:0
    ds_read_b128 v[196:199], v52 offset:512
    ds_read_b128 v[200:203], v53 offset:0
    ds_read_b128 v[204:207], v53 offset:512
    ds_read_b128 v[208:211], v52 offset:4096
    ds_read_b128 v[212:215], v52 offset:4608
    ds_read_b128 v[216:219], v53 offset:4096
    ds_read_b128 v[220:223], v53 offset:4608
    s_waitcnt lgkmcnt(6)
    v_pk_fma_f32 v[128:129], v[192:193], v[64:65], v[128:129] op_sel:[0,1,0] op_sel_hi:[1,1,1]
    v_pk_fma_f32 v[130:131], v[194:195], v[64:65], v[130:131] op_sel:[0,1,0] op_sel_hi:[1,1,1]
    v_pk_fma_f32 v[132:133], v[196:197], v[64:65], v[132:133] op_sel:[0,1,0] op_sel_hi:[1,1,1]
    v_pk_fma_f32 v[134:135], v[198:199], v[64:65], v[134:135] op_sel:[0,1,0] op_sel_hi:[1,1,1]
    s_waitcnt lgkmcnt(4)
    v_pk_fma_f32 v[136:137], v[200:201], v[68:69], v[136:137] op_sel:[0,1,0] op_sel_hi:[1,1,1]
    v_pk_fma_f32 v[138:139], v[202:203], v[68:69], v[138:139] op_sel:[0,1,0] op_sel_hi:[1,1,1]
    v_pk_fma_f32 v[140:141], v[204:205], v[68:69], v[140:141] op_sel:[0,1,0] op_sel_hi:[1,1,1]
    v_pk_fma_f32 v[142:143], v[206:207], v[68:69], v[142:143] op_sel:[0,1,0] op_sel_hi:[1,1,1]
    s_waitcnt lgkmcnt(2)
    v_pk_fma_f32 v[144:145], v[208:209], v[72:73], v[144:145] op_sel:[0,1,0] op_sel_hi:[1,1,1]
    v_pk_fma_f32 v[146:147], v[210:211], v[72:73], v[146:147] op_sel:[0,1,0] op_sel_hi:[1,1,1]
    v_pk_fma_f32 v[148:149], v[212:213], v[72:73], v[148:149] op_sel:[0,1,0] op_sel_hi:[1,1,1]
    v_pk_fma_f32 v[150:151], v[214:215], v[72:73], v[150:151] op_sel:[0,1,0] op_sel_hi:[1,1,1]
    s_waitcnt lgkmcnt(0)
    v_pk_fma_f32 v[152:153], v[216:217], v[76:77], v[152:153] op_sel:[0,1,0] op_sel_hi:[1,1,1]
    v_pk_fma_f32 v[154:155], v[218:219], v[76:77], v[154:155] op_sel:[0,1,0] op_sel_hi:[1,1,1]
    v_pk_fma_f32 v[156:157], v[220:221], v[76:77], v[156:157] op_sel:[0,1,0] op_sel_hi:[1,1,1]
    v_pk_fma_f32 v[158:159], v[222:223], v[76:77], v[158:159] op_sel:[0,1,0] op_sel_hi:[1,1,1]
    v_add_u32 v52, 0x8000, v52
    v_add_u32 v53, 0x8000, v53
    s_cmp_ge_u32 s42, 2
    s_cbranch_scc0 L_rpc0_a2
L_rpc0_a2r:
    s_waitcnt lgkmcnt(3)
    ds_read_b128 v[192:195], v52 offset:0
    ds_read_b128 v[196:199], v52 offset:512
    ds_read_b128 v[200:203], v53 offset:0
    ds_read_b128 v[204:207], v53 offset:512
    s_waitcnt lgkmcnt(2)
    v_pk_fma_f32 v[128:129], v[192:193], v[66:67], v[128:129] op_sel:[0,0,0] op_sel_hi:[1,0,1]
    v_pk_fma_f32 v[130:131], v[194:195], v[66:67], v[130:131] op_sel:[0,0,0] op_sel_hi:[1,0,1]
    v_pk_fma_f32 v[132:133], v[196:197], v[66:67], v[132:133] op_sel:[0,0,0] op_sel_hi:[1,0,1]
    v_pk_fma_f32 v[134:135], v[198:199], v[66:67], v[134:135] op_sel:[0,0,0] op_sel_hi:[1,0,1]
    v_cvt_pk_bf16_f32 v96, v128, v129
    v_cvt_pk_bf16_f32 v97, v130, v131
    v_cvt_pk_bf16_f32 v98, v132, v133
    v_cvt_pk_bf16_f32 v99, v134, v135
    buffer_store_dwordx4 v[96:99], v60, s[12:15], s78 offen offset:0 nt
    s_waitcnt lgkmcnt(0)
    v_pk_fma_f32 v[136:137], v[200:201], v[70:71], v[136:137] op_sel:[0,0,0] op_sel_hi:[1,0,1]
    v_pk_fma_f32 v[138:139], v[202:203], v[70:71], v[138:139] op_sel:[0,0,0] op_sel_hi:[1,0,1]
    v_pk_fma_f32 v[140:141], v[204:205], v[70:71], v[140:141] op_sel:[0,0,0] op_sel_hi:[1,0,1]
    v_pk_fma_f32 v[142:143], v[206:207], v[70:71], v[142:143] op_sel:[0,0,0] op_sel_hi:[1,0,1]
    v_cvt_pk_bf16_f32 v100, v136, v137
    v_cvt_pk_bf16_f32 v101, v138, v139
    v_cvt_pk_bf16_f32 v102, v140, v141
    v_cvt_pk_bf16_f32 v103, v142, v143
    buffer_store_dwordx4 v[100:103], v60, s[12:15], s78 offen offset:1024 nt
L_rpc1_a2:
    ds_read_b32 v43, v59
    s_waitcnt lgkmcnt(0)
    v_readlane_b32 s42, v43, 2
    s_cmp_ge_u32 s42, 3
    s_cbranch_scc0 L_rpc1_a2
    s_waitcnt lgkmcnt(3)
    ds_read_b128 v[208:211], v52 offset:4096
    ds_read_b128 v[212:215], v52 offset:4608
    ds_read_b128 v[216:219], v53 offset:4096
    ds_read_b128 v[220:223], v53 offset:4608
    s_waitcnt lgkmcnt(2)
    v_pk_fma_f32 v[144:145], v[208:209], v[74:75], v[144:145] op_sel:[0,0,0] op_sel_hi:[1,0,1]
    v_pk_fma_f32 v[146:147], v[210:211], v[74:75], v[146:147] op_sel:[0,0,0] op_sel_hi:[1,0,1]
    v_pk_fma_f32 v[148:149], v[212:213], v[74:75], v[148:149] op_sel:[0,0,0] op_sel_hi:[1,0,1]
    v_pk_fma_f32 v[150:151], v[214:215], v[74:75], v[150:151] op_sel:[0,0,0] op_sel_hi:[1,0,1]
    v_cvt_pk_bf16_f32 v104, v144, v145
    v_cvt_pk_bf16_f32 v105, v146, v147
    v_cvt_pk_bf16_f32 v106, v148, v149
    v_cvt_pk_bf16_f32 v107, v150, v151
    buffer_store_dwordx4 v[104:107], v60, s[12:15], s79 offen offset:0 nt
    s_waitcnt lgkmcnt(0)
    v_pk_fma_f32 v[152:153], v[216:217], v[78:79], v[152:153] op_sel:[0,0,0] op_sel_hi:[1,0,1]
    v_pk_fma_f32 v[154:155], v[218:219], v[78:79], v[154:155] op_sel:[0,0,0] op_sel_hi:[1,0,1]
    v_pk_fma_f32 v[156:157], v[220:221], v[78:79], v[156:157] op_sel:[0,0,0] op_sel_hi:[1,0,1]
    v_pk_fma_f32 v[158:159], v[222:223], v[78:79], v[158:159] op_sel:[0,0,0] op_sel_hi:[1,0,1]
    v_cvt_pk_bf16_f32 v108, v152, v153
    v_cvt_pk_bf16_f32 v109, v154, v155
    v_cvt_pk_bf16_f32 v110, v156, v157
    v_cvt_pk_bf16_f32 v111, v158, v159
    buffer_store_dwordx4 v[108:111], v60, s[12:15], s79 offen offset:1024 nt
    s_branch L_out
L_rpg_a2:
    ds_read_b32 v43, v59
    s_waitcnt lgkmcnt(0)
    v_readlane_b32 s40, v43, 0
    v_readlane_b32 s41, v43, 1
    v_readlane_b32 s42, v43, 2
    v_readlane_b32 s43, v43, 3
    s_cmp_ge_u32 s43, 1
    s_cbranch_scc1 L_rpg_a2r
    s_branch L_rpg_a2
L_rpa_a2:
    ds_read_b32 v43, v59
    s_waitcnt lgkmcnt(0)
    v_readlane_b32 s40, v43, 0
    v_readlane_b32 s41, v43, 1
    v_readlane_b32 s42, v43, 2
    v_readlane_b32 s43, v43, 3
    s_cmp_ge_u32 s40, 3
    s_cbranch_scc1 L_rpa_a2r
    s_branch L_rpa_a2
L_rpb_a2:
    ds_read_b32 v43, v59
    s_waitcnt lgkmcnt(0)
    v_readlane_b32 s40, v43, 0
    v_readlane_b32 s41, v43, 1
    v_readlane_b32 s42, v43, 2
    v_readlane_b32 s43, v43, 3
    s_cmp_ge_u32 s41, 3
    s_cbranch_scc1 L_rpb_a2r
    s_branch L_rpb_a2
L_rpc0_a2:
    ds_read_b32 v43, v59
    s_waitcnt lgkmcnt(0)
    v_readlane_b32 s40, v43, 0
    v_readlane_b32 s41, v43, 1
    v_readlane_b32 s42, v43, 2
    v_readlane_b32 s43, v43, 3
    s_cmp_ge_u32 s42, 2
    s_cbranch_scc1 L_rpc0_a2r
    s_branch L_rpc0_a2
L_reduce_d2:
    ds_read_b32 v43, v59
    s_waitcnt lgkmcnt(0)
    v_readlane_b32 s40, v43, 0
    v_readlane_b32 s41, v43, 1
    v_readlane_b32 s42, v43, 2
    v_readlane_b32 s43, v43, 3
    s_min_u32 s82, s40, s41
    s_min_u32 s82, s82, s42
    s_cmp_ge_u32 s82, 1
    s_cbranch_scc0 L_reduce_d2
    ds_read_b64 v[32:33], v58 offset:0
    ds_read_b64 v[34:35], v58 offset:512
    ds_read_b64 v[36:37], v58 offset:1024
    s_mov_b32 s48, s30
    s_mov_b32 s49, s31
    s_mov_b32 s50, 5242880
    s_mov_b32 s51, 0x20000
    s_lshl_b32 s80, s56, 16
    s_add_u32 s80, s80, 0x100000
    s_add_u32 s81, s80, 32768
    s_lshl_b32 s83, s76, 12
    s_add_u32 s80, s80, s83
    v_lshlrev_b32 v42, 3, v1
    buffer_load_dwordx2 v[38:39], v42, s[48:51], s81 offen sc1
    buffer_load_dwordx4 v[128:131], v60, s[48:51], s80 offen offset:0 sc1
    buffer_load_dwordx4 v[132:135], v60, s[48:51], s80 offen offset:1024 sc1
    buffer_load_dwordx4 v[136:139], v60, s[48:51], s80 offen offset:2048 sc1
    buffer_load_dwordx4 v[140:143], v60, s[48:51], s80 offen offset:3072 sc1
    s_add_u32 s80, s80, 4096
    buffer_load_dwordx4 v[144:147], v60, s[48:51], s80 offen offset:0 sc1
    buffer_load_dwordx4 v[148:151], v60, s[48:51], s80 offen offset:1024 sc1
    buffer_load_dwordx4 v[152:155], v60, s[48:51], s80 offen offset:2048 sc1
    buffer_load_dwordx4 v[156:159], v60, s[48:51], s80 offen offset:3072 sc1
    s_add_u32 s80, s80, 4096
    buffer_load_dwordx4 v[160:163], v60, s[48:51], s80 offen offset:0 sc1
    buffer_load_dwordx4 v[164:167], v60, s[48:51], s80 offen offset:1024 sc1
    buffer_load_dwordx4 v[168:171], v60, s[48:51], s80 offen offset:2048 sc1
    buffer_load_dwordx4 v[172:175], v60, s[48:51], s80 offen offset:3072 sc1
    s_add_u32 s80, s80, 4096
    v_add_u32 v43, 118784, v60
    v_mov_b32 v44, 1
    s_waitcnt lgkmcnt(0)
    v_max3_f32 v40, v32, v34, v36
    s_waitcnt vmcnt(12)
    v_max_f32 v40, v40, v38
    v_sub_f32 v32, v32, v40
    v_sub_f32 v34, v34, v40
    v_sub_f32 v36, v36, v40
    v_sub_f32 v38, v38, v40
    v_exp_f32 v32, v32
    v_exp_f32 v34, v34
    v_exp_f32 v36, v36
    v_exp_f32 v38, v38
    s_nop 0
    v_mul_f32 v38, v38, v39
    v_fma_f32 v41, v32, v33, v38
    v_fma_f32 v41, v34, v35, v41
    v_fma_f32 v41, v36, v37, v41
    v_rcp_f32 v33, v41
    s_nop 0
    v_mul_f32 v48, v32, v33
    v_mul_f32 v49, v34, v33
    v_mul_f32 v50, v36, v33
    v_mul_f32 v51, v38, v33
    ds_write_b128 v43, v[48:51]
    ds_write_b32 v22, v44 offset:1792
    ds_read_b128 v[64:67], v57 offset:0
    ds_read_b128 v[68:71], v57 offset:64
    ds_read_b128 v[72:75], v57 offset:128
    ds_read_b128 v[76:79], v57 offset:512
    ds_read_b128 v[80:83], v57 offset:576
    ds_read_b128 v[84:87], v57 offset:640
    s_waitcnt vmcnt(0) lgkmcnt(0)
    v_pk_mul_f32 v[128:129], v[128:129], v[66:67] op_sel:[0,1] op_sel_hi:[1,1]
    v_pk_mul_f32 v[130:131], v[130:131], v[66:67] op_sel:[0,1] op_sel_hi:[1,1]
    v_pk_mul_f32 v[132:133], v[132:133], v[66:67] op_sel:[0,1] op_sel_hi:[1,1]
    v_pk_mul_f32 v[134:135], v[134:135], v[66:67] op_sel:[0,1] op_sel_hi:[1,1]
    v_pk_mul_f32 v[136:137], v[136:137], v[70:71] op_sel:[0,1] op_sel_hi:[1,1]
    v_pk_mul_f32 v[138:139], v[138:139], v[70:71] op_sel:[0,1] op_sel_hi:[1,1]
    v_pk_mul_f32 v[140:141], v[140:141], v[70:71] op_sel:[0,1] op_sel_hi:[1,1]
    v_pk_mul_f32 v[142:143], v[142:143], v[70:71] op_sel:[0,1] op_sel_hi:[1,1]
    v_pk_mul_f32 v[144:145], v[144:145], v[74:75] op_sel:[0,1] op_sel_hi:[1,1]
    v_pk_mul_f32 v[146:147], v[146:147], v[74:75] op_sel:[0,1] op_sel_hi:[1,1]
    v_pk_mul_f32 v[148:149], v[148:149], v[74:75] op_sel:[0,1] op_sel_hi:[1,1]
    v_pk_mul_f32 v[150:151], v[150:151], v[74:75] op_sel:[0,1] op_sel_hi:[1,1]
    v_pk_mul_f32 v[152:153], v[152:153], v[78:79] op_sel:[0,1] op_sel_hi:[1,1]
    v_pk_mul_f32 v[154:155], v[154:155], v[78:79] op_sel:[0,1] op_sel_hi:[1,1]
    v_pk_mul_f32 v[156:157], v[156:157], v[78:79] op_sel:[0,1] op_sel_hi:[1,1]
    v_pk_mul_f32 v[158:159], v[158:159], v[78:79] op_sel:[0,1] op_sel_hi:[1,1]
    v_pk_mul_f32 v[160:161], v[160:161], v[82:83] op_sel:[0,1] op_sel_hi:[1,1]
    v_pk_mul_f32 v[162:163], v[162:163], v[82:83] op_sel:[0,1] op_sel_hi:[1,1]
    v_pk_mul_f32 v[164:165], v[164:165], v[82:83] op_sel:[0,1] op_sel_hi:[1,1]
    v_pk_mul_f32 v[166:167], v[166:167], v[82:83] op_sel:[0,1] op_sel_hi:[1,1]
    v_pk_mul_f32 v[168:169], v[168:169], v[86:87] op_sel:[0,1] op_sel_hi:[1,1]
    v_pk_mul_f32 v[170:171], v[170:171], v[86:87] op_sel:[0,1] op_sel_hi:[1,1]
    v_pk_mul_f32 v[172:173], v[172:173], v[86:87] op_sel:[0,1] op_sel_hi:[1,1]
    v_pk_mul_f32 v[174:175], v[174:175], v[86:87] op_sel:[0,1] op_sel_hi:[1,1]
    s_cmp_ge_u32 s40, 3
    s_cbranch_scc0 L_rpa_d2
L_rpa_d2r:
    s_waitcnt lgkmcnt(3)
    ds_read_b128 v[192:195], v52 offset:0
    ds_read_b128 v[196:199], v52 offset:512
    ds_read_b128 v[200:203], v53 offset:0
    ds_read_b128 v[204:207], v53 offset:512
    ds_read_b128 v[208:211], v54 offset:0
    ds_read_b128 v[212:215], v54 offset:512
    ds_read_b128 v[216:219], v52 offset:4096
    ds_read_b128 v[220:223], v52 offset:4608
    ds_read_b128 v[224:227], v53 offset:4096
    ds_read_b128 v[228:231], v53 offset:4608
    ds_read_b128 v[232:235], v54 offset:4096
    ds_read_b128 v[236:239], v54 offset:4608
    s_waitcnt lgkmcnt(10)
    v_pk_fma_f32 v[128:129], v[192:193], v[64:65], v[128:129] op_sel:[0,0,0] op_sel_hi:[1,0,1]
    v_pk_fma_f32 v[130:131], v[194:195], v[64:65], v[130:131] op_sel:[0,0,0] op_sel_hi:[1,0,1]
    v_pk_fma_f32 v[132:133], v[196:197], v[64:65], v[132:133] op_sel:[0,0,0] op_sel_hi:[1,0,1]
    v_pk_fma_f32 v[134:135], v[198:199], v[64:65], v[134:135] op_sel:[0,0,0] op_sel_hi:[1,0,1]
    s_waitcnt lgkmcnt(8)
    v_pk_fma_f32 v[136:137], v[200:201], v[68:69], v[136:137] op_sel:[0,0,0] op_sel_hi:[1,0,1]
    v_pk_fma_f32 v[138:139], v[202:203], v[68:69], v[138:139] op_sel:[0,0,0] op_sel_hi:[1,0,1]
    v_pk_fma_f32 v[140:141], v[204:205], v[68:69], v[140:141] op_sel:[0,0,0] op_sel_hi:[1,0,1]
    v_pk_fma_f32 v[142:143], v[206:207], v[68:69], v[142:143] op_sel:[0,0,0] op_sel_hi:[1,0,1]
    s_waitcnt lgkmcnt(6)
    v_pk_fma_f32 v[144:145], v[208:209], v[72:73], v[144:145] op_sel:[0,0,0] op_sel_hi:[1,0,1]
    v_pk_fma_f32 v[146:147], v[210:211], v[72:73], v[146:147] op_sel:[0,0,0] op_sel_hi:[1,0,1]
    v_pk_fma_f32 v[148:149], v[212:213], v[72:73], v[148:149] op_sel:[0,0,0] op_sel_hi:[1,0,1]
    v_pk_fma_f32 v[150:151], v[214:215], v[72:73], v[150:151] op_sel:[0,0,0] op_sel_hi:[1,0,1]
    s_waitcnt lgkmcnt(4)
    v_pk_fma_f32 v[152:153], v[216:217], v[76:77], v[152:153] op_sel:[0,0,0] op_sel_hi:[1,0,1]
    v_pk_fma_f32 v[154:155], v[218:219], v[76:77], v[154:155] op_sel:[0,0,0] op_sel_hi:[1,0,1]
    v_pk_fma_f32 v[156:157], v[220:221], v[76:77], v[156:157] op_sel:[0,0,0] op_sel_hi:[1,0,1]
    v_pk_fma_f32 v[158:159], v[222:223], v[76:77], v[158:159] op_sel:[0,0,0] op_sel_hi:[1,0,1]
    s_waitcnt lgkmcnt(2)
    v_pk_fma_f32 v[160:161], v[224:225], v[80:81], v[160:161] op_sel:[0,0,0] op_sel_hi:[1,0,1]
    v_pk_fma_f32 v[162:163], v[226:227], v[80:81], v[162:163] op_sel:[0,0,0] op_sel_hi:[1,0,1]
    v_pk_fma_f32 v[164:165], v[228:229], v[80:81], v[164:165] op_sel:[0,0,0] op_sel_hi:[1,0,1]
    v_pk_fma_f32 v[166:167], v[230:231], v[80:81], v[166:167] op_sel:[0,0,0] op_sel_hi:[1,0,1]
    s_waitcnt lgkmcnt(0)
    v_pk_fma_f32 v[168:169], v[232:233], v[84:85], v[168:169] op_sel:[0,0,0] op_sel_hi:[1,0,1]
    v_pk_fma_f32 v[170:171], v[234:235], v[84:85], v[170:171] op_sel:[0,0,0] op_sel_hi:[1,0,1]
    v_pk_fma_f32 v[172:173], v[236:237], v[84:85], v[172:173] op_sel:[0,0,0] op_sel_hi:[1,0,1]
    v_pk_fma_f32 v[174:175], v[238:239], v[84:85], v[174:175] op_sel:[0,0,0] op_sel_hi:[1,0,1]
    v_add_u32 v52, 0x8000, v52
    v_add_u32 v53, 0x8000, v53
    v_add_u32 v54, 0x8000, v54
    s_cmp_ge_u32 s41, 3
    s_cbranch_scc0 L_rpb_d2
L_rpb_d2r:
    s_waitcnt lgkmcnt(3)
    ds_read_b128 v[192:195], v52 offset:0
    ds_read_b128 v[196:199], v52 offset:512
    ds_read_b128 v[200:203], v53 offset:0
    ds_read_b128 v[204:207], v53 offset:512
    ds_read_b128 v[208:211], v54 offset:0
    ds_read_b128 v[212:215], v54 offset:512
    ds_read_b128 v[216:219], v52 offset:4096
    ds_read_b128 v[220:223], v52 offset:4608
    ds_read_b128 v[224:227], v53 offset:4096
    ds_read_b128 v[228:231], v53 offset:4608
    ds_read_b128 v[232:235], v54 offset:4096
    ds_read_b128 v[236:239], v54 offset:4608
    s_waitcnt lgkmcnt(10)
    v_pk_fma_f32 v[128:129], v[192:193], v[64:65], v[128:129] op_sel:[0,1,0] op_sel_hi:[1,1,1]
    v_pk_fma_f32 v[130:131], v[194:195], v[64:65], v[130:131] op_sel:[0,1,0] op_sel_hi:[1,1,1]
    v_pk_fma_f32 v[132:133], v[196:197], v[64:65], v[132:133] op_sel:[0,1,0] op_sel_hi:[1,1,1]
    v_pk_fma_f32 v[134:135], v[198:199], v[64:65], v[134:135] op_sel:[0,1,0] op_sel_hi:[1,1,1]
    s_waitcnt lgkmcnt(8)
    v_pk_fma_f32 v[136:137], v[200:201], v[68:69], v[136:137] op_sel:[0,1,0] op_sel_hi:[1,1,1]
    v_pk_fma_f32 v[138:139], v[202:203], v[68:69], v[138:139] op_sel:[0,1,0] op_sel_hi:[1,1,1]
    v_pk_fma_f32 v[140:141], v[204:205], v[68:69], v[140:141] op_sel:[0,1,0] op_sel_hi:[1,1,1]
    v_pk_fma_f32 v[142:143], v[206:207], v[68:69], v[142:143] op_sel:[0,1,0] op_sel_hi:[1,1,1]
    s_waitcnt lgkmcnt(6)
    v_pk_fma_f32 v[144:145], v[208:209], v[72:73], v[144:145] op_sel:[0,1,0] op_sel_hi:[1,1,1]
    v_pk_fma_f32 v[146:147], v[210:211], v[72:73], v[146:147] op_sel:[0,1,0] op_sel_hi:[1,1,1]
    v_pk_fma_f32 v[148:149], v[212:213], v[72:73], v[148:149] op_sel:[0,1,0] op_sel_hi:[1,1,1]
    v_pk_fma_f32 v[150:151], v[214:215], v[72:73], v[150:151] op_sel:[0,1,0] op_sel_hi:[1,1,1]
    s_waitcnt lgkmcnt(4)
    v_pk_fma_f32 v[152:153], v[216:217], v[76:77], v[152:153] op_sel:[0,1,0] op_sel_hi:[1,1,1]
    v_pk_fma_f32 v[154:155], v[218:219], v[76:77], v[154:155] op_sel:[0,1,0] op_sel_hi:[1,1,1]
    v_pk_fma_f32 v[156:157], v[220:221], v[76:77], v[156:157] op_sel:[0,1,0] op_sel_hi:[1,1,1]
    v_pk_fma_f32 v[158:159], v[222:223], v[76:77], v[158:159] op_sel:[0,1,0] op_sel_hi:[1,1,1]
    s_waitcnt lgkmcnt(2)
    v_pk_fma_f32 v[160:161], v[224:225], v[80:81], v[160:161] op_sel:[0,1,0] op_sel_hi:[1,1,1]
    v_pk_fma_f32 v[162:163], v[226:227], v[80:81], v[162:163] op_sel:[0,1,0] op_sel_hi:[1,1,1]
    v_pk_fma_f32 v[164:165], v[228:229], v[80:81], v[164:165] op_sel:[0,1,0] op_sel_hi:[1,1,1]
    v_pk_fma_f32 v[166:167], v[230:231], v[80:81], v[166:167] op_sel:[0,1,0] op_sel_hi:[1,1,1]
    s_waitcnt lgkmcnt(0)
    v_pk_fma_f32 v[168:169], v[232:233], v[84:85], v[168:169] op_sel:[0,1,0] op_sel_hi:[1,1,1]
    v_pk_fma_f32 v[170:171], v[234:235], v[84:85], v[170:171] op_sel:[0,1,0] op_sel_hi:[1,1,1]
    v_pk_fma_f32 v[172:173], v[236:237], v[84:85], v[172:173] op_sel:[0,1,0] op_sel_hi:[1,1,1]
    v_pk_fma_f32 v[174:175], v[238:239], v[84:85], v[174:175] op_sel:[0,1,0] op_sel_hi:[1,1,1]
    v_add_u32 v52, 0x8000, v52
    v_add_u32 v53, 0x8000, v53
    v_add_u32 v54, 0x8000, v54
    s_cmp_ge_u32 s42, 2
    s_cbranch_scc0 L_rpc0_d2
L_rpc0_d2r:
    s_waitcnt lgkmcnt(3)
    ds_read_b128 v[192:195], v52 offset:0
    ds_read_b128 v[196:199], v52 offset:512
    ds_read_b128 v[200:203], v53 offset:0
    ds_read_b128 v[204:207], v53 offset:512
    ds_read_b128 v[208:211], v54 offset:0
    ds_read_b128 v[212:215], v54 offset:512
    s_waitcnt lgkmcnt(4)
    v_pk_fma_f32 v[128:129], v[192:193], v[66:67], v[128:129] op_sel:[0,0,0] op_sel_hi:[1,0,1]
    v_pk_fma_f32 v[130:131], v[194:195], v[66:67], v[130:131] op_sel:[0,0,0] op_sel_hi:[1,0,1]
    v_pk_fma_f32 v[132:133], v[196:197], v[66:67], v[132:133] op_sel:[0,0,0] op_sel_hi:[1,0,1]
    v_pk_fma_f32 v[134:135], v[198:199], v[66:67], v[134:135] op_sel:[0,0,0] op_sel_hi:[1,0,1]
    v_cvt_pk_bf16_f32 v96, v128, v129
    v_cvt_pk_bf16_f32 v97, v130, v131
    v_cvt_pk_bf16_f32 v98, v132, v133
    v_cvt_pk_bf16_f32 v99, v134, v135
    buffer_store_dwordx4 v[96:99], v60, s[12:15], s78 offen offset:0 nt
    s_waitcnt lgkmcnt(2)
    v_pk_fma_f32 v[136:137], v[200:201], v[70:71], v[136:137] op_sel:[0,0,0] op_sel_hi:[1,0,1]
    v_pk_fma_f32 v[138:139], v[202:203], v[70:71], v[138:139] op_sel:[0,0,0] op_sel_hi:[1,0,1]
    v_pk_fma_f32 v[140:141], v[204:205], v[70:71], v[140:141] op_sel:[0,0,0] op_sel_hi:[1,0,1]
    v_pk_fma_f32 v[142:143], v[206:207], v[70:71], v[142:143] op_sel:[0,0,0] op_sel_hi:[1,0,1]
    v_cvt_pk_bf16_f32 v100, v136, v137
    v_cvt_pk_bf16_f32 v101, v138, v139
    v_cvt_pk_bf16_f32 v102, v140, v141
    v_cvt_pk_bf16_f32 v103, v142, v143
    buffer_store_dwordx4 v[100:103], v60, s[12:15], s78 offen offset:1024 nt
    s_waitcnt lgkmcnt(0)
    v_pk_fma_f32 v[144:145], v[208:209], v[74:75], v[144:145] op_sel:[0,0,0] op_sel_hi:[1,0,1]
    v_pk_fma_f32 v[146:147], v[210:211], v[74:75], v[146:147] op_sel:[0,0,0] op_sel_hi:[1,0,1]
    v_pk_fma_f32 v[148:149], v[212:213], v[74:75], v[148:149] op_sel:[0,0,0] op_sel_hi:[1,0,1]
    v_pk_fma_f32 v[150:151], v[214:215], v[74:75], v[150:151] op_sel:[0,0,0] op_sel_hi:[1,0,1]
    v_cvt_pk_bf16_f32 v104, v144, v145
    v_cvt_pk_bf16_f32 v105, v146, v147
    v_cvt_pk_bf16_f32 v106, v148, v149
    v_cvt_pk_bf16_f32 v107, v150, v151
    buffer_store_dwordx4 v[104:107], v60, s[12:15], s78 offen offset:2048 nt
L_rpc1_d2:
    ds_read_b32 v43, v59
    s_waitcnt lgkmcnt(0)
    v_readlane_b32 s42, v43, 2
    s_cmp_ge_u32 s42, 3
    s_cbranch_scc0 L_rpc1_d2
    s_waitcnt lgkmcnt(3)
    ds_read_b128 v[216:219], v52 offset:4096
    ds_read_b128 v[220:223], v52 offset:4608
    ds_read_b128 v[224:227], v53 offset:4096
    ds_read_b128 v[228:231], v53 offset:4608
    ds_read_b128 v[232:235], v54 offset:4096
    ds_read_b128 v[236:239], v54 offset:4608
    s_waitcnt lgkmcnt(4)
    v_pk_fma_f32 v[152:153], v[216:217], v[78:79], v[152:153] op_sel:[0,0,0] op_sel_hi:[1,0,1]
    v_pk_fma_f32 v[154:155], v[218:219], v[78:79], v[154:155] op_sel:[0,0,0] op_sel_hi:[1,0,1]
    v_pk_fma_f32 v[156:157], v[220:221], v[78:79], v[156:157] op_sel:[0,0,0] op_sel_hi:[1,0,1]
    v_pk_fma_f32 v[158:159], v[222:223], v[78:79], v[158:159] op_sel:[0,0,0] op_sel_hi:[1,0,1]
    v_cvt_pk_bf16_f32 v108, v152, v153
    v_cvt_pk_bf16_f32 v109, v154, v155
    v_cvt_pk_bf16_f32 v110, v156, v157
    v_cvt_pk_bf16_f32 v111, v158, v159
    buffer_store_dwordx4 v[108:111], v60, s[12:15], s79 offen offset:0 nt
    s_waitcnt lgkmcnt(2)
    v_pk_fma_f32 v[160:161], v[224:225], v[82:83], v[160:161] op_sel:[0,0,0] op_sel_hi:[1,0,1]
    v_pk_fma_f32 v[162:163], v[226:227], v[82:83], v[162:163] op_sel:[0,0,0] op_sel_hi:[1,0,1]
    v_pk_fma_f32 v[164:165], v[228:229], v[82:83], v[164:165] op_sel:[0,0,0] op_sel_hi:[1,0,1]
    v_pk_fma_f32 v[166:167], v[230:231], v[82:83], v[166:167] op_sel:[0,0,0] op_sel_hi:[1,0,1]
    v_cvt_pk_bf16_f32 v112, v160, v161
    v_cvt_pk_bf16_f32 v113, v162, v163
    v_cvt_pk_bf16_f32 v114, v164, v165
    v_cvt_pk_bf16_f32 v115, v166, v167
    buffer_store_dwordx4 v[112:115], v60, s[12:15], s79 offen offset:1024 nt
    s_waitcnt lgkmcnt(0)
    v_pk_fma_f32 v[168:169], v[232:233], v[86:87], v[168:169] op_sel:[0,0,0] op_sel_hi:[1,0,1]
    v_pk_fma_f32 v[170:171], v[234:235], v[86:87], v[170:171] op_sel:[0,0,0] op_sel_hi:[1,0,1]
    v_pk_fma_f32 v[172:173], v[236:237], v[86:87], v[172:173] op_sel:[0,0,0] op_sel_hi:[1,0,1]
    v_pk_fma_f32 v[174:175], v[238:239], v[86:87], v[174:175] op_sel:[0,0,0] op_sel_hi:[1,0,1]
    v_cvt_pk_bf16_f32 v116, v168, v169
    v_cvt_pk_bf16_f32 v117, v170, v171
    v_cvt_pk_bf16_f32 v118, v172, v173
    v_cvt_pk_bf16_f32 v119, v174, v175
    buffer_store_dwordx4 v[116:119], v60, s[12:15], s79 offen offset:2048 nt
    s_branch L_out
L_rpa_d2:
    ds_read_b32 v43, v59
    s_waitcnt lgkmcnt(0)
    v_readlane_b32 s40, v43, 0
    v_readlane_b32 s41, v43, 1
    v_readlane_b32 s42, v43, 2
    v_readlane_b32 s43, v43, 3
    s_cmp_ge_u32 s40, 3
    s_cbranch_scc1 L_rpa_d2r
    s_branch L_rpa_d2
L_rpb_d2:
    ds_read_b32 v43, v59
    s_waitcnt lgkmcnt(0)
    v_readlane_b32 s40, v43, 0
    v_readlane_b32 s41, v43, 1
    v_readlane_b32 s42, v43, 2
    v_readlane_b32 s43, v43, 3
    s_cmp_ge_u32 s41, 3
    s_cbranch_scc1 L_rpb_d2r
    s_branch L_rpb_d2
L_rpc0_d2:
    ds_read_b32 v43, v59
    s_waitcnt lgkmcnt(0)
    v_readlane_b32 s40, v43, 0
    v_readlane_b32 s41, v43, 1
    v_readlane_b32 s42, v43, 2
    v_readlane_b32 s43, v43, 3
    s_cmp_ge_u32 s42, 2
    s_cbranch_scc1 L_rpc0_d2r
    s_branch L_rpc0_d2
L_red_c:
    s_cmp_lg_u32 s52, 1
    s_cbranch_scc1 L_out
L_jobend:
    s_waitcnt vmcnt(0) lgkmcnt(0)
    s_barrier
    s_mov_b32 s52, 0
    s_mov_b32 s64, s54
    s_mov_b32 s53, 0
    s_mov_b32 s61, 98304
    s_cmp_lg_u32 s66, 0
    s_cbranch_scc1 L_cnext
    s_lshl_b32 s83, s56, 2
    v_mov_b32 v48, s83
    v_mov_b32 v49, 1
    v_mov_b32 v50, 0
    v_mov_b32 v51, 2
    s_mov_b64 exec, 1
    global_store_dword v48, v49, s[28:29] sc1
    s_mov_b64 exec, -1
    ds_write_b32 v22, v51
    ds_write_b32 v22, v50 offset:256
    ds_write_b32 v22, v50 offset:512
    ds_write_b32 v22, v50 offset:768
    ds_write_b32 v22, v50 offset:1024
    ds_write_b32 v22, v50 offset:1280
    ds_write_b32 v22, v50 offset:1536
    ds_write_b32 v22, v50 offset:1792
    v_mov_b32 v20, v62
    v_mov_b32 v21, v63
    v_subrev_u32 v8, s55, v8
    v_subrev_u32 v9, s55, v9
    v_subrev_u32 v10, s55, v10
    v_subrev_u32 v11, s55, v11
    v_subrev_u32 v12, s55, v12
    v_subrev_u32 v13, s55, v13
    v_subrev_u32 v14, s55, v14
    v_subrev_u32 v15, s55, v15
    v_mov_b32 v25, 0
    s_cmp_eq_u32 s64, 0
    s_cselect_b32 s65, 2048, s64
    s_add_u32 s77, s65, 31
    s_lshr_b32 s77, s77, 5
    s_cmp_eq_u32 s52, 2
    s_cselect_b32 s77, s46, s77
    s_sub_u32 s67, s77, s53
    s_sub_u32 s83, s67, 1
    s_mul_i32 s84, s83, 171
    s_lshr_b32 s84, s84, 9
    s_mul_i32 s84, s84, 3
    s_sub_u32 s83, s83, s84
    s_sub_u32 s58, 5, s83
    s_cmp_ge_u32 s58, 3
    s_cselect_b32 s84, 3, 0
    s_sub_u32 s58, s58, s84
    s_waitcnt lgkmcnt(0)
    s_barrier
    s_branch L_ljob
L_cnext:
    s_barrier
    s_branch L_cjob
L_out:
L_end:
    s_endpgm
.section .rodata,"a"
.p2align 6
.amdhsa_kernel standalone__paged_block_table_kv_pagedattention__sampling_kernel
  .amdhsa_next_free_vgpr 384
  .amdhsa_next_free_sgpr 102
  .amdhsa_accum_offset 256
  .amdhsa_group_segment_fixed_size 0
  .amdhsa_kernarg_size 64
  .amdhsa_user_sgpr_count 2
  .amdhsa_user_sgpr_kernarg_segment_ptr 1
  .amdhsa_system_sgpr_workgroup_id_x 1
.end_amdhsa_kernel
```
